```python
import torch

def _softmax(x, axis=-1):
    return torch.softmax(x, dim=axis)
def _gelu(x):
    return torch.nn.functional.gelu(x, approximate="tanh")
def _silu(x):
    return torch.nn.functional.silu(x)
def _sigmoid(x):
    return torch.sigmoid(x)
def _layernorm(x, axis=-1, eps=1e-5):
    m = x.mean(dim=axis, keepdim=True)
    v = x.var(dim=axis, keepdim=True, unbiased=False)
    return (x - m) / torch.sqrt(v + eps)
def _scatter_add(tgt, idx, src, axis=0):
    return tgt.clone().index_add_(axis, idx, src)
def _segment_sum(src, seg, n):
    out = torch.zeros((n,) + src.shape[1:], dtype=src.dtype)
    return out.index_add_(0, seg, src)
def _pad(x, pw):
    flat = tuple(v for pair in reversed(pw) for v in pair)
    return torch.nn.functional.pad(x, flat)

kernel_name = 'standalone__mha_block_cached__near_ridge'

def setup_inputs():

    _w = (lambda a: (lambda t: t.to(torch.bfloat16) if t.is_floating_point() else t)(torch.as_tensor(a)))
    B, Sq, D = 32, 128, 448
    H, Sk, Dh = 16, 512, 256
    return {
        "x": _w((lambda *s: torch.randn(*s, dtype=torch.bfloat16) * 0.8)(B, Sq, D)),
        "k_cache": _w((lambda *s: torch.randn(*s, dtype=torch.bfloat16) * 0.8)(B, H, Sk, Dh)),
        "v_cache": _w((lambda *s: torch.randn(*s, dtype=torch.bfloat16) * 0.05)(B, H, Sk, Dh)),
        "wq": _w((lambda *s: torch.randn(*s, dtype=torch.bfloat16) * 0.8)(D, H * Dh) * (D ** -0.5)),
        "wo": _w((lambda *s: torch.randn(*s, dtype=torch.bfloat16) * 0.05)(H * Dh, D) * ((H * Dh) ** -0.5)),
    }

def reference(x, k_cache, v_cache, wq, wo):
    B, Sq, D = x.shape
    H, Dh = 16, 256
    q = (lambda x, *d: x.permute(*d))((x @ wq).reshape(B, Sq, H, Dh), 0, 2, 1, 3)
    scores = torch.einsum("bhqd,bhkd->bhqk", q, k_cache) * (Dh ** -0.5)
    p = _softmax(scores, axis=-1)
    o = torch.einsum("bhqk,bhkd->bhqd", p, v_cache)
    return (lambda x, *d: x.permute(*d))(o, 0, 2, 1, 3).reshape(B, Sq, H * Dh) @ wo
```

```asm
; @launch grid=(256,1,1) block=(256,1,1) lds=152064
.amdgcn_target "amdgcn-amd-amdhsa--gfx950"
.text
.globl standalone__mha_block_cached__near_ridge_kernel
.p2align 8
.type standalone__mha_block_cached__near_ridge_kernel,@function
standalone__mha_block_cached__near_ridge_kernel:
s_load_dwordx8 s[72:79], s[0:1], 0
s_load_dwordx2 s[80:81], s[0:1], 32
s_load_dwordx2 s[82:83], s[0:1], 56
s_cmp_ge_u32 s2, 256
s_cbranch_scc1 L_exit
v_lshrrev_b32 v2, 6, v0
v_and_b32 v1, 63, v0
v_readfirstlane_b32 s33, v2
s_and_b32 s84, s2, 3
s_lshl_b32 s84, s84, 1
s_bfe_u32 s95, s2, 0x10003
s_add_u32 s84, s84, s95
s_bfe_u32 s85, s2, 0x10002
s_lshl_b32 s85, s85, 4
s_lshr_b32 s93, s2, 4
s_add_u32 s85, s85, s93
s_lshl_b32 s88, s84, 10
s_mul_i32 s90, s85, 114688
v_lshrrev_b32 v3, 3, v1
v_lshl_add_u32 v4, v2, 5, v3
v_mul_u32_u24 v4, 896, v4
v_and_b32 v5, 7, v1
v_lshl_add_u32 v128, v5, 4, v4
v_add_u32 v129, 6112, v128
v_add_u32 v130, 12224, v128
v_add_u32 v131, 18336, v128
v_lshrrev_b32 v10, 5, v1
v_and_b32 v11, 31, v1
s_lshl_b32 s92, s85, 9
s_add_u32 s92, s92, 0x2000000
v_lshl_add_u32 v143, v5, 2, s92
v_and_b32 v9, 3, v3
v_lshl_add_u32 v143, v9, 7, v143
v_lshlrev_b32 v11, 4, v11
v_lshl_add_u32 v11, v10, 15, v11
v_lshl_add_u32 v250, v2, 16, v11
v_add_u32 v251, 7136, v250
v_add_u32 v252, 14272, v250
v_add_u32 v253, 21408, v250
s_mul_i32 s28, s33, 4224
v_and_b32 v8, 0xf0, v0
v_add_u32 v8, s93, v8
v_lshlrev_b32 v8, 13, v8
v_bfe_u32 v9, v0, 2, 2
v_lshl_add_u32 v139, v9, 7, v8
s_getpc_b64 s[36:37]
L_pc:
s_lshr_b32 s92, s2, 3
s_lshl_b32 s92, s92, 12
v_lshrrev_b32 v9, 3, v0
v_lshl_add_u32 v9, v9, 7, s92
v_min_u32 v137, L_code_end-L_pc-4, v9
s_mov_b32 s22, 114688
s_mov_b32 s23, 0x00020000
s_sub_u32 s14, 3670016, s88
s_mov_b32 s15, 0x00020000
s_waitcnt lgkmcnt(0)
s_add_u32 s20, s72, s90
s_addc_u32 s21, s73, 0
s_add_u32 s12, s78, s88
s_addc_u32 s13, s79, 0
global_load_dword v142, v143, s[82:83] sc1
s_add_u32 m0, s28, 0
s_mov_b32 s45, 0
buffer_load_dwordx4 v128, s[20:23], s45 offen offset:0 lds
buffer_load_dwordx4 v129, s[20:23], s45 offen offset:1056 lds
buffer_load_dwordx4 v130, s[20:23], s45 offen offset:2112 lds
buffer_load_dwordx4 v131, s[20:23], s45 offen offset:3168 lds
s_add_u32 m0, s28, 16896
s_mov_b32 s45, 0
buffer_load_dwordx4 v250, s[12:15], s45 offen offset:0 lds
buffer_load_dwordx4 v251, s[12:15], s45 offen offset:1056 lds
buffer_load_dwordx4 v252, s[12:15], s45 offen offset:2112 lds
buffer_load_dwordx4 v253, s[12:15], s45 offen offset:3168 lds
global_load_dword v255, v137, s[36:37]
buffer_load_dword v255, v139, s[12:15], 0 offen
s_mov_b32 s30, 2097152
buffer_load_dword v255, v139, s[12:15], s30 offen
s_lshl3_add_u32 s86, s85, s84
s_lshl_b32 s87, s86, 19
s_mul_i32 s89, s84, 458752
s_mul_i32 s91, s86, 114688
s_add_u32 s4, s74, s87
s_addc_u32 s5, s75, 0
s_mov_b32 s6, 0x80000
s_mov_b32 s7, 0x00020000
s_add_u32 s8, s76, s87
s_addc_u32 s9, s77, 0
s_mov_b32 s10, 0x80000
s_mov_b32 s11, 0x00020000
s_add_u32 s40, s80, s89
s_addc_u32 s41, s81, 0
s_mov_b32 s42, 0x70000
s_mov_b32 s43, 0x00020000
s_sub_u32 s16, s40, 480
s_subb_u32 s17, s41, 0
s_mov_b32 s18, 459232
s_mov_b32 s19, 0x00020000
s_add_u32 s24, s82, s91
s_addc_u32 s25, s83, 0
s_mov_b32 s26, 0x1c000
s_mov_b32 s27, 0x00020000
s_mov_b32 s100, s85
s_mov_b32 s101, s84
s_load_dwordx2 s[80:81], s[0:1], 48
s_mul_i32 s72, s33, 28672
s_lshl_b32 s92, s33, 1
s_or_b32 s94, s92, 1
s_cmp_eq_u32 s94, s84
s_cselect_b32 s3, 0x40000000, s72
s_cmp_eq_u32 s92, s84
s_cselect_b32 s72, 0x40000000, s72
s_lshl_b32 s73, s33, 7
s_lshl2_add_u32 s73, s84, s73
s_lshr_b32 s38, s33, 1
s_lshl_b32 s39, s38, 3
s_add_u32 s38, s38, 1
s_mov_b32 s78, 0x00003f80
s_mov_b32 s79, 0x3f800000
s_and_b32 s92, s33, 1
s_lshl_b32 s92, s92, 3
s_and_b32 s94, s33, 2
s_lshl_b32 s94, s94, 1
s_add_u32 s92, s92, s94
s_mul_i32 s34, s92, 896
s_mul_i32 s44, s93, 14336
s_mul_i32 s92, s33, 3584
s_add_u32 s44, s44, s92
s_mov_b32 s31, 0x3db8aa3b
s_mov_b32 s32, 0x41200000
v_lshlrev_b32 v5, 4, v1
v_lshl_add_u32 v246, v2, 10, v5
v_add_u32 v247, 3040, v246
v_add_u32 v248, 6080, v246
v_add_u32 v249, 9120, v246
v_and_b32 v3, 15, v1
v_mul_u32_u24 v3, 1056, v3
v_lshrrev_b32 v4, 4, v1
v_lshl_add_u32 v236, v4, 4, v3
v_lshrrev_b32 v3, 2, v1
v_mul_u32_u24 v3, 1056, v3
v_and_b32 v4, 1, v1
v_lshl_add_u32 v3, v4, 4, v3
v_bfe_u32 v4, v1, 1, 1
v_lshl_add_u32 v239, v4, 3, v3
v_add_u32 v237, 67584, v236
v_add_u32 v240, 67584, v239
v_add_u32 v238, 135168, v236
v_add_u32 v241, 135168, v239
v_lshrrev_b32 v3, 4, v1
v_lshlrev_b32 v3, 14, v3
v_bfe_u32 v4, v1, 3, 1
v_lshl_add_u32 v3, v4, 9, v3
v_and_b32 v4, 7, v1
v_lshl_add_u32 v3, v4, 4, v3
v_sub_u32 v254, v3, v5
v_mov_b32 v232, 0x3f803f80
v_mov_b32 v233, 0x3f803f80
v_mov_b32 v234, 0x3f803f80
v_mov_b32 v235, 0x3f803f80
v_bfe_u32 v3, v1, 3, 1
v_mul_u32_u24 v3, 1056, v3
v_lshl_add_u32 v3, v4, 7, v3
v_lshrrev_b32 v4, 4, v1
v_lshl_add_u32 v3, v4, 4, v3
v_add_u32 v132, s28, v3
v_add_u32 v133, 67584, v132
v_add_u32 v134, 135168, v132
s_mul_i32 s92, s84, 14336
s_lshl_b32 s94, s33, 10
s_add_u32 s74, s92, s94
s_mul_i32 s94, s84, 114688
s_add_u32 s74, s74, s94
s_lshl_b32 s94, s33, 6
s_add_u32 s68, s92, s94
s_add_u32 s75, s74, 4096
s_add_u32 s69, s68, 256
s_add_u32 s76, s74, 8192
s_add_u32 s70, s68, 512
s_add_u32 s77, s74, 12288
s_add_u32 s71, s68, 768
s_cmp_lt_u32 s33, 2
s_cselect_b32 s71, s71, 0x40000000
s_waitcnt lgkmcnt(0)
s_add_u32 m0, s28, 33792
s_mov_b32 s45, 262144
buffer_load_dwordx4 v250, s[12:15], s45 offen offset:0 lds
buffer_load_dwordx4 v251, s[12:15], s45 offen offset:1056 lds
buffer_load_dwordx4 v252, s[12:15], s45 offen offset:2112 lds
buffer_load_dwordx4 v253, s[12:15], s45 offen offset:3168 lds
s_add_u32 m0, s28, 50688
s_mov_b32 s45, 128
buffer_load_dwordx4 v128, s[20:23], s45 offen offset:0 lds
buffer_load_dwordx4 v129, s[20:23], s45 offen offset:1056 lds
buffer_load_dwordx4 v130, s[20:23], s45 offen offset:2112 lds
buffer_load_dwordx4 v131, s[20:23], s45 offen offset:3168 lds
s_waitcnt vmcnt(11)
s_barrier
ds_read_b128 v[208:211], v132 offset:0
ds_read_b128 v[212:215], v132 offset:2112
ds_read_b128 v[216:219], v132 offset:64
ds_read_b128 v[220:223], v132 offset:2176
ds_read_b64_tr_b16 a[224:225], v239 offset:16896
ds_read_b64_tr_b16 a[226:227], v239 offset:17408
ds_read_b64_tr_b16 a[228:229], v239 offset:16928
ds_read_b64_tr_b16 a[230:231], v239 offset:17440
ds_read_b64_tr_b16 a[232:233], v239 offset:16960
ds_read_b64_tr_b16 a[234:235], v239 offset:17472
ds_read_b64_tr_b16 a[236:237], v239 offset:16992
ds_read_b64_tr_b16 a[238:239], v239 offset:17504
ds_read_b64_tr_b16 a[240:241], v239 offset:17024
ds_read_b64_tr_b16 a[242:243], v239 offset:17536
ds_read_b64_tr_b16 a[244:245], v239 offset:17056
ds_read_b64_tr_b16 a[246:247], v239 offset:17568
s_waitcnt lgkmcnt(8)
s_or_b32 s92, s101, s33
s_cbranch_scc1 L_notleader
v_and_b32 v143, 7, v1
v_lshrrev_b32 v142, v143, v142
v_and_b32 v142, 1, v142
v_cmp_eq_u32 vcc, 0, v142
s_lshl_b32 s94, s100, 3
v_mov_b32 v142, s94
v_mov_b32 v145, 1
v_mov_b32 v144, vcc_lo
global_store_dwordx2 v142, v[144:145], s[80:81] sc1
L_notleader:
v_mfma_f32_16x16x32_bf16 v[0:3], a[224:227], v[208:211], 0
s_add_u32 m0, s28, 67584
ds_read_b64_tr_b16 a[248:249], v239 offset:17088
s_mov_b32 s45, 256
v_mfma_f32_16x16x32_bf16 v[4:7], a[224:227], v[212:215], 0
ds_read_b64_tr_b16 a[250:251], v239 offset:17600
buffer_load_dwordx4 v128, s[20:23], s45 offen offset:0 lds
v_mfma_f32_16x16x32_bf16 v[8:11], a[228:231], v[208:211], 0
ds_read_b64_tr_b16 a[252:253], v239 offset:17120
v_mfma_f32_16x16x32_bf16 v[12:15], a[228:231], v[212:215], 0
s_waitcnt lgkmcnt(7)
ds_read_b64_tr_b16 a[254:255], v239 offset:17632
buffer_load_dwordx4 v129, s[20:23], s45 offen offset:1056 lds
v_mfma_f32_16x16x32_bf16 v[16:19], a[232:235], v[208:211], 0
ds_read_b64_tr_b16 a[224:225], v239 offset:17152
v_mfma_f32_16x16x32_bf16 v[20:23], a[232:235], v[212:215], 0
ds_read_b64_tr_b16 a[226:227], v239 offset:17664
v_mfma_f32_16x16x32_bf16 v[24:27], a[236:239], v[208:211], 0
ds_read_b64_tr_b16 a[228:229], v239 offset:17184
buffer_load_dwordx4 v130, s[20:23], s45 offen offset:2112 lds
v_mfma_f32_16x16x32_bf16 v[28:31], a[236:239], v[212:215], 0
s_waitcnt lgkmcnt(7)
ds_read_b64_tr_b16 a[230:231], v239 offset:17696
v_mfma_f32_16x16x32_bf16 v[32:35], a[240:243], v[208:211], 0
ds_read_b64_tr_b16 a[232:233], v239 offset:17216
buffer_load_dwordx4 v131, s[20:23], s45 offen offset:3168 lds
v_mfma_f32_16x16x32_bf16 v[36:39], a[240:243], v[212:215], 0
s_add_u32 m0, s28, 84480
ds_read_b64_tr_b16 a[234:235], v239 offset:17728
s_mov_b32 s45, 524288
v_mfma_f32_16x16x32_bf16 v[40:43], a[244:247], v[208:211], 0
ds_read_b64_tr_b16 a[236:237], v239 offset:17248
v_mfma_f32_16x16x32_bf16 v[44:47], a[244:247], v[212:215], 0
s_waitcnt lgkmcnt(7)
ds_read_b64_tr_b16 a[238:239], v239 offset:17760
buffer_load_dwordx4 v250, s[12:15], s45 offen offset:0 lds
v_mfma_f32_16x16x32_bf16 v[48:51], a[248:251], v[208:211], 0
ds_read_b64_tr_b16 a[240:241], v239 offset:17280
v_mfma_f32_16x16x32_bf16 v[52:55], a[248:251], v[212:215], 0
ds_read_b64_tr_b16 a[242:243], v239 offset:17792
buffer_load_dwordx4 v251, s[12:15], s45 offen offset:1056 lds
v_mfma_f32_16x16x32_bf16 v[56:59], a[252:255], v[208:211], 0
ds_read_b64_tr_b16 a[244:245], v239 offset:17312
v_mfma_f32_16x16x32_bf16 v[60:63], a[252:255], v[212:215], 0
s_waitcnt lgkmcnt(7)
ds_read_b64_tr_b16 a[246:247], v239 offset:17824
v_mfma_f32_16x16x32_bf16 v[64:67], a[224:227], v[208:211], 0
ds_read_b64_tr_b16 a[248:249], v239 offset:17344
buffer_load_dwordx4 v252, s[12:15], s45 offen offset:2112 lds
v_mfma_f32_16x16x32_bf16 v[68:71], a[224:227], v[212:215], 0
ds_read_b64_tr_b16 a[250:251], v239 offset:17856
v_mfma_f32_16x16x32_bf16 v[72:75], a[228:231], v[208:211], 0
s_waitcnt lgkmcnt(6)
ds_read_b64_tr_b16 a[252:253], v239 offset:17376
v_mfma_f32_16x16x32_bf16 v[76:79], a[228:231], v[212:215], 0
s_waitcnt vmcnt(7)
ds_read_b64_tr_b16 a[254:255], v239 offset:17888
s_barrier
v_mfma_f32_16x16x32_bf16 v[80:83], a[232:235], v[208:211], 0
ds_read_b64_tr_b16 a[224:225], v239 offset:33792
buffer_load_dwordx4 v253, s[12:15], s45 offen offset:3168 lds
v_mfma_f32_16x16x32_bf16 v[84:87], a[232:235], v[212:215], 0
s_add_u32 m0, s28, 101376
ds_read_b64_tr_b16 a[226:227], v239 offset:34304
s_mov_b32 s45, 786432
v_mfma_f32_16x16x32_bf16 v[88:91], a[236:239], v[208:211], 0
ds_read_b64_tr_b16 a[228:229], v239 offset:33824
buffer_load_dwordx4 v250, s[12:15], s45 offen offset:0 lds
v_mfma_f32_16x16x32_bf16 v[92:95], a[236:239], v[212:215], 0
s_waitcnt lgkmcnt(7)
ds_read_b64_tr_b16 a[230:231], v239 offset:34336
v_mfma_f32_16x16x32_bf16 v[96:99], a[240:243], v[208:211], 0
ds_read_b64_tr_b16 a[232:233], v239 offset:33856
buffer_load_dwordx4 v251, s[12:15], s45 offen offset:1056 lds
v_mfma_f32_16x16x32_bf16 v[100:103], a[240:243], v[212:215], 0
ds_read_b64_tr_b16 a[234:235], v239 offset:34368
v_mfma_f32_16x16x32_bf16 v[104:107], a[244:247], v[208:211], 0
ds_read_b64_tr_b16 a[236:237], v239 offset:33888
buffer_load_dwordx4 v252, s[12:15], s45 offen offset:2112 lds
v_mfma_f32_16x16x32_bf16 v[108:111], a[244:247], v[212:215], 0
s_waitcnt lgkmcnt(7)
ds_read_b64_tr_b16 a[238:239], v239 offset:34400
v_mfma_f32_16x16x32_bf16 v[112:115], a[248:251], v[208:211], 0
ds_read_b64_tr_b16 a[240:241], v239 offset:33920
v_mfma_f32_16x16x32_bf16 v[116:119], a[248:251], v[212:215], 0
ds_read_b64_tr_b16 a[242:243], v239 offset:34432
buffer_load_dwordx4 v253, s[12:15], s45 offen offset:3168 lds
v_mfma_f32_16x16x32_bf16 v[120:123], a[252:255], v[208:211], 0
s_add_u32 m0, s28, 118272
ds_read_b64_tr_b16 a[244:245], v239 offset:33952
s_mov_b32 s45, 384
v_mfma_f32_16x16x32_bf16 v[124:127], a[252:255], v[212:215], 0
s_waitcnt lgkmcnt(7)
ds_read_b64_tr_b16 a[246:247], v239 offset:34464
v_mfma_f32_16x16x32_bf16 v[0:3], a[224:227], v[216:219], v[0:3]
ds_read_b64_tr_b16 a[248:249], v239 offset:33984
v_mfma_f32_16x16x32_bf16 v[4:7], a[224:227], v[220:223], v[4:7]
ds_read_b64_tr_b16 a[250:251], v239 offset:34496
ds_read_b128 a[128:131], v132 offset:50688
v_mfma_f32_16x16x32_bf16 v[8:11], a[228:231], v[216:219], v[8:11]
ds_read_b64_tr_b16 a[252:253], v239 offset:34016
buffer_load_dwordx4 v128, s[20:23], s45 offen offset:0 lds
v_mfma_f32_16x16x32_bf16 v[12:15], a[228:231], v[220:223], v[12:15]
s_waitcnt lgkmcnt(8)
ds_read_b64_tr_b16 a[254:255], v239 offset:34528
ds_read_b128 a[132:135], v132 offset:52800
v_mfma_f32_16x16x32_bf16 v[16:19], a[232:235], v[216:219], v[16:19]
ds_read_b64_tr_b16 a[224:225], v239 offset:34048
buffer_load_dwordx4 v129, s[20:23], s45 offen offset:1056 lds
v_mfma_f32_16x16x32_bf16 v[20:23], a[232:235], v[220:223], v[20:23]
ds_read_b64_tr_b16 a[226:227], v239 offset:34560
ds_read_b128 a[136:139], v132 offset:50752
v_mfma_f32_16x16x32_bf16 v[24:27], a[236:239], v[216:219], v[24:27]
ds_read_b64_tr_b16 a[228:229], v239 offset:34080
v_mfma_f32_16x16x32_bf16 v[28:31], a[236:239], v[220:223], v[28:31]
s_waitcnt lgkmcnt(10)
ds_read_b64_tr_b16 a[230:231], v239 offset:34592
ds_read_b128 a[140:143], v132 offset:52864
v_mfma_f32_16x16x32_bf16 v[32:35], a[240:243], v[216:219], v[32:35]
ds_read_b64_tr_b16 a[232:233], v239 offset:34112
buffer_load_dwordx4 v130, s[20:23], s45 offen offset:2112 lds
v_mfma_f32_16x16x32_bf16 v[36:39], a[240:243], v[220:223], v[36:39]
ds_read_b64_tr_b16 a[234:235], v239 offset:34624
v_mfma_f32_16x16x32_bf16 v[40:43], a[244:247], v[216:219], v[40:43]
ds_read_b64_tr_b16 a[236:237], v239 offset:34144
v_mfma_f32_16x16x32_bf16 v[44:47], a[244:247], v[220:223], v[44:47]
s_waitcnt lgkmcnt(10)
ds_read_b64_tr_b16 a[238:239], v239 offset:34656
v_mfma_f32_16x16x32_bf16 v[48:51], a[248:251], v[216:219], v[48:51]
ds_read_b64_tr_b16 a[240:241], v239 offset:34176
buffer_load_dwordx4 v131, s[20:23], s45 offen offset:3168 lds
v_mfma_f32_16x16x32_bf16 v[52:55], a[248:251], v[220:223], v[52:55]
s_add_u32 m0, s28, 135168
ds_read_b64_tr_b16 a[242:243], v239 offset:34688
s_mov_b32 s45, 1048576
v_mfma_f32_16x16x32_bf16 v[56:59], a[252:255], v[216:219], v[56:59]
ds_read_b64_tr_b16 a[244:245], v239 offset:34208
v_mfma_f32_16x16x32_bf16 v[60:63], a[252:255], v[220:223], v[60:63]
s_waitcnt lgkmcnt(8)
ds_read_b64_tr_b16 a[246:247], v239 offset:34720
v_mfma_f32_16x16x32_bf16 v[64:67], a[224:227], v[216:219], v[64:67]
ds_read_b64_tr_b16 a[248:249], v239 offset:34240
buffer_load_dwordx4 v250, s[12:15], s45 offen offset:0 lds
v_mfma_f32_16x16x32_bf16 v[68:71], a[224:227], v[220:223], v[68:71]
ds_read_b64_tr_b16 a[250:251], v239 offset:34752
v_mfma_f32_16x16x32_bf16 v[72:75], a[228:231], v[216:219], v[72:75]
s_waitcnt lgkmcnt(6)
ds_read_b64_tr_b16 a[252:253], v239 offset:34272
v_mfma_f32_16x16x32_bf16 v[76:79], a[228:231], v[220:223], v[76:79]
s_waitcnt vmcnt(9)
ds_read_b64_tr_b16 a[254:255], v239 offset:34784
s_barrier
v_mfma_f32_16x16x32_bf16 v[80:83], a[232:235], v[216:219], v[80:83]
ds_read_b64_tr_b16 a[224:225], v240 offset:16896
buffer_load_dwordx4 v251, s[12:15], s45 offen offset:1056 lds
v_mfma_f32_16x16x32_bf16 v[84:87], a[232:235], v[220:223], v[84:87]
ds_read_b64_tr_b16 a[226:227], v240 offset:17408
v_mfma_f32_16x16x32_bf16 v[88:91], a[236:239], v[216:219], v[88:91]
ds_read_b64_tr_b16 a[228:229], v240 offset:16928
v_mfma_f32_16x16x32_bf16 v[92:95], a[236:239], v[220:223], v[92:95]
s_waitcnt lgkmcnt(7)
ds_read_b64_tr_b16 a[230:231], v240 offset:17440
v_mfma_f32_16x16x32_bf16 v[96:99], a[240:243], v[216:219], v[96:99]
ds_read_b64_tr_b16 a[232:233], v240 offset:16960
buffer_load_dwordx4 v252, s[12:15], s45 offen offset:2112 lds
v_mfma_f32_16x16x32_bf16 v[100:103], a[240:243], v[220:223], v[100:103]
ds_read_b64_tr_b16 a[234:235], v240 offset:17472
v_mfma_f32_16x16x32_bf16 v[104:107], a[244:247], v[216:219], v[104:107]
ds_read_b64_tr_b16 a[236:237], v240 offset:16992
v_mfma_f32_16x16x32_bf16 v[108:111], a[244:247], v[220:223], v[108:111]
s_waitcnt lgkmcnt(7)
ds_read_b64_tr_b16 a[238:239], v240 offset:17504
v_mfma_f32_16x16x32_bf16 v[112:115], a[248:251], v[216:219], v[112:115]
ds_read_b64_tr_b16 a[240:241], v240 offset:17024
buffer_load_dwordx4 v253, s[12:15], s45 offen offset:3168 lds
v_mfma_f32_16x16x32_bf16 v[116:119], a[248:251], v[220:223], v[116:119]
s_add_u32 m0, s28, 16896
ds_read_b64_tr_b16 a[242:243], v240 offset:17536
s_mov_b32 s45, 512
v_mfma_f32_16x16x32_bf16 v[120:123], a[252:255], v[216:219], v[120:123]
ds_read_b64_tr_b16 a[244:245], v240 offset:17056
v_mfma_f32_16x16x32_bf16 v[124:127], a[252:255], v[220:223], v[124:127]
s_waitcnt lgkmcnt(7)
ds_read_b64_tr_b16 a[246:247], v240 offset:17568
v_mfma_f32_16x16x32_bf16 v[0:3], a[224:227], a[128:131], v[0:3]
ds_read_b64_tr_b16 a[248:249], v240 offset:17088
v_mfma_f32_16x16x32_bf16 v[4:7], a[224:227], a[132:135], v[4:7]
ds_read_b64_tr_b16 a[250:251], v240 offset:17600
ds_read_b128 a[144:147], v133 offset:0
v_mfma_f32_16x16x32_bf16 v[8:11], a[228:231], a[128:131], v[8:11]
ds_read_b64_tr_b16 a[252:253], v240 offset:17120
buffer_load_dwordx4 v128, s[20:23], s45 offen offset:0 lds
v_mfma_f32_16x16x32_bf16 v[12:15], a[228:231], a[132:135], v[12:15]
s_waitcnt lgkmcnt(8)
ds_read_b64_tr_b16 a[254:255], v240 offset:17632
ds_read_b128 a[148:151], v133 offset:2112
v_mfma_f32_16x16x32_bf16 v[16:19], a[232:235], a[128:131], v[16:19]
ds_read_b64_tr_b16 a[224:225], v240 offset:17152
buffer_load_dwordx4 v129, s[20:23], s45 offen offset:1056 lds
v_mfma_f32_16x16x32_bf16 v[20:23], a[232:235], a[132:135], v[20:23]
ds_read_b64_tr_b16 a[226:227], v240 offset:17664
ds_read_b128 a[152:155], v133 offset:64
v_mfma_f32_16x16x32_bf16 v[24:27], a[236:239], a[128:131], v[24:27]
ds_read_b64_tr_b16 a[228:229], v240 offset:17184
v_mfma_f32_16x16x32_bf16 v[28:31], a[236:239], a[132:135], v[28:31]
s_waitcnt lgkmcnt(10)
ds_read_b64_tr_b16 a[230:231], v240 offset:17696
ds_read_b128 a[156:159], v133 offset:2176
v_mfma_f32_16x16x32_bf16 v[32:35], a[240:243], a[128:131], v[32:35]
ds_read_b64_tr_b16 a[232:233], v240 offset:17216
buffer_load_dwordx4 v130, s[20:23], s45 offen offset:2112 lds
v_mfma_f32_16x16x32_bf16 v[36:39], a[240:243], a[132:135], v[36:39]
ds_read_b64_tr_b16 a[234:235], v240 offset:17728
v_mfma_f32_16x16x32_bf16 v[40:43], a[244:247], a[128:131], v[40:43]
ds_read_b64_tr_b16 a[236:237], v240 offset:17248
v_mfma_f32_16x16x32_bf16 v[44:47], a[244:247], a[132:135], v[44:47]
s_waitcnt lgkmcnt(10)
ds_read_b64_tr_b16 a[238:239], v240 offset:17760
v_mfma_f32_16x16x32_bf16 v[48:51], a[248:251], a[128:131], v[48:51]
ds_read_b64_tr_b16 a[240:241], v240 offset:17280
buffer_load_dwordx4 v131, s[20:23], s45 offen offset:3168 lds
v_mfma_f32_16x16x32_bf16 v[52:55], a[248:251], a[132:135], v[52:55]
s_add_u32 m0, s28, 0
ds_read_b64_tr_b16 a[242:243], v240 offset:17792
s_mov_b32 s45, 1310720
v_mfma_f32_16x16x32_bf16 v[56:59], a[252:255], a[128:131], v[56:59]
ds_read_b64_tr_b16 a[244:245], v240 offset:17312
v_mfma_f32_16x16x32_bf16 v[60:63], a[252:255], a[132:135], v[60:63]
s_waitcnt lgkmcnt(8)
ds_read_b64_tr_b16 a[246:247], v240 offset:17824
v_mfma_f32_16x16x32_bf16 v[64:67], a[224:227], a[128:131], v[64:67]
ds_read_b64_tr_b16 a[248:249], v240 offset:17344
buffer_load_dwordx4 v250, s[12:15], s45 offen offset:0 lds
v_mfma_f32_16x16x32_bf16 v[68:71], a[224:227], a[132:135], v[68:71]
ds_read_b64_tr_b16 a[250:251], v240 offset:17856
v_mfma_f32_16x16x32_bf16 v[72:75], a[228:231], a[128:131], v[72:75]
s_waitcnt lgkmcnt(6)
ds_read_b64_tr_b16 a[252:253], v240 offset:17376
v_mfma_f32_16x16x32_bf16 v[76:79], a[228:231], a[132:135], v[76:79]
s_waitcnt vmcnt(9)
ds_read_b64_tr_b16 a[254:255], v240 offset:17888
s_barrier
v_mfma_f32_16x16x32_bf16 v[80:83], a[232:235], a[128:131], v[80:83]
ds_read_b64_tr_b16 a[224:225], v240 offset:33792
buffer_load_dwordx4 v251, s[12:15], s45 offen offset:1056 lds
v_mfma_f32_16x16x32_bf16 v[84:87], a[232:235], a[132:135], v[84:87]
ds_read_b64_tr_b16 a[226:227], v240 offset:34304
v_mfma_f32_16x16x32_bf16 v[88:91], a[236:239], a[128:131], v[88:91]
ds_read_b64_tr_b16 a[228:229], v240 offset:33824
v_mfma_f32_16x16x32_bf16 v[92:95], a[236:239], a[132:135], v[92:95]
s_waitcnt lgkmcnt(7)
ds_read_b64_tr_b16 a[230:231], v240 offset:34336
v_mfma_f32_16x16x32_bf16 v[96:99], a[240:243], a[128:131], v[96:99]
ds_read_b64_tr_b16 a[232:233], v240 offset:33856
buffer_load_dwordx4 v252, s[12:15], s45 offen offset:2112 lds
v_mfma_f32_16x16x32_bf16 v[100:103], a[240:243], a[132:135], v[100:103]
ds_read_b64_tr_b16 a[234:235], v240 offset:34368
v_mfma_f32_16x16x32_bf16 v[104:107], a[244:247], a[128:131], v[104:107]
ds_read_b64_tr_b16 a[236:237], v240 offset:33888
v_mfma_f32_16x16x32_bf16 v[108:111], a[244:247], a[132:135], v[108:111]
s_waitcnt lgkmcnt(7)
ds_read_b64_tr_b16 a[238:239], v240 offset:34400
v_mfma_f32_16x16x32_bf16 v[112:115], a[248:251], a[128:131], v[112:115]
ds_read_b64_tr_b16 a[240:241], v240 offset:33920
buffer_load_dwordx4 v253, s[12:15], s45 offen offset:3168 lds
v_mfma_f32_16x16x32_bf16 v[116:119], a[248:251], a[132:135], v[116:119]
s_add_u32 m0, s28, 33792
ds_read_b64_tr_b16 a[242:243], v240 offset:34432
s_mov_b32 s45, 640
v_mfma_f32_16x16x32_bf16 v[120:123], a[252:255], a[128:131], v[120:123]
ds_read_b64_tr_b16 a[244:245], v240 offset:33952
v_mfma_f32_16x16x32_bf16 v[124:127], a[252:255], a[132:135], v[124:127]
s_waitcnt lgkmcnt(7)
ds_read_b64_tr_b16 a[246:247], v240 offset:34464
v_mfma_f32_16x16x32_bf16 v[0:3], a[224:227], a[136:139], v[0:3]
ds_read_b64_tr_b16 a[248:249], v240 offset:33984
v_mfma_f32_16x16x32_bf16 v[4:7], a[224:227], a[140:143], v[4:7]
ds_read_b64_tr_b16 a[250:251], v240 offset:34496
ds_read_b128 a[160:163], v133 offset:50688
v_mfma_f32_16x16x32_bf16 v[8:11], a[228:231], a[136:139], v[8:11]
ds_read_b64_tr_b16 a[252:253], v240 offset:34016
buffer_load_dwordx4 v128, s[20:23], s45 offen offset:0 lds
v_mfma_f32_16x16x32_bf16 v[12:15], a[228:231], a[140:143], v[12:15]
s_waitcnt lgkmcnt(8)
ds_read_b64_tr_b16 a[254:255], v240 offset:34528
ds_read_b128 a[164:167], v133 offset:52800
v_mfma_f32_16x16x32_bf16 v[16:19], a[232:235], a[136:139], v[16:19]
ds_read_b64_tr_b16 a[224:225], v240 offset:34048
buffer_load_dwordx4 v129, s[20:23], s45 offen offset:1056 lds
v_mfma_f32_16x16x32_bf16 v[20:23], a[232:235], a[140:143], v[20:23]
ds_read_b64_tr_b16 a[226:227], v240 offset:34560
ds_read_b128 a[168:171], v133 offset:50752
v_mfma_f32_16x16x32_bf16 v[24:27], a[236:239], a[136:139], v[24:27]
ds_read_b64_tr_b16 a[228:229], v240 offset:34080
v_mfma_f32_16x16x32_bf16 v[28:31], a[236:239], a[140:143], v[28:31]
s_waitcnt lgkmcnt(10)
ds_read_b64_tr_b16 a[230:231], v240 offset:34592
ds_read_b128 a[172:175], v133 offset:52864
v_mfma_f32_16x16x32_bf16 v[32:35], a[240:243], a[136:139], v[32:35]
ds_read_b64_tr_b16 a[232:233], v240 offset:34112
buffer_load_dwordx4 v130, s[20:23], s45 offen offset:2112 lds
v_mfma_f32_16x16x32_bf16 v[36:39], a[240:243], a[140:143], v[36:39]
ds_read_b64_tr_b16 a[234:235], v240 offset:34624
v_mfma_f32_16x16x32_bf16 v[40:43], a[244:247], a[136:139], v[40:43]
ds_read_b64_tr_b16 a[236:237], v240 offset:34144
v_mfma_f32_16x16x32_bf16 v[44:47], a[244:247], a[140:143], v[44:47]
s_waitcnt lgkmcnt(10)
ds_read_b64_tr_b16 a[238:239], v240 offset:34656
v_mfma_f32_16x16x32_bf16 v[48:51], a[248:251], a[136:139], v[48:51]
ds_read_b64_tr_b16 a[240:241], v240 offset:34176
buffer_load_dwordx4 v131, s[20:23], s45 offen offset:3168 lds
v_mfma_f32_16x16x32_bf16 v[52:55], a[248:251], a[140:143], v[52:55]
s_add_u32 m0, s28, 50688
ds_read_b64_tr_b16 a[242:243], v240 offset:34688
s_mov_b32 s45, 1572864
v_mfma_f32_16x16x32_bf16 v[56:59], a[252:255], a[136:139], v[56:59]
ds_read_b64_tr_b16 a[244:245], v240 offset:34208
v_mfma_f32_16x16x32_bf16 v[60:63], a[252:255], a[140:143], v[60:63]
s_waitcnt lgkmcnt(8)
ds_read_b64_tr_b16 a[246:247], v240 offset:34720
v_mfma_f32_16x16x32_bf16 v[64:67], a[224:227], a[136:139], v[64:67]
ds_read_b64_tr_b16 a[248:249], v240 offset:34240
buffer_load_dwordx4 v250, s[12:15], s45 offen offset:0 lds
v_mfma_f32_16x16x32_bf16 v[68:71], a[224:227], a[140:143], v[68:71]
ds_read_b64_tr_b16 a[250:251], v240 offset:34752
v_mfma_f32_16x16x32_bf16 v[72:75], a[228:231], a[136:139], v[72:75]
s_waitcnt lgkmcnt(6)
ds_read_b64_tr_b16 a[252:253], v240 offset:34272
v_mfma_f32_16x16x32_bf16 v[76:79], a[228:231], a[140:143], v[76:79]
s_waitcnt vmcnt(9)
ds_read_b64_tr_b16 a[254:255], v240 offset:34784
s_barrier
v_mfma_f32_16x16x32_bf16 v[80:83], a[232:235], a[136:139], v[80:83]
ds_read_b64_tr_b16 a[224:225], v241 offset:0
buffer_load_dwordx4 v251, s[12:15], s45 offen offset:1056 lds
v_mfma_f32_16x16x32_bf16 v[84:87], a[232:235], a[140:143], v[84:87]
ds_read_b64_tr_b16 a[226:227], v241 offset:512
v_mfma_f32_16x16x32_bf16 v[88:91], a[236:239], a[136:139], v[88:91]
ds_read_b64_tr_b16 a[228:229], v241 offset:32
v_mfma_f32_16x16x32_bf16 v[92:95], a[236:239], a[140:143], v[92:95]
s_waitcnt lgkmcnt(7)
ds_read_b64_tr_b16 a[230:231], v241 offset:544
v_mfma_f32_16x16x32_bf16 v[96:99], a[240:243], a[136:139], v[96:99]
ds_read_b64_tr_b16 a[232:233], v241 offset:64
buffer_load_dwordx4 v252, s[12:15], s45 offen offset:2112 lds
v_mfma_f32_16x16x32_bf16 v[100:103], a[240:243], a[140:143], v[100:103]
ds_read_b64_tr_b16 a[234:235], v241 offset:576
v_mfma_f32_16x16x32_bf16 v[104:107], a[244:247], a[136:139], v[104:107]
ds_read_b64_tr_b16 a[236:237], v241 offset:96
v_mfma_f32_16x16x32_bf16 v[108:111], a[244:247], a[140:143], v[108:111]
s_waitcnt lgkmcnt(7)
ds_read_b64_tr_b16 a[238:239], v241 offset:608
v_mfma_f32_16x16x32_bf16 v[112:115], a[248:251], a[136:139], v[112:115]
ds_read_b64_tr_b16 a[240:241], v241 offset:128
buffer_load_dwordx4 v253, s[12:15], s45 offen offset:3168 lds
v_mfma_f32_16x16x32_bf16 v[116:119], a[248:251], a[140:143], v[116:119]
s_add_u32 m0, s28, 84480
ds_read_b64_tr_b16 a[242:243], v241 offset:640
s_mov_b32 s45, 768
v_mfma_f32_16x16x32_bf16 v[120:123], a[252:255], a[136:139], v[120:123]
ds_read_b64_tr_b16 a[244:245], v241 offset:160
v_mfma_f32_16x16x32_bf16 v[124:127], a[252:255], a[140:143], v[124:127]
s_waitcnt lgkmcnt(7)
ds_read_b64_tr_b16 a[246:247], v241 offset:672
v_mfma_f32_16x16x32_bf16 v[0:3], a[224:227], a[144:147], v[0:3]
ds_read_b64_tr_b16 a[248:249], v241 offset:192
v_mfma_f32_16x16x32_bf16 v[4:7], a[224:227], a[148:151], v[4:7]
ds_read_b64_tr_b16 a[250:251], v241 offset:704
ds_read_b128 a[176:179], v132 offset:16896
v_mfma_f32_16x16x32_bf16 v[8:11], a[228:231], a[144:147], v[8:11]
ds_read_b64_tr_b16 a[252:253], v241 offset:224
buffer_load_dwordx4 v128, s[20:23], s45 offen offset:0 lds
v_mfma_f32_16x16x32_bf16 v[12:15], a[228:231], a[148:151], v[12:15]
s_waitcnt lgkmcnt(8)
ds_read_b64_tr_b16 a[254:255], v241 offset:736
ds_read_b128 a[180:183], v132 offset:19008
v_mfma_f32_16x16x32_bf16 v[16:19], a[232:235], a[144:147], v[16:19]
ds_read_b64_tr_b16 a[224:225], v241 offset:256
buffer_load_dwordx4 v129, s[20:23], s45 offen offset:1056 lds
v_mfma_f32_16x16x32_bf16 v[20:23], a[232:235], a[148:151], v[20:23]
ds_read_b64_tr_b16 a[226:227], v241 offset:768
ds_read_b128 a[184:187], v132 offset:16960
v_mfma_f32_16x16x32_bf16 v[24:27], a[236:239], a[144:147], v[24:27]
ds_read_b64_tr_b16 a[228:229], v241 offset:288
v_mfma_f32_16x16x32_bf16 v[28:31], a[236:239], a[148:151], v[28:31]
s_waitcnt lgkmcnt(10)
ds_read_b64_tr_b16 a[230:231], v241 offset:800
ds_read_b128 a[188:191], v132 offset:19072
v_mfma_f32_16x16x32_bf16 v[32:35], a[240:243], a[144:147], v[32:35]
ds_read_b64_tr_b16 a[232:233], v241 offset:320
buffer_load_dwordx4 v130, s[20:23], s45 offen offset:2112 lds
v_mfma_f32_16x16x32_bf16 v[36:39], a[240:243], a[148:151], v[36:39]
ds_read_b64_tr_b16 a[234:235], v241 offset:832
v_mfma_f32_16x16x32_bf16 v[40:43], a[244:247], a[144:147], v[40:43]
ds_read_b64_tr_b16 a[236:237], v241 offset:352
v_mfma_f32_16x16x32_bf16 v[44:47], a[244:247], a[148:151], v[44:47]
s_waitcnt lgkmcnt(10)
ds_read_b64_tr_b16 a[238:239], v241 offset:864
v_mfma_f32_16x16x32_bf16 v[48:51], a[248:251], a[144:147], v[48:51]
ds_read_b64_tr_b16 a[240:241], v241 offset:384
buffer_load_dwordx4 v131, s[20:23], s45 offen offset:3168 lds
v_mfma_f32_16x16x32_bf16 v[52:55], a[248:251], a[148:151], v[52:55]
s_add_u32 m0, s28, 67584
ds_read_b64_tr_b16 a[242:243], v241 offset:896
s_mov_b32 s45, 1835008
v_mfma_f32_16x16x32_bf16 v[56:59], a[252:255], a[144:147], v[56:59]
ds_read_b64_tr_b16 a[244:245], v241 offset:416
v_mfma_f32_16x16x32_bf16 v[60:63], a[252:255], a[148:151], v[60:63]
s_waitcnt lgkmcnt(8)
ds_read_b64_tr_b16 a[246:247], v241 offset:928
v_mfma_f32_16x16x32_bf16 v[64:67], a[224:227], a[144:147], v[64:67]
ds_read_b64_tr_b16 a[248:249], v241 offset:448
buffer_load_dwordx4 v250, s[12:15], s45 offen offset:0 lds
v_mfma_f32_16x16x32_bf16 v[68:71], a[224:227], a[148:151], v[68:71]
ds_read_b64_tr_b16 a[250:251], v241 offset:960
v_mfma_f32_16x16x32_bf16 v[72:75], a[228:231], a[144:147], v[72:75]
s_waitcnt lgkmcnt(6)
ds_read_b64_tr_b16 a[252:253], v241 offset:480
v_mfma_f32_16x16x32_bf16 v[76:79], a[228:231], a[148:151], v[76:79]
s_waitcnt vmcnt(9)
ds_read_b64_tr_b16 a[254:255], v241 offset:992
s_barrier
v_mfma_f32_16x16x32_bf16 v[80:83], a[232:235], a[144:147], v[80:83]
ds_read_b64_tr_b16 a[224:225], v239 offset:0
buffer_load_dwordx4 v251, s[12:15], s45 offen offset:1056 lds
v_mfma_f32_16x16x32_bf16 v[84:87], a[232:235], a[148:151], v[84:87]
ds_read_b64_tr_b16 a[226:227], v239 offset:512
v_mfma_f32_16x16x32_bf16 v[88:91], a[236:239], a[144:147], v[88:91]
ds_read_b64_tr_b16 a[228:229], v239 offset:32
v_mfma_f32_16x16x32_bf16 v[92:95], a[236:239], a[148:151], v[92:95]
s_waitcnt lgkmcnt(7)
ds_read_b64_tr_b16 a[230:231], v239 offset:544
v_mfma_f32_16x16x32_bf16 v[96:99], a[240:243], a[144:147], v[96:99]
ds_read_b64_tr_b16 a[232:233], v239 offset:64
buffer_load_dwordx4 v252, s[12:15], s45 offen offset:2112 lds
v_mfma_f32_16x16x32_bf16 v[100:103], a[240:243], a[148:151], v[100:103]
ds_read_b64_tr_b16 a[234:235], v239 offset:576
v_mfma_f32_16x16x32_bf16 v[104:107], a[244:247], a[144:147], v[104:107]
ds_read_b64_tr_b16 a[236:237], v239 offset:96
v_mfma_f32_16x16x32_bf16 v[108:111], a[244:247], a[148:151], v[108:111]
s_waitcnt lgkmcnt(7)
ds_read_b64_tr_b16 a[238:239], v239 offset:608
v_mfma_f32_16x16x32_bf16 v[112:115], a[248:251], a[144:147], v[112:115]
ds_read_b64_tr_b16 a[240:241], v239 offset:128
buffer_load_dwordx4 v253, s[12:15], s45 offen offset:3168 lds
v_mfma_f32_16x16x32_bf16 v[116:119], a[248:251], a[148:151], v[116:119]
s_add_u32 m0, s28, 101376
ds_read_b64_tr_b16 a[242:243], v239 offset:640
s_mov_b32 s45, 2097152
v_mfma_f32_16x16x32_bf16 v[120:123], a[252:255], a[144:147], v[120:123]
ds_read_b64_tr_b16 a[244:245], v239 offset:160
v_mfma_f32_16x16x32_bf16 v[124:127], a[252:255], a[148:151], v[124:127]
s_waitcnt lgkmcnt(7)
ds_read_b64_tr_b16 a[246:247], v239 offset:672
v_mfma_f32_16x16x32_bf16 v[0:3], a[224:227], a[152:155], v[0:3]
ds_read_b64_tr_b16 a[248:249], v239 offset:192
v_mfma_f32_16x16x32_bf16 v[4:7], a[224:227], a[156:159], v[4:7]
ds_read_b64_tr_b16 a[250:251], v239 offset:704
ds_read_b128 a[192:195], v132 offset:33792
v_mfma_f32_16x16x32_bf16 v[8:11], a[228:231], a[152:155], v[8:11]
ds_read_b64_tr_b16 a[252:253], v239 offset:224
buffer_load_dwordx4 v250, s[12:15], s45 offen offset:0 lds
v_mfma_f32_16x16x32_bf16 v[12:15], a[228:231], a[156:159], v[12:15]
s_waitcnt lgkmcnt(8)
ds_read_b64_tr_b16 a[254:255], v239 offset:736
ds_read_b128 a[196:199], v132 offset:35904
v_mfma_f32_16x16x32_bf16 v[16:19], a[232:235], a[152:155], v[16:19]
ds_read_b64_tr_b16 a[224:225], v239 offset:256
buffer_load_dwordx4 v251, s[12:15], s45 offen offset:1056 lds
v_mfma_f32_16x16x32_bf16 v[20:23], a[232:235], a[156:159], v[20:23]
ds_read_b64_tr_b16 a[226:227], v239 offset:768
ds_read_b128 a[200:203], v132 offset:33856
v_mfma_f32_16x16x32_bf16 v[24:27], a[236:239], a[152:155], v[24:27]
ds_read_b64_tr_b16 a[228:229], v239 offset:288
v_mfma_f32_16x16x32_bf16 v[28:31], a[236:239], a[156:159], v[28:31]
s_waitcnt lgkmcnt(10)
ds_read_b64_tr_b16 a[230:231], v239 offset:800
ds_read_b128 a[204:207], v132 offset:35968
v_mfma_f32_16x16x32_bf16 v[32:35], a[240:243], a[152:155], v[32:35]
ds_read_b64_tr_b16 a[232:233], v239 offset:320
buffer_load_dwordx4 v252, s[12:15], s45 offen offset:2112 lds
v_mfma_f32_16x16x32_bf16 v[36:39], a[240:243], a[156:159], v[36:39]
ds_read_b64_tr_b16 a[234:235], v239 offset:832
v_mfma_f32_16x16x32_bf16 v[40:43], a[244:247], a[152:155], v[40:43]
ds_read_b64_tr_b16 a[236:237], v239 offset:352
v_mfma_f32_16x16x32_bf16 v[44:47], a[244:247], a[156:159], v[44:47]
s_waitcnt lgkmcnt(10)
ds_read_b64_tr_b16 a[238:239], v239 offset:864
v_mfma_f32_16x16x32_bf16 v[48:51], a[248:251], a[152:155], v[48:51]
ds_read_b64_tr_b16 a[240:241], v239 offset:384
buffer_load_dwordx4 v253, s[12:15], s45 offen offset:3168 lds
v_mfma_f32_16x16x32_bf16 v[52:55], a[248:251], a[156:159], v[52:55]
s_add_u32 m0, s28, 118272
ds_read_b64_tr_b16 a[242:243], v239 offset:896
s_mov_b32 s45, 2359296
v_mfma_f32_16x16x32_bf16 v[56:59], a[252:255], a[152:155], v[56:59]
ds_read_b64_tr_b16 a[244:245], v239 offset:416
v_mfma_f32_16x16x32_bf16 v[60:63], a[252:255], a[156:159], v[60:63]
s_waitcnt lgkmcnt(8)
ds_read_b64_tr_b16 a[246:247], v239 offset:928
v_mfma_f32_16x16x32_bf16 v[64:67], a[224:227], a[152:155], v[64:67]
ds_read_b64_tr_b16 a[248:249], v239 offset:448
buffer_load_dwordx4 v250, s[12:15], s45 offen offset:0 lds
v_mfma_f32_16x16x32_bf16 v[68:71], a[224:227], a[156:159], v[68:71]
ds_read_b64_tr_b16 a[250:251], v239 offset:960
v_mfma_f32_16x16x32_bf16 v[72:75], a[228:231], a[152:155], v[72:75]
s_waitcnt lgkmcnt(6)
ds_read_b64_tr_b16 a[252:253], v239 offset:480
v_mfma_f32_16x16x32_bf16 v[76:79], a[228:231], a[156:159], v[76:79]
s_waitcnt vmcnt(9)
ds_read_b64_tr_b16 a[254:255], v239 offset:992
s_barrier
v_mfma_f32_16x16x32_bf16 v[80:83], a[232:235], a[152:155], v[80:83]
ds_read_b64_tr_b16 a[224:225], v239 offset:50688
buffer_load_dwordx4 v251, s[12:15], s45 offen offset:1056 lds
v_mfma_f32_16x16x32_bf16 v[84:87], a[232:235], a[156:159], v[84:87]
ds_read_b64_tr_b16 a[226:227], v239 offset:51200
v_mfma_f32_16x16x32_bf16 v[88:91], a[236:239], a[152:155], v[88:91]
ds_read_b64_tr_b16 a[228:229], v239 offset:50720
v_mfma_f32_16x16x32_bf16 v[92:95], a[236:239], a[156:159], v[92:95]
s_waitcnt lgkmcnt(7)
ds_read_b64_tr_b16 a[230:231], v239 offset:51232
v_mfma_f32_16x16x32_bf16 v[96:99], a[240:243], a[152:155], v[96:99]
ds_read_b64_tr_b16 a[232:233], v239 offset:50752
buffer_load_dwordx4 v252, s[12:15], s45 offen offset:2112 lds
v_mfma_f32_16x16x32_bf16 v[100:103], a[240:243], a[156:159], v[100:103]
ds_read_b64_tr_b16 a[234:235], v239 offset:51264
v_mfma_f32_16x16x32_bf16 v[104:107], a[244:247], a[152:155], v[104:107]
ds_read_b64_tr_b16 a[236:237], v239 offset:50784
v_mfma_f32_16x16x32_bf16 v[108:111], a[244:247], a[156:159], v[108:111]
s_waitcnt lgkmcnt(7)
ds_read_b64_tr_b16 a[238:239], v239 offset:51296
v_mfma_f32_16x16x32_bf16 v[112:115], a[248:251], a[152:155], v[112:115]
ds_read_b64_tr_b16 a[240:241], v239 offset:50816
buffer_load_dwordx4 v253, s[12:15], s45 offen offset:3168 lds
v_mfma_f32_16x16x32_bf16 v[116:119], a[248:251], a[156:159], v[116:119]
s_add_u32 m0, s28, 135168
ds_read_b64_tr_b16 a[242:243], v239 offset:51328
s_mov_b32 s45, 2621440
v_mfma_f32_16x16x32_bf16 v[120:123], a[252:255], a[152:155], v[120:123]
ds_read_b64_tr_b16 a[244:245], v239 offset:50848
v_mfma_f32_16x16x32_bf16 v[124:127], a[252:255], a[156:159], v[124:127]
s_waitcnt lgkmcnt(7)
ds_read_b64_tr_b16 a[246:247], v239 offset:51360
v_mfma_f32_16x16x32_bf16 v[0:3], a[224:227], a[160:163], v[0:3]
ds_read_b64_tr_b16 a[248:249], v239 offset:50880
v_mfma_f32_16x16x32_bf16 v[4:7], a[224:227], a[164:167], v[4:7]
ds_read_b64_tr_b16 a[250:251], v239 offset:51392
ds_read_b128 a[208:211], v133 offset:16896
v_mfma_f32_16x16x32_bf16 v[8:11], a[228:231], a[160:163], v[8:11]
ds_read_b64_tr_b16 a[252:253], v239 offset:50912
buffer_load_dwordx4 v250, s[12:15], s45 offen offset:0 lds
v_mfma_f32_16x16x32_bf16 v[12:15], a[228:231], a[164:167], v[12:15]
s_waitcnt lgkmcnt(8)
ds_read_b64_tr_b16 a[254:255], v239 offset:51424
ds_read_b128 a[212:215], v133 offset:19008
v_mfma_f32_16x16x32_bf16 v[16:19], a[232:235], a[160:163], v[16:19]
ds_read_b64_tr_b16 a[224:225], v239 offset:50944
buffer_load_dwordx4 v251, s[12:15], s45 offen offset:1056 lds
v_mfma_f32_16x16x32_bf16 v[20:23], a[232:235], a[164:167], v[20:23]
ds_read_b64_tr_b16 a[226:227], v239 offset:51456
ds_read_b128 a[216:219], v133 offset:16960
v_mfma_f32_16x16x32_bf16 v[24:27], a[236:239], a[160:163], v[24:27]
ds_read_b64_tr_b16 a[228:229], v239 offset:50976
v_mfma_f32_16x16x32_bf16 v[28:31], a[236:239], a[164:167], v[28:31]
s_waitcnt lgkmcnt(10)
ds_read_b64_tr_b16 a[230:231], v239 offset:51488
ds_read_b128 a[220:223], v133 offset:19072
v_mfma_f32_16x16x32_bf16 v[32:35], a[240:243], a[160:163], v[32:35]
ds_read_b64_tr_b16 a[232:233], v239 offset:51008
buffer_load_dwordx4 v252, s[12:15], s45 offen offset:2112 lds
v_mfma_f32_16x16x32_bf16 v[36:39], a[240:243], a[164:167], v[36:39]
ds_read_b64_tr_b16 a[234:235], v239 offset:51520
v_mfma_f32_16x16x32_bf16 v[40:43], a[244:247], a[160:163], v[40:43]
ds_read_b64_tr_b16 a[236:237], v239 offset:51040
v_mfma_f32_16x16x32_bf16 v[44:47], a[244:247], a[164:167], v[44:47]
s_waitcnt lgkmcnt(10)
ds_read_b64_tr_b16 a[238:239], v239 offset:51552
v_mfma_f32_16x16x32_bf16 v[48:51], a[248:251], a[160:163], v[48:51]
ds_read_b64_tr_b16 a[240:241], v239 offset:51072
buffer_load_dwordx4 v253, s[12:15], s45 offen offset:3168 lds
v_mfma_f32_16x16x32_bf16 v[52:55], a[248:251], a[164:167], v[52:55]
s_add_u32 m0, s28, 16896
ds_read_b64_tr_b16 a[242:243], v239 offset:51584
s_mov_b32 s45, 2883584
v_mfma_f32_16x16x32_bf16 v[56:59], a[252:255], a[160:163], v[56:59]
ds_read_b64_tr_b16 a[244:245], v239 offset:51104
v_mfma_f32_16x16x32_bf16 v[60:63], a[252:255], a[164:167], v[60:63]
s_waitcnt lgkmcnt(8)
ds_read_b64_tr_b16 a[246:247], v239 offset:51616
v_mfma_f32_16x16x32_bf16 v[64:67], a[224:227], a[160:163], v[64:67]
ds_read_b64_tr_b16 a[248:249], v239 offset:51136
buffer_load_dwordx4 v250, s[12:15], s45 offen offset:0 lds
v_mfma_f32_16x16x32_bf16 v[68:71], a[224:227], a[164:167], v[68:71]
ds_read_b64_tr_b16 a[250:251], v239 offset:51648
v_mfma_f32_16x16x32_bf16 v[72:75], a[228:231], a[160:163], v[72:75]
s_waitcnt lgkmcnt(6)
ds_read_b64_tr_b16 a[252:253], v239 offset:51168
v_mfma_f32_16x16x32_bf16 v[76:79], a[228:231], a[164:167], v[76:79]
s_waitcnt vmcnt(13)
ds_read_b64_tr_b16 a[254:255], v239 offset:51680
s_barrier
v_mfma_f32_16x16x32_bf16 v[80:83], a[232:235], a[160:163], v[80:83]
ds_read_b64_tr_b16 a[224:225], v240 offset:0
buffer_load_dwordx4 v251, s[12:15], s45 offen offset:1056 lds
v_mfma_f32_16x16x32_bf16 v[84:87], a[232:235], a[164:167], v[84:87]
ds_read_b64_tr_b16 a[226:227], v240 offset:512
v_mfma_f32_16x16x32_bf16 v[88:91], a[236:239], a[160:163], v[88:91]
ds_read_b64_tr_b16 a[228:229], v240 offset:32
v_mfma_f32_16x16x32_bf16 v[92:95], a[236:239], a[164:167], v[92:95]
s_waitcnt lgkmcnt(7)
ds_read_b64_tr_b16 a[230:231], v240 offset:544
v_mfma_f32_16x16x32_bf16 v[96:99], a[240:243], a[160:163], v[96:99]
ds_read_b64_tr_b16 a[232:233], v240 offset:64
buffer_load_dwordx4 v252, s[12:15], s45 offen offset:2112 lds
v_mfma_f32_16x16x32_bf16 v[100:103], a[240:243], a[164:167], v[100:103]
ds_read_b64_tr_b16 a[234:235], v240 offset:576
v_mfma_f32_16x16x32_bf16 v[104:107], a[244:247], a[160:163], v[104:107]
ds_read_b64_tr_b16 a[236:237], v240 offset:96
v_mfma_f32_16x16x32_bf16 v[108:111], a[244:247], a[164:167], v[108:111]
s_waitcnt lgkmcnt(7)
ds_read_b64_tr_b16 a[238:239], v240 offset:608
v_mfma_f32_16x16x32_bf16 v[112:115], a[248:251], a[160:163], v[112:115]
ds_read_b64_tr_b16 a[240:241], v240 offset:128
buffer_load_dwordx4 v253, s[12:15], s45 offen offset:3168 lds
v_mfma_f32_16x16x32_bf16 v[116:119], a[248:251], a[164:167], v[116:119]
s_add_u32 m0, s28, 0
ds_read_b64_tr_b16 a[242:243], v240 offset:640
s_mov_b32 s45, 3145728
v_mfma_f32_16x16x32_bf16 v[120:123], a[252:255], a[160:163], v[120:123]
ds_read_b64_tr_b16 a[244:245], v240 offset:160
v_mfma_f32_16x16x32_bf16 v[124:127], a[252:255], a[164:167], v[124:127]
s_waitcnt lgkmcnt(7)
ds_read_b64_tr_b16 a[246:247], v240 offset:672
v_mfma_f32_16x16x32_bf16 v[0:3], a[224:227], a[168:171], v[0:3]
ds_read_b64_tr_b16 a[248:249], v240 offset:192
v_mfma_f32_16x16x32_bf16 v[4:7], a[224:227], a[172:175], v[4:7]
ds_read_b64_tr_b16 a[250:251], v240 offset:704
buffer_load_dwordx4 v250, s[12:15], s45 offen offset:0 lds
v_mfma_f32_16x16x32_bf16 v[8:11], a[228:231], a[168:171], v[8:11]
ds_read_b64_tr_b16 a[252:253], v240 offset:224
v_mfma_f32_16x16x32_bf16 v[12:15], a[228:231], a[172:175], v[12:15]
s_waitcnt lgkmcnt(7)
ds_read_b64_tr_b16 a[254:255], v240 offset:736
buffer_load_dwordx4 v251, s[12:15], s45 offen offset:1056 lds
v_mfma_f32_16x16x32_bf16 v[16:19], a[232:235], a[168:171], v[16:19]
ds_read_b64_tr_b16 a[224:225], v240 offset:256
v_mfma_f32_16x16x32_bf16 v[20:23], a[232:235], a[172:175], v[20:23]
ds_read_b64_tr_b16 a[226:227], v240 offset:768
v_mfma_f32_16x16x32_bf16 v[24:27], a[236:239], a[168:171], v[24:27]
ds_read_b64_tr_b16 a[228:229], v240 offset:288
buffer_load_dwordx4 v252, s[12:15], s45 offen offset:2112 lds
v_mfma_f32_16x16x32_bf16 v[28:31], a[236:239], a[172:175], v[28:31]
s_waitcnt lgkmcnt(7)
ds_read_b64_tr_b16 a[230:231], v240 offset:800
v_mfma_f32_16x16x32_bf16 v[32:35], a[240:243], a[168:171], v[32:35]
ds_read_b64_tr_b16 a[232:233], v240 offset:320
buffer_load_dwordx4 v253, s[12:15], s45 offen offset:3168 lds
v_mfma_f32_16x16x32_bf16 v[36:39], a[240:243], a[172:175], v[36:39]
s_add_u32 m0, s28, 33792
ds_read_b64_tr_b16 a[234:235], v240 offset:832
s_mov_b32 s45, 3407872
v_mfma_f32_16x16x32_bf16 v[40:43], a[244:247], a[168:171], v[40:43]
ds_read_b64_tr_b16 a[236:237], v240 offset:352
v_mfma_f32_16x16x32_bf16 v[44:47], a[244:247], a[172:175], v[44:47]
s_waitcnt lgkmcnt(7)
ds_read_b64_tr_b16 a[238:239], v240 offset:864
buffer_load_dwordx4 v250, s[12:15], s45 offen offset:0 lds
v_mfma_f32_16x16x32_bf16 v[48:51], a[248:251], a[168:171], v[48:51]
ds_read_b64_tr_b16 a[240:241], v240 offset:384
v_mfma_f32_16x16x32_bf16 v[52:55], a[248:251], a[172:175], v[52:55]
ds_read_b64_tr_b16 a[242:243], v240 offset:896
buffer_load_dwordx4 v251, s[12:15], s45 offen offset:1056 lds
v_mfma_f32_16x16x32_bf16 v[56:59], a[252:255], a[168:171], v[56:59]
ds_read_b64_tr_b16 a[244:245], v240 offset:416
v_mfma_f32_16x16x32_bf16 v[60:63], a[252:255], a[172:175], v[60:63]
s_waitcnt lgkmcnt(7)
ds_read_b64_tr_b16 a[246:247], v240 offset:928
v_mfma_f32_16x16x32_bf16 v[64:67], a[224:227], a[168:171], v[64:67]
ds_read_b64_tr_b16 a[248:249], v240 offset:448
buffer_load_dwordx4 v252, s[12:15], s45 offen offset:2112 lds
v_mfma_f32_16x16x32_bf16 v[68:71], a[224:227], a[172:175], v[68:71]
ds_read_b64_tr_b16 a[250:251], v240 offset:960
v_mfma_f32_16x16x32_bf16 v[72:75], a[228:231], a[168:171], v[72:75]
s_waitcnt lgkmcnt(6)
ds_read_b64_tr_b16 a[252:253], v240 offset:480
v_mfma_f32_16x16x32_bf16 v[76:79], a[228:231], a[172:175], v[76:79]
s_waitcnt vmcnt(19)
ds_read_b64_tr_b16 a[254:255], v240 offset:992
s_barrier
v_mfma_f32_16x16x32_bf16 v[80:83], a[232:235], a[168:171], v[80:83]
ds_read_b64_tr_b16 a[224:225], v240 offset:33792
buffer_load_dwordx4 v253, s[12:15], s45 offen offset:3168 lds
v_mfma_f32_16x16x32_bf16 v[84:87], a[232:235], a[172:175], v[84:87]
s_add_u32 m0, s28, 50688
ds_read_b64_tr_b16 a[226:227], v240 offset:34304
s_mov_b32 s29, 0
v_mfma_f32_16x16x32_bf16 v[88:91], a[236:239], a[168:171], v[88:91]
ds_read_b64_tr_b16 a[228:229], v240 offset:33824
buffer_load_dwordx4 v246, s[4:7], s29 offen offset:0 nt lds
v_mfma_f32_16x16x32_bf16 v[92:95], a[236:239], a[172:175], v[92:95]
s_waitcnt lgkmcnt(7)
ds_read_b64_tr_b16 a[230:231], v240 offset:34336
v_mfma_f32_16x16x32_bf16 v[96:99], a[240:243], a[168:171], v[96:99]
ds_read_b64_tr_b16 a[232:233], v240 offset:33856
buffer_load_dwordx4 v247, s[4:7], s29 offen offset:1056 nt lds
v_mfma_f32_16x16x32_bf16 v[100:103], a[240:243], a[172:175], v[100:103]
ds_read_b64_tr_b16 a[234:235], v240 offset:34368
v_mfma_f32_16x16x32_bf16 v[104:107], a[244:247], a[168:171], v[104:107]
ds_read_b64_tr_b16 a[236:237], v240 offset:33888
buffer_load_dwordx4 v248, s[4:7], s29 offen offset:2112 nt lds
v_mfma_f32_16x16x32_bf16 v[108:111], a[244:247], a[172:175], v[108:111]
s_waitcnt lgkmcnt(7)
ds_read_b64_tr_b16 a[238:239], v240 offset:34400
v_mfma_f32_16x16x32_bf16 v[112:115], a[248:251], a[168:171], v[112:115]
ds_read_b64_tr_b16 a[240:241], v240 offset:33920
v_mfma_f32_16x16x32_bf16 v[116:119], a[248:251], a[172:175], v[116:119]
ds_read_b64_tr_b16 a[242:243], v240 offset:34432
buffer_load_dwordx4 v249, s[4:7], s29 offen offset:3168 nt lds
v_mfma_f32_16x16x32_bf16 v[120:123], a[252:255], a[168:171], v[120:123]
s_add_u32 m0, s28, 84480
ds_read_b64_tr_b16 a[244:245], v240 offset:33952
s_mov_b32 s29, 16384
v_mfma_f32_16x16x32_bf16 v[124:127], a[252:255], a[172:175], v[124:127]
s_waitcnt lgkmcnt(7)
ds_read_b64_tr_b16 a[246:247], v240 offset:34464
v_mfma_f32_16x16x32_bf16 v[0:3], a[224:227], a[176:179], v[0:3]
ds_read_b64_tr_b16 a[248:249], v240 offset:33984
v_mfma_f32_16x16x32_bf16 v[4:7], a[224:227], a[180:183], v[4:7]
ds_read_b64_tr_b16 a[250:251], v240 offset:34496
buffer_load_dwordx4 v246, s[4:7], s29 offen offset:0 nt lds
v_mfma_f32_16x16x32_bf16 v[8:11], a[228:231], a[176:179], v[8:11]
ds_read_b64_tr_b16 a[252:253], v240 offset:34016
v_mfma_f32_16x16x32_bf16 v[12:15], a[228:231], a[180:183], v[12:15]
s_waitcnt lgkmcnt(7)
ds_read_b64_tr_b16 a[254:255], v240 offset:34528
v_mfma_f32_16x16x32_bf16 v[16:19], a[232:235], a[176:179], v[16:19]
ds_read_b64_tr_b16 a[224:225], v240 offset:34048
v_mfma_f32_16x16x32_bf16 v[20:23], a[232:235], a[180:183], v[20:23]
ds_read_b64_tr_b16 a[226:227], v240 offset:34560
v_mfma_f32_16x16x32_bf16 v[24:27], a[236:239], a[176:179], v[24:27]
ds_read_b64_tr_b16 a[228:229], v240 offset:34080
v_mfma_f32_16x16x32_bf16 v[28:31], a[236:239], a[180:183], v[28:31]
s_waitcnt lgkmcnt(7)
ds_read_b64_tr_b16 a[230:231], v240 offset:34592
v_mfma_f32_16x16x32_bf16 v[32:35], a[240:243], a[176:179], v[32:35]
ds_read_b64_tr_b16 a[232:233], v240 offset:34112
buffer_load_dwordx4 v247, s[4:7], s29 offen offset:1056 nt lds
v_mfma_f32_16x16x32_bf16 v[36:39], a[240:243], a[180:183], v[36:39]
ds_read_b64_tr_b16 a[234:235], v240 offset:34624
v_mfma_f32_16x16x32_bf16 v[40:43], a[244:247], a[176:179], v[40:43]
ds_read_b64_tr_b16 a[236:237], v240 offset:34144
v_mfma_f32_16x16x32_bf16 v[44:47], a[244:247], a[180:183], v[44:47]
s_waitcnt lgkmcnt(7)
ds_read_b64_tr_b16 a[238:239], v240 offset:34656
v_mfma_f32_16x16x32_bf16 v[48:51], a[248:251], a[176:179], v[48:51]
ds_read_b64_tr_b16 a[240:241], v240 offset:34176
v_mfma_f32_16x16x32_bf16 v[52:55], a[248:251], a[180:183], v[52:55]
ds_read_b64_tr_b16 a[242:243], v240 offset:34688
v_mfma_f32_16x16x32_bf16 v[56:59], a[252:255], a[176:179], v[56:59]
ds_read_b64_tr_b16 a[244:245], v240 offset:34208
v_mfma_f32_16x16x32_bf16 v[60:63], a[252:255], a[180:183], v[60:63]
s_waitcnt lgkmcnt(7)
ds_read_b64_tr_b16 a[246:247], v240 offset:34720
v_mfma_f32_16x16x32_bf16 v[64:67], a[224:227], a[176:179], v[64:67]
ds_read_b64_tr_b16 a[248:249], v240 offset:34240
buffer_load_dwordx4 v248, s[4:7], s29 offen offset:2112 nt lds
v_mfma_f32_16x16x32_bf16 v[68:71], a[224:227], a[180:183], v[68:71]
ds_read_b64_tr_b16 a[250:251], v240 offset:34752
v_mfma_f32_16x16x32_bf16 v[72:75], a[228:231], a[176:179], v[72:75]
s_waitcnt lgkmcnt(6)
ds_read_b64_tr_b16 a[252:253], v240 offset:34272
v_mfma_f32_16x16x32_bf16 v[76:79], a[228:231], a[180:183], v[76:79]
s_waitcnt vmcnt(23)
ds_read_b64_tr_b16 a[254:255], v240 offset:34784
s_barrier
v_mfma_f32_16x16x32_bf16 v[80:83], a[232:235], a[176:179], v[80:83]
ds_read_b64_tr_b16 a[224:225], v240 offset:50688
v_mfma_f32_16x16x32_bf16 v[84:87], a[232:235], a[180:183], v[84:87]
ds_read_b64_tr_b16 a[226:227], v240 offset:51200
v_mfma_f32_16x16x32_bf16 v[88:91], a[236:239], a[176:179], v[88:91]
ds_read_b64_tr_b16 a[228:229], v240 offset:50720
v_mfma_f32_16x16x32_bf16 v[92:95], a[236:239], a[180:183], v[92:95]
s_waitcnt lgkmcnt(7)
ds_read_b64_tr_b16 a[230:231], v240 offset:51232
v_mfma_f32_16x16x32_bf16 v[96:99], a[240:243], a[176:179], v[96:99]
ds_read_b64_tr_b16 a[232:233], v240 offset:50752
buffer_load_dwordx4 v249, s[4:7], s29 offen offset:3168 nt lds
v_mfma_f32_16x16x32_bf16 v[100:103], a[240:243], a[180:183], v[100:103]
s_add_u32 m0, s28, 67584
ds_read_b64_tr_b16 a[234:235], v240 offset:51264
s_mov_b32 s45, 512
v_mfma_f32_16x16x32_bf16 v[104:107], a[244:247], a[176:179], v[104:107]
ds_read_b64_tr_b16 a[236:237], v240 offset:50784
v_mfma_f32_16x16x32_bf16 v[108:111], a[244:247], a[180:183], v[108:111]
s_waitcnt lgkmcnt(7)
ds_read_b64_tr_b16 a[238:239], v240 offset:51296
v_mfma_f32_16x16x32_bf16 v[112:115], a[248:251], a[176:179], v[112:115]
ds_read_b64_tr_b16 a[240:241], v240 offset:50816
v_mfma_f32_16x16x32_bf16 v[116:119], a[248:251], a[180:183], v[116:119]
ds_read_b64_tr_b16 a[242:243], v240 offset:51328
v_mfma_f32_16x16x32_bf16 v[120:123], a[252:255], a[176:179], v[120:123]
ds_read_b64_tr_b16 a[244:245], v240 offset:50848
v_mfma_f32_16x16x32_bf16 v[124:127], a[252:255], a[180:183], v[124:127]
s_waitcnt lgkmcnt(7)
ds_read_b64_tr_b16 a[246:247], v240 offset:51360
v_mfma_f32_16x16x32_bf16 v[0:3], a[224:227], a[184:187], v[0:3]
ds_read_b64_tr_b16 a[248:249], v240 offset:50880
v_mfma_f32_16x16x32_bf16 v[4:7], a[224:227], a[188:191], v[4:7]
ds_read_b64_tr_b16 a[250:251], v240 offset:51392
buffer_load_dwordx4 v250, s[12:15], s45 offen offset:0 lds
v_mfma_f32_16x16x32_bf16 v[8:11], a[228:231], a[184:187], v[8:11]
ds_read_b64_tr_b16 a[252:253], v240 offset:50912
v_mfma_f32_16x16x32_bf16 v[12:15], a[228:231], a[188:191], v[12:15]
s_waitcnt lgkmcnt(7)
ds_read_b64_tr_b16 a[254:255], v240 offset:51424
v_mfma_f32_16x16x32_bf16 v[16:19], a[232:235], a[184:187], v[16:19]
ds_read_b64_tr_b16 a[224:225], v240 offset:50944
v_mfma_f32_16x16x32_bf16 v[20:23], a[232:235], a[188:191], v[20:23]
ds_read_b64_tr_b16 a[226:227], v240 offset:51456
v_mfma_f32_16x16x32_bf16 v[24:27], a[236:239], a[184:187], v[24:27]
ds_read_b64_tr_b16 a[228:229], v240 offset:50976
v_mfma_f32_16x16x32_bf16 v[28:31], a[236:239], a[188:191], v[28:31]
s_waitcnt lgkmcnt(7)
ds_read_b64_tr_b16 a[230:231], v240 offset:51488
v_mfma_f32_16x16x32_bf16 v[32:35], a[240:243], a[184:187], v[32:35]
ds_read_b64_tr_b16 a[232:233], v240 offset:51008
buffer_load_dwordx4 v251, s[12:15], s45 offen offset:1056 lds
v_mfma_f32_16x16x32_bf16 v[36:39], a[240:243], a[188:191], v[36:39]
ds_read_b64_tr_b16 a[234:235], v240 offset:51520
v_mfma_f32_16x16x32_bf16 v[40:43], a[244:247], a[184:187], v[40:43]
ds_read_b64_tr_b16 a[236:237], v240 offset:51040
v_mfma_f32_16x16x32_bf16 v[44:47], a[244:247], a[188:191], v[44:47]
s_waitcnt lgkmcnt(7)
ds_read_b64_tr_b16 a[238:239], v240 offset:51552
v_mfma_f32_16x16x32_bf16 v[48:51], a[248:251], a[184:187], v[48:51]
ds_read_b64_tr_b16 a[240:241], v240 offset:51072
v_mfma_f32_16x16x32_bf16 v[52:55], a[248:251], a[188:191], v[52:55]
ds_read_b64_tr_b16 a[242:243], v240 offset:51584
v_mfma_f32_16x16x32_bf16 v[56:59], a[252:255], a[184:187], v[56:59]
ds_read_b64_tr_b16 a[244:245], v240 offset:51104
v_mfma_f32_16x16x32_bf16 v[60:63], a[252:255], a[188:191], v[60:63]
s_waitcnt lgkmcnt(7)
ds_read_b64_tr_b16 a[246:247], v240 offset:51616
v_mfma_f32_16x16x32_bf16 v[64:67], a[224:227], a[184:187], v[64:67]
ds_read_b64_tr_b16 a[248:249], v240 offset:51136
buffer_load_dwordx4 v252, s[12:15], s45 offen offset:2112 lds
v_mfma_f32_16x16x32_bf16 v[68:71], a[224:227], a[188:191], v[68:71]
ds_read_b64_tr_b16 a[250:251], v240 offset:51648
v_mfma_f32_16x16x32_bf16 v[72:75], a[228:231], a[184:187], v[72:75]
s_waitcnt lgkmcnt(6)
ds_read_b64_tr_b16 a[252:253], v240 offset:51168
v_mfma_f32_16x16x32_bf16 v[76:79], a[228:231], a[188:191], v[76:79]
s_waitcnt vmcnt(23)
ds_read_b64_tr_b16 a[254:255], v240 offset:51680
s_barrier
v_mfma_f32_16x16x32_bf16 v[80:83], a[232:235], a[184:187], v[80:83]
ds_read_b64_tr_b16 a[224:225], v241 offset:0
v_mfma_f32_16x16x32_bf16 v[84:87], a[232:235], a[188:191], v[84:87]
ds_read_b64_tr_b16 a[226:227], v241 offset:512
v_mfma_f32_16x16x32_bf16 v[88:91], a[236:239], a[184:187], v[88:91]
ds_read_b64_tr_b16 a[228:229], v241 offset:32
v_mfma_f32_16x16x32_bf16 v[92:95], a[236:239], a[188:191], v[92:95]
s_waitcnt lgkmcnt(7)
ds_read_b64_tr_b16 a[230:231], v241 offset:544
v_mfma_f32_16x16x32_bf16 v[96:99], a[240:243], a[184:187], v[96:99]
ds_read_b64_tr_b16 a[232:233], v241 offset:64
buffer_load_dwordx4 v253, s[12:15], s45 offen offset:3168 lds
v_mfma_f32_16x16x32_bf16 v[100:103], a[240:243], a[188:191], v[100:103]
s_add_u32 m0, s28, 101376
ds_read_b64_tr_b16 a[234:235], v241 offset:576
s_mov_b32 s29, 32768
v_mfma_f32_16x16x32_bf16 v[104:107], a[244:247], a[184:187], v[104:107]
ds_read_b64_tr_b16 a[236:237], v241 offset:96
v_mfma_f32_16x16x32_bf16 v[108:111], a[244:247], a[188:191], v[108:111]
s_waitcnt lgkmcnt(7)
ds_read_b64_tr_b16 a[238:239], v241 offset:608
v_mfma_f32_16x16x32_bf16 v[112:115], a[248:251], a[184:187], v[112:115]
ds_read_b64_tr_b16 a[240:241], v241 offset:128
v_mfma_f32_16x16x32_bf16 v[116:119], a[248:251], a[188:191], v[116:119]
ds_read_b64_tr_b16 a[242:243], v241 offset:640
v_mfma_f32_16x16x32_bf16 v[120:123], a[252:255], a[184:187], v[120:123]
ds_read_b64_tr_b16 a[244:245], v241 offset:160
v_mfma_f32_16x16x32_bf16 v[124:127], a[252:255], a[188:191], v[124:127]
s_waitcnt lgkmcnt(7)
ds_read_b64_tr_b16 a[246:247], v241 offset:672
v_mfma_f32_16x16x32_bf16 v[0:3], a[224:227], a[192:195], v[0:3]
ds_read_b64_tr_b16 a[248:249], v241 offset:192
v_mfma_f32_16x16x32_bf16 v[4:7], a[224:227], a[196:199], v[4:7]
ds_read_b64_tr_b16 a[250:251], v241 offset:704
buffer_load_dwordx4 v246, s[4:7], s29 offen offset:0 nt lds
v_mfma_f32_16x16x32_bf16 v[8:11], a[228:231], a[192:195], v[8:11]
ds_read_b64_tr_b16 a[252:253], v241 offset:224
v_mfma_f32_16x16x32_bf16 v[12:15], a[228:231], a[196:199], v[12:15]
s_waitcnt lgkmcnt(7)
ds_read_b64_tr_b16 a[254:255], v241 offset:736
v_mfma_f32_16x16x32_bf16 v[16:19], a[232:235], a[192:195], v[16:19]
ds_read_b64_tr_b16 a[224:225], v241 offset:256
v_mfma_f32_16x16x32_bf16 v[20:23], a[232:235], a[196:199], v[20:23]
ds_read_b64_tr_b16 a[226:227], v241 offset:768
v_mfma_f32_16x16x32_bf16 v[24:27], a[236:239], a[192:195], v[24:27]
ds_read_b64_tr_b16 a[228:229], v241 offset:288
v_mfma_f32_16x16x32_bf16 v[28:31], a[236:239], a[196:199], v[28:31]
s_waitcnt lgkmcnt(7)
ds_read_b64_tr_b16 a[230:231], v241 offset:800
v_mfma_f32_16x16x32_bf16 v[32:35], a[240:243], a[192:195], v[32:35]
ds_read_b64_tr_b16 a[232:233], v241 offset:320
buffer_load_dwordx4 v247, s[4:7], s29 offen offset:1056 nt lds
v_mfma_f32_16x16x32_bf16 v[36:39], a[240:243], a[196:199], v[36:39]
ds_read_b64_tr_b16 a[234:235], v241 offset:832
v_mfma_f32_16x16x32_bf16 v[40:43], a[244:247], a[192:195], v[40:43]
ds_read_b64_tr_b16 a[236:237], v241 offset:352
v_mfma_f32_16x16x32_bf16 v[44:47], a[244:247], a[196:199], v[44:47]
s_waitcnt lgkmcnt(7)
ds_read_b64_tr_b16 a[238:239], v241 offset:864
v_mfma_f32_16x16x32_bf16 v[48:51], a[248:251], a[192:195], v[48:51]
ds_read_b64_tr_b16 a[240:241], v241 offset:384
v_mfma_f32_16x16x32_bf16 v[52:55], a[248:251], a[196:199], v[52:55]
ds_read_b64_tr_b16 a[242:243], v241 offset:896
v_mfma_f32_16x16x32_bf16 v[56:59], a[252:255], a[192:195], v[56:59]
ds_read_b64_tr_b16 a[244:245], v241 offset:416
v_mfma_f32_16x16x32_bf16 v[60:63], a[252:255], a[196:199], v[60:63]
s_waitcnt lgkmcnt(7)
ds_read_b64_tr_b16 a[246:247], v241 offset:928
v_mfma_f32_16x16x32_bf16 v[64:67], a[224:227], a[192:195], v[64:67]
ds_read_b64_tr_b16 a[248:249], v241 offset:448
buffer_load_dwordx4 v248, s[4:7], s29 offen offset:2112 nt lds
v_mfma_f32_16x16x32_bf16 v[68:71], a[224:227], a[196:199], v[68:71]
ds_read_b64_tr_b16 a[250:251], v241 offset:960
v_mfma_f32_16x16x32_bf16 v[72:75], a[228:231], a[192:195], v[72:75]
s_waitcnt lgkmcnt(6)
ds_read_b64_tr_b16 a[252:253], v241 offset:480
v_mfma_f32_16x16x32_bf16 v[76:79], a[228:231], a[196:199], v[76:79]
s_waitcnt vmcnt(23)
ds_read_b64_tr_b16 a[254:255], v241 offset:992
s_barrier
v_mfma_f32_16x16x32_bf16 v[80:83], a[232:235], a[192:195], v[80:83]
ds_read_b64_tr_b16 a[224:225], v239 offset:16896
v_mfma_f32_16x16x32_bf16 v[84:87], a[232:235], a[196:199], v[84:87]
ds_read_b64_tr_b16 a[226:227], v239 offset:17408
v_mfma_f32_16x16x32_bf16 v[88:91], a[236:239], a[192:195], v[88:91]
ds_read_b64_tr_b16 a[228:229], v239 offset:16928
v_mfma_f32_16x16x32_bf16 v[92:95], a[236:239], a[196:199], v[92:95]
s_waitcnt lgkmcnt(7)
ds_read_b64_tr_b16 a[230:231], v239 offset:17440
v_mfma_f32_16x16x32_bf16 v[96:99], a[240:243], a[192:195], v[96:99]
ds_read_b64_tr_b16 a[232:233], v239 offset:16960
buffer_load_dwordx4 v249, s[4:7], s29 offen offset:3168 nt lds
v_mfma_f32_16x16x32_bf16 v[100:103], a[240:243], a[196:199], v[100:103]
s_add_u32 m0, s28, 118272
ds_read_b64_tr_b16 a[234:235], v239 offset:17472
s_mov_b32 s29, 49152
v_mfma_f32_16x16x32_bf16 v[104:107], a[244:247], a[192:195], v[104:107]
ds_read_b64_tr_b16 a[236:237], v239 offset:16992
v_mfma_f32_16x16x32_bf16 v[108:111], a[244:247], a[196:199], v[108:111]
s_waitcnt lgkmcnt(7)
ds_read_b64_tr_b16 a[238:239], v239 offset:17504
v_mfma_f32_16x16x32_bf16 v[112:115], a[248:251], a[192:195], v[112:115]
ds_read_b64_tr_b16 a[240:241], v239 offset:17024
v_mfma_f32_16x16x32_bf16 v[116:119], a[248:251], a[196:199], v[116:119]
ds_read_b64_tr_b16 a[242:243], v239 offset:17536
v_mfma_f32_16x16x32_bf16 v[120:123], a[252:255], a[192:195], v[120:123]
ds_read_b64_tr_b16 a[244:245], v239 offset:17056
v_mfma_f32_16x16x32_bf16 v[124:127], a[252:255], a[196:199], v[124:127]
s_waitcnt lgkmcnt(7)
ds_read_b64_tr_b16 a[246:247], v239 offset:17568
v_mfma_f32_16x16x32_bf16 v[0:3], a[224:227], a[200:203], v[0:3]
ds_read_b64_tr_b16 a[248:249], v239 offset:17088
v_mfma_f32_16x16x32_bf16 v[4:7], a[224:227], a[204:207], v[4:7]
ds_read_b64_tr_b16 a[250:251], v239 offset:17600
buffer_load_dwordx4 v246, s[4:7], s29 offen offset:0 nt lds
v_mfma_f32_16x16x32_bf16 v[8:11], a[228:231], a[200:203], v[8:11]
ds_read_b64_tr_b16 a[252:253], v239 offset:17120
v_mfma_f32_16x16x32_bf16 v[12:15], a[228:231], a[204:207], v[12:15]
s_waitcnt lgkmcnt(7)
ds_read_b64_tr_b16 a[254:255], v239 offset:17632
v_mfma_f32_16x16x32_bf16 v[16:19], a[232:235], a[200:203], v[16:19]
ds_read_b64_tr_b16 a[224:225], v239 offset:17152
v_mfma_f32_16x16x32_bf16 v[20:23], a[232:235], a[204:207], v[20:23]
ds_read_b64_tr_b16 a[226:227], v239 offset:17664
v_mfma_f32_16x16x32_bf16 v[24:27], a[236:239], a[200:203], v[24:27]
ds_read_b64_tr_b16 a[228:229], v239 offset:17184
v_mfma_f32_16x16x32_bf16 v[28:31], a[236:239], a[204:207], v[28:31]
s_waitcnt lgkmcnt(7)
ds_read_b64_tr_b16 a[230:231], v239 offset:17696
v_mfma_f32_16x16x32_bf16 v[32:35], a[240:243], a[200:203], v[32:35]
ds_read_b64_tr_b16 a[232:233], v239 offset:17216
buffer_load_dwordx4 v247, s[4:7], s29 offen offset:1056 nt lds
v_mfma_f32_16x16x32_bf16 v[36:39], a[240:243], a[204:207], v[36:39]
ds_read_b64_tr_b16 a[234:235], v239 offset:17728
v_mfma_f32_16x16x32_bf16 v[40:43], a[244:247], a[200:203], v[40:43]
ds_read_b64_tr_b16 a[236:237], v239 offset:17248
v_mfma_f32_16x16x32_bf16 v[44:47], a[244:247], a[204:207], v[44:47]
s_waitcnt lgkmcnt(7)
ds_read_b64_tr_b16 a[238:239], v239 offset:17760
v_mfma_f32_16x16x32_bf16 v[48:51], a[248:251], a[200:203], v[48:51]
ds_read_b64_tr_b16 a[240:241], v239 offset:17280
v_mfma_f32_16x16x32_bf16 v[52:55], a[248:251], a[204:207], v[52:55]
ds_read_b64_tr_b16 a[242:243], v239 offset:17792
v_mfma_f32_16x16x32_bf16 v[56:59], a[252:255], a[200:203], v[56:59]
ds_read_b64_tr_b16 a[244:245], v239 offset:17312
v_mfma_f32_16x16x32_bf16 v[60:63], a[252:255], a[204:207], v[60:63]
s_waitcnt lgkmcnt(7)
ds_read_b64_tr_b16 a[246:247], v239 offset:17824
v_mfma_f32_16x16x32_bf16 v[64:67], a[224:227], a[200:203], v[64:67]
ds_read_b64_tr_b16 a[248:249], v239 offset:17344
buffer_load_dwordx4 v248, s[4:7], s29 offen offset:2112 nt lds
v_mfma_f32_16x16x32_bf16 v[68:71], a[224:227], a[204:207], v[68:71]
ds_read_b64_tr_b16 a[250:251], v239 offset:17856
v_mfma_f32_16x16x32_bf16 v[72:75], a[228:231], a[200:203], v[72:75]
s_waitcnt lgkmcnt(6)
ds_read_b64_tr_b16 a[252:253], v239 offset:17376
v_mfma_f32_16x16x32_bf16 v[76:79], a[228:231], a[204:207], v[76:79]
s_waitcnt vmcnt(23)
ds_read_b64_tr_b16 a[254:255], v239 offset:17888
s_barrier
v_mfma_f32_16x16x32_bf16 v[80:83], a[232:235], a[200:203], v[80:83]
ds_read_b64_tr_b16 a[224:225], v239 offset:0
v_mfma_f32_16x16x32_bf16 v[84:87], a[232:235], a[204:207], v[84:87]
ds_read_b64_tr_b16 a[226:227], v239 offset:512
v_mfma_f32_16x16x32_bf16 v[88:91], a[236:239], a[200:203], v[88:91]
ds_read_b64_tr_b16 a[228:229], v239 offset:32
v_mfma_f32_16x16x32_bf16 v[92:95], a[236:239], a[204:207], v[92:95]
s_waitcnt lgkmcnt(7)
ds_read_b64_tr_b16 a[230:231], v239 offset:544
v_mfma_f32_16x16x32_bf16 v[96:99], a[240:243], a[200:203], v[96:99]
ds_read_b64_tr_b16 a[232:233], v239 offset:64
buffer_load_dwordx4 v249, s[4:7], s29 offen offset:3168 nt lds
v_mfma_f32_16x16x32_bf16 v[100:103], a[240:243], a[204:207], v[100:103]
s_add_u32 m0, s28, 135168
ds_read_b64_tr_b16 a[234:235], v239 offset:576
s_mov_b32 s45, 262656
v_mfma_f32_16x16x32_bf16 v[104:107], a[244:247], a[200:203], v[104:107]
ds_read_b64_tr_b16 a[236:237], v239 offset:96
v_mfma_f32_16x16x32_bf16 v[108:111], a[244:247], a[204:207], v[108:111]
s_waitcnt lgkmcnt(7)
ds_read_b64_tr_b16 a[238:239], v239 offset:608
v_mfma_f32_16x16x32_bf16 v[112:115], a[248:251], a[200:203], v[112:115]
ds_read_b64_tr_b16 a[240:241], v239 offset:128
v_mfma_f32_16x16x32_bf16 v[116:119], a[248:251], a[204:207], v[116:119]
ds_read_b64_tr_b16 a[242:243], v239 offset:640
v_mfma_f32_16x16x32_bf16 v[120:123], a[252:255], a[200:203], v[120:123]
ds_read_b64_tr_b16 a[244:245], v239 offset:160
v_mfma_f32_16x16x32_bf16 v[124:127], a[252:255], a[204:207], v[124:127]
s_waitcnt lgkmcnt(7)
ds_read_b64_tr_b16 a[246:247], v239 offset:672
v_mfma_f32_16x16x32_bf16 v[0:3], a[224:227], a[208:211], v[0:3]
ds_read_b64_tr_b16 a[248:249], v239 offset:192
v_mfma_f32_16x16x32_bf16 v[4:7], a[224:227], a[212:215], v[4:7]
ds_read_b64_tr_b16 a[250:251], v239 offset:704
buffer_load_dwordx4 v250, s[12:15], s45 offen offset:0 lds
v_mfma_f32_16x16x32_bf16 v[8:11], a[228:231], a[208:211], v[8:11]
ds_read_b64_tr_b16 a[252:253], v239 offset:224
v_mfma_f32_16x16x32_bf16 v[12:15], a[228:231], a[212:215], v[12:15]
s_waitcnt lgkmcnt(7)
ds_read_b64_tr_b16 a[254:255], v239 offset:736
v_mfma_f32_16x16x32_bf16 v[16:19], a[232:235], a[208:211], v[16:19]
ds_read_b64_tr_b16 a[224:225], v239 offset:256
v_mfma_f32_16x16x32_bf16 v[20:23], a[232:235], a[212:215], v[20:23]
ds_read_b64_tr_b16 a[226:227], v239 offset:768
v_mfma_f32_16x16x32_bf16 v[24:27], a[236:239], a[208:211], v[24:27]
ds_read_b64_tr_b16 a[228:229], v239 offset:288
v_mfma_f32_16x16x32_bf16 v[28:31], a[236:239], a[212:215], v[28:31]
s_waitcnt lgkmcnt(7)
ds_read_b64_tr_b16 a[230:231], v239 offset:800
v_mfma_f32_16x16x32_bf16 v[32:35], a[240:243], a[208:211], v[32:35]
ds_read_b64_tr_b16 a[232:233], v239 offset:320
buffer_load_dwordx4 v251, s[12:15], s45 offen offset:1056 lds
v_mfma_f32_16x16x32_bf16 v[36:39], a[240:243], a[212:215], v[36:39]
ds_read_b64_tr_b16 a[234:235], v239 offset:832
v_mfma_f32_16x16x32_bf16 v[40:43], a[244:247], a[208:211], v[40:43]
ds_read_b64_tr_b16 a[236:237], v239 offset:352
v_mfma_f32_16x16x32_bf16 v[44:47], a[244:247], a[212:215], v[44:47]
s_waitcnt lgkmcnt(7)
ds_read_b64_tr_b16 a[238:239], v239 offset:864
v_mfma_f32_16x16x32_bf16 v[48:51], a[248:251], a[208:211], v[48:51]
ds_read_b64_tr_b16 a[240:241], v239 offset:384
v_mfma_f32_16x16x32_bf16 v[52:55], a[248:251], a[212:215], v[52:55]
ds_read_b64_tr_b16 a[242:243], v239 offset:896
v_mfma_f32_16x16x32_bf16 v[56:59], a[252:255], a[208:211], v[56:59]
ds_read_b64_tr_b16 a[244:245], v239 offset:416
v_mfma_f32_16x16x32_bf16 v[60:63], a[252:255], a[212:215], v[60:63]
s_waitcnt lgkmcnt(7)
ds_read_b64_tr_b16 a[246:247], v239 offset:928
v_mfma_f32_16x16x32_bf16 v[64:67], a[224:227], a[208:211], v[64:67]
ds_read_b64_tr_b16 a[248:249], v239 offset:448
buffer_load_dwordx4 v252, s[12:15], s45 offen offset:2112 lds
v_mfma_f32_16x16x32_bf16 v[68:71], a[224:227], a[212:215], v[68:71]
ds_read_b64_tr_b16 a[250:251], v239 offset:960
v_mfma_f32_16x16x32_bf16 v[72:75], a[228:231], a[208:211], v[72:75]
s_waitcnt lgkmcnt(6)
ds_read_b64_tr_b16 a[252:253], v239 offset:480
v_mfma_f32_16x16x32_bf16 v[76:79], a[228:231], a[212:215], v[76:79]
s_waitcnt vmcnt(23)
ds_read_b64_tr_b16 a[254:255], v239 offset:992
s_barrier
v_mfma_f32_16x16x32_bf16 v[80:83], a[232:235], a[208:211], v[80:83]
ds_read_b64_tr_b16 a[224:225], v239 offset:33792
v_mfma_f32_16x16x32_bf16 v[84:87], a[232:235], a[212:215], v[84:87]
ds_read_b64_tr_b16 a[226:227], v239 offset:34304
v_mfma_f32_16x16x32_bf16 v[88:91], a[236:239], a[208:211], v[88:91]
ds_read_b64_tr_b16 a[228:229], v239 offset:33824
v_mfma_f32_16x16x32_bf16 v[92:95], a[236:239], a[212:215], v[92:95]
s_waitcnt lgkmcnt(7)
ds_read_b64_tr_b16 a[230:231], v239 offset:34336
v_mfma_f32_16x16x32_bf16 v[96:99], a[240:243], a[208:211], v[96:99]
ds_read_b64_tr_b16 a[232:233], v239 offset:33856
buffer_load_dwordx4 v253, s[12:15], s45 offen offset:3168 lds
v_mfma_f32_16x16x32_bf16 v[100:103], a[240:243], a[212:215], v[100:103]
s_add_u32 m0, s28, 16896
ds_read_b64_tr_b16 a[234:235], v239 offset:34368
s_mov_b32 s29, 65536
v_mfma_f32_16x16x32_bf16 v[104:107], a[244:247], a[208:211], v[104:107]
ds_read_b64_tr_b16 a[236:237], v239 offset:33888
v_mfma_f32_16x16x32_bf16 v[108:111], a[244:247], a[212:215], v[108:111]
s_waitcnt lgkmcnt(7)
ds_read_b64_tr_b16 a[238:239], v239 offset:34400
v_mfma_f32_16x16x32_bf16 v[112:115], a[248:251], a[208:211], v[112:115]
ds_read_b64_tr_b16 a[240:241], v239 offset:33920
v_mfma_f32_16x16x32_bf16 v[116:119], a[248:251], a[212:215], v[116:119]
ds_read_b64_tr_b16 a[242:243], v239 offset:34432
v_mfma_f32_16x16x32_bf16 v[120:123], a[252:255], a[208:211], v[120:123]
ds_read_b64_tr_b16 a[244:245], v239 offset:33952
v_mfma_f32_16x16x32_bf16 v[124:127], a[252:255], a[212:215], v[124:127]
s_waitcnt lgkmcnt(7)
ds_read_b64_tr_b16 a[246:247], v239 offset:34464
v_mfma_f32_16x16x32_bf16 v[0:3], a[224:227], a[216:219], v[0:3]
ds_read_b64_tr_b16 a[248:249], v239 offset:33984
v_mfma_f32_16x16x32_bf16 v[4:7], a[224:227], a[220:223], v[4:7]
ds_read_b64_tr_b16 a[250:251], v239 offset:34496
buffer_load_dwordx4 v246, s[4:7], s29 offen offset:0 nt lds
v_mfma_f32_16x16x32_bf16 v[8:11], a[228:231], a[216:219], v[8:11]
ds_read_b64_tr_b16 a[252:253], v239 offset:34016
v_mfma_f32_16x16x32_bf16 v[12:15], a[228:231], a[220:223], v[12:15]
s_waitcnt lgkmcnt(7)
ds_read_b64_tr_b16 a[254:255], v239 offset:34528
v_mfma_f32_16x16x32_bf16 v[16:19], a[232:235], a[216:219], v[16:19]
ds_read_b64_tr_b16 a[224:225], v239 offset:34048
v_mfma_f32_16x16x32_bf16 v[20:23], a[232:235], a[220:223], v[20:23]
ds_read_b64_tr_b16 a[226:227], v239 offset:34560
v_mfma_f32_16x16x32_bf16 v[24:27], a[236:239], a[216:219], v[24:27]
ds_read_b64_tr_b16 a[228:229], v239 offset:34080
v_mfma_f32_16x16x32_bf16 v[28:31], a[236:239], a[220:223], v[28:31]
s_waitcnt lgkmcnt(7)
ds_read_b64_tr_b16 a[230:231], v239 offset:34592
v_mul_f32 v0, s31, v0
v_mul_f32 v1, s31, v1
v_mul_f32 v2, s31, v2
v_mul_f32 v3, s31, v3
v_cvt_pk_bf16_f32 v128, v0, v1
v_cvt_pk_bf16_f32 v129, v2, v3
v_mfma_f32_16x16x32_bf16 v[32:35], a[240:243], a[216:219], v[32:35]
ds_read_b64_tr_b16 a[232:233], v239 offset:34112
buffer_load_dwordx4 v247, s[4:7], s29 offen offset:1056 nt lds
v_mul_f32 v8, s31, v8
v_mul_f32 v9, s31, v9
v_mul_f32 v10, s31, v10
v_mul_f32 v11, s31, v11
v_cvt_pk_bf16_f32 v130, v8, v9
v_cvt_pk_bf16_f32 v131, v10, v11
v_mfma_f32_16x16x32_bf16 v[36:39], a[240:243], a[220:223], v[36:39]
ds_read_b64_tr_b16 a[234:235], v239 offset:34624
v_mul_f32 v4, s31, v4
v_mul_f32 v5, s31, v5
v_mul_f32 v6, s31, v6
v_mul_f32 v7, s31, v7
v_cvt_pk_bf16_f32 v132, v4, v5
v_cvt_pk_bf16_f32 v133, v6, v7
v_mfma_f32_16x16x32_bf16 v[40:43], a[244:247], a[216:219], v[40:43]
ds_read_b64_tr_b16 a[236:237], v239 offset:34144
v_mul_f32 v12, s31, v12
v_mul_f32 v13, s31, v13
v_mul_f32 v14, s31, v14
v_mul_f32 v15, s31, v15
v_cvt_pk_bf16_f32 v134, v12, v13
v_cvt_pk_bf16_f32 v135, v14, v15
v_mfma_f32_16x16x32_bf16 v[44:47], a[244:247], a[220:223], v[44:47]
s_waitcnt lgkmcnt(7)
ds_read_b64_tr_b16 a[238:239], v239 offset:34656
v_permlane32_swap_b32 v128, v130
v_permlane32_swap_b32 v129, v131
v_permlane32_swap_b32 v132, v134
v_mfma_f32_16x16x32_bf16 v[48:51], a[248:251], a[216:219], v[48:51]
ds_read_b64_tr_b16 a[240:241], v239 offset:34176
v_permlane32_swap_b32 v133, v135
v_mul_f32 v16, s31, v16
v_mul_f32 v17, s31, v17
v_mul_f32 v18, s31, v18
v_mul_f32 v19, s31, v19
v_cvt_pk_bf16_f32 v136, v16, v17
v_mfma_f32_16x16x32_bf16 v[52:55], a[248:251], a[220:223], v[52:55]
ds_read_b64_tr_b16 a[242:243], v239 offset:34688
v_cvt_pk_bf16_f32 v137, v18, v19
v_mul_f32 v24, s31, v24
v_mul_f32 v25, s31, v25
v_mul_f32 v26, s31, v26
v_mul_f32 v27, s31, v27
v_cvt_pk_bf16_f32 v138, v24, v25
v_cvt_pk_bf16_f32 v139, v26, v27
v_mfma_f32_16x16x32_bf16 v[56:59], a[252:255], a[216:219], v[56:59]
ds_read_b64_tr_b16 a[244:245], v239 offset:34208
v_mul_f32 v20, s31, v20
v_mul_f32 v21, s31, v21
v_mul_f32 v22, s31, v22
v_mul_f32 v23, s31, v23
v_cvt_pk_bf16_f32 v140, v20, v21
v_cvt_pk_bf16_f32 v141, v22, v23
v_mul_f32 v28, s31, v28
v_mfma_f32_16x16x32_bf16 v[60:63], a[252:255], a[220:223], v[60:63]
s_waitcnt lgkmcnt(7)
ds_read_b64_tr_b16 a[246:247], v239 offset:34720
v_mul_f32 v29, s31, v29
v_mul_f32 v30, s31, v30
v_mul_f32 v31, s31, v31
v_cvt_pk_bf16_f32 v142, v28, v29
v_cvt_pk_bf16_f32 v143, v30, v31
v_permlane32_swap_b32 v136, v138
v_mfma_f32_16x16x32_bf16 v[64:67], a[224:227], a[216:219], v[64:67]
ds_read_b64_tr_b16 a[248:249], v239 offset:34240
buffer_load_dwordx4 v248, s[4:7], s29 offen offset:2112 nt lds
v_permlane32_swap_b32 v137, v139
v_permlane32_swap_b32 v140, v142
v_permlane32_swap_b32 v141, v143
v_mul_f32 v32, s31, v32
v_mfma_f32_16x16x32_bf16 v[68:71], a[224:227], a[220:223], v[68:71]
ds_read_b64_tr_b16 a[250:251], v239 offset:34752
v_mul_f32 v33, s31, v33
v_mul_f32 v34, s31, v34
v_mul_f32 v35, s31, v35
v_cvt_pk_bf16_f32 v144, v32, v33
v_cvt_pk_bf16_f32 v145, v34, v35
v_mul_f32 v40, s31, v40
v_mul_f32 v41, s31, v41
v_mfma_f32_16x16x32_bf16 v[72:75], a[228:231], a[216:219], v[72:75]
s_waitcnt lgkmcnt(6)
ds_read_b64_tr_b16 a[252:253], v239 offset:34272
v_mul_f32 v42, s31, v42
v_mul_f32 v43, s31, v43
v_cvt_pk_bf16_f32 v146, v40, v41
v_cvt_pk_bf16_f32 v147, v42, v43
v_mul_f32 v36, s31, v36
v_mul_f32 v37, s31, v37
v_mul_f32 v38, s31, v38
v_mfma_f32_16x16x32_bf16 v[76:79], a[228:231], a[220:223], v[76:79]
s_waitcnt vmcnt(15)
ds_read_b64_tr_b16 a[254:255], v239 offset:34784
s_barrier
v_mul_f32 v39, s31, v39
v_cvt_pk_bf16_f32 v148, v36, v37
v_cvt_pk_bf16_f32 v149, v38, v39
v_mul_f32 v44, s31, v44
v_mul_f32 v45, s31, v45
v_mul_f32 v46, s31, v46
v_mfma_f32_16x16x32_bf16 v[80:83], a[232:235], a[216:219], v[80:83]
ds_read_b128 a[224:227], v236 offset:50688
v_mul_f32 v47, s31, v47
v_cvt_pk_bf16_f32 v150, v44, v45
v_cvt_pk_bf16_f32 v151, v46, v47
v_permlane32_swap_b32 v144, v146
v_permlane32_swap_b32 v145, v147
v_mfma_f32_16x16x32_bf16 v[84:87], a[232:235], a[220:223], v[84:87]
v_permlane32_swap_b32 v148, v150
v_permlane32_swap_b32 v149, v151
v_mul_f32 v48, s31, v48
v_mul_f32 v49, s31, v49
v_mul_f32 v50, s31, v50
v_mul_f32 v51, s31, v51
v_mfma_f32_16x16x32_bf16 v[88:91], a[236:239], a[216:219], v[88:91]
ds_read_b128 a[228:231], v236 offset:50752
v_cvt_pk_bf16_f32 v152, v48, v49
v_cvt_pk_bf16_f32 v153, v50, v51
v_mul_f32 v56, s31, v56
v_mul_f32 v57, s31, v57
v_mul_f32 v58, s31, v58
v_mul_f32 v59, s31, v59
v_cvt_pk_bf16_f32 v154, v56, v57
v_mfma_f32_16x16x32_bf16 v[92:95], a[236:239], a[220:223], v[92:95]
s_waitcnt lgkmcnt(6)
v_cvt_pk_bf16_f32 v155, v58, v59
v_mul_f32 v52, s31, v52
v_mul_f32 v53, s31, v53
v_mul_f32 v54, s31, v54
v_mul_f32 v55, s31, v55
v_cvt_pk_bf16_f32 v156, v52, v53
v_cvt_pk_bf16_f32 v157, v54, v55
v_mul_f32 v60, s31, v60
v_mfma_f32_16x16x32_bf16 v[96:99], a[240:243], a[216:219], v[96:99]
ds_read_b128 a[232:235], v236 offset:50816
buffer_load_dwordx4 v249, s[4:7], s29 offen offset:3168 nt lds
v_mul_f32 v61, s31, v61
v_mul_f32 v62, s31, v62
v_mul_f32 v63, s31, v63
v_cvt_pk_bf16_f32 v158, v60, v61
v_cvt_pk_bf16_f32 v159, v62, v63
v_permlane32_swap_b32 v152, v154
v_mfma_f32_16x16x32_bf16 v[100:103], a[240:243], a[220:223], v[100:103]
v_permlane32_swap_b32 v153, v155
v_permlane32_swap_b32 v156, v158
v_permlane32_swap_b32 v157, v159
v_mul_f32 v64, s31, v64
v_mul_f32 v65, s31, v65
v_mfma_f32_16x16x32_bf16 v[104:107], a[244:247], a[216:219], v[104:107]
ds_read_b128 a[236:239], v236 offset:50880
v_mul_f32 v66, s31, v66
v_mul_f32 v67, s31, v67
v_cvt_pk_bf16_f32 v160, v64, v65
v_cvt_pk_bf16_f32 v161, v66, v67
v_mul_f32 v72, s31, v72
v_mul_f32 v73, s31, v73
v_mul_f32 v74, s31, v74
v_mfma_f32_16x16x32_bf16 v[108:111], a[244:247], a[220:223], v[108:111]
s_waitcnt lgkmcnt(4)
v_mul_f32 v75, s31, v75
v_cvt_pk_bf16_f32 v162, v72, v73
v_cvt_pk_bf16_f32 v163, v74, v75
v_mul_f32 v68, s31, v68
v_mul_f32 v69, s31, v69
v_mul_f32 v70, s31, v70
v_mul_f32 v71, s31, v71
v_cvt_pk_bf16_f32 v164, v68, v69
v_mfma_f32_16x16x32_bf16 v[112:115], a[248:251], a[216:219], v[112:115]
ds_read_b128 a[240:243], v236 offset:50944
v_cvt_pk_bf16_f32 v165, v70, v71
v_mul_f32 v76, s31, v76
v_mul_f32 v77, s31, v77
v_mul_f32 v78, s31, v78
v_mul_f32 v79, s31, v79
v_cvt_pk_bf16_f32 v166, v76, v77
v_cvt_pk_bf16_f32 v167, v78, v79
v_mfma_f32_16x16x32_bf16 v[116:119], a[248:251], a[220:223], v[116:119]
v_permlane32_swap_b32 v160, v162
v_permlane32_swap_b32 v161, v163
v_permlane32_swap_b32 v164, v166
v_permlane32_swap_b32 v165, v167
v_mfma_f32_16x16x32_bf16 v[120:123], a[252:255], a[216:219], v[120:123]
ds_read_b128 a[244:247], v236 offset:51008
v_mul_f32 v80, s31, v80
v_mul_f32 v81, s31, v81
v_mul_f32 v82, s31, v82
v_mul_f32 v83, s31, v83
v_cvt_pk_bf16_f32 v168, v80, v81
v_cvt_pk_bf16_f32 v169, v82, v83
v_mul_f32 v88, s31, v88
v_mfma_f32_16x16x32_bf16 v[124:127], a[252:255], a[220:223], v[124:127]
s_waitcnt lgkmcnt(4)
v_mul_f32 v89, s31, v89
v_mul_f32 v90, s31, v90
v_mul_f32 v91, s31, v91
v_cvt_pk_bf16_f32 v170, v88, v89
v_cvt_pk_bf16_f32 v171, v90, v91
v_mul_f32 v84, s31, v84
v_mul_f32 v85, s31, v85
v_mul_f32 v86, s31, v86
v_mfma_f32_16x16x32_bf16 v[192:195], a[224:227], v[128:131], 0
ds_read_b128 a[248:251], v236 offset:51072
v_mul_f32 v87, s31, v87
v_cvt_pk_bf16_f32 v172, v84, v85
v_cvt_pk_bf16_f32 v173, v86, v87
v_mul_f32 v92, s31, v92
v_mul_f32 v93, s31, v93
v_mul_f32 v94, s31, v94
v_mul_f32 v95, s31, v95
v_mfma_f32_16x16x32_bf16 v[192:195], a[228:231], v[136:139], v[192:195]
v_cvt_pk_bf16_f32 v174, v92, v93
v_cvt_pk_bf16_f32 v175, v94, v95
v_permlane32_swap_b32 v168, v170
v_permlane32_swap_b32 v169, v171
v_permlane32_swap_b32 v172, v174
v_mfma_f32_16x16x32_bf16 v[196:199], a[228:231], v[140:143], 0
ds_read_b128 a[252:255], v236 offset:51136
v_permlane32_swap_b32 v173, v175
v_mul_f32 v96, s31, v96
v_mul_f32 v97, s31, v97
v_mul_f32 v98, s31, v98
v_mul_f32 v99, s31, v99
v_cvt_pk_bf16_f32 v176, v96, v97
v_mfma_f32_16x16x32_bf16 v[196:199], a[224:227], v[132:135], v[196:199]
s_waitcnt lgkmcnt(4)
v_cvt_pk_bf16_f32 v177, v98, v99
v_mul_f32 v104, s31, v104
v_mul_f32 v105, s31, v105
v_mul_f32 v106, s31, v106
v_mul_f32 v107, s31, v107
v_cvt_pk_bf16_f32 v178, v104, v105
v_cvt_pk_bf16_f32 v179, v106, v107
v_mul_f32 v100, s31, v100
v_mfma_f32_16x16x32_bf16 v[196:199], a[232:235], v[148:151], v[196:199]
s_add_u32 m0, s28, 0
ds_read_b128 a[224:227], v236 offset:51200
v_mul_f32 v101, s31, v101
v_mul_f32 v102, s31, v102
v_mul_f32 v103, s31, v103
v_cvt_pk_bf16_f32 v180, v100, v101
v_cvt_pk_bf16_f32 v181, v102, v103
v_mul_f32 v108, s31, v108
v_mul_f32 v109, s31, v109
v_mfma_f32_16x16x32_bf16 v[196:199], a[236:239], v[156:159], v[196:199]
s_mov_b32 s29, 81920
v_mul_f32 v110, s31, v110
v_mul_f32 v111, s31, v111
v_cvt_pk_bf16_f32 v182, v108, v109
v_cvt_pk_bf16_f32 v183, v110, v111
v_permlane32_swap_b32 v176, v178
v_permlane32_swap_b32 v177, v179
v_mfma_f32_16x16x32_bf16 v[192:195], a[236:239], v[152:155], v[192:195]
ds_read_b128 a[228:231], v236 offset:51264
v_permlane32_swap_b32 v180, v182
v_permlane32_swap_b32 v181, v183
v_mul_f32 v112, s31, v112
v_mul_f32 v113, s31, v113
v_mul_f32 v114, s31, v114
v_mfma_f32_16x16x32_bf16 v[192:195], a[232:235], v[144:147], v[192:195]
s_waitcnt lgkmcnt(4)
v_mul_f32 v115, s31, v115
v_cvt_pk_bf16_f32 v184, v112, v113
v_cvt_pk_bf16_f32 v185, v114, v115
v_mul_f32 v120, s31, v120
v_mul_f32 v121, s31, v121
v_mul_f32 v122, s31, v122
v_mul_f32 v123, s31, v123
v_cvt_pk_bf16_f32 v186, v120, v121
v_mfma_f32_16x16x32_bf16 v[192:195], a[240:243], v[160:163], v[192:195]
ds_read_b128 a[232:235], v236 offset:51328
v_cvt_pk_bf16_f32 v187, v122, v123
v_mul_f32 v116, s31, v116
v_mul_f32 v117, s31, v117
v_mul_f32 v118, s31, v118
v_mul_f32 v119, s31, v119
v_cvt_pk_bf16_f32 v188, v116, v117
v_cvt_pk_bf16_f32 v189, v118, v119
v_mfma_f32_16x16x32_bf16 v[192:195], a[244:247], v[168:171], v[192:195]
v_mul_f32 v124, s31, v124
v_mul_f32 v125, s31, v125
v_mul_f32 v126, s31, v126
v_mul_f32 v127, s31, v127
v_cvt_pk_bf16_f32 v190, v124, v125
v_cvt_pk_bf16_f32 v191, v126, v127
v_permlane32_swap_b32 v184, v186
v_mfma_f32_16x16x32_bf16 v[196:199], a[244:247], v[172:175], v[196:199]
ds_read_b128 a[236:239], v236 offset:51392
v_permlane32_swap_b32 v185, v187
v_permlane32_swap_b32 v188, v190
v_permlane32_swap_b32 v189, v191
v_mfma_f32_16x16x32_bf16 v[196:199], a[240:243], v[164:167], v[196:199]
s_waitcnt lgkmcnt(4)
buffer_load_dwordx4 v246, s[4:7], s29 offen offset:0 nt lds
v_mfma_f32_16x16x32_bf16 v[196:199], a[248:251], v[180:183], v[196:199]
ds_read_b128 a[240:243], v236 offset:51456
v_mfma_f32_16x16x32_bf16 v[196:199], a[252:255], v[188:191], v[196:199]
buffer_load_dwordx4 v247, s[4:7], s29 offen offset:1056 nt lds
v_mfma_f32_16x16x32_bf16 v[192:195], a[252:255], v[184:187], v[192:195]
ds_read_b128 a[244:247], v236 offset:51520
v_mov_b32 v112, v208
v_mfma_f32_16x16x32_bf16 v[192:195], a[248:251], v[176:179], v[192:195]
s_waitcnt lgkmcnt(4)
v_mov_b32 v113, v209
v_mov_b32 v114, v210
v_mfma_f32_16x16x32_bf16 v[200:203], a[224:227], v[128:131], 0
ds_read_b128 a[248:251], v236 offset:51584
v_mov_b32 v115, v211
v_mfma_f32_16x16x32_bf16 v[200:203], a[228:231], v[136:139], v[200:203]
v_mov_b32 v116, v212
v_mov_b32 v117, v213
v_mfma_f32_16x16x32_bf16 v[204:207], a[228:231], v[140:143], 0
ds_read_b128 a[252:255], v236 offset:51648
v_mov_b32 v118, v214
v_mfma_f32_16x16x32_bf16 v[204:207], a[224:227], v[132:135], v[204:207]
s_waitcnt lgkmcnt(4)
v_mov_b32 v119, v215
v_mov_b32 v120, v216
v_mfma_f32_16x16x32_bf16 v[204:207], a[232:235], v[148:151], v[204:207]
ds_read_b64_tr_b16 a[224:225], v240 offset:0
v_mov_b32 v121, v217
v_max3_f32 v242, v192, v193, v194
v_max3_f32 v243, v196, v197, v198
v_mfma_f32_16x16x32_bf16 v[204:207], a[236:239], v[156:159], v[204:207]
ds_read_b64_tr_b16 a[226:227], v240 offset:512
v_mov_b32 v122, v218
v_mfma_f32_16x16x32_bf16 v[200:203], a[236:239], v[152:155], v[200:203]
ds_read_b64_tr_b16 a[228:229], v240 offset:32
v_mov_b32 v123, v219
v_mfma_f32_16x16x32_bf16 v[200:203], a[232:235], v[144:147], v[200:203]
s_waitcnt lgkmcnt(5)
ds_read_b64_tr_b16 a[230:231], v240 offset:544
v_mov_b32 v124, v220
v_mfma_f32_16x16x32_bf16 v[200:203], a[240:243], v[160:163], v[200:203]
ds_read_b64_tr_b16 a[232:233], v240 offset:64
v_mov_b32 v125, v221
v_mfma_f32_16x16x32_bf16 v[200:203], a[244:247], v[168:171], v[200:203]
ds_read_b64_tr_b16 a[234:235], v240 offset:576
v_mov_b32 v126, v222
v_mfma_f32_16x16x32_bf16 v[204:207], a[244:247], v[172:175], v[204:207]
ds_read_b64_tr_b16 a[236:237], v240 offset:96
v_mov_b32 v127, v223
v_mfma_f32_16x16x32_bf16 v[204:207], a[240:243], v[164:167], v[204:207]
s_waitcnt lgkmcnt(7)
ds_read_b64_tr_b16 a[238:239], v240 offset:608
buffer_load_dwordx4 v248, s[4:7], s29 offen offset:2112 nt lds
v_mfma_f32_16x16x32_bf16 v[204:207], a[248:251], v[180:183], v[204:207]
ds_read_b64_tr_b16 a[240:241], v240 offset:128
v_mfma_f32_16x16x32_bf16 v[204:207], a[252:255], v[188:191], v[204:207]
ds_read_b64_tr_b16 a[242:243], v240 offset:640
v_mfma_f32_16x16x32_bf16 v[200:203], a[252:255], v[184:187], v[200:203]
ds_read_b64_tr_b16 a[244:245], v240 offset:160
v_mfma_f32_16x16x32_bf16 v[200:203], a[248:251], v[176:179], v[200:203]
s_waitcnt lgkmcnt(7)
ds_read_b64_tr_b16 a[246:247], v240 offset:672
v_mfma_f32_16x16x32_bf16 a[0:3], a[224:227], v[112:115], 0
ds_read_b64_tr_b16 a[248:249], v240 offset:192
v_mfma_f32_16x16x32_bf16 a[4:7], a[224:227], v[116:119], 0
ds_read_b64_tr_b16 a[250:251], v240 offset:704
v_mfma_f32_16x16x32_bf16 a[8:11], a[228:231], v[112:115], 0
s_waitcnt lgkmcnt(6)
ds_read_b64_tr_b16 a[252:253], v240 offset:224
v_mfma_f32_16x16x32_bf16 a[12:15], a[228:231], v[116:119], 0
s_waitcnt vmcnt(19)
ds_read_b64_tr_b16 a[254:255], v240 offset:736
s_barrier
v_max3_f32 v242, v242, v195, v200
v_max3_f32 v243, v243, v199, v204
v_mfma_f32_16x16x32_bf16 a[16:19], a[232:235], v[112:115], 0
ds_read_b128 a[224:227], v237 offset:16896
buffer_load_dwordx4 v249, s[4:7], s29 offen offset:3168 nt lds
v_max3_f32 v242, v242, v201, v202
v_max3_f32 v243, v243, v205, v206
v_max_f32 v242, v242, v203
v_mfma_f32_16x16x32_bf16 a[20:23], a[232:235], v[116:119], 0
v_max_f32 v243, v243, v207
v_mov_b32 v244, v242
v_mov_b32 v245, v243
v_nop
v_mfma_f32_16x16x32_bf16 a[24:27], a[236:239], v[112:115], 0
ds_read_b128 a[228:231], v237 offset:16960
v_permlane32_swap_b32 v242, v244
v_permlane32_swap_b32 v243, v245
v_mfma_f32_16x16x32_bf16 a[28:31], a[236:239], v[116:119], 0
s_waitcnt lgkmcnt(6)
v_max_f32 v242, v242, v244
v_max_f32 v243, v243, v245
v_mov_b32 v244, v242
v_mov_b32 v245, v243
v_nop
v_mfma_f32_16x16x32_bf16 a[32:35], a[240:243], v[112:115], 0
ds_read_b128 a[232:235], v237 offset:17024
v_permlane16_swap_b32 v242, v244
v_permlane16_swap_b32 v243, v245
v_mfma_f32_16x16x32_bf16 a[36:39], a[240:243], v[116:119], 0
s_add_u32 m0, s28, 33792
v_max_f32 v242, v242, v244
v_max_f32 v243, v243, v245
v_sub_f32 v224, 0, v242
v_sub_f32 v225, 0, v242
v_sub_f32 v226, 0, v242
v_mfma_f32_16x16x32_bf16 a[40:43], a[244:247], v[112:115], 0
s_mov_b32 s45, 524800
ds_read_b128 a[236:239], v237 offset:17088
v_sub_f32 v227, 0, v242
v_sub_f32 v228, 0, v243
v_sub_f32 v229, 0, v243
v_sub_f32 v230, 0, v243
v_mfma_f32_16x16x32_bf16 a[44:47], a[244:247], v[116:119], 0
s_waitcnt lgkmcnt(4)
v_sub_f32 v231, 0, v243
v_sub_f32 v192, v192, v242
v_sub_f32 v193, v193, v242
v_sub_f32 v194, v194, v242
v_sub_f32 v195, v195, v242
v_mfma_f32_16x16x32_bf16 a[48:51], a[248:251], v[112:115], 0
ds_read_b128 a[240:243], v237 offset:17152
v_sub_f32 v196, v196, v243
v_sub_f32 v197, v197, v243
v_sub_f32 v198, v198, v243
v_sub_f32 v199, v199, v243
v_mfma_f32_16x16x32_bf16 a[52:55], a[248:251], v[116:119], 0
v_sub_f32 v200, v200, v242
v_sub_f32 v201, v201, v242
v_sub_f32 v202, v202, v242
v_sub_f32 v203, v203, v242
v_sub_f32 v204, v204, v243
v_mfma_f32_16x16x32_bf16 a[56:59], a[252:255], v[112:115], 0
ds_read_b128 a[244:247], v237 offset:17216
v_sub_f32 v205, v205, v243
v_sub_f32 v206, v206, v243
v_sub_f32 v207, v207, v243
v_mfma_f32_16x16x32_bf16 a[60:63], a[252:255], v[116:119], 0
s_waitcnt lgkmcnt(4)
v_exp_f32 v192, v192
v_exp_f32 v193, v193
v_mfma_f32_16x16x32_bf16 v[208:211], a[224:227], v[128:131], v[224:227]
ds_read_b128 a[248:251], v237 offset:17280
v_exp_f32 v194, v194
v_cvt_pk_bf16_f32 v0, v192, v193
v_mfma_f32_16x16x32_bf16 v[208:211], a[228:231], v[136:139], v[208:211]
buffer_load_dwordx4 v250, s[12:15], s45 offen offset:0 lds
v_exp_f32 v195, v195
v_exp_f32 v196, v196
v_cvt_pk_bf16_f32 v1, v194, v195
v_mfma_f32_16x16x32_bf16 v[212:215], a[228:231], v[140:143], v[228:231]
ds_read_b128 a[252:255], v237 offset:17344
v_exp_f32 v197, v197
v_exp_f32 v198, v198
v_mfma_f32_16x16x32_bf16 v[212:215], a[224:227], v[132:135], v[212:215]
s_waitcnt lgkmcnt(4)
v_cvt_pk_bf16_f32 v4, v196, v197
v_exp_f32 v199, v199
v_exp_f32 v200, v200
v_mfma_f32_16x16x32_bf16 v[212:215], a[232:235], v[148:151], v[212:215]
ds_read_b128 a[224:227], v237 offset:17408
v_cvt_pk_bf16_f32 v5, v198, v199
v_exp_f32 v201, v201
v_mfma_f32_16x16x32_bf16 v[212:215], a[236:239], v[156:159], v[212:215]
v_exp_f32 v202, v202
v_cvt_pk_bf16_f32 v2, v200, v201
v_exp_f32 v203, v203
v_mfma_f32_16x16x32_bf16 v[208:211], a[236:239], v[152:155], v[208:211]
ds_read_b128 a[228:231], v237 offset:17472
v_exp_f32 v204, v204
v_cvt_pk_bf16_f32 v3, v202, v203
v_mfma_f32_16x16x32_bf16 v[208:211], a[232:235], v[144:147], v[208:211]
s_waitcnt lgkmcnt(4)
v_exp_f32 v205, v205
v_exp_f32 v206, v206
v_cvt_pk_bf16_f32 v6, v204, v205
v_mfma_f32_16x16x32_bf16 v[208:211], a[240:243], v[160:163], v[208:211]
ds_read_b128 a[232:235], v237 offset:17536
v_exp_f32 v207, v207
v_mfma_f32_16x16x32_bf16 v[208:211], a[244:247], v[168:171], v[208:211]
v_cvt_pk_bf16_f32 v7, v206, v207
v_mfma_f32_16x16x32_bf16 v[212:215], a[244:247], v[172:175], v[212:215]
ds_read_b128 a[236:239], v237 offset:17600
v_mfma_f32_16x16x32_bf16 v[212:215], a[240:243], v[164:167], v[212:215]
s_waitcnt lgkmcnt(4)
buffer_load_dwordx4 v251, s[12:15], s45 offen offset:1056 lds
v_mfma_f32_16x16x32_bf16 v[212:215], a[248:251], v[180:183], v[212:215]
ds_read_b128 a[240:243], v237 offset:17664
v_mfma_f32_16x16x32_bf16 v[212:215], a[252:255], v[188:191], v[212:215]
buffer_load_dwordx4 v252, s[12:15], s45 offen offset:2112 lds
v_mfma_f32_16x16x32_bf16 v[208:211], a[252:255], v[184:187], v[208:211]
ds_read_b128 a[244:247], v237 offset:17728
v_mfma_f32_16x16x32_bf16 v[208:211], a[248:251], v[176:179], v[208:211]
s_waitcnt lgkmcnt(4)
v_mfma_f32_16x16x32_bf16 v[216:219], a[224:227], v[128:131], v[224:227]
ds_read_b128 a[248:251], v237 offset:17792
v_mfma_f32_16x16x32_bf16 v[216:219], a[228:231], v[136:139], v[216:219]
v_mfma_f32_16x16x32_bf16 v[220:223], a[228:231], v[140:143], v[228:231]
ds_read_b128 a[252:255], v237 offset:17856
v_mfma_f32_16x16x32_bf16 v[220:223], a[224:227], v[132:135], v[220:223]
s_waitcnt lgkmcnt(4)
buffer_load_dwordx4 v253, s[12:15], s45 offen offset:3168 lds
v_mfma_f32_16x16x32_bf16 v[220:223], a[232:235], v[148:151], v[220:223]
s_add_u32 m0, s28, 50688
ds_read_b64_tr_b16 a[224:225], v240 offset:256
v_max3_f32 v242, v208, v209, v210
v_mfma_f32_16x16x32_bf16 v[220:223], a[236:239], v[156:159], v[220:223]
s_mov_b32 s29, 98304
ds_read_b64_tr_b16 a[226:227], v240 offset:768
v_max3_f32 v242, v242, v211, v212
v_mfma_f32_16x16x32_bf16 v[216:219], a[236:239], v[152:155], v[216:219]
ds_read_b64_tr_b16 a[228:229], v240 offset:288
v_max3_f32 v242, v242, v213, v214
v_mfma_f32_16x16x32_bf16 v[216:219], a[232:235], v[144:147], v[216:219]
s_waitcnt lgkmcnt(5)
ds_read_b64_tr_b16 a[230:231], v240 offset:800
v_mfma_f32_16x16x32_bf16 v[216:219], a[240:243], v[160:163], v[216:219]
ds_read_b64_tr_b16 a[232:233], v240 offset:320
buffer_load_dwordx4 v246, s[4:7], s29 offen offset:0 nt lds
v_mfma_f32_16x16x32_bf16 v[216:219], a[244:247], v[168:171], v[216:219]
ds_read_b64_tr_b16 a[234:235], v240 offset:832
v_mfma_f32_16x16x32_bf16 v[220:223], a[244:247], v[172:175], v[220:223]
ds_read_b64_tr_b16 a[236:237], v240 offset:352
v_mfma_f32_16x16x32_bf16 v[220:223], a[240:243], v[164:167], v[220:223]
s_waitcnt lgkmcnt(7)
ds_read_b64_tr_b16 a[238:239], v240 offset:864
v_mfma_f32_16x16x32_bf16 v[220:223], a[248:251], v[180:183], v[220:223]
ds_read_b64_tr_b16 a[240:241], v240 offset:384
v_mfma_f32_16x16x32_bf16 v[220:223], a[252:255], v[188:191], v[220:223]
ds_read_b64_tr_b16 a[242:243], v240 offset:896
v_mfma_f32_16x16x32_bf16 v[216:219], a[252:255], v[184:187], v[216:219]
ds_read_b64_tr_b16 a[244:245], v240 offset:416
buffer_load_dwordx4 v247, s[4:7], s29 offen offset:1056 nt lds
v_mfma_f32_16x16x32_bf16 v[216:219], a[248:251], v[176:179], v[216:219]
s_waitcnt lgkmcnt(7)
ds_read_b64_tr_b16 a[246:247], v240 offset:928
v_mfma_f32_16x16x32_bf16 a[64:67], a[224:227], v[112:115], 0
ds_read_b64_tr_b16 a[248:249], v240 offset:448
v_mfma_f32_16x16x32_bf16 a[68:71], a[224:227], v[116:119], 0
ds_read_b64_tr_b16 a[250:251], v240 offset:960
v_mfma_f32_16x16x32_bf16 a[72:75], a[228:231], v[112:115], 0
s_waitcnt lgkmcnt(6)
ds_read_b64_tr_b16 a[252:253], v240 offset:480
v_mfma_f32_16x16x32_bf16 a[76:79], a[228:231], v[116:119], 0
s_waitcnt vmcnt(14)
ds_read_b64_tr_b16 a[254:255], v240 offset:992
s_barrier
v_mfma_f32_16x16x32_bf16 a[80:83], a[232:235], v[112:115], 0
ds_read_b128 a[224:227], v237 offset:33792
v_max3_f32 v242, v242, v215, v216
v_mfma_f32_16x16x32_bf16 a[84:87], a[232:235], v[116:119], 0
v_max3_f32 v242, v242, v217, v218
v_max3_f32 v242, v242, v219, v220
v_mfma_f32_16x16x32_bf16 a[88:91], a[236:239], v[112:115], 0
ds_read_b128 a[228:231], v237 offset:33856
v_max3_f32 v242, v242, v221, v222
v_mfma_f32_16x16x32_bf16 a[92:95], a[236:239], v[116:119], 0
s_waitcnt lgkmcnt(6)
v_max_f32 v242, v242, v223
v_cmp_lt_f32 vcc, s32, v242
v_mfma_f32_16x16x32_bf16 a[96:99], a[240:243], v[112:115], 0
s_cbranch_vccnz L_rsB1
L_rbB1:
ds_read_b128 a[232:235], v237 offset:33920
buffer_load_dwordx4 v248, s[4:7], s29 offen offset:2112 nt lds
v_mfma_f32_16x16x32_bf16 a[100:103], a[240:243], v[116:119], 0
v_exp_f32 v208, v208
v_mfma_f32_16x16x32_bf16 a[104:107], a[244:247], v[112:115], 0
ds_read_b128 a[236:239], v237 offset:33984
buffer_load_dwordx4 v249, s[4:7], s29 offen offset:3168 nt lds
v_mfma_f32_16x16x32_bf16 a[108:111], a[244:247], v[116:119], 0
s_waitcnt lgkmcnt(4)
v_exp_f32 v209, v209
v_mfma_f32_16x16x32_bf16 a[112:115], a[248:251], v[112:115], 0
s_add_u32 m0, s28, 84480
ds_read_b128 a[240:243], v237 offset:34048
s_mov_b32 s29, 114688
v_mfma_f32_16x16x32_bf16 a[116:119], a[248:251], v[116:119], 0
v_exp_f32 v210, v210
v_mfma_f32_16x16x32_bf16 a[120:123], a[252:255], v[112:115], 0
ds_read_b128 a[244:247], v237 offset:34112
v_cvt_pk_bf16_f32 v8, v208, v209
v_mfma_f32_16x16x32_bf16 a[124:127], a[252:255], v[116:119], 0
s_waitcnt lgkmcnt(4)
v_exp_f32 v211, v211
v_mfma_f32_16x16x32_bf16 v[192:195], a[224:227], v[128:131], v[224:227]
ds_read_b128 a[248:251], v237 offset:34176
v_mfma_f32_16x16x32_bf16 v[192:195], a[228:231], v[136:139], v[192:195]
v_exp_f32 v212, v212
v_mfma_f32_16x16x32_bf16 v[196:199], a[228:231], v[140:143], v[228:231]
ds_read_b128 a[252:255], v237 offset:34240
v_cvt_pk_bf16_f32 v9, v210, v211
v_mfma_f32_16x16x32_bf16 v[196:199], a[224:227], v[132:135], v[196:199]
s_waitcnt lgkmcnt(4)
v_exp_f32 v213, v213
v_mfma_f32_16x16x32_bf16 v[196:199], a[232:235], v[148:151], v[196:199]
ds_read_b128 a[224:227], v237 offset:34304
buffer_load_dwordx4 v246, s[4:7], s29 offen offset:0 nt lds
v_mfma_f32_16x16x32_bf16 v[196:199], a[236:239], v[156:159], v[196:199]
v_exp_f32 v214, v214
v_mfma_f32_16x16x32_bf16 v[192:195], a[236:239], v[152:155], v[192:195]
ds_read_b128 a[228:231], v237 offset:34368
v_cvt_pk_bf16_f32 v12, v212, v213
v_mfma_f32_16x16x32_bf16 v[192:195], a[232:235], v[144:147], v[192:195]
s_waitcnt lgkmcnt(4)
v_exp_f32 v215, v215
v_mfma_f32_16x16x32_bf16 v[192:195], a[240:243], v[160:163], v[192:195]
ds_read_b128 a[232:235], v237 offset:34432
v_mfma_f32_16x16x32_bf16 v[192:195], a[244:247], v[168:171], v[192:195]
v_exp_f32 v216, v216
v_mfma_f32_16x16x32_bf16 v[196:199], a[244:247], v[172:175], v[196:199]
ds_read_b128 a[236:239], v237 offset:34496
v_cvt_pk_bf16_f32 v13, v214, v215
v_mfma_f32_16x16x32_bf16 v[196:199], a[240:243], v[164:167], v[196:199]
s_waitcnt lgkmcnt(4)
v_exp_f32 v217, v217
v_mfma_f32_16x16x32_bf16 v[196:199], a[248:251], v[180:183], v[196:199]
ds_read_b128 a[240:243], v237 offset:34560
buffer_load_dwordx4 v247, s[4:7], s29 offen offset:1056 nt lds
v_mfma_f32_16x16x32_bf16 v[196:199], a[252:255], v[188:191], v[196:199]
v_exp_f32 v218, v218
v_cvt_pk_bf16_f32 v10, v216, v217
v_mfma_f32_16x16x32_bf16 v[192:195], a[252:255], v[184:187], v[192:195]
ds_read_b128 a[244:247], v237 offset:34624
v_exp_f32 v219, v219
v_mfma_f32_16x16x32_bf16 v[192:195], a[248:251], v[176:179], v[192:195]
s_waitcnt lgkmcnt(4)
v_exp_f32 v220, v220
v_cvt_pk_bf16_f32 v11, v218, v219
v_mfma_f32_16x16x32_bf16 v[200:203], a[224:227], v[128:131], v[224:227]
ds_read_b128 a[248:251], v237 offset:34688
v_exp_f32 v221, v221
v_mfma_f32_16x16x32_bf16 v[200:203], a[228:231], v[136:139], v[200:203]
v_exp_f32 v222, v222
v_cvt_pk_bf16_f32 v14, v220, v221
v_mfma_f32_16x16x32_bf16 v[204:207], a[228:231], v[140:143], v[228:231]
ds_read_b128 a[252:255], v237 offset:34752
v_exp_f32 v223, v223
v_mfma_f32_16x16x32_bf16 v[204:207], a[224:227], v[132:135], v[204:207]
s_waitcnt lgkmcnt(4)
v_cvt_pk_bf16_f32 v15, v222, v223
v_mfma_f32_16x16x32_bf16 v[204:207], a[232:235], v[148:151], v[204:207]
ds_read_b64_tr_b16 a[224:225], v241 offset:0
v_max3_f32 v242, v192, v193, v194
v_mfma_f32_16x16x32_bf16 v[204:207], a[236:239], v[156:159], v[204:207]
ds_read_b64_tr_b16 a[226:227], v241 offset:512
v_max3_f32 v242, v242, v195, v196
v_mfma_f32_16x16x32_bf16 v[200:203], a[236:239], v[152:155], v[200:203]
ds_read_b64_tr_b16 a[228:229], v241 offset:32
v_max3_f32 v242, v242, v197, v198
v_mfma_f32_16x16x32_bf16 v[200:203], a[232:235], v[144:147], v[200:203]
s_waitcnt lgkmcnt(5)
ds_read_b64_tr_b16 a[230:231], v241 offset:544
v_mfma_f32_16x16x32_bf16 v[200:203], a[240:243], v[160:163], v[200:203]
ds_read_b64_tr_b16 a[232:233], v241 offset:64
buffer_load_dwordx4 v248, s[4:7], s29 offen offset:2112 nt lds
v_mfma_f32_16x16x32_bf16 v[200:203], a[244:247], v[168:171], v[200:203]
ds_read_b64_tr_b16 a[234:235], v241 offset:576
v_mfma_f32_16x16x32_bf16 v[204:207], a[244:247], v[172:175], v[204:207]
ds_read_b64_tr_b16 a[236:237], v241 offset:96
v_mfma_f32_16x16x32_bf16 v[204:207], a[240:243], v[164:167], v[204:207]
s_waitcnt lgkmcnt(7)
ds_read_b64_tr_b16 a[238:239], v241 offset:608
v_mfma_f32_16x16x32_bf16 v[204:207], a[248:251], v[180:183], v[204:207]
ds_read_b64_tr_b16 a[240:241], v241 offset:128
v_mfma_f32_16x16x32_bf16 v[204:207], a[252:255], v[188:191], v[204:207]
ds_read_b64_tr_b16 a[242:243], v241 offset:640
v_mfma_f32_16x16x32_bf16 v[200:203], a[252:255], v[184:187], v[200:203]
ds_read_b64_tr_b16 a[244:245], v241 offset:160
v_mfma_f32_16x16x32_bf16 v[200:203], a[248:251], v[176:179], v[200:203]
s_waitcnt lgkmcnt(7)
ds_read_b64_tr_b16 a[246:247], v241 offset:672
v_mfma_f32_16x16x32_bf16 a[0:3], a[224:227], v[120:123], a[0:3]
ds_read_b64_tr_b16 a[248:249], v241 offset:192
v_mfma_f32_16x16x32_bf16 a[4:7], a[224:227], v[124:127], a[4:7]
ds_read_b64_tr_b16 a[250:251], v241 offset:704
v_mfma_f32_16x16x32_bf16 a[8:11], a[228:231], v[120:123], a[8:11]
s_waitcnt lgkmcnt(6)
ds_read_b64_tr_b16 a[252:253], v241 offset:224
v_mfma_f32_16x16x32_bf16 a[12:15], a[228:231], v[124:127], a[12:15]
s_waitcnt vmcnt(19)
ds_read_b64_tr_b16 a[254:255], v241 offset:736
s_barrier
v_mfma_f32_16x16x32_bf16 a[16:19], a[232:235], v[120:123], a[16:19]
ds_read_b128 a[224:227], v237 offset:50688
v_max3_f32 v242, v242, v199, v200
v_mfma_f32_16x16x32_bf16 a[20:23], a[232:235], v[124:127], a[20:23]
v_max3_f32 v242, v242, v201, v202
v_max3_f32 v242, v242, v203, v204
v_mfma_f32_16x16x32_bf16 a[24:27], a[236:239], v[120:123], a[24:27]
ds_read_b128 a[228:231], v237 offset:50752
v_max3_f32 v242, v242, v205, v206
v_mfma_f32_16x16x32_bf16 a[28:31], a[236:239], v[124:127], a[28:31]
s_waitcnt lgkmcnt(6)
v_max_f32 v242, v242, v207
v_cmp_lt_f32 vcc, s32, v242
v_mfma_f32_16x16x32_bf16 a[32:35], a[240:243], v[120:123], a[32:35]
s_cbranch_vccnz L_rsB2
L_rbB2:
ds_read_b128 a[232:235], v237 offset:50816
buffer_load_dwordx4 v249, s[4:7], s29 offen offset:3168 nt lds
v_mfma_f32_16x16x32_bf16 a[36:39], a[240:243], v[124:127], a[36:39]
v_exp_f32 v192, v192
v_mfma_f32_16x16x32_bf16 a[40:43], a[244:247], v[120:123], a[40:43]
ds_read_b128 a[236:239], v237 offset:50880
v_mfma_f32_16x16x32_bf16 a[44:47], a[244:247], v[124:127], a[44:47]
s_waitcnt lgkmcnt(4)
v_exp_f32 v193, v193
v_mfma_f32_16x16x32_bf16 a[48:51], a[248:251], v[120:123], a[48:51]
s_add_u32 m0, s28, 67584
ds_read_b128 a[240:243], v237 offset:50944
s_mov_b32 s45, 786944
v_mfma_f32_16x16x32_bf16 a[52:55], a[248:251], v[124:127], a[52:55]
v_exp_f32 v194, v194
v_mfma_f32_16x16x32_bf16 a[56:59], a[252:255], v[120:123], a[56:59]
ds_read_b128 a[244:247], v237 offset:51008
v_cvt_pk_bf16_f32 v16, v192, v193
v_mfma_f32_16x16x32_bf16 a[60:63], a[252:255], v[124:127], a[60:63]
s_waitcnt lgkmcnt(4)
v_exp_f32 v195, v195
v_mfma_f32_16x16x32_bf16 v[208:211], a[224:227], v[128:131], v[224:227]
ds_read_b128 a[248:251], v237 offset:51072
v_mfma_f32_16x16x32_bf16 v[208:211], a[228:231], v[136:139], v[208:211]
v_exp_f32 v196, v196
v_mfma_f32_16x16x32_bf16 v[212:215], a[228:231], v[140:143], v[228:231]
ds_read_b128 a[252:255], v237 offset:51136
v_cvt_pk_bf16_f32 v17, v194, v195
v_mfma_f32_16x16x32_bf16 v[212:215], a[224:227], v[132:135], v[212:215]
s_waitcnt lgkmcnt(4)
v_exp_f32 v197, v197
v_mfma_f32_16x16x32_bf16 v[212:215], a[232:235], v[148:151], v[212:215]
ds_read_b128 a[224:227], v237 offset:51200
buffer_load_dwordx4 v250, s[12:15], s45 offen offset:0 lds
v_mfma_f32_16x16x32_bf16 v[212:215], a[236:239], v[156:159], v[212:215]
v_exp_f32 v198, v198
v_mfma_f32_16x16x32_bf16 v[208:211], a[236:239], v[152:155], v[208:211]
ds_read_b128 a[228:231], v237 offset:51264
v_cvt_pk_bf16_f32 v20, v196, v197
v_mfma_f32_16x16x32_bf16 v[208:211], a[232:235], v[144:147], v[208:211]
s_waitcnt lgkmcnt(4)
v_exp_f32 v199, v199
v_mfma_f32_16x16x32_bf16 v[208:211], a[240:243], v[160:163], v[208:211]
ds_read_b128 a[232:235], v237 offset:51328
buffer_load_dwordx4 v251, s[12:15], s45 offen offset:1056 lds
v_mfma_f32_16x16x32_bf16 v[208:211], a[244:247], v[168:171], v[208:211]
v_exp_f32 v200, v200
v_mfma_f32_16x16x32_bf16 v[212:215], a[244:247], v[172:175], v[212:215]
ds_read_b128 a[236:239], v237 offset:51392
v_cvt_pk_bf16_f32 v21, v198, v199
v_mfma_f32_16x16x32_bf16 v[212:215], a[240:243], v[164:167], v[212:215]
s_waitcnt lgkmcnt(4)
v_exp_f32 v201, v201
v_mfma_f32_16x16x32_bf16 v[212:215], a[248:251], v[180:183], v[212:215]
ds_read_b128 a[240:243], v237 offset:51456
buffer_load_dwordx4 v252, s[12:15], s45 offen offset:2112 lds
v_mfma_f32_16x16x32_bf16 v[212:215], a[252:255], v[188:191], v[212:215]
v_exp_f32 v202, v202
v_cvt_pk_bf16_f32 v18, v200, v201
v_mfma_f32_16x16x32_bf16 v[208:211], a[252:255], v[184:187], v[208:211]
ds_read_b128 a[244:247], v237 offset:51520
v_exp_f32 v203, v203
v_mfma_f32_16x16x32_bf16 v[208:211], a[248:251], v[176:179], v[208:211]
s_waitcnt lgkmcnt(4)
v_exp_f32 v204, v204
v_cvt_pk_bf16_f32 v19, v202, v203
v_mfma_f32_16x16x32_bf16 v[216:219], a[224:227], v[128:131], v[224:227]
ds_read_b128 a[248:251], v237 offset:51584
v_exp_f32 v205, v205
v_mfma_f32_16x16x32_bf16 v[216:219], a[228:231], v[136:139], v[216:219]
v_exp_f32 v206, v206
v_cvt_pk_bf16_f32 v22, v204, v205
v_mfma_f32_16x16x32_bf16 v[220:223], a[228:231], v[140:143], v[228:231]
ds_read_b128 a[252:255], v237 offset:51648
v_exp_f32 v207, v207
v_mfma_f32_16x16x32_bf16 v[220:223], a[224:227], v[132:135], v[220:223]
s_waitcnt lgkmcnt(4)
buffer_load_dwordx4 v253, s[12:15], s45 offen offset:3168 lds
v_cvt_pk_bf16_f32 v23, v206, v207
v_mfma_f32_16x16x32_bf16 v[220:223], a[232:235], v[148:151], v[220:223]
s_add_u32 m0, s28, 101376
ds_read_b64_tr_b16 a[224:225], v241 offset:256
v_max3_f32 v242, v208, v209, v210
v_mfma_f32_16x16x32_bf16 v[220:223], a[236:239], v[156:159], v[220:223]
s_mov_b32 s29, 131072
ds_read_b64_tr_b16 a[226:227], v241 offset:768
v_max3_f32 v242, v242, v211, v212
v_mfma_f32_16x16x32_bf16 v[216:219], a[236:239], v[152:155], v[216:219]
ds_read_b64_tr_b16 a[228:229], v241 offset:288
v_max3_f32 v242, v242, v213, v214
v_mfma_f32_16x16x32_bf16 v[216:219], a[232:235], v[144:147], v[216:219]
s_waitcnt lgkmcnt(5)
ds_read_b64_tr_b16 a[230:231], v241 offset:800
v_mfma_f32_16x16x32_bf16 v[216:219], a[240:243], v[160:163], v[216:219]
ds_read_b64_tr_b16 a[232:233], v241 offset:320
buffer_load_dwordx4 v246, s[4:7], s29 offen offset:0 nt lds
v_mfma_f32_16x16x32_bf16 v[216:219], a[244:247], v[168:171], v[216:219]
ds_read_b64_tr_b16 a[234:235], v241 offset:832
v_mfma_f32_16x16x32_bf16 v[220:223], a[244:247], v[172:175], v[220:223]
ds_read_b64_tr_b16 a[236:237], v241 offset:352
v_mfma_f32_16x16x32_bf16 v[220:223], a[240:243], v[164:167], v[220:223]
s_waitcnt lgkmcnt(7)
ds_read_b64_tr_b16 a[238:239], v241 offset:864
v_mfma_f32_16x16x32_bf16 v[220:223], a[248:251], v[180:183], v[220:223]
ds_read_b64_tr_b16 a[240:241], v241 offset:384
v_mfma_f32_16x16x32_bf16 v[220:223], a[252:255], v[188:191], v[220:223]
ds_read_b64_tr_b16 a[242:243], v241 offset:896
v_mfma_f32_16x16x32_bf16 v[216:219], a[252:255], v[184:187], v[216:219]
ds_read_b64_tr_b16 a[244:245], v241 offset:416
buffer_load_dwordx4 v247, s[4:7], s29 offen offset:1056 nt lds
v_mfma_f32_16x16x32_bf16 v[216:219], a[248:251], v[176:179], v[216:219]
s_waitcnt lgkmcnt(7)
ds_read_b64_tr_b16 a[246:247], v241 offset:928
v_mfma_f32_16x16x32_bf16 a[64:67], a[224:227], v[120:123], a[64:67]
ds_read_b64_tr_b16 a[248:249], v241 offset:448
v_mfma_f32_16x16x32_bf16 a[68:71], a[224:227], v[124:127], a[68:71]
ds_read_b64_tr_b16 a[250:251], v241 offset:960
v_mfma_f32_16x16x32_bf16 a[72:75], a[228:231], v[120:123], a[72:75]
s_waitcnt lgkmcnt(6)
ds_read_b64_tr_b16 a[252:253], v241 offset:480
v_mfma_f32_16x16x32_bf16 a[76:79], a[228:231], v[124:127], a[76:79]
s_waitcnt vmcnt(14)
ds_read_b64_tr_b16 a[254:255], v241 offset:992
s_barrier
v_mfma_f32_16x16x32_bf16 a[80:83], a[232:235], v[120:123], a[80:83]
ds_read_b128 a[224:227], v236 offset:16896
v_max3_f32 v242, v242, v215, v216
v_mfma_f32_16x16x32_bf16 a[84:87], a[232:235], v[124:127], a[84:87]
v_max3_f32 v242, v242, v217, v218
v_max3_f32 v242, v242, v219, v220
v_mfma_f32_16x16x32_bf16 a[88:91], a[236:239], v[120:123], a[88:91]
ds_read_b128 a[228:231], v236 offset:16960
v_max3_f32 v242, v242, v221, v222
v_mfma_f32_16x16x32_bf16 a[92:95], a[236:239], v[124:127], a[92:95]
s_waitcnt lgkmcnt(6)
v_max_f32 v242, v242, v223
v_cmp_lt_f32 vcc, s32, v242
v_mfma_f32_16x16x32_bf16 a[96:99], a[240:243], v[120:123], a[96:99]
s_cbranch_vccnz L_rsB3
L_rbB3:
ds_read_b128 a[232:235], v236 offset:17024
buffer_load_dwordx4 v248, s[4:7], s29 offen offset:2112 nt lds
v_mfma_f32_16x16x32_bf16 a[100:103], a[240:243], v[124:127], a[100:103]
v_exp_f32 v208, v208
v_mfma_f32_16x16x32_bf16 a[104:107], a[244:247], v[120:123], a[104:107]
ds_read_b128 a[236:239], v236 offset:17088
buffer_load_dwordx4 v249, s[4:7], s29 offen offset:3168 nt lds
v_mfma_f32_16x16x32_bf16 a[108:111], a[244:247], v[124:127], a[108:111]
s_waitcnt lgkmcnt(4)
v_exp_f32 v209, v209
v_mfma_f32_16x16x32_bf16 a[112:115], a[248:251], v[120:123], a[112:115]
s_add_u32 m0, s28, 118272
ds_read_b128 a[240:243], v236 offset:17152
s_mov_b32 s29, 147456
v_mfma_f32_16x16x32_bf16 a[116:119], a[248:251], v[124:127], a[116:119]
v_exp_f32 v210, v210
v_mfma_f32_16x16x32_bf16 a[120:123], a[252:255], v[120:123], a[120:123]
ds_read_b128 a[244:247], v236 offset:17216
v_cvt_pk_bf16_f32 v24, v208, v209
v_mfma_f32_16x16x32_bf16 a[124:127], a[252:255], v[124:127], a[124:127]
s_waitcnt lgkmcnt(4)
v_exp_f32 v211, v211
v_mfma_f32_16x16x32_bf16 v[192:195], a[224:227], v[128:131], v[224:227]
ds_read_b128 a[248:251], v236 offset:17280
v_mfma_f32_16x16x32_bf16 v[192:195], a[228:231], v[136:139], v[192:195]
v_exp_f32 v212, v212
v_mfma_f32_16x16x32_bf16 v[196:199], a[228:231], v[140:143], v[228:231]
ds_read_b128 a[252:255], v236 offset:17344
v_cvt_pk_bf16_f32 v25, v210, v211
v_mfma_f32_16x16x32_bf16 v[196:199], a[224:227], v[132:135], v[196:199]
s_waitcnt lgkmcnt(4)
v_exp_f32 v213, v213
v_mfma_f32_16x16x32_bf16 v[196:199], a[232:235], v[148:151], v[196:199]
ds_read_b128 a[224:227], v236 offset:17408
buffer_load_dwordx4 v246, s[4:7], s29 offen offset:0 nt lds
v_mfma_f32_16x16x32_bf16 v[196:199], a[236:239], v[156:159], v[196:199]
v_exp_f32 v214, v214
v_mfma_f32_16x16x32_bf16 v[192:195], a[236:239], v[152:155], v[192:195]
ds_read_b128 a[228:231], v236 offset:17472
v_cvt_pk_bf16_f32 v28, v212, v213
v_mfma_f32_16x16x32_bf16 v[192:195], a[232:235], v[144:147], v[192:195]
s_waitcnt lgkmcnt(4)
v_exp_f32 v215, v215
v_mfma_f32_16x16x32_bf16 v[192:195], a[240:243], v[160:163], v[192:195]
ds_read_b128 a[232:235], v236 offset:17536
v_mfma_f32_16x16x32_bf16 v[192:195], a[244:247], v[168:171], v[192:195]
v_exp_f32 v216, v216
v_mfma_f32_16x16x32_bf16 v[196:199], a[244:247], v[172:175], v[196:199]
ds_read_b128 a[236:239], v236 offset:17600
v_cvt_pk_bf16_f32 v29, v214, v215
v_mfma_f32_16x16x32_bf16 v[196:199], a[240:243], v[164:167], v[196:199]
s_waitcnt lgkmcnt(4)
v_exp_f32 v217, v217
v_mfma_f32_16x16x32_bf16 v[196:199], a[248:251], v[180:183], v[196:199]
ds_read_b128 a[240:243], v236 offset:17664
buffer_load_dwordx4 v247, s[4:7], s29 offen offset:1056 nt lds
v_mfma_f32_16x16x32_bf16 v[196:199], a[252:255], v[188:191], v[196:199]
v_exp_f32 v218, v218
v_cvt_pk_bf16_f32 v26, v216, v217
v_mfma_f32_16x16x32_bf16 v[192:195], a[252:255], v[184:187], v[192:195]
ds_read_b128 a[244:247], v236 offset:17728
v_exp_f32 v219, v219
v_mfma_f32_16x16x32_bf16 v[192:195], a[248:251], v[176:179], v[192:195]
s_waitcnt lgkmcnt(4)
v_exp_f32 v220, v220
v_cvt_pk_bf16_f32 v27, v218, v219
v_mfma_f32_16x16x32_bf16 v[200:203], a[224:227], v[128:131], v[224:227]
ds_read_b128 a[248:251], v236 offset:17792
v_exp_f32 v221, v221
v_mfma_f32_16x16x32_bf16 v[200:203], a[228:231], v[136:139], v[200:203]
v_exp_f32 v222, v222
v_cvt_pk_bf16_f32 v30, v220, v221
v_mfma_f32_16x16x32_bf16 v[204:207], a[228:231], v[140:143], v[228:231]
ds_read_b128 a[252:255], v236 offset:17856
v_exp_f32 v223, v223
v_mfma_f32_16x16x32_bf16 v[204:207], a[224:227], v[132:135], v[204:207]
s_waitcnt lgkmcnt(4)
v_cvt_pk_bf16_f32 v31, v222, v223
v_mfma_f32_16x16x32_bf16 v[204:207], a[232:235], v[148:151], v[204:207]
ds_read_b64_tr_b16 a[224:225], v239 offset:33792
v_max3_f32 v242, v192, v193, v194
v_mfma_f32_16x16x32_bf16 v[204:207], a[236:239], v[156:159], v[204:207]
ds_read_b64_tr_b16 a[226:227], v239 offset:34304
v_max3_f32 v242, v242, v195, v196
v_mfma_f32_16x16x32_bf16 v[200:203], a[236:239], v[152:155], v[200:203]
ds_read_b64_tr_b16 a[228:229], v239 offset:33824
v_max3_f32 v242, v242, v197, v198
v_mfma_f32_16x16x32_bf16 v[200:203], a[232:235], v[144:147], v[200:203]
s_waitcnt lgkmcnt(5)
ds_read_b64_tr_b16 a[230:231], v239 offset:34336
v_mfma_f32_16x16x32_bf16 v[200:203], a[240:243], v[160:163], v[200:203]
ds_read_b64_tr_b16 a[232:233], v239 offset:33856
buffer_load_dwordx4 v248, s[4:7], s29 offen offset:2112 nt lds
v_mfma_f32_16x16x32_bf16 v[200:203], a[244:247], v[168:171], v[200:203]
ds_read_b64_tr_b16 a[234:235], v239 offset:34368
v_mfma_f32_16x16x32_bf16 v[204:207], a[244:247], v[172:175], v[204:207]
ds_read_b64_tr_b16 a[236:237], v239 offset:33888
v_mfma_f32_16x16x32_bf16 v[204:207], a[240:243], v[164:167], v[204:207]
s_waitcnt lgkmcnt(7)
ds_read_b64_tr_b16 a[238:239], v239 offset:34400
v_mfma_f32_16x16x32_bf16 v[204:207], a[248:251], v[180:183], v[204:207]
ds_read_b64_tr_b16 a[240:241], v239 offset:33920
v_mfma_f32_16x16x32_bf16 v[204:207], a[252:255], v[188:191], v[204:207]
ds_read_b64_tr_b16 a[242:243], v239 offset:34432
v_mfma_f32_16x16x32_bf16 v[200:203], a[252:255], v[184:187], v[200:203]
ds_read_b64_tr_b16 a[244:245], v239 offset:33952
v_mfma_f32_16x16x32_bf16 v[200:203], a[248:251], v[176:179], v[200:203]
s_waitcnt lgkmcnt(7)
ds_read_b64_tr_b16 a[246:247], v239 offset:34464
v_mfma_f32_16x16x32_bf16 a[0:3], a[224:227], a[128:131], a[0:3]
ds_read_b64_tr_b16 a[248:249], v239 offset:33984
v_mfma_f32_16x16x32_bf16 a[4:7], a[224:227], a[132:135], a[4:7]
ds_read_b64_tr_b16 a[250:251], v239 offset:34496
v_mfma_f32_16x16x32_bf16 a[8:11], a[228:231], a[128:131], a[8:11]
s_waitcnt lgkmcnt(6)
ds_read_b64_tr_b16 a[252:253], v239 offset:34016
v_mfma_f32_16x16x32_bf16 a[12:15], a[228:231], a[132:135], a[12:15]
s_waitcnt vmcnt(19)
ds_read_b64_tr_b16 a[254:255], v239 offset:34528
s_barrier
v_mfma_f32_16x16x32_bf16 a[16:19], a[232:235], a[128:131], a[16:19]
ds_read_b128 a[224:227], v236 offset:0
v_max3_f32 v242, v242, v199, v200
v_mfma_f32_16x16x32_bf16 a[20:23], a[232:235], a[132:135], a[20:23]
v_max3_f32 v242, v242, v201, v202
v_max3_f32 v242, v242, v203, v204
v_mfma_f32_16x16x32_bf16 a[24:27], a[236:239], a[128:131], a[24:27]
ds_read_b128 a[228:231], v236 offset:64
v_max3_f32 v242, v242, v205, v206
v_mfma_f32_16x16x32_bf16 a[28:31], a[236:239], a[132:135], a[28:31]
s_waitcnt lgkmcnt(6)
v_max_f32 v242, v242, v207
v_cmp_lt_f32 vcc, s32, v242
v_mfma_f32_16x16x32_bf16 a[32:35], a[240:243], a[128:131], a[32:35]
s_cbranch_vccnz L_rsB4
L_rbB4:
ds_read_b128 a[232:235], v236 offset:128
buffer_load_dwordx4 v249, s[4:7], s29 offen offset:3168 nt lds
v_mfma_f32_16x16x32_bf16 a[36:39], a[240:243], a[132:135], a[36:39]
v_exp_f32 v192, v192
v_mfma_f32_16x16x32_bf16 a[40:43], a[244:247], a[128:131], a[40:43]
ds_read_b128 a[236:239], v236 offset:192
v_mfma_f32_16x16x32_bf16 a[44:47], a[244:247], a[132:135], a[44:47]
s_waitcnt lgkmcnt(4)
v_exp_f32 v193, v193
v_mfma_f32_16x16x32_bf16 a[48:51], a[248:251], a[128:131], a[48:51]
s_add_u32 m0, s28, 135168
ds_read_b128 a[240:243], v236 offset:256
s_mov_b32 s45, 1049088
v_mfma_f32_16x16x32_bf16 a[52:55], a[248:251], a[132:135], a[52:55]
v_exp_f32 v194, v194
v_mfma_f32_16x16x32_bf16 a[56:59], a[252:255], a[128:131], a[56:59]
ds_read_b128 a[244:247], v236 offset:320
v_cvt_pk_bf16_f32 v32, v192, v193
v_mfma_f32_16x16x32_bf16 a[60:63], a[252:255], a[132:135], a[60:63]
s_waitcnt lgkmcnt(4)
v_exp_f32 v195, v195
v_mfma_f32_16x16x32_bf16 v[208:211], a[224:227], v[128:131], v[224:227]
ds_read_b128 a[248:251], v236 offset:384
v_mfma_f32_16x16x32_bf16 v[208:211], a[228:231], v[136:139], v[208:211]
v_exp_f32 v196, v196
v_mfma_f32_16x16x32_bf16 v[212:215], a[228:231], v[140:143], v[228:231]
ds_read_b128 a[252:255], v236 offset:448
v_cvt_pk_bf16_f32 v33, v194, v195
v_mfma_f32_16x16x32_bf16 v[212:215], a[224:227], v[132:135], v[212:215]
s_waitcnt lgkmcnt(4)
v_exp_f32 v197, v197
v_mfma_f32_16x16x32_bf16 v[212:215], a[232:235], v[148:151], v[212:215]
ds_read_b128 a[224:227], v236 offset:512
buffer_load_dwordx4 v250, s[12:15], s45 offen offset:0 lds
v_mfma_f32_16x16x32_bf16 v[212:215], a[236:239], v[156:159], v[212:215]
v_exp_f32 v198, v198
v_mfma_f32_16x16x32_bf16 v[208:211], a[236:239], v[152:155], v[208:211]
ds_read_b128 a[228:231], v236 offset:576
v_cvt_pk_bf16_f32 v36, v196, v197
v_mfma_f32_16x16x32_bf16 v[208:211], a[232:235], v[144:147], v[208:211]
s_waitcnt lgkmcnt(4)
v_exp_f32 v199, v199
v_mfma_f32_16x16x32_bf16 v[208:211], a[240:243], v[160:163], v[208:211]
ds_read_b128 a[232:235], v236 offset:640
buffer_load_dwordx4 v251, s[12:15], s45 offen offset:1056 lds
v_mfma_f32_16x16x32_bf16 v[208:211], a[244:247], v[168:171], v[208:211]
v_exp_f32 v200, v200
v_mfma_f32_16x16x32_bf16 v[212:215], a[244:247], v[172:175], v[212:215]
ds_read_b128 a[236:239], v236 offset:704
v_cvt_pk_bf16_f32 v37, v198, v199
v_mfma_f32_16x16x32_bf16 v[212:215], a[240:243], v[164:167], v[212:215]
s_waitcnt lgkmcnt(4)
v_exp_f32 v201, v201
v_mfma_f32_16x16x32_bf16 v[212:215], a[248:251], v[180:183], v[212:215]
ds_read_b128 a[240:243], v236 offset:768
buffer_load_dwordx4 v252, s[12:15], s45 offen offset:2112 lds
v_mfma_f32_16x16x32_bf16 v[212:215], a[252:255], v[188:191], v[212:215]
v_exp_f32 v202, v202
v_cvt_pk_bf16_f32 v34, v200, v201
v_mfma_f32_16x16x32_bf16 v[208:211], a[252:255], v[184:187], v[208:211]
ds_read_b128 a[244:247], v236 offset:832
v_exp_f32 v203, v203
v_mfma_f32_16x16x32_bf16 v[208:211], a[248:251], v[176:179], v[208:211]
s_waitcnt lgkmcnt(4)
v_exp_f32 v204, v204
v_cvt_pk_bf16_f32 v35, v202, v203
v_mfma_f32_16x16x32_bf16 v[216:219], a[224:227], v[128:131], v[224:227]
ds_read_b128 a[248:251], v236 offset:896
v_exp_f32 v205, v205
v_mfma_f32_16x16x32_bf16 v[216:219], a[228:231], v[136:139], v[216:219]
v_exp_f32 v206, v206
v_cvt_pk_bf16_f32 v38, v204, v205
v_mfma_f32_16x16x32_bf16 v[220:223], a[228:231], v[140:143], v[228:231]
ds_read_b128 a[252:255], v236 offset:960
v_exp_f32 v207, v207
v_mfma_f32_16x16x32_bf16 v[220:223], a[224:227], v[132:135], v[220:223]
s_waitcnt lgkmcnt(4)
buffer_load_dwordx4 v253, s[12:15], s45 offen offset:3168 lds
v_cvt_pk_bf16_f32 v39, v206, v207
v_mfma_f32_16x16x32_bf16 v[220:223], a[232:235], v[148:151], v[220:223]
s_add_u32 m0, s28, 16896
ds_read_b64_tr_b16 a[224:225], v239 offset:34048
v_max3_f32 v242, v208, v209, v210
v_mfma_f32_16x16x32_bf16 v[220:223], a[236:239], v[156:159], v[220:223]
s_mov_b32 s29, 163840
ds_read_b64_tr_b16 a[226:227], v239 offset:34560
v_max3_f32 v242, v242, v211, v212
v_mfma_f32_16x16x32_bf16 v[216:219], a[236:239], v[152:155], v[216:219]
ds_read_b64_tr_b16 a[228:229], v239 offset:34080
v_max3_f32 v242, v242, v213, v214
v_mfma_f32_16x16x32_bf16 v[216:219], a[232:235], v[144:147], v[216:219]
s_waitcnt lgkmcnt(5)
ds_read_b64_tr_b16 a[230:231], v239 offset:34592
v_mfma_f32_16x16x32_bf16 v[216:219], a[240:243], v[160:163], v[216:219]
ds_read_b64_tr_b16 a[232:233], v239 offset:34112
buffer_load_dwordx4 v246, s[4:7], s29 offen offset:0 nt lds
v_mfma_f32_16x16x32_bf16 v[216:219], a[244:247], v[168:171], v[216:219]
ds_read_b64_tr_b16 a[234:235], v239 offset:34624
v_mfma_f32_16x16x32_bf16 v[220:223], a[244:247], v[172:175], v[220:223]
ds_read_b64_tr_b16 a[236:237], v239 offset:34144
v_mfma_f32_16x16x32_bf16 v[220:223], a[240:243], v[164:167], v[220:223]
s_waitcnt lgkmcnt(7)
ds_read_b64_tr_b16 a[238:239], v239 offset:34656
v_mfma_f32_16x16x32_bf16 v[220:223], a[248:251], v[180:183], v[220:223]
ds_read_b64_tr_b16 a[240:241], v239 offset:34176
v_mfma_f32_16x16x32_bf16 v[220:223], a[252:255], v[188:191], v[220:223]
ds_read_b64_tr_b16 a[242:243], v239 offset:34688
v_mfma_f32_16x16x32_bf16 v[216:219], a[252:255], v[184:187], v[216:219]
ds_read_b64_tr_b16 a[244:245], v239 offset:34208
buffer_load_dwordx4 v247, s[4:7], s29 offen offset:1056 nt lds
v_mfma_f32_16x16x32_bf16 v[216:219], a[248:251], v[176:179], v[216:219]
s_waitcnt lgkmcnt(7)
ds_read_b64_tr_b16 a[246:247], v239 offset:34720
v_mfma_f32_16x16x32_bf16 a[64:67], a[224:227], a[128:131], a[64:67]
ds_read_b64_tr_b16 a[248:249], v239 offset:34240
v_mfma_f32_16x16x32_bf16 a[68:71], a[224:227], a[132:135], a[68:71]
ds_read_b64_tr_b16 a[250:251], v239 offset:34752
v_mfma_f32_16x16x32_bf16 a[72:75], a[228:231], a[128:131], a[72:75]
s_waitcnt lgkmcnt(6)
ds_read_b64_tr_b16 a[252:253], v239 offset:34272
v_mfma_f32_16x16x32_bf16 a[76:79], a[228:231], a[132:135], a[76:79]
s_waitcnt vmcnt(14)
ds_read_b64_tr_b16 a[254:255], v239 offset:34784
s_barrier
v_mfma_f32_16x16x32_bf16 a[80:83], a[232:235], a[128:131], a[80:83]
ds_read_b128 a[224:227], v236 offset:50688
v_max3_f32 v242, v242, v215, v216
v_mfma_f32_16x16x32_bf16 a[84:87], a[232:235], a[132:135], a[84:87]
v_max3_f32 v242, v242, v217, v218
v_max3_f32 v242, v242, v219, v220
v_mfma_f32_16x16x32_bf16 a[88:91], a[236:239], a[128:131], a[88:91]
ds_read_b128 a[228:231], v236 offset:50752
v_max3_f32 v242, v242, v221, v222
v_mfma_f32_16x16x32_bf16 a[92:95], a[236:239], a[132:135], a[92:95]
s_waitcnt lgkmcnt(6)
v_max_f32 v242, v242, v223
v_cmp_lt_f32 vcc, s32, v242
v_mfma_f32_16x16x32_bf16 a[96:99], a[240:243], a[128:131], a[96:99]
s_cbranch_vccnz L_rsB5
L_rbB5:
ds_read_b128 a[232:235], v236 offset:50816
buffer_load_dwordx4 v248, s[4:7], s29 offen offset:2112 nt lds
v_mfma_f32_16x16x32_bf16 a[100:103], a[240:243], a[132:135], a[100:103]
v_exp_f32 v208, v208
v_mfma_f32_16x16x32_bf16 a[104:107], a[244:247], a[128:131], a[104:107]
ds_read_b128 a[236:239], v236 offset:50880
buffer_load_dwordx4 v249, s[4:7], s29 offen offset:3168 nt lds
v_mfma_f32_16x16x32_bf16 a[108:111], a[244:247], a[132:135], a[108:111]
s_waitcnt lgkmcnt(4)
v_exp_f32 v209, v209
v_mfma_f32_16x16x32_bf16 a[112:115], a[248:251], a[128:131], a[112:115]
s_add_u32 m0, s28, 0
ds_read_b128 a[240:243], v236 offset:50944
s_mov_b32 s29, 180224
v_mfma_f32_16x16x32_bf16 a[116:119], a[248:251], a[132:135], a[116:119]
v_exp_f32 v210, v210
v_mfma_f32_16x16x32_bf16 a[120:123], a[252:255], a[128:131], a[120:123]
ds_read_b128 a[244:247], v236 offset:51008
v_cvt_pk_bf16_f32 v40, v208, v209
v_mfma_f32_16x16x32_bf16 a[124:127], a[252:255], a[132:135], a[124:127]
s_waitcnt lgkmcnt(4)
v_exp_f32 v211, v211
v_mfma_f32_16x16x32_bf16 v[192:195], a[224:227], v[128:131], v[224:227]
ds_read_b128 a[248:251], v236 offset:51072
v_mfma_f32_16x16x32_bf16 v[192:195], a[228:231], v[136:139], v[192:195]
v_exp_f32 v212, v212
v_mfma_f32_16x16x32_bf16 v[196:199], a[228:231], v[140:143], v[228:231]
ds_read_b128 a[252:255], v236 offset:51136
v_cvt_pk_bf16_f32 v41, v210, v211
v_mfma_f32_16x16x32_bf16 v[196:199], a[224:227], v[132:135], v[196:199]
s_waitcnt lgkmcnt(4)
v_exp_f32 v213, v213
v_mfma_f32_16x16x32_bf16 v[196:199], a[232:235], v[148:151], v[196:199]
ds_read_b128 a[224:227], v236 offset:51200
buffer_load_dwordx4 v246, s[4:7], s29 offen offset:0 nt lds
v_mfma_f32_16x16x32_bf16 v[196:199], a[236:239], v[156:159], v[196:199]
v_exp_f32 v214, v214
v_mfma_f32_16x16x32_bf16 v[192:195], a[236:239], v[152:155], v[192:195]
ds_read_b128 a[228:231], v236 offset:51264
v_cvt_pk_bf16_f32 v44, v212, v213
v_mfma_f32_16x16x32_bf16 v[192:195], a[232:235], v[144:147], v[192:195]
s_waitcnt lgkmcnt(4)
v_exp_f32 v215, v215
v_mfma_f32_16x16x32_bf16 v[192:195], a[240:243], v[160:163], v[192:195]
ds_read_b128 a[232:235], v236 offset:51328
v_mfma_f32_16x16x32_bf16 v[192:195], a[244:247], v[168:171], v[192:195]
v_exp_f32 v216, v216
v_mfma_f32_16x16x32_bf16 v[196:199], a[244:247], v[172:175], v[196:199]
ds_read_b128 a[236:239], v236 offset:51392
v_cvt_pk_bf16_f32 v45, v214, v215
v_mfma_f32_16x16x32_bf16 v[196:199], a[240:243], v[164:167], v[196:199]
s_waitcnt lgkmcnt(4)
v_exp_f32 v217, v217
v_mfma_f32_16x16x32_bf16 v[196:199], a[248:251], v[180:183], v[196:199]
ds_read_b128 a[240:243], v236 offset:51456
buffer_load_dwordx4 v247, s[4:7], s29 offen offset:1056 nt lds
v_mfma_f32_16x16x32_bf16 v[196:199], a[252:255], v[188:191], v[196:199]
v_exp_f32 v218, v218
v_cvt_pk_bf16_f32 v42, v216, v217
v_mfma_f32_16x16x32_bf16 v[192:195], a[252:255], v[184:187], v[192:195]
ds_read_b128 a[244:247], v236 offset:51520
v_exp_f32 v219, v219
v_mfma_f32_16x16x32_bf16 v[192:195], a[248:251], v[176:179], v[192:195]
s_waitcnt lgkmcnt(4)
v_exp_f32 v220, v220
v_cvt_pk_bf16_f32 v43, v218, v219
v_mfma_f32_16x16x32_bf16 v[200:203], a[224:227], v[128:131], v[224:227]
ds_read_b128 a[248:251], v236 offset:51584
v_exp_f32 v221, v221
v_mfma_f32_16x16x32_bf16 v[200:203], a[228:231], v[136:139], v[200:203]
v_exp_f32 v222, v222
v_cvt_pk_bf16_f32 v46, v220, v221
v_mfma_f32_16x16x32_bf16 v[204:207], a[228:231], v[140:143], v[228:231]
ds_read_b128 a[252:255], v236 offset:51648
v_exp_f32 v223, v223
v_mfma_f32_16x16x32_bf16 v[204:207], a[224:227], v[132:135], v[204:207]
s_waitcnt lgkmcnt(4)
v_cvt_pk_bf16_f32 v47, v222, v223
v_mfma_f32_16x16x32_bf16 v[204:207], a[232:235], v[148:151], v[204:207]
ds_read_b64_tr_b16 a[224:225], v240 offset:0
v_max3_f32 v242, v192, v193, v194
v_mfma_f32_16x16x32_bf16 v[204:207], a[236:239], v[156:159], v[204:207]
ds_read_b64_tr_b16 a[226:227], v240 offset:512
v_max3_f32 v242, v242, v195, v196
v_mfma_f32_16x16x32_bf16 v[200:203], a[236:239], v[152:155], v[200:203]
ds_read_b64_tr_b16 a[228:229], v240 offset:32
v_max3_f32 v242, v242, v197, v198
v_mfma_f32_16x16x32_bf16 v[200:203], a[232:235], v[144:147], v[200:203]
s_waitcnt lgkmcnt(5)
ds_read_b64_tr_b16 a[230:231], v240 offset:544
v_mfma_f32_16x16x32_bf16 v[200:203], a[240:243], v[160:163], v[200:203]
ds_read_b64_tr_b16 a[232:233], v240 offset:64
buffer_load_dwordx4 v248, s[4:7], s29 offen offset:2112 nt lds
v_mfma_f32_16x16x32_bf16 v[200:203], a[244:247], v[168:171], v[200:203]
ds_read_b64_tr_b16 a[234:235], v240 offset:576
v_mfma_f32_16x16x32_bf16 v[204:207], a[244:247], v[172:175], v[204:207]
ds_read_b64_tr_b16 a[236:237], v240 offset:96
v_mfma_f32_16x16x32_bf16 v[204:207], a[240:243], v[164:167], v[204:207]
s_waitcnt lgkmcnt(7)
ds_read_b64_tr_b16 a[238:239], v240 offset:608
v_mfma_f32_16x16x32_bf16 v[204:207], a[248:251], v[180:183], v[204:207]
ds_read_b64_tr_b16 a[240:241], v240 offset:128
v_mfma_f32_16x16x32_bf16 v[204:207], a[252:255], v[188:191], v[204:207]
ds_read_b64_tr_b16 a[242:243], v240 offset:640
v_mfma_f32_16x16x32_bf16 v[200:203], a[252:255], v[184:187], v[200:203]
ds_read_b64_tr_b16 a[244:245], v240 offset:160
v_mfma_f32_16x16x32_bf16 v[200:203], a[248:251], v[176:179], v[200:203]
s_waitcnt lgkmcnt(7)
ds_read_b64_tr_b16 a[246:247], v240 offset:672
v_mfma_f32_16x16x32_bf16 a[0:3], a[224:227], a[136:139], a[0:3]
ds_read_b64_tr_b16 a[248:249], v240 offset:192
v_mfma_f32_16x16x32_bf16 a[4:7], a[224:227], a[140:143], a[4:7]
ds_read_b64_tr_b16 a[250:251], v240 offset:704
v_mfma_f32_16x16x32_bf16 a[8:11], a[228:231], a[136:139], a[8:11]
s_waitcnt lgkmcnt(6)
ds_read_b64_tr_b16 a[252:253], v240 offset:224
v_mfma_f32_16x16x32_bf16 a[12:15], a[228:231], a[140:143], a[12:15]
s_waitcnt vmcnt(19)
ds_read_b64_tr_b16 a[254:255], v240 offset:736
s_barrier
v_mfma_f32_16x16x32_bf16 a[16:19], a[232:235], a[136:139], a[16:19]
ds_read_b128 a[224:227], v237 offset:16896
v_max3_f32 v242, v242, v199, v200
v_mfma_f32_16x16x32_bf16 a[20:23], a[232:235], a[140:143], a[20:23]
v_max3_f32 v242, v242, v201, v202
v_max3_f32 v242, v242, v203, v204
v_mfma_f32_16x16x32_bf16 a[24:27], a[236:239], a[136:139], a[24:27]
ds_read_b128 a[228:231], v237 offset:16960
v_max3_f32 v242, v242, v205, v206
v_mfma_f32_16x16x32_bf16 a[28:31], a[236:239], a[140:143], a[28:31]
s_waitcnt lgkmcnt(6)
v_max_f32 v242, v242, v207
v_cmp_lt_f32 vcc, s32, v242
v_mfma_f32_16x16x32_bf16 a[32:35], a[240:243], a[136:139], a[32:35]
s_cbranch_vccnz L_rsB6
L_rbB6:
ds_read_b128 a[232:235], v237 offset:17024
buffer_load_dwordx4 v249, s[4:7], s29 offen offset:3168 nt lds
v_mfma_f32_16x16x32_bf16 a[36:39], a[240:243], a[140:143], a[36:39]
v_exp_f32 v192, v192
v_mfma_f32_16x16x32_bf16 a[40:43], a[244:247], a[136:139], a[40:43]
ds_read_b128 a[236:239], v237 offset:17088
v_mfma_f32_16x16x32_bf16 a[44:47], a[244:247], a[140:143], a[44:47]
s_waitcnt lgkmcnt(4)
v_exp_f32 v193, v193
v_mfma_f32_16x16x32_bf16 a[48:51], a[248:251], a[136:139], a[48:51]
s_add_u32 m0, s28, 33792
ds_read_b128 a[240:243], v237 offset:17152
s_mov_b32 s45, 1311232
v_mfma_f32_16x16x32_bf16 a[52:55], a[248:251], a[140:143], a[52:55]
v_exp_f32 v194, v194
v_mfma_f32_16x16x32_bf16 a[56:59], a[252:255], a[136:139], a[56:59]
ds_read_b128 a[244:247], v237 offset:17216
v_cvt_pk_bf16_f32 v48, v192, v193
v_mfma_f32_16x16x32_bf16 a[60:63], a[252:255], a[140:143], a[60:63]
s_waitcnt lgkmcnt(4)
v_exp_f32 v195, v195
v_mfma_f32_16x16x32_bf16 v[208:211], a[224:227], v[128:131], v[224:227]
ds_read_b128 a[248:251], v237 offset:17280
v_mfma_f32_16x16x32_bf16 v[208:211], a[228:231], v[136:139], v[208:211]
v_exp_f32 v196, v196
v_mfma_f32_16x16x32_bf16 v[212:215], a[228:231], v[140:143], v[228:231]
ds_read_b128 a[252:255], v237 offset:17344
v_cvt_pk_bf16_f32 v49, v194, v195
v_mfma_f32_16x16x32_bf16 v[212:215], a[224:227], v[132:135], v[212:215]
s_waitcnt lgkmcnt(4)
v_exp_f32 v197, v197
v_mfma_f32_16x16x32_bf16 v[212:215], a[232:235], v[148:151], v[212:215]
ds_read_b128 a[224:227], v237 offset:17408
buffer_load_dwordx4 v250, s[12:15], s45 offen offset:0 lds
v_mfma_f32_16x16x32_bf16 v[212:215], a[236:239], v[156:159], v[212:215]
v_exp_f32 v198, v198
v_mfma_f32_16x16x32_bf16 v[208:211], a[236:239], v[152:155], v[208:211]
ds_read_b128 a[228:231], v237 offset:17472
v_cvt_pk_bf16_f32 v52, v196, v197
v_mfma_f32_16x16x32_bf16 v[208:211], a[232:235], v[144:147], v[208:211]
s_waitcnt lgkmcnt(4)
v_exp_f32 v199, v199
v_mfma_f32_16x16x32_bf16 v[208:211], a[240:243], v[160:163], v[208:211]
ds_read_b128 a[232:235], v237 offset:17536
buffer_load_dwordx4 v251, s[12:15], s45 offen offset:1056 lds
v_mfma_f32_16x16x32_bf16 v[208:211], a[244:247], v[168:171], v[208:211]
v_exp_f32 v200, v200
v_mfma_f32_16x16x32_bf16 v[212:215], a[244:247], v[172:175], v[212:215]
ds_read_b128 a[236:239], v237 offset:17600
v_cvt_pk_bf16_f32 v53, v198, v199
v_mfma_f32_16x16x32_bf16 v[212:215], a[240:243], v[164:167], v[212:215]
s_waitcnt lgkmcnt(4)
v_exp_f32 v201, v201
v_mfma_f32_16x16x32_bf16 v[212:215], a[248:251], v[180:183], v[212:215]
ds_read_b128 a[240:243], v237 offset:17664
buffer_load_dwordx4 v252, s[12:15], s45 offen offset:2112 lds
v_mfma_f32_16x16x32_bf16 v[212:215], a[252:255], v[188:191], v[212:215]
v_exp_f32 v202, v202
v_cvt_pk_bf16_f32 v50, v200, v201
v_mfma_f32_16x16x32_bf16 v[208:211], a[252:255], v[184:187], v[208:211]
ds_read_b128 a[244:247], v237 offset:17728
v_exp_f32 v203, v203
v_mfma_f32_16x16x32_bf16 v[208:211], a[248:251], v[176:179], v[208:211]
s_waitcnt lgkmcnt(4)
v_exp_f32 v204, v204
v_cvt_pk_bf16_f32 v51, v202, v203
v_mfma_f32_16x16x32_bf16 v[216:219], a[224:227], v[128:131], v[224:227]
ds_read_b128 a[248:251], v237 offset:17792
v_exp_f32 v205, v205
v_mfma_f32_16x16x32_bf16 v[216:219], a[228:231], v[136:139], v[216:219]
v_exp_f32 v206, v206
v_cvt_pk_bf16_f32 v54, v204, v205
v_mfma_f32_16x16x32_bf16 v[220:223], a[228:231], v[140:143], v[228:231]
ds_read_b128 a[252:255], v237 offset:17856
v_exp_f32 v207, v207
v_mfma_f32_16x16x32_bf16 v[220:223], a[224:227], v[132:135], v[220:223]
s_waitcnt lgkmcnt(4)
buffer_load_dwordx4 v253, s[12:15], s45 offen offset:3168 lds
v_cvt_pk_bf16_f32 v55, v206, v207
v_mfma_f32_16x16x32_bf16 v[220:223], a[232:235], v[148:151], v[220:223]
s_add_u32 m0, s28, 50688
ds_read_b64_tr_b16 a[224:225], v240 offset:256
v_max3_f32 v242, v208, v209, v210
v_mfma_f32_16x16x32_bf16 v[220:223], a[236:239], v[156:159], v[220:223]
s_mov_b32 s29, 196608
ds_read_b64_tr_b16 a[226:227], v240 offset:768
v_max3_f32 v242, v242, v211, v212
v_mfma_f32_16x16x32_bf16 v[216:219], a[236:239], v[152:155], v[216:219]
ds_read_b64_tr_b16 a[228:229], v240 offset:288
v_max3_f32 v242, v242, v213, v214
v_mfma_f32_16x16x32_bf16 v[216:219], a[232:235], v[144:147], v[216:219]
s_waitcnt lgkmcnt(5)
ds_read_b64_tr_b16 a[230:231], v240 offset:800
v_mfma_f32_16x16x32_bf16 v[216:219], a[240:243], v[160:163], v[216:219]
ds_read_b64_tr_b16 a[232:233], v240 offset:320
buffer_load_dwordx4 v246, s[4:7], s29 offen offset:0 nt lds
v_mfma_f32_16x16x32_bf16 v[216:219], a[244:247], v[168:171], v[216:219]
ds_read_b64_tr_b16 a[234:235], v240 offset:832
v_mfma_f32_16x16x32_bf16 v[220:223], a[244:247], v[172:175], v[220:223]
ds_read_b64_tr_b16 a[236:237], v240 offset:352
v_mfma_f32_16x16x32_bf16 v[220:223], a[240:243], v[164:167], v[220:223]
s_waitcnt lgkmcnt(7)
ds_read_b64_tr_b16 a[238:239], v240 offset:864
v_mfma_f32_16x16x32_bf16 v[220:223], a[248:251], v[180:183], v[220:223]
ds_read_b64_tr_b16 a[240:241], v240 offset:384
v_mfma_f32_16x16x32_bf16 v[220:223], a[252:255], v[188:191], v[220:223]
ds_read_b64_tr_b16 a[242:243], v240 offset:896
v_mfma_f32_16x16x32_bf16 v[216:219], a[252:255], v[184:187], v[216:219]
ds_read_b64_tr_b16 a[244:245], v240 offset:416
buffer_load_dwordx4 v247, s[4:7], s29 offen offset:1056 nt lds
v_mfma_f32_16x16x32_bf16 v[216:219], a[248:251], v[176:179], v[216:219]
s_waitcnt lgkmcnt(7)
ds_read_b64_tr_b16 a[246:247], v240 offset:928
v_mfma_f32_16x16x32_bf16 a[64:67], a[224:227], a[136:139], a[64:67]
ds_read_b64_tr_b16 a[248:249], v240 offset:448
v_mfma_f32_16x16x32_bf16 a[68:71], a[224:227], a[140:143], a[68:71]
ds_read_b64_tr_b16 a[250:251], v240 offset:960
v_mfma_f32_16x16x32_bf16 a[72:75], a[228:231], a[136:139], a[72:75]
s_waitcnt lgkmcnt(6)
ds_read_b64_tr_b16 a[252:253], v240 offset:480
v_mfma_f32_16x16x32_bf16 a[76:79], a[228:231], a[140:143], a[76:79]
s_waitcnt vmcnt(14)
ds_read_b64_tr_b16 a[254:255], v240 offset:992
s_barrier
v_mfma_f32_16x16x32_bf16 a[80:83], a[232:235], a[136:139], a[80:83]
ds_read_b128 a[224:227], v237 offset:33792
v_max3_f32 v242, v242, v215, v216
v_mfma_f32_16x16x32_bf16 a[84:87], a[232:235], a[140:143], a[84:87]
v_max3_f32 v242, v242, v217, v218
v_max3_f32 v242, v242, v219, v220
v_mfma_f32_16x16x32_bf16 a[88:91], a[236:239], a[136:139], a[88:91]
ds_read_b128 a[228:231], v237 offset:33856
v_max3_f32 v242, v242, v221, v222
v_mfma_f32_16x16x32_bf16 a[92:95], a[236:239], a[140:143], a[92:95]
s_waitcnt lgkmcnt(6)
v_max_f32 v242, v242, v223
v_cmp_lt_f32 vcc, s32, v242
v_mfma_f32_16x16x32_bf16 a[96:99], a[240:243], a[136:139], a[96:99]
s_cbranch_vccnz L_rsB7
L_rbB7:
ds_read_b128 a[232:235], v237 offset:33920
buffer_load_dwordx4 v248, s[4:7], s29 offen offset:2112 nt lds
v_mfma_f32_16x16x32_bf16 a[100:103], a[240:243], a[140:143], a[100:103]
v_exp_f32 v208, v208
v_mfma_f32_16x16x32_bf16 a[104:107], a[244:247], a[136:139], a[104:107]
ds_read_b128 a[236:239], v237 offset:33984
buffer_load_dwordx4 v249, s[4:7], s29 offen offset:3168 nt lds
v_mfma_f32_16x16x32_bf16 a[108:111], a[244:247], a[140:143], a[108:111]
s_waitcnt lgkmcnt(4)
v_exp_f32 v209, v209
v_mfma_f32_16x16x32_bf16 a[112:115], a[248:251], a[136:139], a[112:115]
s_add_u32 m0, s28, 84480
ds_read_b128 a[240:243], v237 offset:34048
s_mov_b32 s29, 212992
v_mfma_f32_16x16x32_bf16 a[116:119], a[248:251], a[140:143], a[116:119]
v_exp_f32 v210, v210
v_mfma_f32_16x16x32_bf16 a[120:123], a[252:255], a[136:139], a[120:123]
ds_read_b128 a[244:247], v237 offset:34112
v_cvt_pk_bf16_f32 v56, v208, v209
v_mfma_f32_16x16x32_bf16 a[124:127], a[252:255], a[140:143], a[124:127]
s_waitcnt lgkmcnt(4)
v_exp_f32 v211, v211
v_mfma_f32_16x16x32_bf16 v[192:195], a[224:227], v[128:131], v[224:227]
ds_read_b128 a[248:251], v237 offset:34176
v_mfma_f32_16x16x32_bf16 v[192:195], a[228:231], v[136:139], v[192:195]
v_exp_f32 v212, v212
v_mfma_f32_16x16x32_bf16 v[196:199], a[228:231], v[140:143], v[228:231]
ds_read_b128 a[252:255], v237 offset:34240
v_cvt_pk_bf16_f32 v57, v210, v211
v_mfma_f32_16x16x32_bf16 v[196:199], a[224:227], v[132:135], v[196:199]
s_waitcnt lgkmcnt(4)
v_exp_f32 v213, v213
v_mfma_f32_16x16x32_bf16 v[196:199], a[232:235], v[148:151], v[196:199]
ds_read_b128 a[224:227], v237 offset:34304
buffer_load_dwordx4 v246, s[4:7], s29 offen offset:0 nt lds
v_mfma_f32_16x16x32_bf16 v[196:199], a[236:239], v[156:159], v[196:199]
v_exp_f32 v214, v214
v_mfma_f32_16x16x32_bf16 v[192:195], a[236:239], v[152:155], v[192:195]
ds_read_b128 a[228:231], v237 offset:34368
v_cvt_pk_bf16_f32 v60, v212, v213
v_mfma_f32_16x16x32_bf16 v[192:195], a[232:235], v[144:147], v[192:195]
s_waitcnt lgkmcnt(4)
v_exp_f32 v215, v215
v_mfma_f32_16x16x32_bf16 v[192:195], a[240:243], v[160:163], v[192:195]
ds_read_b128 a[232:235], v237 offset:34432
v_mfma_f32_16x16x32_bf16 v[192:195], a[244:247], v[168:171], v[192:195]
v_exp_f32 v216, v216
v_mfma_f32_16x16x32_bf16 v[196:199], a[244:247], v[172:175], v[196:199]
ds_read_b128 a[236:239], v237 offset:34496
v_cvt_pk_bf16_f32 v61, v214, v215
v_mfma_f32_16x16x32_bf16 v[196:199], a[240:243], v[164:167], v[196:199]
s_waitcnt lgkmcnt(4)
v_exp_f32 v217, v217
v_mfma_f32_16x16x32_bf16 v[196:199], a[248:251], v[180:183], v[196:199]
ds_read_b128 a[240:243], v237 offset:34560
buffer_load_dwordx4 v247, s[4:7], s29 offen offset:1056 nt lds
v_mfma_f32_16x16x32_bf16 v[196:199], a[252:255], v[188:191], v[196:199]
v_exp_f32 v218, v218
v_cvt_pk_bf16_f32 v58, v216, v217
v_mfma_f32_16x16x32_bf16 v[192:195], a[252:255], v[184:187], v[192:195]
ds_read_b128 a[244:247], v237 offset:34624
v_exp_f32 v219, v219
v_mfma_f32_16x16x32_bf16 v[192:195], a[248:251], v[176:179], v[192:195]
s_waitcnt lgkmcnt(4)
v_exp_f32 v220, v220
v_cvt_pk_bf16_f32 v59, v218, v219
v_mfma_f32_16x16x32_bf16 v[200:203], a[224:227], v[128:131], v[224:227]
ds_read_b128 a[248:251], v237 offset:34688
v_exp_f32 v221, v221
v_mfma_f32_16x16x32_bf16 v[200:203], a[228:231], v[136:139], v[200:203]
v_exp_f32 v222, v222
v_cvt_pk_bf16_f32 v62, v220, v221
v_mfma_f32_16x16x32_bf16 v[204:207], a[228:231], v[140:143], v[228:231]
ds_read_b128 a[252:255], v237 offset:34752
v_exp_f32 v223, v223
v_mfma_f32_16x16x32_bf16 v[204:207], a[224:227], v[132:135], v[204:207]
s_waitcnt lgkmcnt(4)
v_cvt_pk_bf16_f32 v63, v222, v223
v_mfma_f32_16x16x32_bf16 v[204:207], a[232:235], v[148:151], v[204:207]
ds_read_b64_tr_b16 a[224:225], v241 offset:0
v_max3_f32 v242, v192, v193, v194
v_mfma_f32_16x16x32_bf16 v[204:207], a[236:239], v[156:159], v[204:207]
ds_read_b64_tr_b16 a[226:227], v241 offset:512
v_max3_f32 v242, v242, v195, v196
v_mfma_f32_16x16x32_bf16 v[200:203], a[236:239], v[152:155], v[200:203]
ds_read_b64_tr_b16 a[228:229], v241 offset:32
v_max3_f32 v242, v242, v197, v198
v_mfma_f32_16x16x32_bf16 v[200:203], a[232:235], v[144:147], v[200:203]
s_waitcnt lgkmcnt(5)
ds_read_b64_tr_b16 a[230:231], v241 offset:544
v_mfma_f32_16x16x32_bf16 v[200:203], a[240:243], v[160:163], v[200:203]
ds_read_b64_tr_b16 a[232:233], v241 offset:64
buffer_load_dwordx4 v248, s[4:7], s29 offen offset:2112 nt lds
v_mfma_f32_16x16x32_bf16 v[200:203], a[244:247], v[168:171], v[200:203]
ds_read_b64_tr_b16 a[234:235], v241 offset:576
v_mfma_f32_16x16x32_bf16 v[204:207], a[244:247], v[172:175], v[204:207]
ds_read_b64_tr_b16 a[236:237], v241 offset:96
v_mfma_f32_16x16x32_bf16 v[204:207], a[240:243], v[164:167], v[204:207]
s_waitcnt lgkmcnt(7)
ds_read_b64_tr_b16 a[238:239], v241 offset:608
v_mfma_f32_16x16x32_bf16 v[204:207], a[248:251], v[180:183], v[204:207]
ds_read_b64_tr_b16 a[240:241], v241 offset:128
v_mfma_f32_16x16x32_bf16 v[204:207], a[252:255], v[188:191], v[204:207]
ds_read_b64_tr_b16 a[242:243], v241 offset:640
v_mfma_f32_16x16x32_bf16 v[200:203], a[252:255], v[184:187], v[200:203]
ds_read_b64_tr_b16 a[244:245], v241 offset:160
v_mfma_f32_16x16x32_bf16 v[200:203], a[248:251], v[176:179], v[200:203]
s_waitcnt lgkmcnt(7)
ds_read_b64_tr_b16 a[246:247], v241 offset:672
v_mfma_f32_16x16x32_bf16 a[0:3], a[224:227], a[144:147], a[0:3]
ds_read_b64_tr_b16 a[248:249], v241 offset:192
v_mfma_f32_16x16x32_bf16 a[4:7], a[224:227], a[148:151], a[4:7]
ds_read_b64_tr_b16 a[250:251], v241 offset:704
v_mfma_f32_16x16x32_bf16 a[8:11], a[228:231], a[144:147], a[8:11]
s_waitcnt lgkmcnt(6)
ds_read_b64_tr_b16 a[252:253], v241 offset:224
v_mfma_f32_16x16x32_bf16 a[12:15], a[228:231], a[148:151], a[12:15]
s_waitcnt vmcnt(19)
ds_read_b64_tr_b16 a[254:255], v241 offset:736
s_barrier
v_mfma_f32_16x16x32_bf16 a[16:19], a[232:235], a[144:147], a[16:19]
ds_read_b128 a[224:227], v237 offset:50688
v_max3_f32 v242, v242, v199, v200
v_mfma_f32_16x16x32_bf16 a[20:23], a[232:235], a[148:151], a[20:23]
v_max3_f32 v242, v242, v201, v202
v_max3_f32 v242, v242, v203, v204
v_mfma_f32_16x16x32_bf16 a[24:27], a[236:239], a[144:147], a[24:27]
ds_read_b128 a[228:231], v237 offset:50752
v_max3_f32 v242, v242, v205, v206
v_mfma_f32_16x16x32_bf16 a[28:31], a[236:239], a[148:151], a[28:31]
s_waitcnt lgkmcnt(6)
v_max_f32 v242, v242, v207
v_cmp_lt_f32 vcc, s32, v242
v_mfma_f32_16x16x32_bf16 a[32:35], a[240:243], a[144:147], a[32:35]
s_cbranch_vccnz L_rsB8
L_rbB8:
ds_read_b128 a[232:235], v237 offset:50816
buffer_load_dwordx4 v249, s[4:7], s29 offen offset:3168 nt lds
v_mfma_f32_16x16x32_bf16 a[36:39], a[240:243], a[148:151], a[36:39]
v_exp_f32 v192, v192
v_mfma_f32_16x16x32_bf16 a[40:43], a[244:247], a[144:147], a[40:43]
ds_read_b128 a[236:239], v237 offset:50880
v_mfma_f32_16x16x32_bf16 a[44:47], a[244:247], a[148:151], a[44:47]
s_waitcnt lgkmcnt(4)
v_exp_f32 v193, v193
v_mfma_f32_16x16x32_bf16 a[48:51], a[248:251], a[144:147], a[48:51]
s_add_u32 m0, s28, 67584
ds_read_b128 a[240:243], v237 offset:50944
s_mov_b32 s45, 1573376
v_mfma_f32_16x16x32_bf16 a[52:55], a[248:251], a[148:151], a[52:55]
v_exp_f32 v194, v194
v_mfma_f32_16x16x32_bf16 a[56:59], a[252:255], a[144:147], a[56:59]
ds_read_b128 a[244:247], v237 offset:51008
v_cvt_pk_bf16_f32 v64, v192, v193
v_mfma_f32_16x16x32_bf16 a[60:63], a[252:255], a[148:151], a[60:63]
s_waitcnt lgkmcnt(4)
v_exp_f32 v195, v195
v_mfma_f32_16x16x32_bf16 v[208:211], a[224:227], v[128:131], v[224:227]
ds_read_b128 a[248:251], v237 offset:51072
v_mfma_f32_16x16x32_bf16 v[208:211], a[228:231], v[136:139], v[208:211]
v_exp_f32 v196, v196
v_mfma_f32_16x16x32_bf16 v[212:215], a[228:231], v[140:143], v[228:231]
ds_read_b128 a[252:255], v237 offset:51136
v_cvt_pk_bf16_f32 v65, v194, v195
v_mfma_f32_16x16x32_bf16 v[212:215], a[224:227], v[132:135], v[212:215]
s_waitcnt lgkmcnt(4)
v_exp_f32 v197, v197
v_mfma_f32_16x16x32_bf16 v[212:215], a[232:235], v[148:151], v[212:215]
ds_read_b128 a[224:227], v237 offset:51200
buffer_load_dwordx4 v250, s[12:15], s45 offen offset:0 lds
v_mfma_f32_16x16x32_bf16 v[212:215], a[236:239], v[156:159], v[212:215]
v_exp_f32 v198, v198
v_mfma_f32_16x16x32_bf16 v[208:211], a[236:239], v[152:155], v[208:211]
ds_read_b128 a[228:231], v237 offset:51264
v_cvt_pk_bf16_f32 v68, v196, v197
v_mfma_f32_16x16x32_bf16 v[208:211], a[232:235], v[144:147], v[208:211]
s_waitcnt lgkmcnt(4)
v_exp_f32 v199, v199
v_mfma_f32_16x16x32_bf16 v[208:211], a[240:243], v[160:163], v[208:211]
ds_read_b128 a[232:235], v237 offset:51328
buffer_load_dwordx4 v251, s[12:15], s45 offen offset:1056 lds
v_mfma_f32_16x16x32_bf16 v[208:211], a[244:247], v[168:171], v[208:211]
v_exp_f32 v200, v200
v_mfma_f32_16x16x32_bf16 v[212:215], a[244:247], v[172:175], v[212:215]
ds_read_b128 a[236:239], v237 offset:51392
v_cvt_pk_bf16_f32 v69, v198, v199
v_mfma_f32_16x16x32_bf16 v[212:215], a[240:243], v[164:167], v[212:215]
s_waitcnt lgkmcnt(4)
v_exp_f32 v201, v201
v_mfma_f32_16x16x32_bf16 v[212:215], a[248:251], v[180:183], v[212:215]
ds_read_b128 a[240:243], v237 offset:51456
buffer_load_dwordx4 v252, s[12:15], s45 offen offset:2112 lds
v_mfma_f32_16x16x32_bf16 v[212:215], a[252:255], v[188:191], v[212:215]
v_exp_f32 v202, v202
v_cvt_pk_bf16_f32 v66, v200, v201
v_mfma_f32_16x16x32_bf16 v[208:211], a[252:255], v[184:187], v[208:211]
ds_read_b128 a[244:247], v237 offset:51520
v_exp_f32 v203, v203
v_mfma_f32_16x16x32_bf16 v[208:211], a[248:251], v[176:179], v[208:211]
s_waitcnt lgkmcnt(4)
v_exp_f32 v204, v204
v_cvt_pk_bf16_f32 v67, v202, v203
v_mfma_f32_16x16x32_bf16 v[216:219], a[224:227], v[128:131], v[224:227]
ds_read_b128 a[248:251], v237 offset:51584
v_exp_f32 v205, v205
v_mfma_f32_16x16x32_bf16 v[216:219], a[228:231], v[136:139], v[216:219]
v_exp_f32 v206, v206
v_cvt_pk_bf16_f32 v70, v204, v205
v_mfma_f32_16x16x32_bf16 v[220:223], a[228:231], v[140:143], v[228:231]
ds_read_b128 a[252:255], v237 offset:51648
v_exp_f32 v207, v207
v_mfma_f32_16x16x32_bf16 v[220:223], a[224:227], v[132:135], v[220:223]
s_waitcnt lgkmcnt(4)
buffer_load_dwordx4 v253, s[12:15], s45 offen offset:3168 lds
v_cvt_pk_bf16_f32 v71, v206, v207
v_mfma_f32_16x16x32_bf16 v[220:223], a[232:235], v[148:151], v[220:223]
s_add_u32 m0, s28, 101376
ds_read_b64_tr_b16 a[224:225], v241 offset:256
v_max3_f32 v242, v208, v209, v210
v_mfma_f32_16x16x32_bf16 v[220:223], a[236:239], v[156:159], v[220:223]
s_mov_b32 s29, 229376
ds_read_b64_tr_b16 a[226:227], v241 offset:768
v_max3_f32 v242, v242, v211, v212
v_mfma_f32_16x16x32_bf16 v[216:219], a[236:239], v[152:155], v[216:219]
ds_read_b64_tr_b16 a[228:229], v241 offset:288
v_max3_f32 v242, v242, v213, v214
v_mfma_f32_16x16x32_bf16 v[216:219], a[232:235], v[144:147], v[216:219]
s_waitcnt lgkmcnt(5)
ds_read_b64_tr_b16 a[230:231], v241 offset:800
v_mfma_f32_16x16x32_bf16 v[216:219], a[240:243], v[160:163], v[216:219]
ds_read_b64_tr_b16 a[232:233], v241 offset:320
buffer_load_dwordx4 v246, s[4:7], s29 offen offset:0 nt lds
v_mfma_f32_16x16x32_bf16 v[216:219], a[244:247], v[168:171], v[216:219]
ds_read_b64_tr_b16 a[234:235], v241 offset:832
v_mfma_f32_16x16x32_bf16 v[220:223], a[244:247], v[172:175], v[220:223]
ds_read_b64_tr_b16 a[236:237], v241 offset:352
v_mfma_f32_16x16x32_bf16 v[220:223], a[240:243], v[164:167], v[220:223]
s_waitcnt lgkmcnt(7)
ds_read_b64_tr_b16 a[238:239], v241 offset:864
v_mfma_f32_16x16x32_bf16 v[220:223], a[248:251], v[180:183], v[220:223]
ds_read_b64_tr_b16 a[240:241], v241 offset:384
v_mfma_f32_16x16x32_bf16 v[220:223], a[252:255], v[188:191], v[220:223]
ds_read_b64_tr_b16 a[242:243], v241 offset:896
v_mfma_f32_16x16x32_bf16 v[216:219], a[252:255], v[184:187], v[216:219]
ds_read_b64_tr_b16 a[244:245], v241 offset:416
buffer_load_dwordx4 v247, s[4:7], s29 offen offset:1056 nt lds
v_mfma_f32_16x16x32_bf16 v[216:219], a[248:251], v[176:179], v[216:219]
s_waitcnt lgkmcnt(7)
ds_read_b64_tr_b16 a[246:247], v241 offset:928
v_mfma_f32_16x16x32_bf16 a[64:67], a[224:227], a[144:147], a[64:67]
ds_read_b64_tr_b16 a[248:249], v241 offset:448
v_mfma_f32_16x16x32_bf16 a[68:71], a[224:227], a[148:151], a[68:71]
ds_read_b64_tr_b16 a[250:251], v241 offset:960
v_mfma_f32_16x16x32_bf16 a[72:75], a[228:231], a[144:147], a[72:75]
s_waitcnt lgkmcnt(6)
ds_read_b64_tr_b16 a[252:253], v241 offset:480
v_mfma_f32_16x16x32_bf16 a[76:79], a[228:231], a[148:151], a[76:79]
s_waitcnt vmcnt(14)
ds_read_b64_tr_b16 a[254:255], v241 offset:992
s_barrier
v_mfma_f32_16x16x32_bf16 a[80:83], a[232:235], a[144:147], a[80:83]
ds_read_b128 a[224:227], v236 offset:16896
v_max3_f32 v242, v242, v215, v216
v_mfma_f32_16x16x32_bf16 a[84:87], a[232:235], a[148:151], a[84:87]
v_max3_f32 v242, v242, v217, v218
v_max3_f32 v242, v242, v219, v220
v_mfma_f32_16x16x32_bf16 a[88:91], a[236:239], a[144:147], a[88:91]
ds_read_b128 a[228:231], v236 offset:16960
v_max3_f32 v242, v242, v221, v222
v_mfma_f32_16x16x32_bf16 a[92:95], a[236:239], a[148:151], a[92:95]
s_waitcnt lgkmcnt(6)
v_max_f32 v242, v242, v223
v_cmp_lt_f32 vcc, s32, v242
v_mfma_f32_16x16x32_bf16 a[96:99], a[240:243], a[144:147], a[96:99]
s_cbranch_vccnz L_rsB9
L_rbB9:
ds_read_b128 a[232:235], v236 offset:17024
buffer_load_dwordx4 v248, s[4:7], s29 offen offset:2112 nt lds
v_mfma_f32_16x16x32_bf16 a[100:103], a[240:243], a[148:151], a[100:103]
v_exp_f32 v208, v208
v_mfma_f32_16x16x32_bf16 a[104:107], a[244:247], a[144:147], a[104:107]
ds_read_b128 a[236:239], v236 offset:17088
buffer_load_dwordx4 v249, s[4:7], s29 offen offset:3168 nt lds
v_mfma_f32_16x16x32_bf16 a[108:111], a[244:247], a[148:151], a[108:111]
s_waitcnt lgkmcnt(4)
v_exp_f32 v209, v209
v_mfma_f32_16x16x32_bf16 a[112:115], a[248:251], a[144:147], a[112:115]
s_add_u32 m0, s28, 118272
ds_read_b128 a[240:243], v236 offset:17152
s_mov_b32 s29, 245760
v_mfma_f32_16x16x32_bf16 a[116:119], a[248:251], a[148:151], a[116:119]
v_exp_f32 v210, v210
v_mfma_f32_16x16x32_bf16 a[120:123], a[252:255], a[144:147], a[120:123]
ds_read_b128 a[244:247], v236 offset:17216
v_cvt_pk_bf16_f32 v72, v208, v209
v_mfma_f32_16x16x32_bf16 a[124:127], a[252:255], a[148:151], a[124:127]
s_waitcnt lgkmcnt(4)
v_exp_f32 v211, v211
v_mfma_f32_16x16x32_bf16 v[192:195], a[224:227], v[128:131], v[224:227]
ds_read_b128 a[248:251], v236 offset:17280
v_mfma_f32_16x16x32_bf16 v[192:195], a[228:231], v[136:139], v[192:195]
v_exp_f32 v212, v212
v_mfma_f32_16x16x32_bf16 v[196:199], a[228:231], v[140:143], v[228:231]
ds_read_b128 a[252:255], v236 offset:17344
v_cvt_pk_bf16_f32 v73, v210, v211
v_mfma_f32_16x16x32_bf16 v[196:199], a[224:227], v[132:135], v[196:199]
s_waitcnt lgkmcnt(4)
v_exp_f32 v213, v213
v_mfma_f32_16x16x32_bf16 v[196:199], a[232:235], v[148:151], v[196:199]
ds_read_b128 a[224:227], v236 offset:17408
buffer_load_dwordx4 v246, s[4:7], s29 offen offset:0 nt lds
v_mfma_f32_16x16x32_bf16 v[196:199], a[236:239], v[156:159], v[196:199]
v_exp_f32 v214, v214
v_mfma_f32_16x16x32_bf16 v[192:195], a[236:239], v[152:155], v[192:195]
ds_read_b128 a[228:231], v236 offset:17472
v_cvt_pk_bf16_f32 v76, v212, v213
v_mfma_f32_16x16x32_bf16 v[192:195], a[232:235], v[144:147], v[192:195]
s_waitcnt lgkmcnt(4)
v_exp_f32 v215, v215
v_mfma_f32_16x16x32_bf16 v[192:195], a[240:243], v[160:163], v[192:195]
ds_read_b128 a[232:235], v236 offset:17536
v_mfma_f32_16x16x32_bf16 v[192:195], a[244:247], v[168:171], v[192:195]
v_exp_f32 v216, v216
v_mfma_f32_16x16x32_bf16 v[196:199], a[244:247], v[172:175], v[196:199]
ds_read_b128 a[236:239], v236 offset:17600
v_cvt_pk_bf16_f32 v77, v214, v215
v_mfma_f32_16x16x32_bf16 v[196:199], a[240:243], v[164:167], v[196:199]
s_waitcnt lgkmcnt(4)
v_exp_f32 v217, v217
v_mfma_f32_16x16x32_bf16 v[196:199], a[248:251], v[180:183], v[196:199]
ds_read_b128 a[240:243], v236 offset:17664
buffer_load_dwordx4 v247, s[4:7], s29 offen offset:1056 nt lds
v_mfma_f32_16x16x32_bf16 v[196:199], a[252:255], v[188:191], v[196:199]
v_exp_f32 v218, v218
v_cvt_pk_bf16_f32 v74, v216, v217
v_mfma_f32_16x16x32_bf16 v[192:195], a[252:255], v[184:187], v[192:195]
ds_read_b128 a[244:247], v236 offset:17728
v_exp_f32 v219, v219
v_mfma_f32_16x16x32_bf16 v[192:195], a[248:251], v[176:179], v[192:195]
s_waitcnt lgkmcnt(4)
v_exp_f32 v220, v220
v_cvt_pk_bf16_f32 v75, v218, v219
v_mfma_f32_16x16x32_bf16 v[200:203], a[224:227], v[128:131], v[224:227]
ds_read_b128 a[248:251], v236 offset:17792
v_exp_f32 v221, v221
v_mfma_f32_16x16x32_bf16 v[200:203], a[228:231], v[136:139], v[200:203]
v_exp_f32 v222, v222
v_cvt_pk_bf16_f32 v78, v220, v221
v_mfma_f32_16x16x32_bf16 v[204:207], a[228:231], v[140:143], v[228:231]
ds_read_b128 a[252:255], v236 offset:17856
v_exp_f32 v223, v223
v_mfma_f32_16x16x32_bf16 v[204:207], a[224:227], v[132:135], v[204:207]
s_waitcnt lgkmcnt(4)
v_cvt_pk_bf16_f32 v79, v222, v223
v_mfma_f32_16x16x32_bf16 v[204:207], a[232:235], v[148:151], v[204:207]
ds_read_b64_tr_b16 a[224:225], v239 offset:33792
v_max3_f32 v242, v192, v193, v194
v_mfma_f32_16x16x32_bf16 v[204:207], a[236:239], v[156:159], v[204:207]
ds_read_b64_tr_b16 a[226:227], v239 offset:34304
v_max3_f32 v242, v242, v195, v196
v_mfma_f32_16x16x32_bf16 v[200:203], a[236:239], v[152:155], v[200:203]
ds_read_b64_tr_b16 a[228:229], v239 offset:33824
v_max3_f32 v242, v242, v197, v198
v_mfma_f32_16x16x32_bf16 v[200:203], a[232:235], v[144:147], v[200:203]
s_waitcnt lgkmcnt(5)
ds_read_b64_tr_b16 a[230:231], v239 offset:34336
v_mfma_f32_16x16x32_bf16 v[200:203], a[240:243], v[160:163], v[200:203]
ds_read_b64_tr_b16 a[232:233], v239 offset:33856
buffer_load_dwordx4 v248, s[4:7], s29 offen offset:2112 nt lds
v_mfma_f32_16x16x32_bf16 v[200:203], a[244:247], v[168:171], v[200:203]
ds_read_b64_tr_b16 a[234:235], v239 offset:34368
v_mfma_f32_16x16x32_bf16 v[204:207], a[244:247], v[172:175], v[204:207]
ds_read_b64_tr_b16 a[236:237], v239 offset:33888
v_mfma_f32_16x16x32_bf16 v[204:207], a[240:243], v[164:167], v[204:207]
s_waitcnt lgkmcnt(7)
ds_read_b64_tr_b16 a[238:239], v239 offset:34400
v_mfma_f32_16x16x32_bf16 v[204:207], a[248:251], v[180:183], v[204:207]
ds_read_b64_tr_b16 a[240:241], v239 offset:33920
v_mfma_f32_16x16x32_bf16 v[204:207], a[252:255], v[188:191], v[204:207]
ds_read_b64_tr_b16 a[242:243], v239 offset:34432
v_mfma_f32_16x16x32_bf16 v[200:203], a[252:255], v[184:187], v[200:203]
ds_read_b64_tr_b16 a[244:245], v239 offset:33952
v_mfma_f32_16x16x32_bf16 v[200:203], a[248:251], v[176:179], v[200:203]
s_waitcnt lgkmcnt(7)
ds_read_b64_tr_b16 a[246:247], v239 offset:34464
v_mfma_f32_16x16x32_bf16 a[0:3], a[224:227], a[152:155], a[0:3]
ds_read_b64_tr_b16 a[248:249], v239 offset:33984
v_mfma_f32_16x16x32_bf16 a[4:7], a[224:227], a[156:159], a[4:7]
ds_read_b64_tr_b16 a[250:251], v239 offset:34496
v_mfma_f32_16x16x32_bf16 a[8:11], a[228:231], a[152:155], a[8:11]
s_waitcnt lgkmcnt(6)
ds_read_b64_tr_b16 a[252:253], v239 offset:34016
v_mfma_f32_16x16x32_bf16 a[12:15], a[228:231], a[156:159], a[12:15]
s_waitcnt vmcnt(19)
ds_read_b64_tr_b16 a[254:255], v239 offset:34528
s_barrier
v_mfma_f32_16x16x32_bf16 a[16:19], a[232:235], a[152:155], a[16:19]
ds_read_b128 a[224:227], v236 offset:0
v_max3_f32 v242, v242, v199, v200
v_mfma_f32_16x16x32_bf16 a[20:23], a[232:235], a[156:159], a[20:23]
v_max3_f32 v242, v242, v201, v202
v_max3_f32 v242, v242, v203, v204
v_mfma_f32_16x16x32_bf16 a[24:27], a[236:239], a[152:155], a[24:27]
ds_read_b128 a[228:231], v236 offset:64
v_max3_f32 v242, v242, v205, v206
v_mfma_f32_16x16x32_bf16 a[28:31], a[236:239], a[156:159], a[28:31]
s_waitcnt lgkmcnt(6)
v_max_f32 v242, v242, v207
v_cmp_lt_f32 vcc, s32, v242
v_mfma_f32_16x16x32_bf16 a[32:35], a[240:243], a[152:155], a[32:35]
s_cbranch_vccnz L_rsB10
L_rbB10:
ds_read_b128 a[232:235], v236 offset:128
buffer_load_dwordx4 v249, s[4:7], s29 offen offset:3168 nt lds
v_mfma_f32_16x16x32_bf16 a[36:39], a[240:243], a[156:159], a[36:39]
v_exp_f32 v192, v192
v_mfma_f32_16x16x32_bf16 a[40:43], a[244:247], a[152:155], a[40:43]
ds_read_b128 a[236:239], v236 offset:192
v_mfma_f32_16x16x32_bf16 a[44:47], a[244:247], a[156:159], a[44:47]
s_waitcnt lgkmcnt(4)
v_exp_f32 v193, v193
v_mfma_f32_16x16x32_bf16 a[48:51], a[248:251], a[152:155], a[48:51]
s_add_u32 m0, s28, 135168
ds_read_b128 a[240:243], v236 offset:256
s_mov_b32 s45, 1835520
v_mfma_f32_16x16x32_bf16 a[52:55], a[248:251], a[156:159], a[52:55]
v_exp_f32 v194, v194
v_mfma_f32_16x16x32_bf16 a[56:59], a[252:255], a[152:155], a[56:59]
ds_read_b128 a[244:247], v236 offset:320
v_cvt_pk_bf16_f32 v80, v192, v193
v_mfma_f32_16x16x32_bf16 a[60:63], a[252:255], a[156:159], a[60:63]
s_waitcnt lgkmcnt(4)
v_exp_f32 v195, v195
v_mfma_f32_16x16x32_bf16 v[208:211], a[224:227], v[128:131], v[224:227]
ds_read_b128 a[248:251], v236 offset:384
v_mfma_f32_16x16x32_bf16 v[208:211], a[228:231], v[136:139], v[208:211]
v_exp_f32 v196, v196
v_mfma_f32_16x16x32_bf16 v[212:215], a[228:231], v[140:143], v[228:231]
ds_read_b128 a[252:255], v236 offset:448
v_cvt_pk_bf16_f32 v81, v194, v195
v_mfma_f32_16x16x32_bf16 v[212:215], a[224:227], v[132:135], v[212:215]
s_waitcnt lgkmcnt(4)
v_exp_f32 v197, v197
v_mfma_f32_16x16x32_bf16 v[212:215], a[232:235], v[148:151], v[212:215]
ds_read_b128 a[224:227], v236 offset:512
buffer_load_dwordx4 v250, s[12:15], s45 offen offset:0 lds
v_mfma_f32_16x16x32_bf16 v[212:215], a[236:239], v[156:159], v[212:215]
v_exp_f32 v198, v198
v_mfma_f32_16x16x32_bf16 v[208:211], a[236:239], v[152:155], v[208:211]
ds_read_b128 a[228:231], v236 offset:576
v_cvt_pk_bf16_f32 v84, v196, v197
v_mfma_f32_16x16x32_bf16 v[208:211], a[232:235], v[144:147], v[208:211]
s_waitcnt lgkmcnt(4)
v_exp_f32 v199, v199
v_mfma_f32_16x16x32_bf16 v[208:211], a[240:243], v[160:163], v[208:211]
ds_read_b128 a[232:235], v236 offset:640
buffer_load_dwordx4 v251, s[12:15], s45 offen offset:1056 lds
v_mfma_f32_16x16x32_bf16 v[208:211], a[244:247], v[168:171], v[208:211]
v_exp_f32 v200, v200
v_mfma_f32_16x16x32_bf16 v[212:215], a[244:247], v[172:175], v[212:215]
ds_read_b128 a[236:239], v236 offset:704
v_cvt_pk_bf16_f32 v85, v198, v199
v_mfma_f32_16x16x32_bf16 v[212:215], a[240:243], v[164:167], v[212:215]
s_waitcnt lgkmcnt(4)
v_exp_f32 v201, v201
v_mfma_f32_16x16x32_bf16 v[212:215], a[248:251], v[180:183], v[212:215]
ds_read_b128 a[240:243], v236 offset:768
buffer_load_dwordx4 v252, s[12:15], s45 offen offset:2112 lds
v_mfma_f32_16x16x32_bf16 v[212:215], a[252:255], v[188:191], v[212:215]
v_exp_f32 v202, v202
v_cvt_pk_bf16_f32 v82, v200, v201
v_mfma_f32_16x16x32_bf16 v[208:211], a[252:255], v[184:187], v[208:211]
ds_read_b128 a[244:247], v236 offset:832
v_exp_f32 v203, v203
v_mfma_f32_16x16x32_bf16 v[208:211], a[248:251], v[176:179], v[208:211]
s_waitcnt lgkmcnt(4)
v_exp_f32 v204, v204
v_cvt_pk_bf16_f32 v83, v202, v203
v_mfma_f32_16x16x32_bf16 v[216:219], a[224:227], v[128:131], v[224:227]
ds_read_b128 a[248:251], v236 offset:896
v_exp_f32 v205, v205
v_mfma_f32_16x16x32_bf16 v[216:219], a[228:231], v[136:139], v[216:219]
v_exp_f32 v206, v206
v_cvt_pk_bf16_f32 v86, v204, v205
v_mfma_f32_16x16x32_bf16 v[220:223], a[228:231], v[140:143], v[228:231]
ds_read_b128 a[252:255], v236 offset:960
v_exp_f32 v207, v207
v_mfma_f32_16x16x32_bf16 v[220:223], a[224:227], v[132:135], v[220:223]
s_waitcnt lgkmcnt(4)
buffer_load_dwordx4 v253, s[12:15], s45 offen offset:3168 lds
v_cvt_pk_bf16_f32 v87, v206, v207
v_mfma_f32_16x16x32_bf16 v[220:223], a[232:235], v[148:151], v[220:223]
ds_read_b64_tr_b16 a[224:225], v239 offset:34048
v_max3_f32 v242, v208, v209, v210
v_add_u32 v246, v246, v254
v_mfma_f32_16x16x32_bf16 v[220:223], a[236:239], v[156:159], v[220:223]
ds_read_b64_tr_b16 a[226:227], v239 offset:34560
v_max3_f32 v242, v242, v211, v212
v_add_u32 v247, v247, v254
v_mfma_f32_16x16x32_bf16 v[216:219], a[236:239], v[152:155], v[216:219]
ds_read_b64_tr_b16 a[228:229], v239 offset:34080
v_max3_f32 v242, v242, v213, v214
v_add_u32 v248, v248, v254
v_mfma_f32_16x16x32_bf16 v[216:219], a[232:235], v[144:147], v[216:219]
s_waitcnt lgkmcnt(5)
ds_read_b64_tr_b16 a[230:231], v239 offset:34592
s_add_u32 m0, s28, 16896
s_mov_b32 s29, 0
v_add_u32 v249, v249, v254
v_mfma_f32_16x16x32_bf16 v[216:219], a[240:243], v[160:163], v[216:219]
ds_read_b64_tr_b16 a[232:233], v239 offset:34112
buffer_load_dwordx4 v246, s[8:11], s29 offen offset:0 nt lds
v_mfma_f32_16x16x32_bf16 v[216:219], a[244:247], v[168:171], v[216:219]
ds_read_b64_tr_b16 a[234:235], v239 offset:34624
v_mfma_f32_16x16x32_bf16 v[220:223], a[244:247], v[172:175], v[220:223]
ds_read_b64_tr_b16 a[236:237], v239 offset:34144
v_mfma_f32_16x16x32_bf16 v[220:223], a[240:243], v[164:167], v[220:223]
s_waitcnt lgkmcnt(7)
ds_read_b64_tr_b16 a[238:239], v239 offset:34656
v_mfma_f32_16x16x32_bf16 v[220:223], a[248:251], v[180:183], v[220:223]
ds_read_b64_tr_b16 a[240:241], v239 offset:34176
v_mfma_f32_16x16x32_bf16 v[220:223], a[252:255], v[188:191], v[220:223]
ds_read_b64_tr_b16 a[242:243], v239 offset:34688
v_mfma_f32_16x16x32_bf16 v[216:219], a[252:255], v[184:187], v[216:219]
ds_read_b64_tr_b16 a[244:245], v239 offset:34208
buffer_load_dwordx4 v247, s[8:11], s29 offen offset:1056 nt lds
v_mfma_f32_16x16x32_bf16 v[216:219], a[248:251], v[176:179], v[216:219]
s_waitcnt lgkmcnt(7)
ds_read_b64_tr_b16 a[246:247], v239 offset:34720
v_mfma_f32_16x16x32_bf16 a[64:67], a[224:227], a[152:155], a[64:67]
ds_read_b64_tr_b16 a[248:249], v239 offset:34240
v_mfma_f32_16x16x32_bf16 a[68:71], a[224:227], a[156:159], a[68:71]
ds_read_b64_tr_b16 a[250:251], v239 offset:34752
v_mfma_f32_16x16x32_bf16 a[72:75], a[228:231], a[152:155], a[72:75]
s_waitcnt lgkmcnt(6)
ds_read_b64_tr_b16 a[252:253], v239 offset:34272
v_mfma_f32_16x16x32_bf16 a[76:79], a[228:231], a[156:159], a[76:79]
s_waitcnt vmcnt(14)
ds_read_b64_tr_b16 a[254:255], v239 offset:34784
s_barrier
v_mfma_f32_16x16x32_bf16 a[80:83], a[232:235], a[152:155], a[80:83]
ds_read_b128 a[224:227], v236 offset:50688
v_max3_f32 v242, v242, v215, v216
v_mfma_f32_16x16x32_bf16 a[84:87], a[232:235], a[156:159], a[84:87]
v_max3_f32 v242, v242, v217, v218
v_max3_f32 v242, v242, v219, v220
v_mfma_f32_16x16x32_bf16 a[88:91], a[236:239], a[152:155], a[88:91]
ds_read_b128 a[228:231], v236 offset:50752
v_max3_f32 v242, v242, v221, v222
v_mfma_f32_16x16x32_bf16 a[92:95], a[236:239], a[156:159], a[92:95]
s_waitcnt lgkmcnt(6)
v_max_f32 v242, v242, v223
v_cmp_lt_f32 vcc, s32, v242
v_mfma_f32_16x16x32_bf16 a[96:99], a[240:243], a[152:155], a[96:99]
s_cbranch_vccnz L_rsB11
L_rbB11:
ds_read_b128 a[232:235], v236 offset:50816
buffer_load_dwordx4 v248, s[8:11], s29 offen offset:2112 nt lds
v_mfma_f32_16x16x32_bf16 a[100:103], a[240:243], a[156:159], a[100:103]
v_exp_f32 v208, v208
v_mfma_f32_16x16x32_bf16 a[104:107], a[244:247], a[152:155], a[104:107]
ds_read_b128 a[236:239], v236 offset:50880
buffer_load_dwordx4 v249, s[8:11], s29 offen offset:3168 nt lds
v_mfma_f32_16x16x32_bf16 a[108:111], a[244:247], a[156:159], a[108:111]
s_waitcnt lgkmcnt(4)
v_exp_f32 v209, v209
v_mfma_f32_16x16x32_bf16 a[112:115], a[248:251], a[152:155], a[112:115]
s_add_u32 m0, s28, 0
ds_read_b128 a[240:243], v236 offset:50944
s_mov_b32 s29, 65536
v_mfma_f32_16x16x32_bf16 a[116:119], a[248:251], a[156:159], a[116:119]
v_exp_f32 v210, v210
v_mfma_f32_16x16x32_bf16 a[120:123], a[252:255], a[152:155], a[120:123]
ds_read_b128 a[244:247], v236 offset:51008
v_cvt_pk_bf16_f32 v88, v208, v209
v_mfma_f32_16x16x32_bf16 a[124:127], a[252:255], a[156:159], a[124:127]
s_waitcnt lgkmcnt(4)
v_exp_f32 v211, v211
v_mfma_f32_16x16x32_bf16 v[192:195], a[224:227], v[128:131], v[224:227]
ds_read_b128 a[248:251], v236 offset:51072
v_mfma_f32_16x16x32_bf16 v[192:195], a[228:231], v[136:139], v[192:195]
v_exp_f32 v212, v212
v_mfma_f32_16x16x32_bf16 v[196:199], a[228:231], v[140:143], v[228:231]
ds_read_b128 a[252:255], v236 offset:51136
v_cvt_pk_bf16_f32 v89, v210, v211
v_mfma_f32_16x16x32_bf16 v[196:199], a[224:227], v[132:135], v[196:199]
s_waitcnt lgkmcnt(4)
v_exp_f32 v213, v213
v_mfma_f32_16x16x32_bf16 v[196:199], a[232:235], v[148:151], v[196:199]
ds_read_b128 a[224:227], v236 offset:51200
buffer_load_dwordx4 v246, s[8:11], s29 offen offset:0 nt lds
v_mfma_f32_16x16x32_bf16 v[196:199], a[236:239], v[156:159], v[196:199]
v_exp_f32 v214, v214
v_mfma_f32_16x16x32_bf16 v[192:195], a[236:239], v[152:155], v[192:195]
ds_read_b128 a[228:231], v236 offset:51264
v_cvt_pk_bf16_f32 v92, v212, v213
v_mfma_f32_16x16x32_bf16 v[192:195], a[232:235], v[144:147], v[192:195]
s_waitcnt lgkmcnt(4)
v_exp_f32 v215, v215
v_mfma_f32_16x16x32_bf16 v[192:195], a[240:243], v[160:163], v[192:195]
ds_read_b128 a[232:235], v236 offset:51328
v_mfma_f32_16x16x32_bf16 v[192:195], a[244:247], v[168:171], v[192:195]
v_exp_f32 v216, v216
v_mfma_f32_16x16x32_bf16 v[196:199], a[244:247], v[172:175], v[196:199]
ds_read_b128 a[236:239], v236 offset:51392
v_cvt_pk_bf16_f32 v93, v214, v215
v_mfma_f32_16x16x32_bf16 v[196:199], a[240:243], v[164:167], v[196:199]
s_waitcnt lgkmcnt(4)
v_exp_f32 v217, v217
v_mfma_f32_16x16x32_bf16 v[196:199], a[248:251], v[180:183], v[196:199]
ds_read_b128 a[240:243], v236 offset:51456
buffer_load_dwordx4 v247, s[8:11], s29 offen offset:1056 nt lds
v_mfma_f32_16x16x32_bf16 v[196:199], a[252:255], v[188:191], v[196:199]
v_exp_f32 v218, v218
v_cvt_pk_bf16_f32 v90, v216, v217
v_mfma_f32_16x16x32_bf16 v[192:195], a[252:255], v[184:187], v[192:195]
ds_read_b128 a[244:247], v236 offset:51520
v_exp_f32 v219, v219
v_mfma_f32_16x16x32_bf16 v[192:195], a[248:251], v[176:179], v[192:195]
s_waitcnt lgkmcnt(4)
v_exp_f32 v220, v220
v_cvt_pk_bf16_f32 v91, v218, v219
v_mfma_f32_16x16x32_bf16 v[200:203], a[224:227], v[128:131], v[224:227]
ds_read_b128 a[248:251], v236 offset:51584
v_exp_f32 v221, v221
v_mfma_f32_16x16x32_bf16 v[200:203], a[228:231], v[136:139], v[200:203]
v_exp_f32 v222, v222
v_cvt_pk_bf16_f32 v94, v220, v221
v_mfma_f32_16x16x32_bf16 v[204:207], a[228:231], v[140:143], v[228:231]
ds_read_b128 a[252:255], v236 offset:51648
v_exp_f32 v223, v223
v_mfma_f32_16x16x32_bf16 v[204:207], a[224:227], v[132:135], v[204:207]
s_waitcnt lgkmcnt(4)
v_cvt_pk_bf16_f32 v95, v222, v223
v_mfma_f32_16x16x32_bf16 v[204:207], a[232:235], v[148:151], v[204:207]
ds_read_b64_tr_b16 a[224:225], v240 offset:0
v_max3_f32 v242, v192, v193, v194
v_mfma_f32_16x16x32_bf16 v[204:207], a[236:239], v[156:159], v[204:207]
ds_read_b64_tr_b16 a[226:227], v240 offset:512
v_max3_f32 v242, v242, v195, v196
v_mfma_f32_16x16x32_bf16 v[200:203], a[236:239], v[152:155], v[200:203]
ds_read_b64_tr_b16 a[228:229], v240 offset:32
v_max3_f32 v242, v242, v197, v198
v_mfma_f32_16x16x32_bf16 v[200:203], a[232:235], v[144:147], v[200:203]
s_waitcnt lgkmcnt(5)
ds_read_b64_tr_b16 a[230:231], v240 offset:544
v_mfma_f32_16x16x32_bf16 v[200:203], a[240:243], v[160:163], v[200:203]
ds_read_b64_tr_b16 a[232:233], v240 offset:64
buffer_load_dwordx4 v248, s[8:11], s29 offen offset:2112 nt lds
v_mfma_f32_16x16x32_bf16 v[200:203], a[244:247], v[168:171], v[200:203]
ds_read_b64_tr_b16 a[234:235], v240 offset:576
v_mfma_f32_16x16x32_bf16 v[204:207], a[244:247], v[172:175], v[204:207]
ds_read_b64_tr_b16 a[236:237], v240 offset:96
v_mfma_f32_16x16x32_bf16 v[204:207], a[240:243], v[164:167], v[204:207]
s_waitcnt lgkmcnt(7)
ds_read_b64_tr_b16 a[238:239], v240 offset:608
v_mfma_f32_16x16x32_bf16 v[204:207], a[248:251], v[180:183], v[204:207]
ds_read_b64_tr_b16 a[240:241], v240 offset:128
v_mfma_f32_16x16x32_bf16 v[204:207], a[252:255], v[188:191], v[204:207]
ds_read_b64_tr_b16 a[242:243], v240 offset:640
v_mfma_f32_16x16x32_bf16 v[200:203], a[252:255], v[184:187], v[200:203]
ds_read_b64_tr_b16 a[244:245], v240 offset:160
v_mfma_f32_16x16x32_bf16 v[200:203], a[248:251], v[176:179], v[200:203]
s_waitcnt lgkmcnt(7)
ds_read_b64_tr_b16 a[246:247], v240 offset:672
v_mfma_f32_16x16x32_bf16 a[0:3], a[224:227], a[160:163], a[0:3]
ds_read_b64_tr_b16 a[248:249], v240 offset:192
v_mfma_f32_16x16x32_bf16 a[4:7], a[224:227], a[164:167], a[4:7]
ds_read_b64_tr_b16 a[250:251], v240 offset:704
v_mfma_f32_16x16x32_bf16 a[8:11], a[228:231], a[160:163], a[8:11]
s_waitcnt lgkmcnt(6)
ds_read_b64_tr_b16 a[252:253], v240 offset:224
v_mfma_f32_16x16x32_bf16 a[12:15], a[228:231], a[164:167], a[12:15]
s_waitcnt vmcnt(19)
ds_read_b64_tr_b16 a[254:255], v240 offset:736
s_barrier
v_mfma_f32_16x16x32_bf16 a[16:19], a[232:235], a[160:163], a[16:19]
ds_read_b128 a[224:227], v237 offset:16896
v_max3_f32 v242, v242, v199, v200
v_mfma_f32_16x16x32_bf16 a[20:23], a[232:235], a[164:167], a[20:23]
v_max3_f32 v242, v242, v201, v202
v_max3_f32 v242, v242, v203, v204
v_mfma_f32_16x16x32_bf16 a[24:27], a[236:239], a[160:163], a[24:27]
ds_read_b128 a[228:231], v237 offset:16960
v_max3_f32 v242, v242, v205, v206
v_mfma_f32_16x16x32_bf16 a[28:31], a[236:239], a[164:167], a[28:31]
s_waitcnt lgkmcnt(6)
v_max_f32 v242, v242, v207
v_cmp_lt_f32 vcc, s32, v242
v_mfma_f32_16x16x32_bf16 a[32:35], a[240:243], a[160:163], a[32:35]
s_cbranch_vccnz L_rsB12
L_rbB12:
ds_read_b128 a[232:235], v237 offset:17024
buffer_load_dwordx4 v249, s[8:11], s29 offen offset:3168 nt lds
v_mfma_f32_16x16x32_bf16 a[36:39], a[240:243], a[164:167], a[36:39]
v_exp_f32 v192, v192
v_mfma_f32_16x16x32_bf16 a[40:43], a[244:247], a[160:163], a[40:43]
ds_read_b128 a[236:239], v237 offset:17088
v_mfma_f32_16x16x32_bf16 a[44:47], a[244:247], a[164:167], a[44:47]
s_waitcnt lgkmcnt(4)
v_exp_f32 v193, v193
v_mfma_f32_16x16x32_bf16 a[48:51], a[248:251], a[160:163], a[48:51]
s_add_u32 m0, s28, 33792
ds_read_b128 a[240:243], v237 offset:17152
s_mov_b32 s45, 2097664
v_mfma_f32_16x16x32_bf16 a[52:55], a[248:251], a[164:167], a[52:55]
v_exp_f32 v194, v194
v_mfma_f32_16x16x32_bf16 a[56:59], a[252:255], a[160:163], a[56:59]
ds_read_b128 a[244:247], v237 offset:17216
v_cvt_pk_bf16_f32 v96, v192, v193
v_mfma_f32_16x16x32_bf16 a[60:63], a[252:255], a[164:167], a[60:63]
s_waitcnt lgkmcnt(4)
v_exp_f32 v195, v195
v_mfma_f32_16x16x32_bf16 v[208:211], a[224:227], v[128:131], v[224:227]
ds_read_b128 a[248:251], v237 offset:17280
v_mfma_f32_16x16x32_bf16 v[208:211], a[228:231], v[136:139], v[208:211]
v_exp_f32 v196, v196
v_mfma_f32_16x16x32_bf16 v[212:215], a[228:231], v[140:143], v[228:231]
ds_read_b128 a[252:255], v237 offset:17344
v_cvt_pk_bf16_f32 v97, v194, v195
v_mfma_f32_16x16x32_bf16 v[212:215], a[224:227], v[132:135], v[212:215]
s_waitcnt lgkmcnt(4)
v_exp_f32 v197, v197
v_mfma_f32_16x16x32_bf16 v[212:215], a[232:235], v[148:151], v[212:215]
ds_read_b128 a[224:227], v237 offset:17408
buffer_load_dwordx4 v250, s[12:15], s45 offen offset:0 lds
v_mfma_f32_16x16x32_bf16 v[212:215], a[236:239], v[156:159], v[212:215]
v_exp_f32 v198, v198
v_mfma_f32_16x16x32_bf16 v[208:211], a[236:239], v[152:155], v[208:211]
ds_read_b128 a[228:231], v237 offset:17472
v_cvt_pk_bf16_f32 v100, v196, v197
v_mfma_f32_16x16x32_bf16 v[208:211], a[232:235], v[144:147], v[208:211]
s_waitcnt lgkmcnt(4)
v_exp_f32 v199, v199
v_mfma_f32_16x16x32_bf16 v[208:211], a[240:243], v[160:163], v[208:211]
ds_read_b128 a[232:235], v237 offset:17536
buffer_load_dwordx4 v251, s[12:15], s45 offen offset:1056 lds
v_mfma_f32_16x16x32_bf16 v[208:211], a[244:247], v[168:171], v[208:211]
v_exp_f32 v200, v200
v_mfma_f32_16x16x32_bf16 v[212:215], a[244:247], v[172:175], v[212:215]
ds_read_b128 a[236:239], v237 offset:17600
v_cvt_pk_bf16_f32 v101, v198, v199
v_mfma_f32_16x16x32_bf16 v[212:215], a[240:243], v[164:167], v[212:215]
s_waitcnt lgkmcnt(4)
v_exp_f32 v201, v201
v_mfma_f32_16x16x32_bf16 v[212:215], a[248:251], v[180:183], v[212:215]
ds_read_b128 a[240:243], v237 offset:17664
buffer_load_dwordx4 v252, s[12:15], s45 offen offset:2112 lds
v_mfma_f32_16x16x32_bf16 v[212:215], a[252:255], v[188:191], v[212:215]
v_exp_f32 v202, v202
v_cvt_pk_bf16_f32 v98, v200, v201
v_mfma_f32_16x16x32_bf16 v[208:211], a[252:255], v[184:187], v[208:211]
ds_read_b128 a[244:247], v237 offset:17728
v_exp_f32 v203, v203
v_mfma_f32_16x16x32_bf16 v[208:211], a[248:251], v[176:179], v[208:211]
s_waitcnt lgkmcnt(4)
v_exp_f32 v204, v204
v_cvt_pk_bf16_f32 v99, v202, v203
v_mfma_f32_16x16x32_bf16 v[216:219], a[224:227], v[128:131], v[224:227]
ds_read_b128 a[248:251], v237 offset:17792
v_exp_f32 v205, v205
v_mfma_f32_16x16x32_bf16 v[216:219], a[228:231], v[136:139], v[216:219]
v_exp_f32 v206, v206
v_cvt_pk_bf16_f32 v102, v204, v205
v_mfma_f32_16x16x32_bf16 v[220:223], a[228:231], v[140:143], v[228:231]
ds_read_b128 a[252:255], v237 offset:17856
v_exp_f32 v207, v207
v_mfma_f32_16x16x32_bf16 v[220:223], a[224:227], v[132:135], v[220:223]
s_waitcnt lgkmcnt(4)
buffer_load_dwordx4 v253, s[12:15], s45 offen offset:3168 lds
v_cvt_pk_bf16_f32 v103, v206, v207
v_mfma_f32_16x16x32_bf16 v[220:223], a[232:235], v[148:151], v[220:223]
s_add_u32 m0, s28, 50688
ds_read_b64_tr_b16 a[224:225], v240 offset:256
v_max3_f32 v242, v208, v209, v210
v_mfma_f32_16x16x32_bf16 v[220:223], a[236:239], v[156:159], v[220:223]
s_mov_b32 s29, 131072
ds_read_b64_tr_b16 a[226:227], v240 offset:768
v_max3_f32 v242, v242, v211, v212
v_mfma_f32_16x16x32_bf16 v[216:219], a[236:239], v[152:155], v[216:219]
ds_read_b64_tr_b16 a[228:229], v240 offset:288
v_max3_f32 v242, v242, v213, v214
v_mfma_f32_16x16x32_bf16 v[216:219], a[232:235], v[144:147], v[216:219]
s_waitcnt lgkmcnt(5)
ds_read_b64_tr_b16 a[230:231], v240 offset:800
v_mfma_f32_16x16x32_bf16 v[216:219], a[240:243], v[160:163], v[216:219]
ds_read_b64_tr_b16 a[232:233], v240 offset:320
buffer_load_dwordx4 v246, s[8:11], s29 offen offset:0 nt lds
v_mfma_f32_16x16x32_bf16 v[216:219], a[244:247], v[168:171], v[216:219]
ds_read_b64_tr_b16 a[234:235], v240 offset:832
v_mfma_f32_16x16x32_bf16 v[220:223], a[244:247], v[172:175], v[220:223]
ds_read_b64_tr_b16 a[236:237], v240 offset:352
v_mfma_f32_16x16x32_bf16 v[220:223], a[240:243], v[164:167], v[220:223]
s_waitcnt lgkmcnt(7)
ds_read_b64_tr_b16 a[238:239], v240 offset:864
v_mfma_f32_16x16x32_bf16 v[220:223], a[248:251], v[180:183], v[220:223]
ds_read_b64_tr_b16 a[240:241], v240 offset:384
v_mfma_f32_16x16x32_bf16 v[220:223], a[252:255], v[188:191], v[220:223]
ds_read_b64_tr_b16 a[242:243], v240 offset:896
v_mfma_f32_16x16x32_bf16 v[216:219], a[252:255], v[184:187], v[216:219]
ds_read_b64_tr_b16 a[244:245], v240 offset:416
buffer_load_dwordx4 v247, s[8:11], s29 offen offset:1056 nt lds
v_mfma_f32_16x16x32_bf16 v[216:219], a[248:251], v[176:179], v[216:219]
s_waitcnt lgkmcnt(7)
ds_read_b64_tr_b16 a[246:247], v240 offset:928
v_mfma_f32_16x16x32_bf16 a[64:67], a[224:227], a[160:163], a[64:67]
ds_read_b64_tr_b16 a[248:249], v240 offset:448
v_mfma_f32_16x16x32_bf16 a[68:71], a[224:227], a[164:167], a[68:71]
ds_read_b64_tr_b16 a[250:251], v240 offset:960
v_mfma_f32_16x16x32_bf16 a[72:75], a[228:231], a[160:163], a[72:75]
s_waitcnt lgkmcnt(6)
ds_read_b64_tr_b16 a[252:253], v240 offset:480
v_mfma_f32_16x16x32_bf16 a[76:79], a[228:231], a[164:167], a[76:79]
s_waitcnt vmcnt(14)
ds_read_b64_tr_b16 a[254:255], v240 offset:992
s_barrier
v_mfma_f32_16x16x32_bf16 a[80:83], a[232:235], a[160:163], a[80:83]
ds_read_b128 a[224:227], v237 offset:33792
v_max3_f32 v242, v242, v215, v216
v_mfma_f32_16x16x32_bf16 a[84:87], a[232:235], a[164:167], a[84:87]
v_max3_f32 v242, v242, v217, v218
v_max3_f32 v242, v242, v219, v220
v_mfma_f32_16x16x32_bf16 a[88:91], a[236:239], a[160:163], a[88:91]
ds_read_b128 a[228:231], v237 offset:33856
v_max3_f32 v242, v242, v221, v222
v_mfma_f32_16x16x32_bf16 a[92:95], a[236:239], a[164:167], a[92:95]
s_waitcnt lgkmcnt(6)
v_max_f32 v242, v242, v223
v_cmp_lt_f32 vcc, s32, v242
v_mfma_f32_16x16x32_bf16 a[96:99], a[240:243], a[160:163], a[96:99]
s_cbranch_vccnz L_rsB13
L_rbB13:
ds_read_b128 a[232:235], v237 offset:33920
buffer_load_dwordx4 v248, s[8:11], s29 offen offset:2112 nt lds
v_mfma_f32_16x16x32_bf16 a[100:103], a[240:243], a[164:167], a[100:103]
v_exp_f32 v208, v208
v_mfma_f32_16x16x32_bf16 a[104:107], a[244:247], a[160:163], a[104:107]
ds_read_b128 a[236:239], v237 offset:33984
buffer_load_dwordx4 v249, s[8:11], s29 offen offset:3168 nt lds
v_mfma_f32_16x16x32_bf16 a[108:111], a[244:247], a[164:167], a[108:111]
s_waitcnt lgkmcnt(4)
v_exp_f32 v209, v209
v_mfma_f32_16x16x32_bf16 a[112:115], a[248:251], a[160:163], a[112:115]
s_add_u32 m0, s28, 84480
ds_read_b128 a[240:243], v237 offset:34048
s_mov_b32 s29, 196608
v_mfma_f32_16x16x32_bf16 a[116:119], a[248:251], a[164:167], a[116:119]
v_exp_f32 v210, v210
v_mfma_f32_16x16x32_bf16 a[120:123], a[252:255], a[160:163], a[120:123]
ds_read_b128 a[244:247], v237 offset:34112
v_cvt_pk_bf16_f32 v104, v208, v209
v_mfma_f32_16x16x32_bf16 a[124:127], a[252:255], a[164:167], a[124:127]
s_waitcnt lgkmcnt(4)
v_exp_f32 v211, v211
v_mfma_f32_16x16x32_bf16 v[192:195], a[224:227], v[128:131], v[224:227]
ds_read_b128 a[248:251], v237 offset:34176
v_mfma_f32_16x16x32_bf16 v[192:195], a[228:231], v[136:139], v[192:195]
v_exp_f32 v212, v212
v_mfma_f32_16x16x32_bf16 v[196:199], a[228:231], v[140:143], v[228:231]
ds_read_b128 a[252:255], v237 offset:34240
v_cvt_pk_bf16_f32 v105, v210, v211
v_mfma_f32_16x16x32_bf16 v[196:199], a[224:227], v[132:135], v[196:199]
s_waitcnt lgkmcnt(4)
v_exp_f32 v213, v213
v_mfma_f32_16x16x32_bf16 v[196:199], a[232:235], v[148:151], v[196:199]
ds_read_b128 a[224:227], v237 offset:34304
buffer_load_dwordx4 v246, s[8:11], s29 offen offset:0 nt lds
v_mfma_f32_16x16x32_bf16 v[196:199], a[236:239], v[156:159], v[196:199]
v_exp_f32 v214, v214
v_mfma_f32_16x16x32_bf16 v[192:195], a[236:239], v[152:155], v[192:195]
ds_read_b128 a[228:231], v237 offset:34368
v_cvt_pk_bf16_f32 v108, v212, v213
v_mfma_f32_16x16x32_bf16 v[192:195], a[232:235], v[144:147], v[192:195]
s_waitcnt lgkmcnt(4)
v_exp_f32 v215, v215
v_mfma_f32_16x16x32_bf16 v[192:195], a[240:243], v[160:163], v[192:195]
ds_read_b128 a[232:235], v237 offset:34432
v_mfma_f32_16x16x32_bf16 v[192:195], a[244:247], v[168:171], v[192:195]
v_exp_f32 v216, v216
v_mfma_f32_16x16x32_bf16 v[196:199], a[244:247], v[172:175], v[196:199]
ds_read_b128 a[236:239], v237 offset:34496
v_cvt_pk_bf16_f32 v109, v214, v215
v_mfma_f32_16x16x32_bf16 v[196:199], a[240:243], v[164:167], v[196:199]
s_waitcnt lgkmcnt(4)
v_exp_f32 v217, v217
v_mfma_f32_16x16x32_bf16 v[196:199], a[248:251], v[180:183], v[196:199]
ds_read_b128 a[240:243], v237 offset:34560
buffer_load_dwordx4 v247, s[8:11], s29 offen offset:1056 nt lds
v_mfma_f32_16x16x32_bf16 v[196:199], a[252:255], v[188:191], v[196:199]
v_exp_f32 v218, v218
v_cvt_pk_bf16_f32 v106, v216, v217
v_mfma_f32_16x16x32_bf16 v[192:195], a[252:255], v[184:187], v[192:195]
ds_read_b128 a[244:247], v237 offset:34624
v_exp_f32 v219, v219
v_mfma_f32_16x16x32_bf16 v[192:195], a[248:251], v[176:179], v[192:195]
s_waitcnt lgkmcnt(4)
v_exp_f32 v220, v220
v_cvt_pk_bf16_f32 v107, v218, v219
v_mfma_f32_16x16x32_bf16 v[200:203], a[224:227], v[128:131], v[224:227]
ds_read_b128 a[248:251], v237 offset:34688
v_exp_f32 v221, v221
v_mfma_f32_16x16x32_bf16 v[200:203], a[228:231], v[136:139], v[200:203]
v_exp_f32 v222, v222
v_cvt_pk_bf16_f32 v110, v220, v221
v_mfma_f32_16x16x32_bf16 v[204:207], a[228:231], v[140:143], v[228:231]
ds_read_b128 a[252:255], v237 offset:34752
v_exp_f32 v223, v223
v_mfma_f32_16x16x32_bf16 v[204:207], a[224:227], v[132:135], v[204:207]
s_waitcnt lgkmcnt(4)
v_cvt_pk_bf16_f32 v111, v222, v223
v_mfma_f32_16x16x32_bf16 v[204:207], a[232:235], v[148:151], v[204:207]
ds_read_b64_tr_b16 a[224:225], v241 offset:0
v_max3_f32 v242, v192, v193, v194
v_mfma_f32_16x16x32_bf16 v[204:207], a[236:239], v[156:159], v[204:207]
ds_read_b64_tr_b16 a[226:227], v241 offset:512
v_max3_f32 v242, v242, v195, v196
v_mfma_f32_16x16x32_bf16 v[200:203], a[236:239], v[152:155], v[200:203]
ds_read_b64_tr_b16 a[228:229], v241 offset:32
v_max3_f32 v242, v242, v197, v198
v_mfma_f32_16x16x32_bf16 v[200:203], a[232:235], v[144:147], v[200:203]
s_waitcnt lgkmcnt(5)
ds_read_b64_tr_b16 a[230:231], v241 offset:544
v_mfma_f32_16x16x32_bf16 v[200:203], a[240:243], v[160:163], v[200:203]
ds_read_b64_tr_b16 a[232:233], v241 offset:64
buffer_load_dwordx4 v248, s[8:11], s29 offen offset:2112 nt lds
v_mfma_f32_16x16x32_bf16 v[200:203], a[244:247], v[168:171], v[200:203]
ds_read_b64_tr_b16 a[234:235], v241 offset:576
v_mfma_f32_16x16x32_bf16 v[204:207], a[244:247], v[172:175], v[204:207]
ds_read_b64_tr_b16 a[236:237], v241 offset:96
v_mfma_f32_16x16x32_bf16 v[204:207], a[240:243], v[164:167], v[204:207]
s_waitcnt lgkmcnt(7)
ds_read_b64_tr_b16 a[238:239], v241 offset:608
v_mfma_f32_16x16x32_bf16 v[204:207], a[248:251], v[180:183], v[204:207]
ds_read_b64_tr_b16 a[240:241], v241 offset:128
v_mfma_f32_16x16x32_bf16 v[204:207], a[252:255], v[188:191], v[204:207]
ds_read_b64_tr_b16 a[242:243], v241 offset:640
v_mfma_f32_16x16x32_bf16 v[200:203], a[252:255], v[184:187], v[200:203]
ds_read_b64_tr_b16 a[244:245], v241 offset:160
v_mfma_f32_16x16x32_bf16 v[200:203], a[248:251], v[176:179], v[200:203]
s_waitcnt lgkmcnt(7)
ds_read_b64_tr_b16 a[246:247], v241 offset:672
v_mfma_f32_16x16x32_bf16 a[0:3], a[224:227], a[168:171], a[0:3]
ds_read_b64_tr_b16 a[248:249], v241 offset:192
v_mfma_f32_16x16x32_bf16 a[4:7], a[224:227], a[172:175], a[4:7]
ds_read_b64_tr_b16 a[250:251], v241 offset:704
v_mfma_f32_16x16x32_bf16 a[8:11], a[228:231], a[168:171], a[8:11]
s_waitcnt lgkmcnt(6)
ds_read_b64_tr_b16 a[252:253], v241 offset:224
v_mfma_f32_16x16x32_bf16 a[12:15], a[228:231], a[172:175], a[12:15]
s_waitcnt vmcnt(19)
ds_read_b64_tr_b16 a[254:255], v241 offset:736
s_barrier
v_mfma_f32_16x16x32_bf16 a[16:19], a[232:235], a[168:171], a[16:19]
ds_read_b128 a[224:227], v237 offset:50688
v_max3_f32 v242, v242, v199, v200
v_mfma_f32_16x16x32_bf16 a[20:23], a[232:235], a[172:175], a[20:23]
v_max3_f32 v242, v242, v201, v202
v_max3_f32 v242, v242, v203, v204
v_mfma_f32_16x16x32_bf16 a[24:27], a[236:239], a[168:171], a[24:27]
ds_read_b128 a[228:231], v237 offset:50752
v_max3_f32 v242, v242, v205, v206
v_mfma_f32_16x16x32_bf16 a[28:31], a[236:239], a[172:175], a[28:31]
s_waitcnt lgkmcnt(6)
v_max_f32 v242, v242, v207
v_cmp_lt_f32 vcc, s32, v242
v_mfma_f32_16x16x32_bf16 a[32:35], a[240:243], a[168:171], a[32:35]
s_cbranch_vccnz L_rsB14
L_rbB14:
ds_read_b128 a[232:235], v237 offset:50816
buffer_load_dwordx4 v249, s[8:11], s29 offen offset:3168 nt lds
v_mfma_f32_16x16x32_bf16 a[36:39], a[240:243], a[172:175], a[36:39]
v_exp_f32 v192, v192
v_mfma_f32_16x16x32_bf16 a[40:43], a[244:247], a[168:171], a[40:43]
ds_read_b128 a[236:239], v237 offset:50880
v_mfma_f32_16x16x32_bf16 a[44:47], a[244:247], a[172:175], a[44:47]
s_waitcnt lgkmcnt(4)
v_exp_f32 v193, v193
v_mfma_f32_16x16x32_bf16 a[48:51], a[248:251], a[168:171], a[48:51]
s_add_u32 m0, s28, 67584
ds_read_b128 a[240:243], v237 offset:50944
s_mov_b32 s45, 2359808
v_mfma_f32_16x16x32_bf16 a[52:55], a[248:251], a[172:175], a[52:55]
v_exp_f32 v194, v194
v_mfma_f32_16x16x32_bf16 a[56:59], a[252:255], a[168:171], a[56:59]
ds_read_b128 a[244:247], v237 offset:51008
v_cvt_pk_bf16_f32 v112, v192, v193
v_mfma_f32_16x16x32_bf16 a[60:63], a[252:255], a[172:175], a[60:63]
s_waitcnt lgkmcnt(4)
v_exp_f32 v195, v195
v_mfma_f32_16x16x32_bf16 v[208:211], a[224:227], v[128:131], v[224:227]
ds_read_b128 a[248:251], v237 offset:51072
v_mfma_f32_16x16x32_bf16 v[208:211], a[228:231], v[136:139], v[208:211]
v_exp_f32 v196, v196
v_mfma_f32_16x16x32_bf16 v[212:215], a[228:231], v[140:143], v[228:231]
ds_read_b128 a[252:255], v237 offset:51136
v_cvt_pk_bf16_f32 v113, v194, v195
v_mfma_f32_16x16x32_bf16 v[212:215], a[224:227], v[132:135], v[212:215]
s_waitcnt lgkmcnt(4)
v_exp_f32 v197, v197
v_mfma_f32_16x16x32_bf16 v[212:215], a[232:235], v[148:151], v[212:215]
ds_read_b128 a[224:227], v237 offset:51200
buffer_load_dwordx4 v250, s[12:15], s45 offen offset:0 lds
v_mfma_f32_16x16x32_bf16 v[212:215], a[236:239], v[156:159], v[212:215]
v_exp_f32 v198, v198
v_mfma_f32_16x16x32_bf16 v[208:211], a[236:239], v[152:155], v[208:211]
ds_read_b128 a[228:231], v237 offset:51264
v_cvt_pk_bf16_f32 v116, v196, v197
v_mfma_f32_16x16x32_bf16 v[208:211], a[232:235], v[144:147], v[208:211]
s_waitcnt lgkmcnt(4)
v_exp_f32 v199, v199
v_mfma_f32_16x16x32_bf16 v[208:211], a[240:243], v[160:163], v[208:211]
ds_read_b128 a[232:235], v237 offset:51328
buffer_load_dwordx4 v251, s[12:15], s45 offen offset:1056 lds
v_mfma_f32_16x16x32_bf16 v[208:211], a[244:247], v[168:171], v[208:211]
v_exp_f32 v200, v200
v_mfma_f32_16x16x32_bf16 v[212:215], a[244:247], v[172:175], v[212:215]
ds_read_b128 a[236:239], v237 offset:51392
v_cvt_pk_bf16_f32 v117, v198, v199
v_mfma_f32_16x16x32_bf16 v[212:215], a[240:243], v[164:167], v[212:215]
s_waitcnt lgkmcnt(4)
v_exp_f32 v201, v201
v_mfma_f32_16x16x32_bf16 v[212:215], a[248:251], v[180:183], v[212:215]
ds_read_b128 a[240:243], v237 offset:51456
buffer_load_dwordx4 v252, s[12:15], s45 offen offset:2112 lds
v_mfma_f32_16x16x32_bf16 v[212:215], a[252:255], v[188:191], v[212:215]
v_exp_f32 v202, v202
v_cvt_pk_bf16_f32 v114, v200, v201
v_mfma_f32_16x16x32_bf16 v[208:211], a[252:255], v[184:187], v[208:211]
ds_read_b128 a[244:247], v237 offset:51520
v_exp_f32 v203, v203
v_mfma_f32_16x16x32_bf16 v[208:211], a[248:251], v[176:179], v[208:211]
s_waitcnt lgkmcnt(4)
v_exp_f32 v204, v204
v_cvt_pk_bf16_f32 v115, v202, v203
v_mfma_f32_16x16x32_bf16 v[216:219], a[224:227], v[128:131], v[224:227]
ds_read_b128 a[248:251], v237 offset:51584
v_exp_f32 v205, v205
v_mfma_f32_16x16x32_bf16 v[216:219], a[228:231], v[136:139], v[216:219]
v_exp_f32 v206, v206
v_cvt_pk_bf16_f32 v118, v204, v205
v_mfma_f32_16x16x32_bf16 v[220:223], a[228:231], v[140:143], v[228:231]
ds_read_b128 a[252:255], v237 offset:51648
v_exp_f32 v207, v207
v_mfma_f32_16x16x32_bf16 v[220:223], a[224:227], v[132:135], v[220:223]
s_waitcnt lgkmcnt(4)
buffer_load_dwordx4 v253, s[12:15], s45 offen offset:3168 lds
v_cvt_pk_bf16_f32 v119, v206, v207
v_mfma_f32_16x16x32_bf16 v[220:223], a[232:235], v[148:151], v[220:223]
s_add_u32 m0, s28, 101376
ds_read_b64_tr_b16 a[224:225], v241 offset:256
v_max3_f32 v242, v208, v209, v210
v_mfma_f32_16x16x32_bf16 v[220:223], a[236:239], v[156:159], v[220:223]
s_mov_b32 s29, 128
ds_read_b64_tr_b16 a[226:227], v241 offset:768
v_max3_f32 v242, v242, v211, v212
v_mfma_f32_16x16x32_bf16 v[216:219], a[236:239], v[152:155], v[216:219]
ds_read_b64_tr_b16 a[228:229], v241 offset:288
v_max3_f32 v242, v242, v213, v214
v_mfma_f32_16x16x32_bf16 v[216:219], a[232:235], v[144:147], v[216:219]
s_waitcnt lgkmcnt(5)
ds_read_b64_tr_b16 a[230:231], v241 offset:800
v_mfma_f32_16x16x32_bf16 v[216:219], a[240:243], v[160:163], v[216:219]
ds_read_b64_tr_b16 a[232:233], v241 offset:320
buffer_load_dwordx4 v246, s[8:11], s29 offen offset:0 nt lds
v_mfma_f32_16x16x32_bf16 v[216:219], a[244:247], v[168:171], v[216:219]
ds_read_b64_tr_b16 a[234:235], v241 offset:832
v_mfma_f32_16x16x32_bf16 v[220:223], a[244:247], v[172:175], v[220:223]
ds_read_b64_tr_b16 a[236:237], v241 offset:352
v_mfma_f32_16x16x32_bf16 v[220:223], a[240:243], v[164:167], v[220:223]
s_waitcnt lgkmcnt(7)
ds_read_b64_tr_b16 a[238:239], v241 offset:864
v_mfma_f32_16x16x32_bf16 v[220:223], a[248:251], v[180:183], v[220:223]
ds_read_b64_tr_b16 a[240:241], v241 offset:384
v_mfma_f32_16x16x32_bf16 v[220:223], a[252:255], v[188:191], v[220:223]
ds_read_b64_tr_b16 a[242:243], v241 offset:896
v_mfma_f32_16x16x32_bf16 v[216:219], a[252:255], v[184:187], v[216:219]
ds_read_b64_tr_b16 a[244:245], v241 offset:416
buffer_load_dwordx4 v247, s[8:11], s29 offen offset:1056 nt lds
v_mfma_f32_16x16x32_bf16 v[216:219], a[248:251], v[176:179], v[216:219]
s_waitcnt lgkmcnt(7)
ds_read_b64_tr_b16 a[246:247], v241 offset:928
v_mfma_f32_16x16x32_bf16 a[64:67], a[224:227], a[168:171], a[64:67]
ds_read_b64_tr_b16 a[248:249], v241 offset:448
v_mfma_f32_16x16x32_bf16 a[68:71], a[224:227], a[172:175], a[68:71]
ds_read_b64_tr_b16 a[250:251], v241 offset:960
v_mfma_f32_16x16x32_bf16 a[72:75], a[228:231], a[168:171], a[72:75]
s_waitcnt lgkmcnt(6)
ds_read_b64_tr_b16 a[252:253], v241 offset:480
v_mfma_f32_16x16x32_bf16 a[76:79], a[228:231], a[172:175], a[76:79]
s_waitcnt vmcnt(14)
ds_read_b64_tr_b16 a[254:255], v241 offset:992
s_barrier
v_mfma_f32_16x16x32_bf16 a[80:83], a[232:235], a[168:171], a[80:83]
ds_read_b64_tr_b16 a[224:225], v239 offset:16896
buffer_load_dwordx4 v248, s[8:11], s29 offen offset:2112 nt lds
v_max3_f32 v242, v242, v215, v216
v_mfma_f32_16x16x32_bf16 a[84:87], a[232:235], a[172:175], a[84:87]
ds_read_b64_tr_b16 a[226:227], v239 offset:17024
v_max3_f32 v242, v242, v217, v218
v_mfma_f32_16x16x32_bf16 a[88:91], a[236:239], a[168:171], a[88:91]
ds_read_b64_tr_b16 a[228:229], v239 offset:17152
v_max3_f32 v242, v242, v219, v220
v_mfma_f32_16x16x32_bf16 a[92:95], a[236:239], a[172:175], a[92:95]
s_waitcnt lgkmcnt(7)
ds_read_b64_tr_b16 a[230:231], v239 offset:17280
v_max3_f32 v242, v242, v221, v222
v_mfma_f32_16x16x32_bf16 a[96:99], a[240:243], a[168:171], a[96:99]
ds_read_b64_tr_b16 a[232:233], v239 offset:17408
v_max_f32 v242, v242, v223
v_mfma_f32_16x16x32_bf16 a[100:103], a[240:243], a[172:175], a[100:103]
ds_read_b64_tr_b16 a[234:235], v239 offset:17536
v_cmp_lt_f32 vcc, s32, v242
v_mfma_f32_16x16x32_bf16 a[104:107], a[244:247], a[168:171], a[104:107]
s_cbranch_vccnz L_rsB15
L_rbB15:
ds_read_b64_tr_b16 a[236:237], v239 offset:17664
buffer_load_dwordx4 v249, s[8:11], s29 offen offset:3168 nt lds
v_mfma_f32_16x16x32_bf16 a[108:111], a[244:247], a[172:175], a[108:111]
s_waitcnt lgkmcnt(7)
ds_read_b64_tr_b16 a[238:239], v239 offset:17792
s_add_u32 m0, s28, 118272
v_mfma_f32_16x16x32_bf16 a[112:115], a[248:251], a[168:171], a[112:115]
s_mov_b32 s29, 65664
ds_read_b64_tr_b16 a[240:241], v239 offset:16928
v_mfma_f32_16x16x32_bf16 a[116:119], a[248:251], a[172:175], a[116:119]
ds_read_b64_tr_b16 a[242:243], v239 offset:17056
v_mfma_f32_16x16x32_bf16 a[120:123], a[252:255], a[168:171], a[120:123]
ds_read_b64_tr_b16 a[244:245], v239 offset:17184
v_mfma_f32_16x16x32_bf16 a[124:127], a[252:255], a[172:175], a[124:127]
ds_read_b64_tr_b16 a[246:247], v239 offset:17312
v_exp_f32 v208, v208
v_mfma_f32_16x16x32_bf16 v[224:227], v[232:235], v[0:3], 0
v_exp_f32 v209, v209
v_mfma_f32_16x16x32_bf16 v[224:227], v[232:235], v[8:11], v[224:227]
buffer_load_dwordx4 v246, s[8:11], s29 offen offset:0 nt lds
v_exp_f32 v210, v210
v_cvt_pk_bf16_f32 v120, v208, v209
v_mfma_f32_16x16x32_bf16 v[224:227], v[232:235], v[16:19], v[224:227]
v_exp_f32 v211, v211
v_mfma_f32_16x16x32_bf16 v[224:227], v[232:235], v[24:27], v[224:227]
s_waitcnt lgkmcnt(8)
v_exp_f32 v212, v212
v_cvt_pk_bf16_f32 v121, v210, v211
v_mfma_f32_16x16x32_bf16 v[192:195], a[224:227], v[0:3], 0
ds_read_b64_tr_b16 a[248:249], v239 offset:17440
v_exp_f32 v213, v213
v_mfma_f32_16x16x32_bf16 v[192:195], a[228:231], v[8:11], v[192:195]
ds_read_b64_tr_b16 a[250:251], v239 offset:17568
v_exp_f32 v214, v214
v_mfma_f32_16x16x32_bf16 v[196:199], a[228:231], v[12:15], 0
ds_read_b64_tr_b16 a[252:253], v239 offset:17696
v_cvt_pk_bf16_f32 v124, v212, v213
v_mfma_f32_16x16x32_bf16 v[196:199], a[224:227], v[4:7], v[196:199]
s_waitcnt lgkmcnt(7)
ds_read_b64_tr_b16 a[254:255], v239 offset:17824
v_exp_f32 v215, v215
v_mfma_f32_16x16x32_bf16 v[196:199], a[232:235], v[20:23], v[196:199]
ds_read_b64_tr_b16 a[224:225], v239 offset:16960
v_exp_f32 v216, v216
v_mfma_f32_16x16x32_bf16 v[196:199], a[236:239], v[28:31], v[196:199]
ds_read_b64_tr_b16 a[226:227], v239 offset:17088
v_cvt_pk_bf16_f32 v125, v214, v215
v_mfma_f32_16x16x32_bf16 v[192:195], a[236:239], v[24:27], v[192:195]
ds_read_b64_tr_b16 a[228:229], v239 offset:17216
v_exp_f32 v217, v217
v_mfma_f32_16x16x32_bf16 v[192:195], a[232:235], v[16:19], v[192:195]
s_waitcnt lgkmcnt(7)
ds_read_b64_tr_b16 a[230:231], v239 offset:17344
v_exp_f32 v218, v218
v_mfma_f32_16x16x32_bf16 v[200:203], a[240:243], v[0:3], 0
ds_read_b64_tr_b16 a[232:233], v239 offset:17472
v_cvt_pk_bf16_f32 v122, v216, v217
v_mfma_f32_16x16x32_bf16 v[200:203], a[244:247], v[8:11], v[200:203]
ds_read_b64_tr_b16 a[234:235], v239 offset:17600
v_exp_f32 v219, v219
v_mfma_f32_16x16x32_bf16 v[204:207], a[244:247], v[12:15], 0
ds_read_b64_tr_b16 a[236:237], v239 offset:17728
v_exp_f32 v220, v220
v_mfma_f32_16x16x32_bf16 v[204:207], a[240:243], v[4:7], v[204:207]
s_waitcnt lgkmcnt(7)
ds_read_b64_tr_b16 a[238:239], v239 offset:17856
v_cvt_pk_bf16_f32 v123, v218, v219
v_mfma_f32_16x16x32_bf16 v[204:207], a[248:251], v[20:23], v[204:207]
ds_read_b64_tr_b16 a[240:241], v239 offset:16992
v_exp_f32 v221, v221
v_mfma_f32_16x16x32_bf16 v[204:207], a[252:255], v[28:31], v[204:207]
ds_read_b64_tr_b16 a[242:243], v239 offset:17120
v_exp_f32 v222, v222
v_mfma_f32_16x16x32_bf16 v[200:203], a[252:255], v[24:27], v[200:203]
ds_read_b64_tr_b16 a[244:245], v239 offset:17248
v_cvt_pk_bf16_f32 v126, v220, v221
v_mfma_f32_16x16x32_bf16 v[200:203], a[248:251], v[16:19], v[200:203]
ds_read_b64_tr_b16 a[246:247], v239 offset:17376
v_exp_f32 v223, v223
v_mfma_f32_16x16x32_bf16 v[228:231], v[232:235], v[4:7], 0
v_cvt_pk_bf16_f32 v127, v222, v223
v_mfma_f32_16x16x32_bf16 v[228:231], v[232:235], v[12:15], v[228:231]
buffer_load_dwordx4 v247, s[8:11], s29 offen offset:1056 nt lds
v_mfma_f32_16x16x32_bf16 v[228:231], v[232:235], v[20:23], v[228:231]
v_mfma_f32_16x16x32_bf16 v[228:231], v[232:235], v[28:31], v[228:231]
s_waitcnt lgkmcnt(8)
v_mfma_f32_16x16x32_bf16 v[208:211], a[224:227], v[0:3], 0
ds_read_b64_tr_b16 a[248:249], v239 offset:17504
v_mfma_f32_16x16x32_bf16 v[208:211], a[228:231], v[8:11], v[208:211]
ds_read_b64_tr_b16 a[250:251], v239 offset:17632
v_mfma_f32_16x16x32_bf16 v[212:215], a[228:231], v[12:15], 0
ds_read_b64_tr_b16 a[252:253], v239 offset:17760
v_mfma_f32_16x16x32_bf16 v[212:215], a[224:227], v[4:7], v[212:215]
s_waitcnt lgkmcnt(7)
ds_read_b64_tr_b16 a[254:255], v239 offset:17888
v_mfma_f32_16x16x32_bf16 v[212:215], a[232:235], v[20:23], v[212:215]
ds_read_b64_tr_b16 a[224:225], v239 offset:33792
buffer_load_dwordx4 v248, s[8:11], s29 offen offset:2112 nt lds
v_mfma_f32_16x16x32_bf16 v[212:215], a[236:239], v[28:31], v[212:215]
ds_read_b64_tr_b16 a[226:227], v239 offset:34304
v_mfma_f32_16x16x32_bf16 v[208:211], a[236:239], v[24:27], v[208:211]
ds_read_b64_tr_b16 a[228:229], v239 offset:33824
v_mfma_f32_16x16x32_bf16 v[208:211], a[232:235], v[16:19], v[208:211]
s_waitcnt lgkmcnt(7)
ds_read_b64_tr_b16 a[230:231], v239 offset:34336
v_mfma_f32_16x16x32_bf16 v[216:219], a[240:243], v[0:3], 0
ds_read_b64_tr_b16 a[232:233], v239 offset:33856
v_mfma_f32_16x16x32_bf16 v[216:219], a[244:247], v[8:11], v[216:219]
ds_read_b64_tr_b16 a[234:235], v239 offset:34368
v_mfma_f32_16x16x32_bf16 v[220:223], a[244:247], v[12:15], 0
ds_read_b64_tr_b16 a[236:237], v239 offset:33888
v_mfma_f32_16x16x32_bf16 v[220:223], a[240:243], v[4:7], v[220:223]
s_waitcnt lgkmcnt(7)
ds_read_b64_tr_b16 a[238:239], v239 offset:34400
v_mfma_f32_16x16x32_bf16 v[220:223], a[248:251], v[20:23], v[220:223]
ds_read_b64_tr_b16 a[240:241], v239 offset:33920
v_mfma_f32_16x16x32_bf16 v[220:223], a[252:255], v[28:31], v[220:223]
ds_read_b64_tr_b16 a[242:243], v239 offset:34432
v_mfma_f32_16x16x32_bf16 v[216:219], a[252:255], v[24:27], v[216:219]
ds_read_b64_tr_b16 a[244:245], v239 offset:33952
v_mfma_f32_16x16x32_bf16 v[216:219], a[248:251], v[16:19], v[216:219]
s_waitcnt lgkmcnt(7)
ds_read_b64_tr_b16 a[246:247], v239 offset:34464
v_mfma_f32_16x16x32_bf16 a[0:3], a[224:227], a[176:179], a[0:3]
ds_read_b64_tr_b16 a[248:249], v239 offset:33984
v_mfma_f32_16x16x32_bf16 a[4:7], a[224:227], a[180:183], a[4:7]
ds_read_b64_tr_b16 a[250:251], v239 offset:34496
v_mfma_f32_16x16x32_bf16 a[8:11], a[228:231], a[176:179], a[8:11]
s_waitcnt lgkmcnt(6)
ds_read_b64_tr_b16 a[252:253], v239 offset:34016
buffer_load_dwordx4 v249, s[8:11], s29 offen offset:3168 nt lds
v_mfma_f32_16x16x32_bf16 a[12:15], a[228:231], a[180:183], a[12:15]
s_waitcnt vmcnt(20)
ds_read_b64_tr_b16 a[254:255], v239 offset:34528
s_barrier
v_mfma_f32_16x16x32_bf16 a[16:19], a[232:235], a[176:179], a[16:19]
ds_read_b64_tr_b16 a[224:225], v239 offset:0
v_mfma_f32_16x16x32_bf16 a[20:23], a[232:235], a[180:183], a[20:23]
ds_read_b64_tr_b16 a[226:227], v239 offset:128
v_mfma_f32_16x16x32_bf16 a[24:27], a[236:239], a[176:179], a[24:27]
ds_read_b64_tr_b16 a[228:229], v239 offset:256
v_mfma_f32_16x16x32_bf16 a[28:31], a[236:239], a[180:183], a[28:31]
s_waitcnt lgkmcnt(7)
ds_read_b64_tr_b16 a[230:231], v239 offset:384
v_mfma_f32_16x16x32_bf16 a[32:35], a[240:243], a[176:179], a[32:35]
ds_read_b64_tr_b16 a[232:233], v239 offset:512
v_mfma_f32_16x16x32_bf16 a[36:39], a[240:243], a[180:183], a[36:39]
s_add_u32 m0, s28, 135168
ds_read_b64_tr_b16 a[234:235], v239 offset:640
s_mov_b32 s45, 2621952
v_mfma_f32_16x16x32_bf16 a[40:43], a[244:247], a[176:179], a[40:43]
ds_read_b64_tr_b16 a[236:237], v239 offset:768
v_mfma_f32_16x16x32_bf16 a[44:47], a[244:247], a[180:183], a[44:47]
s_waitcnt lgkmcnt(7)
ds_read_b64_tr_b16 a[238:239], v239 offset:896
v_mfma_f32_16x16x32_bf16 a[48:51], a[248:251], a[176:179], a[48:51]
ds_read_b64_tr_b16 a[240:241], v239 offset:32
v_mfma_f32_16x16x32_bf16 a[52:55], a[248:251], a[180:183], a[52:55]
ds_read_b64_tr_b16 a[242:243], v239 offset:160
v_mfma_f32_16x16x32_bf16 a[56:59], a[252:255], a[176:179], a[56:59]
ds_read_b64_tr_b16 a[244:245], v239 offset:288
v_mfma_f32_16x16x32_bf16 a[60:63], a[252:255], a[180:183], a[60:63]
ds_read_b64_tr_b16 a[246:247], v239 offset:416
v_mfma_f32_16x16x32_bf16 v[224:227], v[232:235], v[32:35], v[224:227]
v_mfma_f32_16x16x32_bf16 v[224:227], v[232:235], v[40:43], v[224:227]
buffer_load_dwordx4 v250, s[12:15], s45 offen offset:0 lds
v_mfma_f32_16x16x32_bf16 v[224:227], v[232:235], v[48:51], v[224:227]
v_mfma_f32_16x16x32_bf16 v[224:227], v[232:235], v[56:59], v[224:227]
s_waitcnt lgkmcnt(8)
v_mfma_f32_16x16x32_bf16 v[192:195], a[224:227], v[32:35], v[192:195]
ds_read_b64_tr_b16 a[248:249], v239 offset:544
v_mfma_f32_16x16x32_bf16 v[192:195], a[228:231], v[40:43], v[192:195]
ds_read_b64_tr_b16 a[250:251], v239 offset:672
v_mfma_f32_16x16x32_bf16 v[196:199], a[228:231], v[44:47], v[196:199]
ds_read_b64_tr_b16 a[252:253], v239 offset:800
v_mfma_f32_16x16x32_bf16 v[196:199], a[224:227], v[36:39], v[196:199]
s_waitcnt lgkmcnt(7)
ds_read_b64_tr_b16 a[254:255], v239 offset:928
buffer_load_dwordx4 v251, s[12:15], s45 offen offset:1056 lds
v_mfma_f32_16x16x32_bf16 v[196:199], a[232:235], v[52:55], v[196:199]
ds_read_b64_tr_b16 a[224:225], v239 offset:64
v_mfma_f32_16x16x32_bf16 v[196:199], a[236:239], v[60:63], v[196:199]
ds_read_b64_tr_b16 a[226:227], v239 offset:192
v_mfma_f32_16x16x32_bf16 v[192:195], a[236:239], v[56:59], v[192:195]
ds_read_b64_tr_b16 a[228:229], v239 offset:320
v_mfma_f32_16x16x32_bf16 v[192:195], a[232:235], v[48:51], v[192:195]
s_waitcnt lgkmcnt(7)
ds_read_b64_tr_b16 a[230:231], v239 offset:448
v_mfma_f32_16x16x32_bf16 v[200:203], a[240:243], v[32:35], v[200:203]
ds_read_b64_tr_b16 a[232:233], v239 offset:576
v_mfma_f32_16x16x32_bf16 v[200:203], a[244:247], v[40:43], v[200:203]
ds_read_b64_tr_b16 a[234:235], v239 offset:704
v_mfma_f32_16x16x32_bf16 v[204:207], a[244:247], v[44:47], v[204:207]
ds_read_b64_tr_b16 a[236:237], v239 offset:832
v_mfma_f32_16x16x32_bf16 v[204:207], a[240:243], v[36:39], v[204:207]
s_waitcnt lgkmcnt(7)
ds_read_b64_tr_b16 a[238:239], v239 offset:960
v_mfma_f32_16x16x32_bf16 v[204:207], a[248:251], v[52:55], v[204:207]
ds_read_b64_tr_b16 a[240:241], v239 offset:96
v_mfma_f32_16x16x32_bf16 v[204:207], a[252:255], v[60:63], v[204:207]
ds_read_b64_tr_b16 a[242:243], v239 offset:224
v_mfma_f32_16x16x32_bf16 v[200:203], a[252:255], v[56:59], v[200:203]
ds_read_b64_tr_b16 a[244:245], v239 offset:352
v_mfma_f32_16x16x32_bf16 v[200:203], a[248:251], v[48:51], v[200:203]
ds_read_b64_tr_b16 a[246:247], v239 offset:480
v_mfma_f32_16x16x32_bf16 v[228:231], v[232:235], v[36:39], v[228:231]
buffer_load_dwordx4 v252, s[12:15], s45 offen offset:2112 lds
v_mfma_f32_16x16x32_bf16 v[228:231], v[232:235], v[44:47], v[228:231]
buffer_load_dwordx4 v253, s[12:15], s45 offen offset:3168 lds
v_mfma_f32_16x16x32_bf16 v[228:231], v[232:235], v[52:55], v[228:231]
s_add_u32 m0, s28, 16896
s_mov_b32 s29, 131200
v_mfma_f32_16x16x32_bf16 v[228:231], v[232:235], v[60:63], v[228:231]
s_waitcnt lgkmcnt(8)
v_mfma_f32_16x16x32_bf16 v[208:211], a[224:227], v[32:35], v[208:211]
ds_read_b64_tr_b16 a[248:249], v239 offset:608
v_mfma_f32_16x16x32_bf16 v[208:211], a[228:231], v[40:43], v[208:211]
ds_read_b64_tr_b16 a[250:251], v239 offset:736
v_mfma_f32_16x16x32_bf16 v[212:215], a[228:231], v[44:47], v[212:215]
ds_read_b64_tr_b16 a[252:253], v239 offset:864
v_mfma_f32_16x16x32_bf16 v[212:215], a[224:227], v[36:39], v[212:215]
s_waitcnt lgkmcnt(7)
ds_read_b64_tr_b16 a[254:255], v239 offset:992
v_mfma_f32_16x16x32_bf16 v[212:215], a[232:235], v[52:55], v[212:215]
ds_read_b64_tr_b16 a[224:225], v239 offset:34048
buffer_load_dwordx4 v246, s[8:11], s29 offen offset:0 nt lds
v_mfma_f32_16x16x32_bf16 v[212:215], a[236:239], v[60:63], v[212:215]
ds_read_b64_tr_b16 a[226:227], v239 offset:34560
v_mfma_f32_16x16x32_bf16 v[208:211], a[236:239], v[56:59], v[208:211]
ds_read_b64_tr_b16 a[228:229], v239 offset:34080
v_mfma_f32_16x16x32_bf16 v[208:211], a[232:235], v[48:51], v[208:211]
s_waitcnt lgkmcnt(7)
ds_read_b64_tr_b16 a[230:231], v239 offset:34592
v_mfma_f32_16x16x32_bf16 v[216:219], a[240:243], v[32:35], v[216:219]
ds_read_b64_tr_b16 a[232:233], v239 offset:34112
v_mfma_f32_16x16x32_bf16 v[216:219], a[244:247], v[40:43], v[216:219]
ds_read_b64_tr_b16 a[234:235], v239 offset:34624
v_mfma_f32_16x16x32_bf16 v[220:223], a[244:247], v[44:47], v[220:223]
ds_read_b64_tr_b16 a[236:237], v239 offset:34144
v_mfma_f32_16x16x32_bf16 v[220:223], a[240:243], v[36:39], v[220:223]
s_waitcnt lgkmcnt(7)
ds_read_b64_tr_b16 a[238:239], v239 offset:34656
buffer_load_dwordx4 v247, s[8:11], s29 offen offset:1056 nt lds
v_mfma_f32_16x16x32_bf16 v[220:223], a[248:251], v[52:55], v[220:223]
ds_read_b64_tr_b16 a[240:241], v239 offset:34176
v_mfma_f32_16x16x32_bf16 v[220:223], a[252:255], v[60:63], v[220:223]
ds_read_b64_tr_b16 a[242:243], v239 offset:34688
v_mfma_f32_16x16x32_bf16 v[216:219], a[252:255], v[56:59], v[216:219]
ds_read_b64_tr_b16 a[244:245], v239 offset:34208
v_mfma_f32_16x16x32_bf16 v[216:219], a[248:251], v[48:51], v[216:219]
s_waitcnt lgkmcnt(7)
ds_read_b64_tr_b16 a[246:247], v239 offset:34720
v_mfma_f32_16x16x32_bf16 a[64:67], a[224:227], a[176:179], a[64:67]
ds_read_b64_tr_b16 a[248:249], v239 offset:34240
v_mfma_f32_16x16x32_bf16 a[68:71], a[224:227], a[180:183], a[68:71]
ds_read_b64_tr_b16 a[250:251], v239 offset:34752
v_mfma_f32_16x16x32_bf16 a[72:75], a[228:231], a[176:179], a[72:75]
s_waitcnt lgkmcnt(6)
ds_read_b64_tr_b16 a[252:253], v239 offset:34272
buffer_load_dwordx4 v248, s[8:11], s29 offen offset:2112 nt lds
v_mfma_f32_16x16x32_bf16 a[76:79], a[228:231], a[180:183], a[76:79]
s_waitcnt vmcnt(15)
ds_read_b64_tr_b16 a[254:255], v239 offset:34784
s_barrier
v_mfma_f32_16x16x32_bf16 a[80:83], a[232:235], a[176:179], a[80:83]
ds_read_b64_tr_b16 a[224:225], v239 offset:50688
v_mfma_f32_16x16x32_bf16 a[84:87], a[232:235], a[180:183], a[84:87]
ds_read_b64_tr_b16 a[226:227], v239 offset:50816
v_mfma_f32_16x16x32_bf16 a[88:91], a[236:239], a[176:179], a[88:91]
ds_read_b64_tr_b16 a[228:229], v239 offset:50944
v_mfma_f32_16x16x32_bf16 a[92:95], a[236:239], a[180:183], a[92:95]
s_waitcnt lgkmcnt(7)
ds_read_b64_tr_b16 a[230:231], v239 offset:51072
v_mfma_f32_16x16x32_bf16 a[96:99], a[240:243], a[176:179], a[96:99]
ds_read_b64_tr_b16 a[232:233], v239 offset:51200
v_mfma_f32_16x16x32_bf16 a[100:103], a[240:243], a[180:183], a[100:103]
ds_read_b64_tr_b16 a[234:235], v239 offset:51328
buffer_load_dwordx4 v249, s[8:11], s29 offen offset:3168 nt lds
v_mfma_f32_16x16x32_bf16 a[104:107], a[244:247], a[176:179], a[104:107]
s_add_u32 m0, s28, 0
ds_read_b64_tr_b16 a[236:237], v239 offset:51456
s_mov_b32 s29, 196736
v_mfma_f32_16x16x32_bf16 a[108:111], a[244:247], a[180:183], a[108:111]
s_waitcnt lgkmcnt(7)
ds_read_b64_tr_b16 a[238:239], v239 offset:51584
v_mfma_f32_16x16x32_bf16 a[112:115], a[248:251], a[176:179], a[112:115]
ds_read_b64_tr_b16 a[240:241], v239 offset:50720
v_mfma_f32_16x16x32_bf16 a[116:119], a[248:251], a[180:183], a[116:119]
ds_read_b64_tr_b16 a[242:243], v239 offset:50848
v_mfma_f32_16x16x32_bf16 a[120:123], a[252:255], a[176:179], a[120:123]
ds_read_b64_tr_b16 a[244:245], v239 offset:50976
v_mfma_f32_16x16x32_bf16 a[124:127], a[252:255], a[180:183], a[124:127]
ds_read_b64_tr_b16 a[246:247], v239 offset:51104
v_mfma_f32_16x16x32_bf16 v[224:227], v[232:235], v[64:67], v[224:227]
v_mfma_f32_16x16x32_bf16 v[224:227], v[232:235], v[72:75], v[224:227]
buffer_load_dwordx4 v246, s[8:11], s29 offen offset:0 nt lds
v_mfma_f32_16x16x32_bf16 v[224:227], v[232:235], v[80:83], v[224:227]
v_mfma_f32_16x16x32_bf16 v[224:227], v[232:235], v[88:91], v[224:227]
s_waitcnt lgkmcnt(8)
v_mfma_f32_16x16x32_bf16 v[192:195], a[224:227], v[64:67], v[192:195]
ds_read_b64_tr_b16 a[248:249], v239 offset:51232
v_mfma_f32_16x16x32_bf16 v[192:195], a[228:231], v[72:75], v[192:195]
ds_read_b64_tr_b16 a[250:251], v239 offset:51360
v_mfma_f32_16x16x32_bf16 v[196:199], a[228:231], v[76:79], v[196:199]
ds_read_b64_tr_b16 a[252:253], v239 offset:51488
v_mfma_f32_16x16x32_bf16 v[196:199], a[224:227], v[68:71], v[196:199]
s_waitcnt lgkmcnt(7)
ds_read_b64_tr_b16 a[254:255], v239 offset:51616
v_mfma_f32_16x16x32_bf16 v[196:199], a[232:235], v[84:87], v[196:199]
ds_read_b64_tr_b16 a[224:225], v239 offset:50752
v_mfma_f32_16x16x32_bf16 v[196:199], a[236:239], v[92:95], v[196:199]
ds_read_b64_tr_b16 a[226:227], v239 offset:50880
v_mfma_f32_16x16x32_bf16 v[192:195], a[236:239], v[88:91], v[192:195]
ds_read_b64_tr_b16 a[228:229], v239 offset:51008
v_mfma_f32_16x16x32_bf16 v[192:195], a[232:235], v[80:83], v[192:195]
s_waitcnt lgkmcnt(7)
ds_read_b64_tr_b16 a[230:231], v239 offset:51136
v_mfma_f32_16x16x32_bf16 v[200:203], a[240:243], v[64:67], v[200:203]
ds_read_b64_tr_b16 a[232:233], v239 offset:51264
v_mfma_f32_16x16x32_bf16 v[200:203], a[244:247], v[72:75], v[200:203]
ds_read_b64_tr_b16 a[234:235], v239 offset:51392
v_mfma_f32_16x16x32_bf16 v[204:207], a[244:247], v[76:79], v[204:207]
ds_read_b64_tr_b16 a[236:237], v239 offset:51520
v_mfma_f32_16x16x32_bf16 v[204:207], a[240:243], v[68:71], v[204:207]
s_waitcnt lgkmcnt(7)
ds_read_b64_tr_b16 a[238:239], v239 offset:51648
v_mfma_f32_16x16x32_bf16 v[204:207], a[248:251], v[84:87], v[204:207]
ds_read_b64_tr_b16 a[240:241], v239 offset:50784
v_mfma_f32_16x16x32_bf16 v[204:207], a[252:255], v[92:95], v[204:207]
ds_read_b64_tr_b16 a[242:243], v239 offset:50912
v_mfma_f32_16x16x32_bf16 v[200:203], a[252:255], v[88:91], v[200:203]
ds_read_b64_tr_b16 a[244:245], v239 offset:51040
v_mfma_f32_16x16x32_bf16 v[200:203], a[248:251], v[80:83], v[200:203]
ds_read_b64_tr_b16 a[246:247], v239 offset:51168
v_mfma_f32_16x16x32_bf16 v[228:231], v[232:235], v[68:71], v[228:231]
buffer_load_dwordx4 v247, s[8:11], s29 offen offset:1056 nt lds
v_mfma_f32_16x16x32_bf16 v[228:231], v[232:235], v[76:79], v[228:231]
v_mfma_f32_16x16x32_bf16 v[228:231], v[232:235], v[84:87], v[228:231]
v_mfma_f32_16x16x32_bf16 v[228:231], v[232:235], v[92:95], v[228:231]
s_waitcnt lgkmcnt(8)
v_mfma_f32_16x16x32_bf16 v[208:211], a[224:227], v[64:67], v[208:211]
ds_read_b64_tr_b16 a[248:249], v239 offset:51296
v_mfma_f32_16x16x32_bf16 v[208:211], a[228:231], v[72:75], v[208:211]
ds_read_b64_tr_b16 a[250:251], v239 offset:51424
v_mfma_f32_16x16x32_bf16 v[212:215], a[228:231], v[76:79], v[212:215]
ds_read_b64_tr_b16 a[252:253], v239 offset:51552
v_mfma_f32_16x16x32_bf16 v[212:215], a[224:227], v[68:71], v[212:215]
s_waitcnt lgkmcnt(7)
ds_read_b64_tr_b16 a[254:255], v239 offset:51680
v_mfma_f32_16x16x32_bf16 v[212:215], a[232:235], v[84:87], v[212:215]
ds_read_b64_tr_b16 a[224:225], v240 offset:0
buffer_load_dwordx4 v248, s[8:11], s29 offen offset:2112 nt lds
v_mfma_f32_16x16x32_bf16 v[212:215], a[236:239], v[92:95], v[212:215]
ds_read_b64_tr_b16 a[226:227], v240 offset:512
v_mfma_f32_16x16x32_bf16 v[208:211], a[236:239], v[88:91], v[208:211]
ds_read_b64_tr_b16 a[228:229], v240 offset:32
v_mfma_f32_16x16x32_bf16 v[208:211], a[232:235], v[80:83], v[208:211]
s_waitcnt lgkmcnt(7)
ds_read_b64_tr_b16 a[230:231], v240 offset:544
v_mfma_f32_16x16x32_bf16 v[216:219], a[240:243], v[64:67], v[216:219]
ds_read_b64_tr_b16 a[232:233], v240 offset:64
v_mfma_f32_16x16x32_bf16 v[216:219], a[244:247], v[72:75], v[216:219]
ds_read_b64_tr_b16 a[234:235], v240 offset:576
v_mfma_f32_16x16x32_bf16 v[220:223], a[244:247], v[76:79], v[220:223]
ds_read_b64_tr_b16 a[236:237], v240 offset:96
v_mfma_f32_16x16x32_bf16 v[220:223], a[240:243], v[68:71], v[220:223]
s_waitcnt lgkmcnt(7)
ds_read_b64_tr_b16 a[238:239], v240 offset:608
v_mfma_f32_16x16x32_bf16 v[220:223], a[248:251], v[84:87], v[220:223]
ds_read_b64_tr_b16 a[240:241], v240 offset:128
v_mfma_f32_16x16x32_bf16 v[220:223], a[252:255], v[92:95], v[220:223]
ds_read_b64_tr_b16 a[242:243], v240 offset:640
v_mfma_f32_16x16x32_bf16 v[216:219], a[252:255], v[88:91], v[216:219]
ds_read_b64_tr_b16 a[244:245], v240 offset:160
v_mfma_f32_16x16x32_bf16 v[216:219], a[248:251], v[80:83], v[216:219]
s_waitcnt lgkmcnt(7)
ds_read_b64_tr_b16 a[246:247], v240 offset:672
v_mfma_f32_16x16x32_bf16 a[0:3], a[224:227], a[184:187], a[0:3]
ds_read_b64_tr_b16 a[248:249], v240 offset:192
v_mfma_f32_16x16x32_bf16 a[4:7], a[224:227], a[188:191], a[4:7]
ds_read_b64_tr_b16 a[250:251], v240 offset:704
v_mfma_f32_16x16x32_bf16 a[8:11], a[228:231], a[184:187], a[8:11]
s_waitcnt lgkmcnt(6)
ds_read_b64_tr_b16 a[252:253], v240 offset:224
buffer_load_dwordx4 v249, s[8:11], s29 offen offset:3168 nt lds
v_mfma_f32_16x16x32_bf16 a[12:15], a[228:231], a[188:191], a[12:15]
s_waitcnt vmcnt(20)
ds_read_b64_tr_b16 a[254:255], v240 offset:736
s_barrier
v_mfma_f32_16x16x32_bf16 a[16:19], a[232:235], a[184:187], a[16:19]
ds_read_b64_tr_b16 a[224:225], v240 offset:16896
v_mfma_f32_16x16x32_bf16 a[20:23], a[232:235], a[188:191], a[20:23]
ds_read_b64_tr_b16 a[226:227], v240 offset:17024
v_mfma_f32_16x16x32_bf16 a[24:27], a[236:239], a[184:187], a[24:27]
ds_read_b64_tr_b16 a[228:229], v240 offset:17152
v_mfma_f32_16x16x32_bf16 a[28:31], a[236:239], a[188:191], a[28:31]
s_waitcnt lgkmcnt(7)
ds_read_b64_tr_b16 a[230:231], v240 offset:17280
v_mfma_f32_16x16x32_bf16 a[32:35], a[240:243], a[184:187], a[32:35]
ds_read_b64_tr_b16 a[232:233], v240 offset:17408
v_mfma_f32_16x16x32_bf16 a[36:39], a[240:243], a[188:191], a[36:39]
s_add_u32 m0, s28, 33792
ds_read_b64_tr_b16 a[234:235], v240 offset:17536
s_mov_b32 s45, 2884096
v_mfma_f32_16x16x32_bf16 a[40:43], a[244:247], a[184:187], a[40:43]
ds_read_b64_tr_b16 a[236:237], v240 offset:17664
v_mfma_f32_16x16x32_bf16 a[44:47], a[244:247], a[188:191], a[44:47]
s_waitcnt lgkmcnt(7)
ds_read_b64_tr_b16 a[238:239], v240 offset:17792
v_mfma_f32_16x16x32_bf16 a[48:51], a[248:251], a[184:187], a[48:51]
ds_read_b64_tr_b16 a[240:241], v240 offset:16928
v_mfma_f32_16x16x32_bf16 a[52:55], a[248:251], a[188:191], a[52:55]
ds_read_b64_tr_b16 a[242:243], v240 offset:17056
v_mfma_f32_16x16x32_bf16 a[56:59], a[252:255], a[184:187], a[56:59]
ds_read_b64_tr_b16 a[244:245], v240 offset:17184
v_mfma_f32_16x16x32_bf16 a[60:63], a[252:255], a[188:191], a[60:63]
ds_read_b64_tr_b16 a[246:247], v240 offset:17312
v_mfma_f32_16x16x32_bf16 v[224:227], v[232:235], v[96:99], v[224:227]
v_mfma_f32_16x16x32_bf16 v[224:227], v[232:235], v[104:107], v[224:227]
buffer_load_dwordx4 v250, s[12:15], s45 offen offset:0 lds
v_mfma_f32_16x16x32_bf16 v[224:227], v[232:235], v[112:115], v[224:227]
v_mfma_f32_16x16x32_bf16 v[224:227], v[232:235], v[120:123], v[224:227]
s_waitcnt lgkmcnt(8)
v_mfma_f32_16x16x32_bf16 v[192:195], a[224:227], v[96:99], v[192:195]
ds_read_b64_tr_b16 a[248:249], v240 offset:17440
v_mfma_f32_16x16x32_bf16 v[192:195], a[228:231], v[104:107], v[192:195]
ds_read_b64_tr_b16 a[250:251], v240 offset:17568
v_mfma_f32_16x16x32_bf16 v[196:199], a[228:231], v[108:111], v[196:199]
ds_read_b64_tr_b16 a[252:253], v240 offset:17696
v_mfma_f32_16x16x32_bf16 v[196:199], a[224:227], v[100:103], v[196:199]
s_waitcnt lgkmcnt(7)
ds_read_b64_tr_b16 a[254:255], v240 offset:17824
buffer_load_dwordx4 v251, s[12:15], s45 offen offset:1056 lds
v_mfma_f32_16x16x32_bf16 v[196:199], a[232:235], v[116:119], v[196:199]
ds_read_b64_tr_b16 a[224:225], v240 offset:16960
v_mfma_f32_16x16x32_bf16 v[196:199], a[236:239], v[124:127], v[196:199]
ds_read_b64_tr_b16 a[226:227], v240 offset:17088
v_mfma_f32_16x16x32_bf16 v[192:195], a[236:239], v[120:123], v[192:195]
ds_read_b64_tr_b16 a[228:229], v240 offset:17216
v_mfma_f32_16x16x32_bf16 v[192:195], a[232:235], v[112:115], v[192:195]
s_waitcnt lgkmcnt(7)
ds_read_b64_tr_b16 a[230:231], v240 offset:17344
v_mfma_f32_16x16x32_bf16 v[200:203], a[240:243], v[96:99], v[200:203]
ds_read_b64_tr_b16 a[232:233], v240 offset:17472
v_mfma_f32_16x16x32_bf16 v[200:203], a[244:247], v[104:107], v[200:203]
ds_read_b64_tr_b16 a[234:235], v240 offset:17600
v_mfma_f32_16x16x32_bf16 v[204:207], a[244:247], v[108:111], v[204:207]
ds_read_b64_tr_b16 a[236:237], v240 offset:17728
v_mfma_f32_16x16x32_bf16 v[204:207], a[240:243], v[100:103], v[204:207]
s_waitcnt lgkmcnt(7)
ds_read_b64_tr_b16 a[238:239], v240 offset:17856
v_mfma_f32_16x16x32_bf16 v[204:207], a[248:251], v[116:119], v[204:207]
ds_read_b64_tr_b16 a[240:241], v240 offset:16992
v_mfma_f32_16x16x32_bf16 v[204:207], a[252:255], v[124:127], v[204:207]
ds_read_b64_tr_b16 a[242:243], v240 offset:17120
v_mfma_f32_16x16x32_bf16 v[200:203], a[252:255], v[120:123], v[200:203]
ds_read_b64_tr_b16 a[244:245], v240 offset:17248
v_mfma_f32_16x16x32_bf16 v[200:203], a[248:251], v[112:115], v[200:203]
ds_read_b64_tr_b16 a[246:247], v240 offset:17376
v_mfma_f32_16x16x32_bf16 v[228:231], v[232:235], v[100:103], v[228:231]
buffer_load_dwordx4 v252, s[12:15], s45 offen offset:2112 lds
v_mfma_f32_16x16x32_bf16 v[228:231], v[232:235], v[108:111], v[228:231]
buffer_load_dwordx4 v253, s[12:15], s45 offen offset:3168 lds
v_mfma_f32_16x16x32_bf16 v[228:231], v[232:235], v[116:119], v[228:231]
s_add_u32 m0, s28, 50688
s_mov_b32 s29, 256
v_mfma_f32_16x16x32_bf16 v[228:231], v[232:235], v[124:127], v[228:231]
s_waitcnt lgkmcnt(8)
v_mfma_f32_16x16x32_bf16 v[208:211], a[224:227], v[96:99], v[208:211]
ds_read_b64_tr_b16 a[248:249], v240 offset:17504
v_mfma_f32_16x16x32_bf16 v[208:211], a[228:231], v[104:107], v[208:211]
ds_read_b64_tr_b16 a[250:251], v240 offset:17632
v_mfma_f32_16x16x32_bf16 v[212:215], a[228:231], v[108:111], v[212:215]
ds_read_b64_tr_b16 a[252:253], v240 offset:17760
v_mfma_f32_16x16x32_bf16 v[212:215], a[224:227], v[100:103], v[212:215]
s_waitcnt lgkmcnt(7)
ds_read_b64_tr_b16 a[254:255], v240 offset:17888
v_mfma_f32_16x16x32_bf16 v[212:215], a[232:235], v[116:119], v[212:215]
ds_read_b64_tr_b16 a[224:225], v240 offset:256
buffer_load_dwordx4 v246, s[8:11], s29 offen offset:0 nt lds
v_mfma_f32_16x16x32_bf16 v[212:215], a[236:239], v[124:127], v[212:215]
ds_read_b64_tr_b16 a[226:227], v240 offset:768
v_rcp_f32 v242, v224
v_mfma_f32_16x16x32_bf16 v[208:211], a[236:239], v[120:123], v[208:211]
ds_read_b64_tr_b16 a[228:229], v240 offset:288
v_rcp_f32 v243, v228
v_mfma_f32_16x16x32_bf16 v[208:211], a[232:235], v[112:115], v[208:211]
s_waitcnt lgkmcnt(7)
ds_read_b64_tr_b16 a[230:231], v240 offset:800
v_mfma_f32_16x16x32_bf16 v[216:219], a[240:243], v[96:99], v[216:219]
ds_read_b64_tr_b16 a[232:233], v240 offset:320
v_mul_f32 v192, v192, v242
v_mfma_f32_16x16x32_bf16 v[216:219], a[244:247], v[104:107], v[216:219]
ds_read_b64_tr_b16 a[234:235], v240 offset:832
v_mul_f32 v193, v193, v242
v_mfma_f32_16x16x32_bf16 v[220:223], a[244:247], v[108:111], v[220:223]
ds_read_b64_tr_b16 a[236:237], v240 offset:352
v_mul_f32 v194, v194, v242
v_mfma_f32_16x16x32_bf16 v[220:223], a[240:243], v[100:103], v[220:223]
s_waitcnt lgkmcnt(7)
ds_read_b64_tr_b16 a[238:239], v240 offset:864
buffer_load_dwordx4 v247, s[8:11], s29 offen offset:1056 nt lds
v_mul_f32 v195, v195, v242
v_mfma_f32_16x16x32_bf16 v[220:223], a[248:251], v[116:119], v[220:223]
ds_read_b64_tr_b16 a[240:241], v240 offset:384
v_cvt_pk_bf16_f32 v192, v192, v193
v_mfma_f32_16x16x32_bf16 v[220:223], a[252:255], v[124:127], v[220:223]
ds_read_b64_tr_b16 a[242:243], v240 offset:896
v_cvt_pk_bf16_f32 v193, v194, v195
v_mfma_f32_16x16x32_bf16 v[216:219], a[252:255], v[120:123], v[216:219]
ds_read_b64_tr_b16 a[244:245], v240 offset:416
v_mul_f32 v196, v196, v243
v_mfma_f32_16x16x32_bf16 v[216:219], a[248:251], v[112:115], v[216:219]
s_waitcnt lgkmcnt(7)
ds_read_b64_tr_b16 a[246:247], v240 offset:928
v_mul_f32 v197, v197, v243
v_mfma_f32_16x16x32_bf16 a[64:67], a[224:227], a[184:187], a[64:67]
ds_read_b64_tr_b16 a[248:249], v240 offset:448
v_mul_f32 v198, v198, v243
v_mfma_f32_16x16x32_bf16 a[68:71], a[224:227], a[188:191], a[68:71]
ds_read_b64_tr_b16 a[250:251], v240 offset:960
v_mul_f32 v199, v199, v243
v_mfma_f32_16x16x32_bf16 a[72:75], a[228:231], a[184:187], a[72:75]
s_waitcnt lgkmcnt(6)
ds_read_b64_tr_b16 a[252:253], v240 offset:480
buffer_load_dwordx4 v248, s[8:11], s29 offen offset:2112 nt lds
v_cvt_pk_bf16_f32 v196, v196, v197
v_mfma_f32_16x16x32_bf16 a[76:79], a[228:231], a[188:191], a[76:79]
s_waitcnt vmcnt(15)
ds_read_b64_tr_b16 a[254:255], v240 offset:992
s_barrier
v_mfma_f32_16x16x32_bf16 a[80:83], a[232:235], a[184:187], a[80:83]
ds_read_b64_tr_b16 a[224:225], v240 offset:33792
v_cvt_pk_bf16_f32 v197, v198, v199
v_mfma_f32_16x16x32_bf16 a[84:87], a[232:235], a[188:191], a[84:87]
ds_read_b64_tr_b16 a[226:227], v240 offset:33920
v_mul_f32 v200, v200, v242
v_mul_f32 v201, v201, v242
v_mfma_f32_16x16x32_bf16 a[88:91], a[236:239], a[184:187], a[88:91]
ds_read_b64_tr_b16 a[228:229], v240 offset:34048
v_mul_f32 v202, v202, v242
v_mul_f32 v203, v203, v242
v_mfma_f32_16x16x32_bf16 a[92:95], a[236:239], a[188:191], a[92:95]
s_waitcnt lgkmcnt(7)
ds_read_b64_tr_b16 a[230:231], v240 offset:34176
v_cvt_pk_bf16_f32 v194, v200, v201
v_cvt_pk_bf16_f32 v195, v202, v203
v_mfma_f32_16x16x32_bf16 a[96:99], a[240:243], a[184:187], a[96:99]
ds_read_b64_tr_b16 a[232:233], v240 offset:34304
v_mul_f32 v204, v204, v243
v_mul_f32 v205, v205, v243
v_mfma_f32_16x16x32_bf16 a[100:103], a[240:243], a[188:191], a[100:103]
ds_read_b64_tr_b16 a[234:235], v240 offset:34432
buffer_load_dwordx4 v249, s[8:11], s29 offen offset:3168 nt lds
v_mul_f32 v206, v206, v243
v_mul_f32 v207, v207, v243
v_mfma_f32_16x16x32_bf16 a[104:107], a[244:247], a[184:187], a[104:107]
s_add_u32 m0, s28, 84480
ds_read_b64_tr_b16 a[236:237], v240 offset:34560
v_cvt_pk_bf16_f32 v198, v204, v205
v_cvt_pk_bf16_f32 v199, v206, v207
v_mfma_f32_16x16x32_bf16 a[108:111], a[244:247], a[188:191], a[108:111]
s_waitcnt lgkmcnt(7)
ds_read_b64_tr_b16 a[238:239], v240 offset:34688
v_accvgpr_write_b32 a128, v192
v_accvgpr_write_b32 a129, v193
v_mfma_f32_16x16x32_bf16 a[112:115], a[248:251], a[184:187], a[112:115]
s_mov_b32 s29, 65792
ds_read_b64_tr_b16 a[240:241], v240 offset:33824
v_accvgpr_write_b32 a130, v194
v_accvgpr_write_b32 a131, v195
v_mfma_f32_16x16x32_bf16 a[116:119], a[248:251], a[188:191], a[116:119]
ds_read_b64_tr_b16 a[242:243], v240 offset:33952
v_accvgpr_write_b32 a132, v196
v_accvgpr_write_b32 a133, v197
v_mfma_f32_16x16x32_bf16 a[120:123], a[252:255], a[184:187], a[120:123]
ds_read_b64_tr_b16 a[244:245], v240 offset:34080
v_accvgpr_write_b32 a134, v198
v_accvgpr_write_b32 a135, v199
v_mfma_f32_16x16x32_bf16 a[124:127], a[252:255], a[188:191], a[124:127]
s_waitcnt lgkmcnt(7)
ds_read_b64_tr_b16 a[246:247], v240 offset:34208
v_mul_f32 v208, v208, v242
v_mul_f32 v209, v209, v242
v_mfma_f32_16x16x32_bf16 v[192:195], a[224:227], v[0:3], 0
ds_read_b64_tr_b16 a[248:249], v240 offset:34336
v_mul_f32 v210, v210, v242
v_mul_f32 v211, v211, v242
v_mfma_f32_16x16x32_bf16 v[192:195], a[228:231], v[8:11], v[192:195]
ds_read_b64_tr_b16 a[250:251], v240 offset:34464
buffer_load_dwordx4 v246, s[8:11], s29 offen offset:0 nt lds
v_cvt_pk_bf16_f32 v208, v208, v209
v_cvt_pk_bf16_f32 v209, v210, v211
v_mfma_f32_16x16x32_bf16 v[196:199], a[228:231], v[12:15], 0
ds_read_b64_tr_b16 a[252:253], v240 offset:34592
v_mul_f32 v212, v212, v243
v_mul_f32 v213, v213, v243
v_mfma_f32_16x16x32_bf16 v[196:199], a[224:227], v[4:7], v[196:199]
s_waitcnt lgkmcnt(7)
ds_read_b64_tr_b16 a[254:255], v240 offset:34720
v_mul_f32 v214, v214, v243
v_mul_f32 v215, v215, v243
v_mfma_f32_16x16x32_bf16 v[196:199], a[232:235], v[20:23], v[196:199]
ds_read_b64_tr_b16 a[224:225], v240 offset:33856
v_cvt_pk_bf16_f32 v212, v212, v213
v_cvt_pk_bf16_f32 v213, v214, v215
v_mfma_f32_16x16x32_bf16 v[196:199], a[236:239], v[28:31], v[196:199]
ds_read_b64_tr_b16 a[226:227], v240 offset:33984
v_mul_f32 v216, v216, v242
v_mul_f32 v217, v217, v242
v_mfma_f32_16x16x32_bf16 v[192:195], a[236:239], v[24:27], v[192:195]
ds_read_b64_tr_b16 a[228:229], v240 offset:34112
buffer_load_dwordx4 v247, s[8:11], s29 offen offset:1056 nt lds
v_mul_f32 v218, v218, v242
v_mul_f32 v219, v219, v242
v_mfma_f32_16x16x32_bf16 v[192:195], a[232:235], v[16:19], v[192:195]
s_waitcnt lgkmcnt(7)
ds_read_b64_tr_b16 a[230:231], v240 offset:34240
v_cvt_pk_bf16_f32 v210, v216, v217
v_cvt_pk_bf16_f32 v211, v218, v219
v_mfma_f32_16x16x32_bf16 v[200:203], a[240:243], v[0:3], 0
ds_read_b64_tr_b16 a[232:233], v240 offset:34368
v_mul_f32 v220, v220, v243
v_mul_f32 v221, v221, v243
v_mfma_f32_16x16x32_bf16 v[200:203], a[244:247], v[8:11], v[200:203]
ds_read_b64_tr_b16 a[234:235], v240 offset:34496
v_mul_f32 v222, v222, v243
v_mul_f32 v223, v223, v243
v_mfma_f32_16x16x32_bf16 v[204:207], a[244:247], v[12:15], 0
ds_read_b64_tr_b16 a[236:237], v240 offset:34624
v_cvt_pk_bf16_f32 v214, v220, v221
v_cvt_pk_bf16_f32 v215, v222, v223
v_mfma_f32_16x16x32_bf16 v[204:207], a[240:243], v[4:7], v[204:207]
s_waitcnt lgkmcnt(7)
ds_read_b64_tr_b16 a[238:239], v240 offset:34752
v_accvgpr_write_b32 a136, v208
v_accvgpr_write_b32 a137, v209
v_mfma_f32_16x16x32_bf16 v[204:207], a[248:251], v[20:23], v[204:207]
ds_read_b64_tr_b16 a[240:241], v240 offset:33888
v_accvgpr_write_b32 a138, v210
v_accvgpr_write_b32 a139, v211
v_mfma_f32_16x16x32_bf16 v[204:207], a[252:255], v[28:31], v[204:207]
ds_read_b64_tr_b16 a[242:243], v240 offset:34016
v_accvgpr_write_b32 a140, v212
v_accvgpr_write_b32 a141, v213
v_mfma_f32_16x16x32_bf16 v[200:203], a[252:255], v[24:27], v[200:203]
ds_read_b64_tr_b16 a[244:245], v240 offset:34144
v_accvgpr_write_b32 a142, v214
v_accvgpr_write_b32 a143, v215
v_mfma_f32_16x16x32_bf16 v[200:203], a[248:251], v[16:19], v[200:203]
s_waitcnt lgkmcnt(7)
ds_read_b64_tr_b16 a[246:247], v240 offset:34272
buffer_load_dwordx4 v248, s[8:11], s29 offen offset:2112 nt lds
v_mfma_f32_16x16x32_bf16 v[208:211], a[224:227], v[0:3], 0
ds_read_b64_tr_b16 a[248:249], v240 offset:34400
v_mfma_f32_16x16x32_bf16 v[208:211], a[228:231], v[8:11], v[208:211]
ds_read_b64_tr_b16 a[250:251], v240 offset:34528
v_mfma_f32_16x16x32_bf16 v[212:215], a[228:231], v[12:15], 0
ds_read_b64_tr_b16 a[252:253], v240 offset:34656
buffer_load_dwordx4 v249, s[8:11], s29 offen offset:3168 nt lds
v_mfma_f32_16x16x32_bf16 v[212:215], a[224:227], v[4:7], v[212:215]
s_waitcnt lgkmcnt(7)
ds_read_b64_tr_b16 a[254:255], v240 offset:34784
s_add_u32 m0, s28, 67584
v_mfma_f32_16x16x32_bf16 v[212:215], a[232:235], v[20:23], v[212:215]
s_mov_b32 s29, 131328
ds_read_b64_tr_b16 a[224:225], v241 offset:0
v_mfma_f32_16x16x32_bf16 v[212:215], a[236:239], v[28:31], v[212:215]
ds_read_b64_tr_b16 a[226:227], v241 offset:512
v_mfma_f32_16x16x32_bf16 v[208:211], a[236:239], v[24:27], v[208:211]
ds_read_b64_tr_b16 a[228:229], v241 offset:32
v_mfma_f32_16x16x32_bf16 v[208:211], a[232:235], v[16:19], v[208:211]
s_waitcnt lgkmcnt(7)
ds_read_b64_tr_b16 a[230:231], v241 offset:544
v_mfma_f32_16x16x32_bf16 v[216:219], a[240:243], v[0:3], 0
ds_read_b64_tr_b16 a[232:233], v241 offset:64
buffer_load_dwordx4 v246, s[8:11], s29 offen offset:0 nt lds
v_mfma_f32_16x16x32_bf16 v[216:219], a[244:247], v[8:11], v[216:219]
ds_read_b64_tr_b16 a[234:235], v241 offset:576
v_mfma_f32_16x16x32_bf16 v[220:223], a[244:247], v[12:15], 0
ds_read_b64_tr_b16 a[236:237], v241 offset:96
v_mfma_f32_16x16x32_bf16 v[220:223], a[240:243], v[4:7], v[220:223]
s_waitcnt lgkmcnt(7)
ds_read_b64_tr_b16 a[238:239], v241 offset:608
v_mfma_f32_16x16x32_bf16 v[220:223], a[248:251], v[20:23], v[220:223]
ds_read_b64_tr_b16 a[240:241], v241 offset:128
v_mfma_f32_16x16x32_bf16 v[220:223], a[252:255], v[28:31], v[220:223]
ds_read_b64_tr_b16 a[242:243], v241 offset:640
v_mfma_f32_16x16x32_bf16 v[216:219], a[252:255], v[24:27], v[216:219]
ds_read_b64_tr_b16 a[244:245], v241 offset:160
buffer_load_dwordx4 v247, s[8:11], s29 offen offset:1056 nt lds
v_mfma_f32_16x16x32_bf16 v[216:219], a[248:251], v[16:19], v[216:219]
s_waitcnt lgkmcnt(7)
ds_read_b64_tr_b16 a[246:247], v241 offset:672
v_mfma_f32_16x16x32_bf16 a[0:3], a[224:227], a[192:195], a[0:3]
ds_read_b64_tr_b16 a[248:249], v241 offset:192
v_mfma_f32_16x16x32_bf16 a[4:7], a[224:227], a[196:199], a[4:7]
ds_read_b64_tr_b16 a[250:251], v241 offset:704
v_mfma_f32_16x16x32_bf16 a[8:11], a[228:231], a[192:195], a[8:11]
s_waitcnt lgkmcnt(6)
ds_read_b64_tr_b16 a[252:253], v241 offset:224
v_mfma_f32_16x16x32_bf16 a[12:15], a[228:231], a[196:199], a[12:15]
s_waitcnt vmcnt(22)
ds_read_b64_tr_b16 a[254:255], v241 offset:736
s_barrier
v_mfma_f32_16x16x32_bf16 a[16:19], a[232:235], a[192:195], a[16:19]
ds_read_b64_tr_b16 a[224:225], v240 offset:50688
buffer_load_dwordx4 v248, s[8:11], s29 offen offset:2112 nt lds
v_mfma_f32_16x16x32_bf16 a[20:23], a[232:235], a[196:199], a[20:23]
ds_read_b64_tr_b16 a[226:227], v240 offset:50816
v_mfma_f32_16x16x32_bf16 a[24:27], a[236:239], a[192:195], a[24:27]
ds_read_b64_tr_b16 a[228:229], v240 offset:50944
v_mfma_f32_16x16x32_bf16 a[28:31], a[236:239], a[196:199], a[28:31]
s_waitcnt lgkmcnt(7)
ds_read_b64_tr_b16 a[230:231], v240 offset:51072
v_mfma_f32_16x16x32_bf16 a[32:35], a[240:243], a[192:195], a[32:35]
ds_read_b64_tr_b16 a[232:233], v240 offset:51200
v_mfma_f32_16x16x32_bf16 a[36:39], a[240:243], a[196:199], a[36:39]
ds_read_b64_tr_b16 a[234:235], v240 offset:51328
v_mfma_f32_16x16x32_bf16 a[40:43], a[244:247], a[192:195], a[40:43]
ds_read_b64_tr_b16 a[236:237], v240 offset:51456
buffer_load_dwordx4 v249, s[8:11], s29 offen offset:3168 nt lds
v_mfma_f32_16x16x32_bf16 a[44:47], a[244:247], a[196:199], a[44:47]
s_waitcnt lgkmcnt(7)
ds_read_b64_tr_b16 a[238:239], v240 offset:51584
s_add_u32 m0, s28, 101376
v_mfma_f32_16x16x32_bf16 a[48:51], a[248:251], a[192:195], a[48:51]
s_mov_b32 s45, 3146240
ds_read_b64_tr_b16 a[240:241], v240 offset:50720
v_mfma_f32_16x16x32_bf16 a[52:55], a[248:251], a[196:199], a[52:55]
ds_read_b64_tr_b16 a[242:243], v240 offset:50848
v_mfma_f32_16x16x32_bf16 a[56:59], a[252:255], a[192:195], a[56:59]
ds_read_b64_tr_b16 a[244:245], v240 offset:50976
v_mfma_f32_16x16x32_bf16 a[60:63], a[252:255], a[196:199], a[60:63]
s_waitcnt lgkmcnt(7)
ds_read_b64_tr_b16 a[246:247], v240 offset:51104
v_mfma_f32_16x16x32_bf16 v[192:195], a[224:227], v[32:35], v[192:195]
ds_read_b64_tr_b16 a[248:249], v240 offset:51232
v_mfma_f32_16x16x32_bf16 v[192:195], a[228:231], v[40:43], v[192:195]
ds_read_b64_tr_b16 a[250:251], v240 offset:51360
buffer_load_dwordx4 v250, s[12:15], s45 offen offset:0 lds
v_mfma_f32_16x16x32_bf16 v[196:199], a[228:231], v[44:47], v[196:199]
ds_read_b64_tr_b16 a[252:253], v240 offset:51488
v_mfma_f32_16x16x32_bf16 v[196:199], a[224:227], v[36:39], v[196:199]
s_waitcnt lgkmcnt(7)
ds_read_b64_tr_b16 a[254:255], v240 offset:51616
v_mfma_f32_16x16x32_bf16 v[196:199], a[232:235], v[52:55], v[196:199]
ds_read_b64_tr_b16 a[224:225], v240 offset:50752
v_mfma_f32_16x16x32_bf16 v[196:199], a[236:239], v[60:63], v[196:199]
ds_read_b64_tr_b16 a[226:227], v240 offset:50880
v_mfma_f32_16x16x32_bf16 v[192:195], a[236:239], v[56:59], v[192:195]
ds_read_b64_tr_b16 a[228:229], v240 offset:51008
v_mfma_f32_16x16x32_bf16 v[192:195], a[232:235], v[48:51], v[192:195]
s_waitcnt lgkmcnt(7)
ds_read_b64_tr_b16 a[230:231], v240 offset:51136
v_mfma_f32_16x16x32_bf16 v[200:203], a[240:243], v[32:35], v[200:203]
ds_read_b64_tr_b16 a[232:233], v240 offset:51264
v_mfma_f32_16x16x32_bf16 v[200:203], a[244:247], v[40:43], v[200:203]
ds_read_b64_tr_b16 a[234:235], v240 offset:51392
v_mfma_f32_16x16x32_bf16 v[204:207], a[244:247], v[44:47], v[204:207]
ds_read_b64_tr_b16 a[236:237], v240 offset:51520
v_mfma_f32_16x16x32_bf16 v[204:207], a[240:243], v[36:39], v[204:207]
s_waitcnt lgkmcnt(7)
ds_read_b64_tr_b16 a[238:239], v240 offset:51648
v_mfma_f32_16x16x32_bf16 v[204:207], a[248:251], v[52:55], v[204:207]
ds_read_b64_tr_b16 a[240:241], v240 offset:50784
buffer_load_dwordx4 v251, s[12:15], s45 offen offset:1056 lds
v_mfma_f32_16x16x32_bf16 v[204:207], a[252:255], v[60:63], v[204:207]
ds_read_b64_tr_b16 a[242:243], v240 offset:50912
v_mfma_f32_16x16x32_bf16 v[200:203], a[252:255], v[56:59], v[200:203]
ds_read_b64_tr_b16 a[244:245], v240 offset:51040
v_mfma_f32_16x16x32_bf16 v[200:203], a[248:251], v[48:51], v[200:203]
s_waitcnt lgkmcnt(7)
ds_read_b64_tr_b16 a[246:247], v240 offset:51168
v_mfma_f32_16x16x32_bf16 v[208:211], a[224:227], v[32:35], v[208:211]
ds_read_b64_tr_b16 a[248:249], v240 offset:51296
v_mfma_f32_16x16x32_bf16 v[208:211], a[228:231], v[40:43], v[208:211]
ds_read_b64_tr_b16 a[250:251], v240 offset:51424
v_mfma_f32_16x16x32_bf16 v[212:215], a[228:231], v[44:47], v[212:215]
ds_read_b64_tr_b16 a[252:253], v240 offset:51552
v_mfma_f32_16x16x32_bf16 v[212:215], a[224:227], v[36:39], v[212:215]
s_waitcnt lgkmcnt(7)
ds_read_b64_tr_b16 a[254:255], v240 offset:51680
v_mfma_f32_16x16x32_bf16 v[212:215], a[232:235], v[52:55], v[212:215]
ds_read_b64_tr_b16 a[224:225], v241 offset:256
v_mfma_f32_16x16x32_bf16 v[212:215], a[236:239], v[60:63], v[212:215]
ds_read_b64_tr_b16 a[226:227], v241 offset:768
v_mfma_f32_16x16x32_bf16 v[208:211], a[236:239], v[56:59], v[208:211]
ds_read_b64_tr_b16 a[228:229], v241 offset:288
v_mfma_f32_16x16x32_bf16 v[208:211], a[232:235], v[48:51], v[208:211]
s_waitcnt lgkmcnt(7)
ds_read_b64_tr_b16 a[230:231], v241 offset:800
v_mfma_f32_16x16x32_bf16 v[216:219], a[240:243], v[32:35], v[216:219]
ds_read_b64_tr_b16 a[232:233], v241 offset:320
buffer_load_dwordx4 v252, s[12:15], s45 offen offset:2112 lds
v_mfma_f32_16x16x32_bf16 v[216:219], a[244:247], v[40:43], v[216:219]
ds_read_b64_tr_b16 a[234:235], v241 offset:832
v_mfma_f32_16x16x32_bf16 v[220:223], a[244:247], v[44:47], v[220:223]
ds_read_b64_tr_b16 a[236:237], v241 offset:352
v_mfma_f32_16x16x32_bf16 v[220:223], a[240:243], v[36:39], v[220:223]
s_waitcnt lgkmcnt(7)
ds_read_b64_tr_b16 a[238:239], v241 offset:864
v_mfma_f32_16x16x32_bf16 v[220:223], a[248:251], v[52:55], v[220:223]
ds_read_b64_tr_b16 a[240:241], v241 offset:384
v_mfma_f32_16x16x32_bf16 v[220:223], a[252:255], v[60:63], v[220:223]
ds_read_b64_tr_b16 a[242:243], v241 offset:896
v_mfma_f32_16x16x32_bf16 v[216:219], a[252:255], v[56:59], v[216:219]
ds_read_b64_tr_b16 a[244:245], v241 offset:416
v_mfma_f32_16x16x32_bf16 v[216:219], a[248:251], v[48:51], v[216:219]
s_waitcnt lgkmcnt(7)
ds_read_b64_tr_b16 a[246:247], v241 offset:928
v_mfma_f32_16x16x32_bf16 a[64:67], a[224:227], a[192:195], a[64:67]
ds_read_b64_tr_b16 a[248:249], v241 offset:448
v_mfma_f32_16x16x32_bf16 a[68:71], a[224:227], a[196:199], a[68:71]
ds_read_b64_tr_b16 a[250:251], v241 offset:960
v_mfma_f32_16x16x32_bf16 a[72:75], a[228:231], a[192:195], a[72:75]
s_waitcnt lgkmcnt(6)
ds_read_b64_tr_b16 a[252:253], v241 offset:480
v_mfma_f32_16x16x32_bf16 a[76:79], a[228:231], a[196:199], a[76:79]
s_waitcnt vmcnt(15)
ds_read_b64_tr_b16 a[254:255], v241 offset:992
s_barrier
v_mfma_f32_16x16x32_bf16 a[80:83], a[232:235], a[192:195], a[80:83]
ds_read_b64_tr_b16 a[224:225], v239 offset:16896
buffer_load_dwordx4 v253, s[12:15], s45 offen offset:3168 lds
v_mfma_f32_16x16x32_bf16 a[84:87], a[232:235], a[196:199], a[84:87]
ds_read_b64_tr_b16 a[226:227], v239 offset:17024
v_mfma_f32_16x16x32_bf16 a[88:91], a[236:239], a[192:195], a[88:91]
ds_read_b64_tr_b16 a[228:229], v239 offset:17152
v_mfma_f32_16x16x32_bf16 a[92:95], a[236:239], a[196:199], a[92:95]
s_waitcnt lgkmcnt(7)
ds_read_b64_tr_b16 a[230:231], v239 offset:17280
v_mfma_f32_16x16x32_bf16 a[96:99], a[240:243], a[192:195], a[96:99]
ds_read_b64_tr_b16 a[232:233], v239 offset:17408
v_mfma_f32_16x16x32_bf16 a[100:103], a[240:243], a[196:199], a[100:103]
s_add_u32 m0, s28, 118272
ds_read_b64_tr_b16 a[234:235], v239 offset:17536
s_mov_b32 s29, 196864
v_mfma_f32_16x16x32_bf16 a[104:107], a[244:247], a[192:195], a[104:107]
ds_read_b64_tr_b16 a[236:237], v239 offset:17664
v_mfma_f32_16x16x32_bf16 a[108:111], a[244:247], a[196:199], a[108:111]
s_waitcnt lgkmcnt(7)
ds_read_b64_tr_b16 a[238:239], v239 offset:17792
v_mfma_f32_16x16x32_bf16 a[112:115], a[248:251], a[192:195], a[112:115]
ds_read_b64_tr_b16 a[240:241], v239 offset:16928
v_mfma_f32_16x16x32_bf16 a[116:119], a[248:251], a[196:199], a[116:119]
ds_read_b64_tr_b16 a[242:243], v239 offset:17056
v_mfma_f32_16x16x32_bf16 a[120:123], a[252:255], a[192:195], a[120:123]
ds_read_b64_tr_b16 a[244:245], v239 offset:17184
v_mfma_f32_16x16x32_bf16 a[124:127], a[252:255], a[196:199], a[124:127]
s_waitcnt lgkmcnt(7)
ds_read_b64_tr_b16 a[246:247], v239 offset:17312
v_mfma_f32_16x16x32_bf16 v[192:195], a[224:227], v[64:67], v[192:195]
ds_read_b64_tr_b16 a[248:249], v239 offset:17440
v_mfma_f32_16x16x32_bf16 v[192:195], a[228:231], v[72:75], v[192:195]
ds_read_b64_tr_b16 a[250:251], v239 offset:17568
buffer_load_dwordx4 v246, s[8:11], s29 offen offset:0 nt lds
v_mfma_f32_16x16x32_bf16 v[196:199], a[228:231], v[76:79], v[196:199]
ds_read_b64_tr_b16 a[252:253], v239 offset:17696
v_mfma_f32_16x16x32_bf16 v[196:199], a[224:227], v[68:71], v[196:199]
s_waitcnt lgkmcnt(7)
ds_read_b64_tr_b16 a[254:255], v239 offset:17824
v_mfma_f32_16x16x32_bf16 v[196:199], a[232:235], v[84:87], v[196:199]
ds_read_b64_tr_b16 a[224:225], v239 offset:16960
v_mfma_f32_16x16x32_bf16 v[196:199], a[236:239], v[92:95], v[196:199]
ds_read_b64_tr_b16 a[226:227], v239 offset:17088
v_mfma_f32_16x16x32_bf16 v[192:195], a[236:239], v[88:91], v[192:195]
ds_read_b64_tr_b16 a[228:229], v239 offset:17216
buffer_load_dwordx4 v247, s[8:11], s29 offen offset:1056 nt lds
v_mfma_f32_16x16x32_bf16 v[192:195], a[232:235], v[80:83], v[192:195]
s_waitcnt lgkmcnt(7)
ds_read_b64_tr_b16 a[230:231], v239 offset:17344
v_mfma_f32_16x16x32_bf16 v[200:203], a[240:243], v[64:67], v[200:203]
ds_read_b64_tr_b16 a[232:233], v239 offset:17472
v_mfma_f32_16x16x32_bf16 v[200:203], a[244:247], v[72:75], v[200:203]
ds_read_b64_tr_b16 a[234:235], v239 offset:17600
v_mfma_f32_16x16x32_bf16 v[204:207], a[244:247], v[76:79], v[204:207]
ds_read_b64_tr_b16 a[236:237], v239 offset:17728
v_mfma_f32_16x16x32_bf16 v[204:207], a[240:243], v[68:71], v[204:207]
s_waitcnt lgkmcnt(7)
ds_read_b64_tr_b16 a[238:239], v239 offset:17856
v_mfma_f32_16x16x32_bf16 v[204:207], a[248:251], v[84:87], v[204:207]
ds_read_b64_tr_b16 a[240:241], v239 offset:16992
buffer_load_dwordx4 v248, s[8:11], s29 offen offset:2112 nt lds
v_mfma_f32_16x16x32_bf16 v[204:207], a[252:255], v[92:95], v[204:207]
ds_read_b64_tr_b16 a[242:243], v239 offset:17120
v_mfma_f32_16x16x32_bf16 v[200:203], a[252:255], v[88:91], v[200:203]
ds_read_b64_tr_b16 a[244:245], v239 offset:17248
v_mfma_f32_16x16x32_bf16 v[200:203], a[248:251], v[80:83], v[200:203]
s_waitcnt lgkmcnt(7)
ds_read_b64_tr_b16 a[246:247], v239 offset:17376
v_mfma_f32_16x16x32_bf16 v[208:211], a[224:227], v[64:67], v[208:211]
ds_read_b64_tr_b16 a[248:249], v239 offset:17504
v_mfma_f32_16x16x32_bf16 v[208:211], a[228:231], v[72:75], v[208:211]
ds_read_b64_tr_b16 a[250:251], v239 offset:17632
v_mfma_f32_16x16x32_bf16 v[212:215], a[228:231], v[76:79], v[212:215]
ds_read_b64_tr_b16 a[252:253], v239 offset:17760
buffer_load_dwordx4 v249, s[8:11], s29 offen offset:3168 nt lds
v_mfma_f32_16x16x32_bf16 v[212:215], a[224:227], v[68:71], v[212:215]
s_waitcnt lgkmcnt(7)
ds_read_b64_tr_b16 a[254:255], v239 offset:17888
s_add_u32 m0, s28, 135168
v_mfma_f32_16x16x32_bf16 v[212:215], a[232:235], v[84:87], v[212:215]
s_mov_b32 s29, 384
ds_read_b64_tr_b16 a[224:225], v239 offset:33792
v_mfma_f32_16x16x32_bf16 v[212:215], a[236:239], v[92:95], v[212:215]
ds_read_b64_tr_b16 a[226:227], v239 offset:34304
v_mfma_f32_16x16x32_bf16 v[208:211], a[236:239], v[88:91], v[208:211]
ds_read_b64_tr_b16 a[228:229], v239 offset:33824
v_mfma_f32_16x16x32_bf16 v[208:211], a[232:235], v[80:83], v[208:211]
s_waitcnt lgkmcnt(7)
ds_read_b64_tr_b16 a[230:231], v239 offset:34336
v_mfma_f32_16x16x32_bf16 v[216:219], a[240:243], v[64:67], v[216:219]
ds_read_b64_tr_b16 a[232:233], v239 offset:33856
buffer_load_dwordx4 v246, s[8:11], s29 offen offset:0 nt lds
v_mfma_f32_16x16x32_bf16 v[216:219], a[244:247], v[72:75], v[216:219]
ds_read_b64_tr_b16 a[234:235], v239 offset:34368
v_mfma_f32_16x16x32_bf16 v[220:223], a[244:247], v[76:79], v[220:223]
ds_read_b64_tr_b16 a[236:237], v239 offset:33888
v_mfma_f32_16x16x32_bf16 v[220:223], a[240:243], v[68:71], v[220:223]
s_waitcnt lgkmcnt(7)
ds_read_b64_tr_b16 a[238:239], v239 offset:34400
v_mfma_f32_16x16x32_bf16 v[220:223], a[248:251], v[84:87], v[220:223]
ds_read_b64_tr_b16 a[240:241], v239 offset:33920
v_mfma_f32_16x16x32_bf16 v[220:223], a[252:255], v[92:95], v[220:223]
ds_read_b64_tr_b16 a[242:243], v239 offset:34432
v_mfma_f32_16x16x32_bf16 v[216:219], a[252:255], v[88:91], v[216:219]
ds_read_b64_tr_b16 a[244:245], v239 offset:33952
buffer_load_dwordx4 v247, s[8:11], s29 offen offset:1056 nt lds
v_mfma_f32_16x16x32_bf16 v[216:219], a[248:251], v[80:83], v[216:219]
s_waitcnt lgkmcnt(7)
ds_read_b64_tr_b16 a[246:247], v239 offset:34464
v_mfma_f32_16x16x32_bf16 a[0:3], a[224:227], a[200:203], a[0:3]
ds_read_b64_tr_b16 a[248:249], v239 offset:33984
v_mfma_f32_16x16x32_bf16 a[4:7], a[224:227], a[204:207], a[4:7]
ds_read_b64_tr_b16 a[250:251], v239 offset:34496
v_mfma_f32_16x16x32_bf16 a[8:11], a[228:231], a[200:203], a[8:11]
s_waitcnt lgkmcnt(6)
ds_read_b64_tr_b16 a[252:253], v239 offset:34016
v_mfma_f32_16x16x32_bf16 a[12:15], a[228:231], a[204:207], a[12:15]
s_waitcnt vmcnt(22)
ds_read_b64_tr_b16 a[254:255], v239 offset:34528
s_barrier
v_mfma_f32_16x16x32_bf16 a[16:19], a[232:235], a[200:203], a[16:19]
ds_read_b64_tr_b16 a[224:225], v239 offset:0
buffer_load_dwordx4 v248, s[8:11], s29 offen offset:2112 nt lds
v_mfma_f32_16x16x32_bf16 a[20:23], a[232:235], a[204:207], a[20:23]
ds_read_b64_tr_b16 a[226:227], v239 offset:128
v_mfma_f32_16x16x32_bf16 a[24:27], a[236:239], a[200:203], a[24:27]
ds_read_b64_tr_b16 a[228:229], v239 offset:256
v_mfma_f32_16x16x32_bf16 a[28:31], a[236:239], a[204:207], a[28:31]
s_waitcnt lgkmcnt(7)
ds_read_b64_tr_b16 a[230:231], v239 offset:384
v_mfma_f32_16x16x32_bf16 a[32:35], a[240:243], a[200:203], a[32:35]
ds_read_b64_tr_b16 a[232:233], v239 offset:512
v_mfma_f32_16x16x32_bf16 a[36:39], a[240:243], a[204:207], a[36:39]
ds_read_b64_tr_b16 a[234:235], v239 offset:640
v_mfma_f32_16x16x32_bf16 a[40:43], a[244:247], a[200:203], a[40:43]
ds_read_b64_tr_b16 a[236:237], v239 offset:768
buffer_load_dwordx4 v249, s[8:11], s29 offen offset:3168 nt lds
v_mfma_f32_16x16x32_bf16 a[44:47], a[244:247], a[204:207], a[44:47]
s_waitcnt lgkmcnt(7)
ds_read_b64_tr_b16 a[238:239], v239 offset:896
s_add_u32 m0, s28, 16896
v_mfma_f32_16x16x32_bf16 a[48:51], a[248:251], a[200:203], a[48:51]
s_mov_b32 s45, 3408384
ds_read_b64_tr_b16 a[240:241], v239 offset:32
v_mfma_f32_16x16x32_bf16 a[52:55], a[248:251], a[204:207], a[52:55]
ds_read_b64_tr_b16 a[242:243], v239 offset:160
v_mfma_f32_16x16x32_bf16 a[56:59], a[252:255], a[200:203], a[56:59]
ds_read_b64_tr_b16 a[244:245], v239 offset:288
v_mfma_f32_16x16x32_bf16 a[60:63], a[252:255], a[204:207], a[60:63]
s_waitcnt lgkmcnt(7)
ds_read_b64_tr_b16 a[246:247], v239 offset:416
v_mfma_f32_16x16x32_bf16 v[192:195], a[224:227], v[96:99], v[192:195]
ds_read_b64_tr_b16 a[248:249], v239 offset:544
v_mfma_f32_16x16x32_bf16 v[192:195], a[228:231], v[104:107], v[192:195]
ds_read_b64_tr_b16 a[250:251], v239 offset:672
buffer_load_dwordx4 v250, s[12:15], s45 offen offset:0 lds
v_mfma_f32_16x16x32_bf16 v[196:199], a[228:231], v[108:111], v[196:199]
ds_read_b64_tr_b16 a[252:253], v239 offset:800
v_mfma_f32_16x16x32_bf16 v[196:199], a[224:227], v[100:103], v[196:199]
s_waitcnt lgkmcnt(7)
ds_read_b64_tr_b16 a[254:255], v239 offset:928
v_mfma_f32_16x16x32_bf16 v[196:199], a[232:235], v[116:119], v[196:199]
ds_read_b64_tr_b16 a[224:225], v239 offset:64
v_mfma_f32_16x16x32_bf16 v[196:199], a[236:239], v[124:127], v[196:199]
ds_read_b64_tr_b16 a[226:227], v239 offset:192
v_mfma_f32_16x16x32_bf16 v[192:195], a[236:239], v[120:123], v[192:195]
ds_read_b64_tr_b16 a[228:229], v239 offset:320
v_mfma_f32_16x16x32_bf16 v[192:195], a[232:235], v[112:115], v[192:195]
s_waitcnt lgkmcnt(7)
ds_read_b64_tr_b16 a[230:231], v239 offset:448
v_mfma_f32_16x16x32_bf16 v[200:203], a[240:243], v[96:99], v[200:203]
ds_read_b64_tr_b16 a[232:233], v239 offset:576
v_mfma_f32_16x16x32_bf16 v[200:203], a[244:247], v[104:107], v[200:203]
ds_read_b64_tr_b16 a[234:235], v239 offset:704
v_mfma_f32_16x16x32_bf16 v[204:207], a[244:247], v[108:111], v[204:207]
ds_read_b64_tr_b16 a[236:237], v239 offset:832
v_mfma_f32_16x16x32_bf16 v[204:207], a[240:243], v[100:103], v[204:207]
s_waitcnt lgkmcnt(7)
ds_read_b64_tr_b16 a[238:239], v239 offset:960
v_mfma_f32_16x16x32_bf16 v[204:207], a[248:251], v[116:119], v[204:207]
ds_read_b64_tr_b16 a[240:241], v239 offset:96
buffer_load_dwordx4 v251, s[12:15], s45 offen offset:1056 lds
v_mfma_f32_16x16x32_bf16 v[204:207], a[252:255], v[124:127], v[204:207]
ds_read_b64_tr_b16 a[242:243], v239 offset:224
v_mfma_f32_16x16x32_bf16 v[200:203], a[252:255], v[120:123], v[200:203]
ds_read_b64_tr_b16 a[244:245], v239 offset:352
v_mfma_f32_16x16x32_bf16 v[200:203], a[248:251], v[112:115], v[200:203]
s_waitcnt lgkmcnt(7)
ds_read_b64_tr_b16 a[246:247], v239 offset:480
v_mfma_f32_16x16x32_bf16 v[208:211], a[224:227], v[96:99], v[208:211]
ds_read_b64_tr_b16 a[248:249], v239 offset:608
v_mfma_f32_16x16x32_bf16 v[208:211], a[228:231], v[104:107], v[208:211]
ds_read_b64_tr_b16 a[250:251], v239 offset:736
v_mfma_f32_16x16x32_bf16 v[212:215], a[228:231], v[108:111], v[212:215]
ds_read_b64_tr_b16 a[252:253], v239 offset:864
v_mfma_f32_16x16x32_bf16 v[212:215], a[224:227], v[100:103], v[212:215]
s_waitcnt lgkmcnt(7)
ds_read_b64_tr_b16 a[254:255], v239 offset:992
v_mfma_f32_16x16x32_bf16 v[212:215], a[232:235], v[116:119], v[212:215]
ds_read_b64_tr_b16 a[224:225], v239 offset:34048
v_mul_f32 v192, v192, v242
v_mfma_f32_16x16x32_bf16 v[212:215], a[236:239], v[124:127], v[212:215]
ds_read_b64_tr_b16 a[226:227], v239 offset:34560
v_mul_f32 v193, v193, v242
v_mfma_f32_16x16x32_bf16 v[208:211], a[236:239], v[120:123], v[208:211]
ds_read_b64_tr_b16 a[228:229], v239 offset:34080
v_mul_f32 v194, v194, v242
v_mfma_f32_16x16x32_bf16 v[208:211], a[232:235], v[112:115], v[208:211]
s_waitcnt lgkmcnt(7)
ds_read_b64_tr_b16 a[230:231], v239 offset:34592
v_mul_f32 v195, v195, v242
v_mfma_f32_16x16x32_bf16 v[216:219], a[240:243], v[96:99], v[216:219]
ds_read_b64_tr_b16 a[232:233], v239 offset:34112
buffer_load_dwordx4 v252, s[12:15], s45 offen offset:2112 lds
v_cvt_pk_bf16_f32 v192, v192, v193
v_mfma_f32_16x16x32_bf16 v[216:219], a[244:247], v[104:107], v[216:219]
ds_read_b64_tr_b16 a[234:235], v239 offset:34624
v_cvt_pk_bf16_f32 v193, v194, v195
v_mfma_f32_16x16x32_bf16 v[220:223], a[244:247], v[108:111], v[220:223]
ds_read_b64_tr_b16 a[236:237], v239 offset:34144
v_mul_f32 v196, v196, v243
v_mfma_f32_16x16x32_bf16 v[220:223], a[240:243], v[100:103], v[220:223]
s_waitcnt lgkmcnt(7)
ds_read_b64_tr_b16 a[238:239], v239 offset:34656
v_mul_f32 v197, v197, v243
v_mfma_f32_16x16x32_bf16 v[220:223], a[248:251], v[116:119], v[220:223]
ds_read_b64_tr_b16 a[240:241], v239 offset:34176
v_mul_f32 v198, v198, v243
v_mfma_f32_16x16x32_bf16 v[220:223], a[252:255], v[124:127], v[220:223]
ds_read_b64_tr_b16 a[242:243], v239 offset:34688
v_mul_f32 v199, v199, v243
v_mfma_f32_16x16x32_bf16 v[216:219], a[252:255], v[120:123], v[216:219]
ds_read_b64_tr_b16 a[244:245], v239 offset:34208
v_cvt_pk_bf16_f32 v196, v196, v197
v_mfma_f32_16x16x32_bf16 v[216:219], a[248:251], v[112:115], v[216:219]
s_waitcnt lgkmcnt(7)
ds_read_b64_tr_b16 a[246:247], v239 offset:34720
v_cvt_pk_bf16_f32 v197, v198, v199
v_mfma_f32_16x16x32_bf16 a[64:67], a[224:227], a[200:203], a[64:67]
ds_read_b64_tr_b16 a[248:249], v239 offset:34240
v_mul_f32 v200, v200, v242
v_mfma_f32_16x16x32_bf16 a[68:71], a[224:227], a[204:207], a[68:71]
ds_read_b64_tr_b16 a[250:251], v239 offset:34752
v_mul_f32 v201, v201, v242
v_mfma_f32_16x16x32_bf16 a[72:75], a[228:231], a[200:203], a[72:75]
s_waitcnt lgkmcnt(6)
ds_read_b64_tr_b16 a[252:253], v239 offset:34272
v_mul_f32 v202, v202, v242
v_mfma_f32_16x16x32_bf16 a[76:79], a[228:231], a[204:207], a[76:79]
s_waitcnt vmcnt(11)
ds_read_b64_tr_b16 a[254:255], v239 offset:34784
s_barrier
v_mfma_f32_16x16x32_bf16 a[80:83], a[232:235], a[200:203], a[80:83]
ds_read_b64_tr_b16 a[224:225], v239 offset:50688
buffer_load_dwordx4 v253, s[12:15], s45 offen offset:3168 lds
v_mul_f32 v203, v203, v242
v_mfma_f32_16x16x32_bf16 a[84:87], a[232:235], a[204:207], a[84:87]
ds_read_b64_tr_b16 a[226:227], v239 offset:50816
v_cvt_pk_bf16_f32 v194, v200, v201
v_mfma_f32_16x16x32_bf16 a[88:91], a[236:239], a[200:203], a[88:91]
ds_read_b64_tr_b16 a[228:229], v239 offset:50944
v_cvt_pk_bf16_f32 v195, v202, v203
v_mfma_f32_16x16x32_bf16 a[92:95], a[236:239], a[204:207], a[92:95]
s_waitcnt lgkmcnt(7)
ds_read_b64_tr_b16 a[230:231], v239 offset:51072
v_mul_f32 v204, v204, v243
v_mfma_f32_16x16x32_bf16 a[96:99], a[240:243], a[200:203], a[96:99]
ds_read_b64_tr_b16 a[232:233], v239 offset:51200
v_mul_f32 v205, v205, v243
v_mfma_f32_16x16x32_bf16 a[100:103], a[240:243], a[204:207], a[100:103]
s_add_u32 m0, s28, 0
ds_read_b64_tr_b16 a[234:235], v239 offset:51328
v_mul_f32 v206, v206, v243
v_mul_f32 v207, v207, v243
v_mfma_f32_16x16x32_bf16 a[104:107], a[244:247], a[200:203], a[104:107]
s_mov_b32 s29, 65920
ds_read_b64_tr_b16 a[236:237], v239 offset:51456
v_cvt_pk_bf16_f32 v198, v204, v205
v_cvt_pk_bf16_f32 v199, v206, v207
v_mfma_f32_16x16x32_bf16 a[108:111], a[244:247], a[204:207], a[108:111]
s_waitcnt lgkmcnt(7)
ds_read_b64_tr_b16 a[238:239], v239 offset:51584
v_accvgpr_write_b32 a144, v192
v_accvgpr_write_b32 a145, v193
v_mfma_f32_16x16x32_bf16 a[112:115], a[248:251], a[200:203], a[112:115]
ds_read_b64_tr_b16 a[240:241], v239 offset:50720
v_accvgpr_write_b32 a146, v194
v_accvgpr_write_b32 a147, v195
v_mfma_f32_16x16x32_bf16 a[116:119], a[248:251], a[204:207], a[116:119]
ds_read_b64_tr_b16 a[242:243], v239 offset:50848
v_accvgpr_write_b32 a148, v196
v_accvgpr_write_b32 a149, v197
v_mfma_f32_16x16x32_bf16 a[120:123], a[252:255], a[200:203], a[120:123]
ds_read_b64_tr_b16 a[244:245], v239 offset:50976
v_accvgpr_write_b32 a150, v198
v_accvgpr_write_b32 a151, v199
v_mfma_f32_16x16x32_bf16 a[124:127], a[252:255], a[204:207], a[124:127]
s_waitcnt lgkmcnt(7)
ds_read_b64_tr_b16 a[246:247], v239 offset:51104
v_mul_f32 v208, v208, v242
v_mul_f32 v209, v209, v242
v_mfma_f32_16x16x32_bf16 v[192:195], a[224:227], v[0:3], 0
ds_read_b64_tr_b16 a[248:249], v239 offset:51232
v_mul_f32 v210, v210, v242
v_mul_f32 v211, v211, v242
v_mfma_f32_16x16x32_bf16 v[192:195], a[228:231], v[8:11], v[192:195]
ds_read_b64_tr_b16 a[250:251], v239 offset:51360
buffer_load_dwordx4 v246, s[8:11], s29 offen offset:0 nt lds
v_cvt_pk_bf16_f32 v208, v208, v209
v_cvt_pk_bf16_f32 v209, v210, v211
v_mfma_f32_16x16x32_bf16 v[196:199], a[228:231], v[12:15], 0
ds_read_b64_tr_b16 a[252:253], v239 offset:51488
v_mul_f32 v212, v212, v243
v_mul_f32 v213, v213, v243
v_mfma_f32_16x16x32_bf16 v[196:199], a[224:227], v[4:7], v[196:199]
s_waitcnt lgkmcnt(7)
ds_read_b64_tr_b16 a[254:255], v239 offset:51616
v_mul_f32 v214, v214, v243
v_mul_f32 v215, v215, v243
v_mfma_f32_16x16x32_bf16 v[196:199], a[232:235], v[20:23], v[196:199]
ds_read_b64_tr_b16 a[224:225], v239 offset:50752
v_cvt_pk_bf16_f32 v212, v212, v213
v_cvt_pk_bf16_f32 v213, v214, v215
v_mfma_f32_16x16x32_bf16 v[196:199], a[236:239], v[28:31], v[196:199]
ds_read_b64_tr_b16 a[226:227], v239 offset:50880
v_mul_f32 v216, v216, v242
v_mul_f32 v217, v217, v242
v_mfma_f32_16x16x32_bf16 v[192:195], a[236:239], v[24:27], v[192:195]
ds_read_b64_tr_b16 a[228:229], v239 offset:51008
buffer_load_dwordx4 v247, s[8:11], s29 offen offset:1056 nt lds
v_mul_f32 v218, v218, v242
v_mul_f32 v219, v219, v242
v_mfma_f32_16x16x32_bf16 v[192:195], a[232:235], v[16:19], v[192:195]
s_waitcnt lgkmcnt(7)
ds_read_b64_tr_b16 a[230:231], v239 offset:51136
v_cvt_pk_bf16_f32 v210, v216, v217
v_cvt_pk_bf16_f32 v211, v218, v219
v_mfma_f32_16x16x32_bf16 v[200:203], a[240:243], v[0:3], 0
ds_read_b64_tr_b16 a[232:233], v239 offset:51264
v_mul_f32 v220, v220, v243
v_mul_f32 v221, v221, v243
v_mfma_f32_16x16x32_bf16 v[200:203], a[244:247], v[8:11], v[200:203]
ds_read_b64_tr_b16 a[234:235], v239 offset:51392
v_mul_f32 v222, v222, v243
v_mul_f32 v223, v223, v243
v_mfma_f32_16x16x32_bf16 v[204:207], a[244:247], v[12:15], 0
ds_read_b64_tr_b16 a[236:237], v239 offset:51520
v_cvt_pk_bf16_f32 v214, v220, v221
v_cvt_pk_bf16_f32 v215, v222, v223
v_mfma_f32_16x16x32_bf16 v[204:207], a[240:243], v[4:7], v[204:207]
s_waitcnt lgkmcnt(7)
ds_read_b64_tr_b16 a[238:239], v239 offset:51648
v_accvgpr_write_b32 a152, v208
v_accvgpr_write_b32 a153, v209
v_mfma_f32_16x16x32_bf16 v[204:207], a[248:251], v[20:23], v[204:207]
ds_read_b64_tr_b16 a[240:241], v239 offset:50784
v_accvgpr_write_b32 a154, v210
v_accvgpr_write_b32 a155, v211
v_mfma_f32_16x16x32_bf16 v[204:207], a[252:255], v[28:31], v[204:207]
ds_read_b64_tr_b16 a[242:243], v239 offset:50912
v_accvgpr_write_b32 a156, v212
v_accvgpr_write_b32 a157, v213
v_mfma_f32_16x16x32_bf16 v[200:203], a[252:255], v[24:27], v[200:203]
ds_read_b64_tr_b16 a[244:245], v239 offset:51040
v_accvgpr_write_b32 a158, v214
v_accvgpr_write_b32 a159, v215
v_mfma_f32_16x16x32_bf16 v[200:203], a[248:251], v[16:19], v[200:203]
s_waitcnt lgkmcnt(7)
ds_read_b64_tr_b16 a[246:247], v239 offset:51168
buffer_load_dwordx4 v248, s[8:11], s29 offen offset:2112 nt lds
v_mfma_f32_16x16x32_bf16 v[208:211], a[224:227], v[0:3], 0
ds_read_b64_tr_b16 a[248:249], v239 offset:51296
v_mfma_f32_16x16x32_bf16 v[208:211], a[228:231], v[8:11], v[208:211]
ds_read_b64_tr_b16 a[250:251], v239 offset:51424
v_mfma_f32_16x16x32_bf16 v[212:215], a[228:231], v[12:15], 0
ds_read_b64_tr_b16 a[252:253], v239 offset:51552
buffer_load_dwordx4 v249, s[8:11], s29 offen offset:3168 nt lds
v_mfma_f32_16x16x32_bf16 v[212:215], a[224:227], v[4:7], v[212:215]
s_waitcnt lgkmcnt(7)
ds_read_b64_tr_b16 a[254:255], v239 offset:51680
s_add_u32 m0, s28, 33792
v_mfma_f32_16x16x32_bf16 v[212:215], a[232:235], v[20:23], v[212:215]
s_mov_b32 s29, 131456
ds_read_b64_tr_b16 a[224:225], v240 offset:33792
v_mfma_f32_16x16x32_bf16 v[212:215], a[236:239], v[28:31], v[212:215]
ds_read_b64_tr_b16 a[226:227], v240 offset:34304
v_mfma_f32_16x16x32_bf16 v[208:211], a[236:239], v[24:27], v[208:211]
ds_read_b64_tr_b16 a[228:229], v240 offset:33824
v_mfma_f32_16x16x32_bf16 v[208:211], a[232:235], v[16:19], v[208:211]
s_waitcnt lgkmcnt(7)
ds_read_b64_tr_b16 a[230:231], v240 offset:34336
v_mfma_f32_16x16x32_bf16 v[216:219], a[240:243], v[0:3], 0
ds_read_b64_tr_b16 a[232:233], v240 offset:33856
buffer_load_dwordx4 v246, s[8:11], s29 offen offset:0 nt lds
v_mfma_f32_16x16x32_bf16 v[216:219], a[244:247], v[8:11], v[216:219]
ds_read_b64_tr_b16 a[234:235], v240 offset:34368
v_mfma_f32_16x16x32_bf16 v[220:223], a[244:247], v[12:15], 0
ds_read_b64_tr_b16 a[236:237], v240 offset:33888
v_mfma_f32_16x16x32_bf16 v[220:223], a[240:243], v[4:7], v[220:223]
s_waitcnt lgkmcnt(7)
ds_read_b64_tr_b16 a[238:239], v240 offset:34400
v_mfma_f32_16x16x32_bf16 v[220:223], a[248:251], v[20:23], v[220:223]
ds_read_b64_tr_b16 a[240:241], v240 offset:33920
v_mfma_f32_16x16x32_bf16 v[220:223], a[252:255], v[28:31], v[220:223]
ds_read_b64_tr_b16 a[242:243], v240 offset:34432
v_mfma_f32_16x16x32_bf16 v[216:219], a[252:255], v[24:27], v[216:219]
ds_read_b64_tr_b16 a[244:245], v240 offset:33952
buffer_load_dwordx4 v247, s[8:11], s29 offen offset:1056 nt lds
v_mfma_f32_16x16x32_bf16 v[216:219], a[248:251], v[16:19], v[216:219]
s_waitcnt lgkmcnt(7)
ds_read_b64_tr_b16 a[246:247], v240 offset:34464
v_mfma_f32_16x16x32_bf16 a[0:3], a[224:227], a[208:211], a[0:3]
ds_read_b64_tr_b16 a[248:249], v240 offset:33984
v_mfma_f32_16x16x32_bf16 a[4:7], a[224:227], a[212:215], a[4:7]
ds_read_b64_tr_b16 a[250:251], v240 offset:34496
v_mfma_f32_16x16x32_bf16 a[8:11], a[228:231], a[208:211], a[8:11]
s_waitcnt lgkmcnt(6)
ds_read_b64_tr_b16 a[252:253], v240 offset:34016
v_mfma_f32_16x16x32_bf16 a[12:15], a[228:231], a[212:215], a[12:15]
s_waitcnt vmcnt(18)
ds_read_b64_tr_b16 a[254:255], v240 offset:34528
s_barrier
v_mfma_f32_16x16x32_bf16 a[16:19], a[232:235], a[208:211], a[16:19]
ds_read_b64_tr_b16 a[224:225], v240 offset:16896
buffer_load_dwordx4 v248, s[8:11], s29 offen offset:2112 nt lds
v_mfma_f32_16x16x32_bf16 a[20:23], a[232:235], a[212:215], a[20:23]
ds_read_b64_tr_b16 a[226:227], v240 offset:17024
v_mfma_f32_16x16x32_bf16 a[24:27], a[236:239], a[208:211], a[24:27]
ds_read_b64_tr_b16 a[228:229], v240 offset:17152
v_mfma_f32_16x16x32_bf16 a[28:31], a[236:239], a[212:215], a[28:31]
s_waitcnt lgkmcnt(7)
ds_read_b64_tr_b16 a[230:231], v240 offset:17280
v_mfma_f32_16x16x32_bf16 a[32:35], a[240:243], a[208:211], a[32:35]
ds_read_b64_tr_b16 a[232:233], v240 offset:17408
v_mfma_f32_16x16x32_bf16 a[36:39], a[240:243], a[212:215], a[36:39]
ds_read_b64_tr_b16 a[234:235], v240 offset:17536
v_mfma_f32_16x16x32_bf16 a[40:43], a[244:247], a[208:211], a[40:43]
ds_read_b64_tr_b16 a[236:237], v240 offset:17664
buffer_load_dwordx4 v249, s[8:11], s29 offen offset:3168 nt lds
v_mfma_f32_16x16x32_bf16 a[44:47], a[244:247], a[212:215], a[44:47]
s_waitcnt lgkmcnt(7)
ds_read_b64_tr_b16 a[238:239], v240 offset:17792
s_add_u32 m0, s28, 50688
v_mfma_f32_16x16x32_bf16 a[48:51], a[248:251], a[208:211], a[48:51]
s_mov_b32 s29, 196992
ds_read_b64_tr_b16 a[240:241], v240 offset:16928
v_mfma_f32_16x16x32_bf16 a[52:55], a[248:251], a[212:215], a[52:55]
ds_read_b64_tr_b16 a[242:243], v240 offset:17056
v_mfma_f32_16x16x32_bf16 a[56:59], a[252:255], a[208:211], a[56:59]
ds_read_b64_tr_b16 a[244:245], v240 offset:17184
v_mfma_f32_16x16x32_bf16 a[60:63], a[252:255], a[212:215], a[60:63]
s_waitcnt lgkmcnt(7)
ds_read_b64_tr_b16 a[246:247], v240 offset:17312
v_mfma_f32_16x16x32_bf16 v[192:195], a[224:227], v[32:35], v[192:195]
ds_read_b64_tr_b16 a[248:249], v240 offset:17440
v_mfma_f32_16x16x32_bf16 v[192:195], a[228:231], v[40:43], v[192:195]
ds_read_b64_tr_b16 a[250:251], v240 offset:17568
buffer_load_dwordx4 v246, s[8:11], s29 offen offset:0 nt lds
v_mfma_f32_16x16x32_bf16 v[196:199], a[228:231], v[44:47], v[196:199]
ds_read_b64_tr_b16 a[252:253], v240 offset:17696
v_mfma_f32_16x16x32_bf16 v[196:199], a[224:227], v[36:39], v[196:199]
s_waitcnt lgkmcnt(7)
ds_read_b64_tr_b16 a[254:255], v240 offset:17824
v_mfma_f32_16x16x32_bf16 v[196:199], a[232:235], v[52:55], v[196:199]
ds_read_b64_tr_b16 a[224:225], v240 offset:16960
v_mfma_f32_16x16x32_bf16 v[196:199], a[236:239], v[60:63], v[196:199]
ds_read_b64_tr_b16 a[226:227], v240 offset:17088
v_mfma_f32_16x16x32_bf16 v[192:195], a[236:239], v[56:59], v[192:195]
ds_read_b64_tr_b16 a[228:229], v240 offset:17216
v_mfma_f32_16x16x32_bf16 v[192:195], a[232:235], v[48:51], v[192:195]
s_waitcnt lgkmcnt(7)
ds_read_b64_tr_b16 a[230:231], v240 offset:17344
v_mfma_f32_16x16x32_bf16 v[200:203], a[240:243], v[32:35], v[200:203]
ds_read_b64_tr_b16 a[232:233], v240 offset:17472
v_mfma_f32_16x16x32_bf16 v[200:203], a[244:247], v[40:43], v[200:203]
ds_read_b64_tr_b16 a[234:235], v240 offset:17600
v_mfma_f32_16x16x32_bf16 v[204:207], a[244:247], v[44:47], v[204:207]
ds_read_b64_tr_b16 a[236:237], v240 offset:17728
v_mfma_f32_16x16x32_bf16 v[204:207], a[240:243], v[36:39], v[204:207]
s_waitcnt lgkmcnt(7)
ds_read_b64_tr_b16 a[238:239], v240 offset:17856
v_mfma_f32_16x16x32_bf16 v[204:207], a[248:251], v[52:55], v[204:207]
ds_read_b64_tr_b16 a[240:241], v240 offset:16992
buffer_load_dwordx4 v247, s[8:11], s29 offen offset:1056 nt lds
v_mfma_f32_16x16x32_bf16 v[204:207], a[252:255], v[60:63], v[204:207]
ds_read_b64_tr_b16 a[242:243], v240 offset:17120
v_mfma_f32_16x16x32_bf16 v[200:203], a[252:255], v[56:59], v[200:203]
ds_read_b64_tr_b16 a[244:245], v240 offset:17248
v_mfma_f32_16x16x32_bf16 v[200:203], a[248:251], v[48:51], v[200:203]
s_waitcnt lgkmcnt(7)
ds_read_b64_tr_b16 a[246:247], v240 offset:17376
v_mfma_f32_16x16x32_bf16 v[208:211], a[224:227], v[32:35], v[208:211]
ds_read_b64_tr_b16 a[248:249], v240 offset:17504
v_mfma_f32_16x16x32_bf16 v[208:211], a[228:231], v[40:43], v[208:211]
ds_read_b64_tr_b16 a[250:251], v240 offset:17632
v_mfma_f32_16x16x32_bf16 v[212:215], a[228:231], v[44:47], v[212:215]
ds_read_b64_tr_b16 a[252:253], v240 offset:17760
v_mfma_f32_16x16x32_bf16 v[212:215], a[224:227], v[36:39], v[212:215]
s_waitcnt lgkmcnt(7)
ds_read_b64_tr_b16 a[254:255], v240 offset:17888
v_mfma_f32_16x16x32_bf16 v[212:215], a[232:235], v[52:55], v[212:215]
ds_read_b64_tr_b16 a[224:225], v240 offset:34048
v_mfma_f32_16x16x32_bf16 v[212:215], a[236:239], v[60:63], v[212:215]
ds_read_b64_tr_b16 a[226:227], v240 offset:34560
v_mfma_f32_16x16x32_bf16 v[208:211], a[236:239], v[56:59], v[208:211]
ds_read_b64_tr_b16 a[228:229], v240 offset:34080
v_mfma_f32_16x16x32_bf16 v[208:211], a[232:235], v[48:51], v[208:211]
s_waitcnt lgkmcnt(7)
ds_read_b64_tr_b16 a[230:231], v240 offset:34592
v_mfma_f32_16x16x32_bf16 v[216:219], a[240:243], v[32:35], v[216:219]
ds_read_b64_tr_b16 a[232:233], v240 offset:34112
buffer_load_dwordx4 v248, s[8:11], s29 offen offset:2112 nt lds
v_mfma_f32_16x16x32_bf16 v[216:219], a[244:247], v[40:43], v[216:219]
ds_read_b64_tr_b16 a[234:235], v240 offset:34624
v_mfma_f32_16x16x32_bf16 v[220:223], a[244:247], v[44:47], v[220:223]
ds_read_b64_tr_b16 a[236:237], v240 offset:34144
v_mfma_f32_16x16x32_bf16 v[220:223], a[240:243], v[36:39], v[220:223]
s_waitcnt lgkmcnt(7)
ds_read_b64_tr_b16 a[238:239], v240 offset:34656
v_mfma_f32_16x16x32_bf16 v[220:223], a[248:251], v[52:55], v[220:223]
ds_read_b64_tr_b16 a[240:241], v240 offset:34176
v_mfma_f32_16x16x32_bf16 v[220:223], a[252:255], v[60:63], v[220:223]
ds_read_b64_tr_b16 a[242:243], v240 offset:34688
v_mfma_f32_16x16x32_bf16 v[216:219], a[252:255], v[56:59], v[216:219]
ds_read_b64_tr_b16 a[244:245], v240 offset:34208
v_mfma_f32_16x16x32_bf16 v[216:219], a[248:251], v[48:51], v[216:219]
s_waitcnt lgkmcnt(7)
ds_read_b64_tr_b16 a[246:247], v240 offset:34720
v_mfma_f32_16x16x32_bf16 a[64:67], a[224:227], a[208:211], a[64:67]
ds_read_b64_tr_b16 a[248:249], v240 offset:34240
v_mfma_f32_16x16x32_bf16 a[68:71], a[224:227], a[212:215], a[68:71]
ds_read_b64_tr_b16 a[250:251], v240 offset:34752
v_mfma_f32_16x16x32_bf16 a[72:75], a[228:231], a[208:211], a[72:75]
s_waitcnt lgkmcnt(6)
ds_read_b64_tr_b16 a[252:253], v240 offset:34272
v_mfma_f32_16x16x32_bf16 a[76:79], a[228:231], a[212:215], a[76:79]
s_waitcnt vmcnt(11)
ds_read_b64_tr_b16 a[254:255], v240 offset:34784
s_barrier
v_mfma_f32_16x16x32_bf16 a[80:83], a[232:235], a[208:211], a[80:83]
ds_read_b64_tr_b16 a[224:225], v240 offset:0
buffer_load_dwordx4 v249, s[8:11], s29 offen offset:3168 nt lds
v_mfma_f32_16x16x32_bf16 a[84:87], a[232:235], a[212:215], a[84:87]
ds_read_b64_tr_b16 a[226:227], v240 offset:128
v_sub_u32 v246, v246, v254
v_mfma_f32_16x16x32_bf16 a[88:91], a[236:239], a[208:211], a[88:91]
ds_read_b64_tr_b16 a[228:229], v240 offset:256
v_sub_u32 v247, v247, v254
v_mfma_f32_16x16x32_bf16 a[92:95], a[236:239], a[212:215], a[92:95]
s_waitcnt lgkmcnt(7)
ds_read_b64_tr_b16 a[230:231], v240 offset:384
v_sub_u32 v248, v248, v254
v_mfma_f32_16x16x32_bf16 a[96:99], a[240:243], a[208:211], a[96:99]
s_add_u32 m0, s28, 84480
ds_read_b64_tr_b16 a[232:233], v240 offset:512
v_sub_u32 v249, v249, v254
v_mfma_f32_16x16x32_bf16 a[100:103], a[240:243], a[212:215], a[100:103]
s_mov_b32 s29, 262144
ds_read_b64_tr_b16 a[234:235], v240 offset:640
v_mfma_f32_16x16x32_bf16 a[104:107], a[244:247], a[208:211], a[104:107]
ds_read_b64_tr_b16 a[236:237], v240 offset:768
v_mfma_f32_16x16x32_bf16 a[108:111], a[244:247], a[212:215], a[108:111]
s_waitcnt lgkmcnt(7)
ds_read_b64_tr_b16 a[238:239], v240 offset:896
v_mfma_f32_16x16x32_bf16 a[112:115], a[248:251], a[208:211], a[112:115]
ds_read_b64_tr_b16 a[240:241], v240 offset:32
v_mfma_f32_16x16x32_bf16 a[116:119], a[248:251], a[212:215], a[116:119]
ds_read_b64_tr_b16 a[242:243], v240 offset:160
v_mfma_f32_16x16x32_bf16 a[120:123], a[252:255], a[208:211], a[120:123]
ds_read_b64_tr_b16 a[244:245], v240 offset:288
v_mfma_f32_16x16x32_bf16 a[124:127], a[252:255], a[212:215], a[124:127]
s_waitcnt lgkmcnt(7)
ds_read_b64_tr_b16 a[246:247], v240 offset:416
v_mfma_f32_16x16x32_bf16 v[192:195], a[224:227], v[64:67], v[192:195]
ds_read_b64_tr_b16 a[248:249], v240 offset:544
v_mfma_f32_16x16x32_bf16 v[192:195], a[228:231], v[72:75], v[192:195]
ds_read_b64_tr_b16 a[250:251], v240 offset:672
buffer_load_dwordx4 v246, s[4:7], s29 offen offset:0 nt lds
v_mfma_f32_16x16x32_bf16 v[196:199], a[228:231], v[76:79], v[196:199]
ds_read_b64_tr_b16 a[252:253], v240 offset:800
v_mfma_f32_16x16x32_bf16 v[196:199], a[224:227], v[68:71], v[196:199]
s_waitcnt lgkmcnt(7)
ds_read_b64_tr_b16 a[254:255], v240 offset:928
v_mfma_f32_16x16x32_bf16 v[196:199], a[232:235], v[84:87], v[196:199]
ds_read_b64_tr_b16 a[224:225], v240 offset:64
v_mfma_f32_16x16x32_bf16 v[196:199], a[236:239], v[92:95], v[196:199]
ds_read_b64_tr_b16 a[226:227], v240 offset:192
v_mfma_f32_16x16x32_bf16 v[192:195], a[236:239], v[88:91], v[192:195]
ds_read_b64_tr_b16 a[228:229], v240 offset:320
v_mfma_f32_16x16x32_bf16 v[192:195], a[232:235], v[80:83], v[192:195]
s_waitcnt lgkmcnt(7)
ds_read_b64_tr_b16 a[230:231], v240 offset:448
v_mfma_f32_16x16x32_bf16 v[200:203], a[240:243], v[64:67], v[200:203]
ds_read_b64_tr_b16 a[232:233], v240 offset:576
v_mfma_f32_16x16x32_bf16 v[200:203], a[244:247], v[72:75], v[200:203]
ds_read_b64_tr_b16 a[234:235], v240 offset:704
v_mfma_f32_16x16x32_bf16 v[204:207], a[244:247], v[76:79], v[204:207]
ds_read_b64_tr_b16 a[236:237], v240 offset:832
v_mfma_f32_16x16x32_bf16 v[204:207], a[240:243], v[68:71], v[204:207]
s_waitcnt lgkmcnt(7)
ds_read_b64_tr_b16 a[238:239], v240 offset:960
v_mfma_f32_16x16x32_bf16 v[204:207], a[248:251], v[84:87], v[204:207]
ds_read_b64_tr_b16 a[240:241], v240 offset:96
buffer_load_dwordx4 v247, s[4:7], s29 offen offset:1056 nt lds
v_mfma_f32_16x16x32_bf16 v[204:207], a[252:255], v[92:95], v[204:207]
ds_read_b64_tr_b16 a[242:243], v240 offset:224
v_mfma_f32_16x16x32_bf16 v[200:203], a[252:255], v[88:91], v[200:203]
ds_read_b64_tr_b16 a[244:245], v240 offset:352
v_mfma_f32_16x16x32_bf16 v[200:203], a[248:251], v[80:83], v[200:203]
s_waitcnt lgkmcnt(7)
ds_read_b64_tr_b16 a[246:247], v240 offset:480
v_mfma_f32_16x16x32_bf16 v[208:211], a[224:227], v[64:67], v[208:211]
ds_read_b64_tr_b16 a[248:249], v240 offset:608
v_mfma_f32_16x16x32_bf16 v[208:211], a[228:231], v[72:75], v[208:211]
ds_read_b64_tr_b16 a[250:251], v240 offset:736
v_mfma_f32_16x16x32_bf16 v[212:215], a[228:231], v[76:79], v[212:215]
ds_read_b64_tr_b16 a[252:253], v240 offset:864
v_mfma_f32_16x16x32_bf16 v[212:215], a[224:227], v[68:71], v[212:215]
s_waitcnt lgkmcnt(7)
ds_read_b64_tr_b16 a[254:255], v240 offset:992
v_mfma_f32_16x16x32_bf16 v[212:215], a[232:235], v[84:87], v[212:215]
ds_read_b64_tr_b16 a[224:225], v239 offset:16896
v_mfma_f32_16x16x32_bf16 v[212:215], a[236:239], v[92:95], v[212:215]
ds_read_b64_tr_b16 a[226:227], v239 offset:17408
v_mfma_f32_16x16x32_bf16 v[208:211], a[236:239], v[88:91], v[208:211]
ds_read_b64_tr_b16 a[228:229], v239 offset:16928
v_mfma_f32_16x16x32_bf16 v[208:211], a[232:235], v[80:83], v[208:211]
s_waitcnt lgkmcnt(7)
ds_read_b64_tr_b16 a[230:231], v239 offset:17440
v_mfma_f32_16x16x32_bf16 v[216:219], a[240:243], v[64:67], v[216:219]
ds_read_b64_tr_b16 a[232:233], v239 offset:16960
buffer_load_dwordx4 v248, s[4:7], s29 offen offset:2112 nt lds
v_mfma_f32_16x16x32_bf16 v[216:219], a[244:247], v[72:75], v[216:219]
ds_read_b64_tr_b16 a[234:235], v239 offset:17472
v_mfma_f32_16x16x32_bf16 v[220:223], a[244:247], v[76:79], v[220:223]
ds_read_b64_tr_b16 a[236:237], v239 offset:16992
v_mfma_f32_16x16x32_bf16 v[220:223], a[240:243], v[68:71], v[220:223]
s_waitcnt lgkmcnt(7)
ds_read_b64_tr_b16 a[238:239], v239 offset:17504
v_mfma_f32_16x16x32_bf16 v[220:223], a[248:251], v[84:87], v[220:223]
ds_read_b64_tr_b16 a[240:241], v239 offset:17024
v_mfma_f32_16x16x32_bf16 v[220:223], a[252:255], v[92:95], v[220:223]
ds_read_b64_tr_b16 a[242:243], v239 offset:17536
v_mfma_f32_16x16x32_bf16 v[216:219], a[252:255], v[88:91], v[216:219]
ds_read_b64_tr_b16 a[244:245], v239 offset:17056
v_mfma_f32_16x16x32_bf16 v[216:219], a[248:251], v[80:83], v[216:219]
s_waitcnt lgkmcnt(7)
ds_read_b64_tr_b16 a[246:247], v239 offset:17568
v_mfma_f32_16x16x32_bf16 a[0:3], a[224:227], a[216:219], a[0:3]
ds_read_b64_tr_b16 a[248:249], v239 offset:17088
v_mfma_f32_16x16x32_bf16 a[4:7], a[224:227], a[220:223], a[4:7]
ds_read_b64_tr_b16 a[250:251], v239 offset:17600
v_mfma_f32_16x16x32_bf16 a[8:11], a[228:231], a[216:219], a[8:11]
s_waitcnt lgkmcnt(6)
ds_read_b64_tr_b16 a[252:253], v239 offset:17120
v_mfma_f32_16x16x32_bf16 a[12:15], a[228:231], a[220:223], a[12:15]
s_waitcnt vmcnt(15)
ds_read_b64_tr_b16 a[254:255], v239 offset:17632
s_barrier
v_mfma_f32_16x16x32_bf16 a[16:19], a[232:235], a[216:219], a[16:19]
ds_read_b64_tr_b16 a[224:225], v240 offset:50688
buffer_load_dwordx4 v249, s[4:7], s29 offen offset:3168 nt lds
v_mfma_f32_16x16x32_bf16 a[20:23], a[232:235], a[220:223], a[20:23]
ds_read_b64_tr_b16 a[226:227], v240 offset:50816
v_mfma_f32_16x16x32_bf16 a[24:27], a[236:239], a[216:219], a[24:27]
ds_read_b64_tr_b16 a[228:229], v240 offset:50944
v_mfma_f32_16x16x32_bf16 a[28:31], a[236:239], a[220:223], a[28:31]
s_waitcnt lgkmcnt(7)
ds_read_b64_tr_b16 a[230:231], v240 offset:51072
v_mfma_f32_16x16x32_bf16 a[32:35], a[240:243], a[216:219], a[32:35]
ds_read_b64_tr_b16 a[232:233], v240 offset:51200
v_mfma_f32_16x16x32_bf16 a[36:39], a[240:243], a[220:223], a[36:39]
s_add_u32 m0, s28, 101376
ds_read_b64_tr_b16 a[234:235], v240 offset:51328
s_mov_b32 s29, 278528
v_mfma_f32_16x16x32_bf16 a[40:43], a[244:247], a[216:219], a[40:43]
ds_read_b64_tr_b16 a[236:237], v240 offset:51456
v_mfma_f32_16x16x32_bf16 a[44:47], a[244:247], a[220:223], a[44:47]
s_waitcnt lgkmcnt(7)
ds_read_b64_tr_b16 a[238:239], v240 offset:51584
v_mfma_f32_16x16x32_bf16 a[48:51], a[248:251], a[216:219], a[48:51]
ds_read_b64_tr_b16 a[240:241], v240 offset:50720
v_mfma_f32_16x16x32_bf16 a[52:55], a[248:251], a[220:223], a[52:55]
ds_read_b64_tr_b16 a[242:243], v240 offset:50848
v_mfma_f32_16x16x32_bf16 a[56:59], a[252:255], a[216:219], a[56:59]
ds_read_b64_tr_b16 a[244:245], v240 offset:50976
v_mfma_f32_16x16x32_bf16 a[60:63], a[252:255], a[220:223], a[60:63]
s_waitcnt lgkmcnt(7)
ds_read_b64_tr_b16 a[246:247], v240 offset:51104
v_mfma_f32_16x16x32_bf16 v[192:195], a[224:227], v[96:99], v[192:195]
ds_read_b64_tr_b16 a[248:249], v240 offset:51232
v_mfma_f32_16x16x32_bf16 v[192:195], a[228:231], v[104:107], v[192:195]
ds_read_b64_tr_b16 a[250:251], v240 offset:51360
buffer_load_dwordx4 v246, s[4:7], s29 offen offset:0 nt lds
v_mfma_f32_16x16x32_bf16 v[196:199], a[228:231], v[108:111], v[196:199]
ds_read_b64_tr_b16 a[252:253], v240 offset:51488
v_accvgpr_read_b32 v244, a0
v_accvgpr_read_b32 v245, a1
v_mfma_f32_16x16x32_bf16 v[196:199], a[224:227], v[100:103], v[196:199]
s_waitcnt lgkmcnt(7)
ds_read_b64_tr_b16 a[254:255], v240 offset:51616
v_mul_f32 v244, s31, v244
v_mul_f32 v245, s31, v245
v_mfma_f32_16x16x32_bf16 v[196:199], a[232:235], v[116:119], v[196:199]
ds_read_b64_tr_b16 a[224:225], v240 offset:50752
v_cvt_pk_bf16_f32 v128, v244, v245
v_accvgpr_read_b32 v244, a2
v_mfma_f32_16x16x32_bf16 v[196:199], a[236:239], v[124:127], v[196:199]
ds_read_b64_tr_b16 a[226:227], v240 offset:50880
v_accvgpr_read_b32 v245, a3
v_mul_f32 v244, s31, v244
v_mfma_f32_16x16x32_bf16 v[192:195], a[236:239], v[120:123], v[192:195]
ds_read_b64_tr_b16 a[228:229], v240 offset:51008
v_mul_f32 v245, s31, v245
v_cvt_pk_bf16_f32 v129, v244, v245
v_mfma_f32_16x16x32_bf16 v[192:195], a[232:235], v[112:115], v[192:195]
s_waitcnt lgkmcnt(7)
ds_read_b64_tr_b16 a[230:231], v240 offset:51136
v_accvgpr_read_b32 v244, a8
v_accvgpr_read_b32 v245, a9
v_mfma_f32_16x16x32_bf16 v[200:203], a[240:243], v[96:99], v[200:203]
ds_read_b64_tr_b16 a[232:233], v240 offset:51264
v_mul_f32 v244, s31, v244
v_mul_f32 v245, s31, v245
v_mfma_f32_16x16x32_bf16 v[200:203], a[244:247], v[104:107], v[200:203]
ds_read_b64_tr_b16 a[234:235], v240 offset:51392
v_cvt_pk_bf16_f32 v130, v244, v245
v_accvgpr_read_b32 v244, a10
v_mfma_f32_16x16x32_bf16 v[204:207], a[244:247], v[108:111], v[204:207]
ds_read_b64_tr_b16 a[236:237], v240 offset:51520
v_accvgpr_read_b32 v245, a11
v_mul_f32 v244, s31, v244
v_mfma_f32_16x16x32_bf16 v[204:207], a[240:243], v[100:103], v[204:207]
s_waitcnt lgkmcnt(7)
ds_read_b64_tr_b16 a[238:239], v240 offset:51648
v_mul_f32 v245, s31, v245
v_cvt_pk_bf16_f32 v131, v244, v245
v_mfma_f32_16x16x32_bf16 v[204:207], a[248:251], v[116:119], v[204:207]
ds_read_b64_tr_b16 a[240:241], v240 offset:50784
buffer_load_dwordx4 v247, s[4:7], s29 offen offset:1056 nt lds
v_accvgpr_read_b32 v244, a4
v_accvgpr_read_b32 v245, a5
v_mfma_f32_16x16x32_bf16 v[204:207], a[252:255], v[124:127], v[204:207]
ds_read_b64_tr_b16 a[242:243], v240 offset:50912
v_mul_f32 v244, s31, v244
v_mul_f32 v245, s31, v245
v_mfma_f32_16x16x32_bf16 v[200:203], a[252:255], v[120:123], v[200:203]
ds_read_b64_tr_b16 a[244:245], v240 offset:51040
v_cvt_pk_bf16_f32 v132, v244, v245
v_accvgpr_read_b32 v244, a6
v_mfma_f32_16x16x32_bf16 v[200:203], a[248:251], v[112:115], v[200:203]
s_waitcnt lgkmcnt(7)
ds_read_b64_tr_b16 a[246:247], v240 offset:51168
v_accvgpr_read_b32 v245, a7
v_mul_f32 v244, s31, v244
v_mfma_f32_16x16x32_bf16 v[208:211], a[224:227], v[96:99], v[208:211]
ds_read_b64_tr_b16 a[248:249], v240 offset:51296
v_mul_f32 v245, s31, v245
v_cvt_pk_bf16_f32 v133, v244, v245
v_accvgpr_read_b32 v244, a12
v_mfma_f32_16x16x32_bf16 v[208:211], a[228:231], v[104:107], v[208:211]
ds_read_b64_tr_b16 a[250:251], v240 offset:51424
v_accvgpr_read_b32 v245, a13
v_mul_f32 v244, s31, v244
v_mul_f32 v245, s31, v245
v_mfma_f32_16x16x32_bf16 v[212:215], a[228:231], v[108:111], v[212:215]
ds_read_b64_tr_b16 a[252:253], v240 offset:51552
v_cvt_pk_bf16_f32 v134, v244, v245
v_accvgpr_read_b32 v244, a14
v_accvgpr_read_b32 v245, a15
v_mfma_f32_16x16x32_bf16 v[212:215], a[224:227], v[100:103], v[212:215]
s_waitcnt lgkmcnt(7)
ds_read_b64_tr_b16 a[254:255], v240 offset:51680
v_mul_f32 v244, s31, v244
v_mul_f32 v245, s31, v245
v_cvt_pk_bf16_f32 v135, v244, v245
v_mfma_f32_16x16x32_bf16 v[212:215], a[232:235], v[116:119], v[212:215]
ds_read_b64_tr_b16 a[224:225], v239 offset:17152
v_mul_f32 v192, v192, v242
v_permlane32_swap_b32 v128, v130
v_mfma_f32_16x16x32_bf16 v[212:215], a[236:239], v[124:127], v[212:215]
ds_read_b64_tr_b16 a[226:227], v239 offset:17664
v_mul_f32 v193, v193, v242
v_permlane32_swap_b32 v129, v131
v_mfma_f32_16x16x32_bf16 v[208:211], a[236:239], v[120:123], v[208:211]
ds_read_b64_tr_b16 a[228:229], v239 offset:17184
v_mul_f32 v194, v194, v242
v_permlane32_swap_b32 v132, v134
v_mfma_f32_16x16x32_bf16 v[208:211], a[232:235], v[112:115], v[208:211]
s_waitcnt lgkmcnt(7)
ds_read_b64_tr_b16 a[230:231], v239 offset:17696
v_mul_f32 v195, v195, v242
v_permlane32_swap_b32 v133, v135
v_mfma_f32_16x16x32_bf16 v[216:219], a[240:243], v[96:99], v[216:219]
ds_read_b64_tr_b16 a[232:233], v239 offset:17216
buffer_load_dwordx4 v248, s[4:7], s29 offen offset:2112 nt lds
v_cvt_pk_bf16_f32 v192, v192, v193
v_accvgpr_read_b32 v244, a16
v_accvgpr_read_b32 v245, a17
v_mfma_f32_16x16x32_bf16 v[216:219], a[244:247], v[104:107], v[216:219]
ds_read_b64_tr_b16 a[234:235], v239 offset:17728
v_cvt_pk_bf16_f32 v193, v194, v195
v_mul_f32 v244, s31, v244
v_mul_f32 v245, s31, v245
v_mfma_f32_16x16x32_bf16 v[220:223], a[244:247], v[108:111], v[220:223]
ds_read_b64_tr_b16 a[236:237], v239 offset:17248
v_mul_f32 v196, v196, v243
v_cvt_pk_bf16_f32 v136, v244, v245
v_accvgpr_read_b32 v244, a18
v_mfma_f32_16x16x32_bf16 v[220:223], a[240:243], v[100:103], v[220:223]
s_waitcnt lgkmcnt(7)
ds_read_b64_tr_b16 a[238:239], v239 offset:17760
v_mul_f32 v197, v197, v243
v_accvgpr_read_b32 v245, a19
v_mul_f32 v244, s31, v244
v_mfma_f32_16x16x32_bf16 v[220:223], a[248:251], v[116:119], v[220:223]
ds_read_b64_tr_b16 a[240:241], v239 offset:17280
v_mul_f32 v198, v198, v243
v_mul_f32 v245, s31, v245
v_cvt_pk_bf16_f32 v137, v244, v245
v_mfma_f32_16x16x32_bf16 v[220:223], a[252:255], v[124:127], v[220:223]
ds_read_b64_tr_b16 a[242:243], v239 offset:17792
v_mul_f32 v199, v199, v243
v_accvgpr_read_b32 v244, a24
v_accvgpr_read_b32 v245, a25
v_mfma_f32_16x16x32_bf16 v[216:219], a[252:255], v[120:123], v[216:219]
ds_read_b64_tr_b16 a[244:245], v239 offset:17312
v_cvt_pk_bf16_f32 v196, v196, v197
v_mul_f32 v244, s31, v244
v_mul_f32 v245, s31, v245
v_mfma_f32_16x16x32_bf16 v[216:219], a[248:251], v[112:115], v[216:219]
s_waitcnt lgkmcnt(7)
ds_read_b64_tr_b16 a[246:247], v239 offset:17824
v_cvt_pk_bf16_f32 v197, v198, v199
v_cvt_pk_bf16_f32 v138, v244, v245
v_accvgpr_read_b32 v244, a26
v_mfma_f32_16x16x32_bf16 a[64:67], a[224:227], a[216:219], a[64:67]
ds_read_b64_tr_b16 a[248:249], v239 offset:17344
v_mul_f32 v200, v200, v242
v_accvgpr_read_b32 v245, a27
v_mul_f32 v244, s31, v244
v_mfma_f32_16x16x32_bf16 a[68:71], a[224:227], a[220:223], a[68:71]
ds_read_b64_tr_b16 a[250:251], v239 offset:17856
v_mul_f32 v201, v201, v242
v_mul_f32 v245, s31, v245
v_cvt_pk_bf16_f32 v139, v244, v245
v_mfma_f32_16x16x32_bf16 a[72:75], a[228:231], a[216:219], a[72:75]
s_waitcnt lgkmcnt(6)
ds_read_b64_tr_b16 a[252:253], v239 offset:17376
v_mul_f32 v202, v202, v242
v_accvgpr_read_b32 v244, a20
v_accvgpr_read_b32 v245, a21
v_mfma_f32_16x16x32_bf16 a[76:79], a[228:231], a[220:223], a[76:79]
s_waitcnt vmcnt(23)
ds_read_b64_tr_b16 a[254:255], v239 offset:17888
s_barrier
v_mul_f32 v244, s31, v244
v_mul_f32 v245, s31, v245
v_mfma_f32_16x16x32_bf16 a[80:83], a[232:235], a[216:219], a[80:83]
ds_read_b64_tr_b16 a[224:225], v241 offset:0
buffer_load_dwordx4 v249, s[4:7], s29 offen offset:3168 nt lds
v_mul_f32 v203, v203, v242
v_cvt_pk_bf16_f32 v140, v244, v245
v_accvgpr_read_b32 v244, a22
v_mfma_f32_16x16x32_bf16 a[84:87], a[232:235], a[220:223], a[84:87]
ds_read_b64_tr_b16 a[226:227], v241 offset:128
v_cvt_pk_bf16_f32 v194, v200, v201
v_accvgpr_read_b32 v245, a23
v_mul_f32 v244, s31, v244
v_mbcnt_lo_u32_b32 v250, -1, 0
v_mfma_f32_16x16x32_bf16 a[88:91], a[236:239], a[216:219], a[88:91]
ds_read_b64_tr_b16 a[228:229], v241 offset:256
v_cvt_pk_bf16_f32 v195, v202, v203
v_mul_f32 v245, s31, v245
v_cvt_pk_bf16_f32 v141, v244, v245
v_mbcnt_hi_u32_b32 v250, -1, v250
v_mfma_f32_16x16x32_bf16 a[92:95], a[236:239], a[220:223], a[92:95]
s_waitcnt lgkmcnt(7)
ds_read_b64_tr_b16 a[230:231], v241 offset:384
v_mul_f32 v204, v204, v243
v_accvgpr_read_b32 v244, a28
v_accvgpr_read_b32 v245, a29
v_mul_f32 v244, s31, v244
v_lshrrev_b32 v251, 5, v250
v_mfma_f32_16x16x32_bf16 a[96:99], a[240:243], a[216:219], a[96:99]
ds_read_b64_tr_b16 a[232:233], v241 offset:512
v_mul_f32 v205, v205, v243
v_mul_f32 v245, s31, v245
v_cvt_pk_bf16_f32 v142, v244, v245
v_accvgpr_read_b32 v244, a30
v_and_b32 v252, 31, v250
v_mfma_f32_16x16x32_bf16 a[100:103], a[240:243], a[220:223], a[100:103]
ds_read_b64_tr_b16 a[234:235], v241 offset:640
v_mul_f32 v206, v206, v243
v_mul_f32 v207, v207, v243
v_accvgpr_read_b32 v245, a31
v_mul_f32 v244, s31, v244
v_mul_f32 v245, s31, v245
v_min_u32 v252, 27, v252
v_mfma_f32_16x16x32_bf16 a[104:107], a[244:247], a[216:219], a[104:107]
ds_read_b64_tr_b16 a[236:237], v241 offset:768
v_cvt_pk_bf16_f32 v198, v204, v205
v_cvt_pk_bf16_f32 v199, v206, v207
v_cvt_pk_bf16_f32 v143, v244, v245
v_permlane32_swap_b32 v136, v138
v_mul_u32_u24 v251, 14336, v251
v_mfma_f32_16x16x32_bf16 a[108:111], a[244:247], a[220:223], a[108:111]
s_waitcnt lgkmcnt(7)
ds_read_b64_tr_b16 a[238:239], v241 offset:896
v_accvgpr_write_b32 a160, v192
v_accvgpr_write_b32 a161, v193
v_permlane32_swap_b32 v137, v139
v_lshl_add_u32 v253, v252, 4, v251
v_mfma_f32_16x16x32_bf16 a[112:115], a[248:251], a[216:219], a[112:115]
ds_read_b64_tr_b16 a[240:241], v241 offset:32
v_accvgpr_write_b32 a162, v194
v_accvgpr_write_b32 a163, v195
v_permlane32_swap_b32 v140, v142
v_add_u32 v253, s34, v253
v_mfma_f32_16x16x32_bf16 a[116:119], a[248:251], a[220:223], a[116:119]
ds_read_b64_tr_b16 a[242:243], v241 offset:160
v_accvgpr_write_b32 a164, v196
v_accvgpr_write_b32 a165, v197
v_permlane32_swap_b32 v141, v143
v_add_u32 v250, 480, v253
v_mfma_f32_16x16x32_bf16 a[120:123], a[252:255], a[216:219], a[120:123]
ds_read_b64_tr_b16 a[244:245], v241 offset:288
v_accvgpr_write_b32 a166, v198
v_accvgpr_write_b32 a167, v199
v_accvgpr_read_b32 v244, a32
v_accvgpr_read_b32 v245, a33
v_add_u32 v251, 320, v253
v_mfma_f32_16x16x32_bf16 a[124:127], a[252:255], a[220:223], a[124:127]
s_waitcnt lgkmcnt(7)
ds_read_b64_tr_b16 a[246:247], v241 offset:416
v_mul_f32 v208, v208, v242
v_mul_f32 v209, v209, v242
v_mul_f32 v244, s31, v244
v_mul_f32 v245, s31, v245
v_add_u32 v252, 160, v253
v_mfma_f32_16x16x32_bf16 v[192:195], a[224:227], v[0:3], 0
s_add_u32 m0, s28, 67584
ds_read_b64_tr_b16 a[248:249], v241 offset:544
s_mov_b32 s45, 0
v_mul_f32 v210, v210, v242
v_mul_f32 v211, v211, v242
v_cvt_pk_bf16_f32 v144, v244, v245
v_accvgpr_read_b32 v244, a34
v_mfma_f32_16x16x32_bf16 v[192:195], a[228:231], v[8:11], v[192:195]
ds_read_b64_tr_b16 a[250:251], v241 offset:672
buffer_load_dwordx4 v250, s[16:19], s45 offen offset:0 lds
v_cvt_pk_bf16_f32 v208, v208, v209
v_cvt_pk_bf16_f32 v209, v210, v211
v_accvgpr_read_b32 v245, a35
v_mul_f32 v244, s31, v244
v_mfma_f32_16x16x32_bf16 v[196:199], a[228:231], v[12:15], 0
ds_read_b64_tr_b16 a[252:253], v241 offset:800
v_mul_f32 v212, v212, v243
v_mul_f32 v213, v213, v243
v_mul_f32 v245, s31, v245
v_cvt_pk_bf16_f32 v145, v244, v245
v_mfma_f32_16x16x32_bf16 v[196:199], a[224:227], v[4:7], v[196:199]
s_waitcnt lgkmcnt(7)
ds_read_b64_tr_b16 a[254:255], v241 offset:928
v_mul_f32 v214, v214, v243
v_mul_f32 v215, v215, v243
v_accvgpr_read_b32 v244, a40
v_accvgpr_read_b32 v245, a41
v_mfma_f32_16x16x32_bf16 v[196:199], a[232:235], v[20:23], v[196:199]
ds_read_b64_tr_b16 a[224:225], v241 offset:64
v_cvt_pk_bf16_f32 v212, v212, v213
v_cvt_pk_bf16_f32 v213, v214, v215
v_mul_f32 v244, s31, v244
v_mul_f32 v245, s31, v245
v_mfma_f32_16x16x32_bf16 v[196:199], a[236:239], v[28:31], v[196:199]
ds_read_b64_tr_b16 a[226:227], v241 offset:192
v_mul_f32 v216, v216, v242
v_mul_f32 v217, v217, v242
v_cvt_pk_bf16_f32 v146, v244, v245
v_accvgpr_read_b32 v244, a42
v_mfma_f32_16x16x32_bf16 v[192:195], a[236:239], v[24:27], v[192:195]
ds_read_b64_tr_b16 a[228:229], v241 offset:320
v_mul_f32 v218, v218, v242
v_mul_f32 v219, v219, v242
v_accvgpr_read_b32 v245, a43
v_mul_f32 v244, s31, v244
v_mfma_f32_16x16x32_bf16 v[192:195], a[232:235], v[16:19], v[192:195]
s_waitcnt lgkmcnt(7)
ds_read_b64_tr_b16 a[230:231], v241 offset:448
v_cvt_pk_bf16_f32 v210, v216, v217
v_cvt_pk_bf16_f32 v211, v218, v219
v_mul_f32 v245, s31, v245
v_cvt_pk_bf16_f32 v147, v244, v245
v_mfma_f32_16x16x32_bf16 v[200:203], a[240:243], v[0:3], 0
ds_read_b64_tr_b16 a[232:233], v241 offset:576
buffer_load_dwordx4 v251, s[16:19], s45 offen offset:1056 lds
v_mul_f32 v220, v220, v243
v_mul_f32 v221, v221, v243
v_accvgpr_read_b32 v244, a36
v_accvgpr_read_b32 v245, a37
v_mfma_f32_16x16x32_bf16 v[200:203], a[244:247], v[8:11], v[200:203]
ds_read_b64_tr_b16 a[234:235], v241 offset:704
v_mul_f32 v222, v222, v243
v_mul_f32 v223, v223, v243
v_mul_f32 v244, s31, v244
v_mul_f32 v245, s31, v245
v_mfma_f32_16x16x32_bf16 v[204:207], a[244:247], v[12:15], 0
ds_read_b64_tr_b16 a[236:237], v241 offset:832
v_cvt_pk_bf16_f32 v214, v220, v221
v_cvt_pk_bf16_f32 v215, v222, v223
v_cvt_pk_bf16_f32 v148, v244, v245
v_accvgpr_read_b32 v244, a38
v_mfma_f32_16x16x32_bf16 v[204:207], a[240:243], v[4:7], v[204:207]
s_waitcnt lgkmcnt(7)
ds_read_b64_tr_b16 a[238:239], v241 offset:960
v_accvgpr_write_b32 a168, v208
v_accvgpr_write_b32 a169, v209
v_accvgpr_read_b32 v245, a39
v_mul_f32 v244, s31, v244
v_mfma_f32_16x16x32_bf16 v[204:207], a[248:251], v[20:23], v[204:207]
ds_read_b64_tr_b16 a[240:241], v241 offset:96
v_accvgpr_write_b32 a170, v210
v_accvgpr_write_b32 a171, v211
v_mul_f32 v245, s31, v245
v_cvt_pk_bf16_f32 v149, v244, v245
v_mfma_f32_16x16x32_bf16 v[204:207], a[252:255], v[28:31], v[204:207]
ds_read_b64_tr_b16 a[242:243], v241 offset:224
v_accvgpr_write_b32 a172, v212
v_accvgpr_write_b32 a173, v213
v_accvgpr_read_b32 v244, a44
v_accvgpr_read_b32 v245, a45
v_mfma_f32_16x16x32_bf16 v[200:203], a[252:255], v[24:27], v[200:203]
ds_read_b64_tr_b16 a[244:245], v241 offset:352
v_accvgpr_write_b32 a174, v214
v_accvgpr_write_b32 a175, v215
v_mul_f32 v244, s31, v244
v_mul_f32 v245, s31, v245
v_mfma_f32_16x16x32_bf16 v[200:203], a[248:251], v[16:19], v[200:203]
s_waitcnt lgkmcnt(7)
ds_read_b64_tr_b16 a[246:247], v241 offset:480
v_cvt_pk_bf16_f32 v150, v244, v245
v_accvgpr_read_b32 v244, a46
v_accvgpr_read_b32 v245, a47
v_mfma_f32_16x16x32_bf16 v[208:211], a[224:227], v[0:3], 0
ds_read_b64_tr_b16 a[248:249], v241 offset:608
buffer_load_dwordx4 v252, s[16:19], s45 offen offset:2112 lds
v_mul_f32 v244, s31, v244
v_mul_f32 v245, s31, v245
v_cvt_pk_bf16_f32 v151, v244, v245
v_mfma_f32_16x16x32_bf16 v[208:211], a[228:231], v[8:11], v[208:211]
ds_read_b64_tr_b16 a[250:251], v241 offset:736
v_permlane32_swap_b32 v144, v146
v_mfma_f32_16x16x32_bf16 v[212:215], a[228:231], v[12:15], 0
s_waitcnt lgkmcnt(6)
ds_read_b64_tr_b16 a[252:253], v241 offset:864
v_permlane32_swap_b32 v145, v147
v_permlane32_swap_b32 v148, v150
v_mfma_f32_16x16x32_bf16 v[212:215], a[224:227], v[4:7], v[212:215]
s_waitcnt vmcnt(19)
ds_read_b64_tr_b16 a[254:255], v241 offset:992
s_barrier
v_permlane32_swap_b32 v149, v151
v_mfma_f32_16x16x32_bf16 v[212:215], a[232:235], v[20:23], v[212:215]
ds_read_b64_tr_b16 a[224:225], v239 offset:0
v_accvgpr_read_b32 v244, a48
v_accvgpr_read_b32 v245, a49
v_mfma_f32_16x16x32_bf16 v[212:215], a[236:239], v[28:31], v[212:215]
ds_read_b64_tr_b16 a[226:227], v239 offset:128
v_mul_f32 v244, s31, v244
v_mul_f32 v245, s31, v245
v_mfma_f32_16x16x32_bf16 v[208:211], a[236:239], v[24:27], v[208:211]
ds_read_b64_tr_b16 a[228:229], v239 offset:256
v_cvt_pk_bf16_f32 v152, v244, v245
v_accvgpr_read_b32 v244, a50
v_mfma_f32_16x16x32_bf16 v[208:211], a[232:235], v[16:19], v[208:211]
s_waitcnt lgkmcnt(7)
ds_read_b64_tr_b16 a[230:231], v239 offset:384
v_accvgpr_read_b32 v245, a51
v_mul_f32 v244, s31, v244
v_mfma_f32_16x16x32_bf16 v[216:219], a[240:243], v[0:3], 0
ds_read_b64_tr_b16 a[232:233], v239 offset:512
buffer_load_dwordx4 v253, s[16:19], s45 offen offset:3168 lds
v_mul_f32 v245, s31, v245
v_cvt_pk_bf16_f32 v153, v244, v245
v_mfma_f32_16x16x32_bf16 v[216:219], a[244:247], v[8:11], v[216:219]
s_add_u32 m0, s28, 118272
ds_read_b64_tr_b16 a[234:235], v239 offset:640
v_accvgpr_read_b32 v244, a56
v_accvgpr_read_b32 v245, a57
v_mfma_f32_16x16x32_bf16 v[220:223], a[244:247], v[12:15], 0
s_mov_b32 s45, 448
ds_read_b64_tr_b16 a[236:237], v239 offset:768
v_mul_f32 v244, s31, v244
v_mul_f32 v245, s31, v245
v_mfma_f32_16x16x32_bf16 v[220:223], a[240:243], v[4:7], v[220:223]
s_waitcnt lgkmcnt(7)
ds_read_b64_tr_b16 a[238:239], v239 offset:896
v_cvt_pk_bf16_f32 v154, v244, v245
v_accvgpr_read_b32 v244, a58
v_mfma_f32_16x16x32_bf16 v[220:223], a[248:251], v[20:23], v[220:223]
ds_read_b64_tr_b16 a[240:241], v239 offset:32
v_accvgpr_read_b32 v245, a59
v_mul_f32 v244, s31, v244
v_mfma_f32_16x16x32_bf16 v[220:223], a[252:255], v[28:31], v[220:223]
ds_read_b64_tr_b16 a[242:243], v239 offset:160
v_mul_f32 v245, s31, v245
v_cvt_pk_bf16_f32 v155, v244, v245
v_mfma_f32_16x16x32_bf16 v[216:219], a[252:255], v[24:27], v[216:219]
ds_read_b64_tr_b16 a[244:245], v239 offset:288
v_accvgpr_read_b32 v244, a52
v_accvgpr_read_b32 v245, a53
v_mfma_f32_16x16x32_bf16 v[216:219], a[248:251], v[16:19], v[216:219]
s_waitcnt lgkmcnt(7)
ds_read_b64_tr_b16 a[246:247], v239 offset:416
v_mul_f32 v244, s31, v244
v_mul_f32 v245, s31, v245
v_mfma_f32_16x16x32_bf16 v[192:195], a[224:227], v[32:35], v[192:195]
ds_read_b64_tr_b16 a[248:249], v239 offset:544
v_cvt_pk_bf16_f32 v156, v244, v245
v_accvgpr_read_b32 v244, a54
v_mfma_f32_16x16x32_bf16 v[192:195], a[228:231], v[40:43], v[192:195]
ds_read_b64_tr_b16 a[250:251], v239 offset:672
buffer_load_dwordx4 v250, s[16:19], s45 offen offset:0 lds
v_accvgpr_read_b32 v245, a55
v_mul_f32 v244, s31, v244
v_mfma_f32_16x16x32_bf16 v[196:199], a[228:231], v[44:47], v[196:199]
ds_read_b64_tr_b16 a[252:253], v239 offset:800
v_mul_f32 v245, s31, v245
v_cvt_pk_bf16_f32 v157, v244, v245
v_mfma_f32_16x16x32_bf16 v[196:199], a[224:227], v[36:39], v[196:199]
s_waitcnt lgkmcnt(7)
ds_read_b64_tr_b16 a[254:255], v239 offset:928
v_accvgpr_read_b32 v244, a60
v_accvgpr_read_b32 v245, a61
v_mul_f32 v244, s31, v244
v_mfma_f32_16x16x32_bf16 v[196:199], a[232:235], v[52:55], v[196:199]
ds_read_b64_tr_b16 a[224:225], v239 offset:64
buffer_load_dwordx4 v251, s[16:19], s45 offen offset:1056 lds
v_mul_f32 v245, s31, v245
v_cvt_pk_bf16_f32 v158, v244, v245
v_accvgpr_read_b32 v244, a62
v_mfma_f32_16x16x32_bf16 v[196:199], a[236:239], v[60:63], v[196:199]
ds_read_b64_tr_b16 a[226:227], v239 offset:192
v_accvgpr_read_b32 v245, a63
v_mul_f32 v244, s31, v244
v_mul_f32 v245, s31, v245
v_mfma_f32_16x16x32_bf16 v[192:195], a[236:239], v[56:59], v[192:195]
ds_read_b64_tr_b16 a[228:229], v239 offset:320
v_cvt_pk_bf16_f32 v159, v244, v245
v_permlane32_swap_b32 v152, v154
v_mfma_f32_16x16x32_bf16 v[192:195], a[232:235], v[48:51], v[192:195]
s_waitcnt lgkmcnt(7)
ds_read_b64_tr_b16 a[230:231], v239 offset:448
v_permlane32_swap_b32 v153, v155
v_mfma_f32_16x16x32_bf16 v[200:203], a[240:243], v[32:35], v[200:203]
ds_read_b64_tr_b16 a[232:233], v239 offset:576
buffer_load_dwordx4 v252, s[16:19], s45 offen offset:2112 lds
v_permlane32_swap_b32 v156, v158
v_mfma_f32_16x16x32_bf16 v[200:203], a[244:247], v[40:43], v[200:203]
ds_read_b64_tr_b16 a[234:235], v239 offset:704
v_permlane32_swap_b32 v157, v159
v_mfma_f32_16x16x32_bf16 v[204:207], a[244:247], v[44:47], v[204:207]
ds_read_b64_tr_b16 a[236:237], v239 offset:832
v_accvgpr_read_b32 v244, a64
v_accvgpr_read_b32 v245, a65
v_mfma_f32_16x16x32_bf16 v[204:207], a[240:243], v[36:39], v[204:207]
s_waitcnt lgkmcnt(7)
ds_read_b64_tr_b16 a[238:239], v239 offset:960
v_mul_f32 v244, s31, v244
v_mul_f32 v245, s31, v245
v_mfma_f32_16x16x32_bf16 v[204:207], a[248:251], v[52:55], v[204:207]
ds_read_b64_tr_b16 a[240:241], v239 offset:96
buffer_load_dwordx4 v253, s[16:19], s45 offen offset:3168 lds
v_cvt_pk_bf16_f32 v160, v244, v245
v_accvgpr_read_b32 v244, a66
v_mfma_f32_16x16x32_bf16 v[204:207], a[252:255], v[60:63], v[204:207]
s_add_u32 m0, s28, 16896
ds_read_b64_tr_b16 a[242:243], v239 offset:224
v_accvgpr_read_b32 v245, a67
v_mul_f32 v244, s31, v244
v_mfma_f32_16x16x32_bf16 v[200:203], a[252:255], v[56:59], v[200:203]
s_mov_b32 s29, 294912
ds_read_b64_tr_b16 a[244:245], v239 offset:352
v_mul_f32 v245, s31, v245
v_cvt_pk_bf16_f32 v161, v244, v245
v_mfma_f32_16x16x32_bf16 v[200:203], a[248:251], v[48:51], v[200:203]
s_waitcnt lgkmcnt(7)
ds_read_b64_tr_b16 a[246:247], v239 offset:480
v_accvgpr_read_b32 v244, a72
v_accvgpr_read_b32 v245, a73
v_mfma_f32_16x16x32_bf16 v[208:211], a[224:227], v[32:35], v[208:211]
ds_read_b64_tr_b16 a[248:249], v239 offset:608
buffer_load_dwordx4 v246, s[4:7], s29 offen offset:0 nt lds
v_mul_f32 v244, s31, v244
v_mul_f32 v245, s31, v245
v_mfma_f32_16x16x32_bf16 v[208:211], a[228:231], v[40:43], v[208:211]
ds_read_b64_tr_b16 a[250:251], v239 offset:736
v_cvt_pk_bf16_f32 v162, v244, v245
v_accvgpr_read_b32 v244, a74
v_mfma_f32_16x16x32_bf16 v[212:215], a[228:231], v[44:47], v[212:215]
s_waitcnt lgkmcnt(6)
ds_read_b64_tr_b16 a[252:253], v239 offset:864
v_accvgpr_read_b32 v245, a75
v_mul_f32 v244, s31, v244
v_mfma_f32_16x16x32_bf16 v[212:215], a[224:227], v[36:39], v[212:215]
s_waitcnt vmcnt(21)
ds_read_b64_tr_b16 a[254:255], v239 offset:992
s_barrier
v_mul_f32 v245, s31, v245
v_mfma_f32_16x16x32_bf16 v[212:215], a[232:235], v[52:55], v[212:215]
ds_read_b64_tr_b16 a[224:225], v239 offset:33792
buffer_load_dwordx4 v247, s[4:7], s29 offen offset:1056 nt lds
v_cvt_pk_bf16_f32 v163, v244, v245
v_accvgpr_read_b32 v244, a68
v_mfma_f32_16x16x32_bf16 v[212:215], a[236:239], v[60:63], v[212:215]
ds_read_b64_tr_b16 a[226:227], v239 offset:33920
v_accvgpr_read_b32 v245, a69
v_mul_f32 v244, s31, v244
v_mfma_f32_16x16x32_bf16 v[208:211], a[236:239], v[56:59], v[208:211]
ds_read_b64_tr_b16 a[228:229], v239 offset:34048
v_mul_f32 v245, s31, v245
v_cvt_pk_bf16_f32 v164, v244, v245
v_mfma_f32_16x16x32_bf16 v[208:211], a[232:235], v[48:51], v[208:211]
s_waitcnt lgkmcnt(7)
ds_read_b64_tr_b16 a[230:231], v239 offset:34176
v_accvgpr_read_b32 v244, a70
v_accvgpr_read_b32 v245, a71
v_mfma_f32_16x16x32_bf16 v[216:219], a[240:243], v[32:35], v[216:219]
ds_read_b64_tr_b16 a[232:233], v239 offset:34304
buffer_load_dwordx4 v248, s[4:7], s29 offen offset:2112 nt lds
v_mul_f32 v244, s31, v244
v_mul_f32 v245, s31, v245
v_cvt_pk_bf16_f32 v165, v244, v245
v_mfma_f32_16x16x32_bf16 v[216:219], a[244:247], v[40:43], v[216:219]
ds_read_b64_tr_b16 a[234:235], v239 offset:34432
v_accvgpr_read_b32 v244, a76
v_accvgpr_read_b32 v245, a77
v_mul_f32 v244, s31, v244
v_mfma_f32_16x16x32_bf16 v[220:223], a[244:247], v[44:47], v[220:223]
ds_read_b64_tr_b16 a[236:237], v239 offset:34560
v_mul_f32 v245, s31, v245
v_cvt_pk_bf16_f32 v166, v244, v245
v_accvgpr_read_b32 v244, a78
v_mfma_f32_16x16x32_bf16 v[220:223], a[240:243], v[36:39], v[220:223]
s_waitcnt lgkmcnt(7)
ds_read_b64_tr_b16 a[238:239], v239 offset:34688
v_accvgpr_read_b32 v245, a79
v_mul_f32 v244, s31, v244
v_mul_f32 v245, s31, v245
v_mfma_f32_16x16x32_bf16 v[220:223], a[248:251], v[52:55], v[220:223]
ds_read_b64_tr_b16 a[240:241], v239 offset:33824
buffer_load_dwordx4 v249, s[4:7], s29 offen offset:3168 nt lds
v_cvt_pk_bf16_f32 v167, v244, v245
v_permlane32_swap_b32 v160, v162
v_mfma_f32_16x16x32_bf16 v[220:223], a[252:255], v[60:63], v[220:223]
s_add_u32 m0, s28, 135168
ds_read_b64_tr_b16 a[242:243], v239 offset:33952
v_permlane32_swap_b32 v161, v163
v_mfma_f32_16x16x32_bf16 v[216:219], a[252:255], v[56:59], v[216:219]
s_mov_b32 s29, 311296
ds_read_b64_tr_b16 a[244:245], v239 offset:34080
v_permlane32_swap_b32 v164, v166
v_mfma_f32_16x16x32_bf16 v[216:219], a[248:251], v[48:51], v[216:219]
s_waitcnt lgkmcnt(7)
ds_read_b64_tr_b16 a[246:247], v239 offset:34208
v_permlane32_swap_b32 v165, v167
v_mfma_f32_16x16x32_bf16 v[192:195], a[224:227], v[64:67], v[192:195]
ds_read_b64_tr_b16 a[248:249], v239 offset:34336
v_accvgpr_read_b32 v244, a80
v_accvgpr_read_b32 v245, a81
v_mfma_f32_16x16x32_bf16 v[192:195], a[228:231], v[72:75], v[192:195]
ds_read_b64_tr_b16 a[250:251], v239 offset:34464
buffer_load_dwordx4 v246, s[4:7], s29 offen offset:0 nt lds
v_mul_f32 v244, s31, v244
v_mul_f32 v245, s31, v245
v_mfma_f32_16x16x32_bf16 v[196:199], a[228:231], v[76:79], v[196:199]
ds_read_b64_tr_b16 a[252:253], v239 offset:34592
v_cvt_pk_bf16_f32 v168, v244, v245
v_accvgpr_read_b32 v244, a82
v_mfma_f32_16x16x32_bf16 v[196:199], a[224:227], v[68:71], v[196:199]
s_waitcnt lgkmcnt(7)
ds_read_b64_tr_b16 a[254:255], v239 offset:34720
v_accvgpr_read_b32 v245, a83
v_mul_f32 v244, s31, v244
v_mfma_f32_16x16x32_bf16 v[196:199], a[232:235], v[84:87], v[196:199]
ds_read_b64_tr_b16 a[224:225], v239 offset:33856
v_mul_f32 v245, s31, v245
v_cvt_pk_bf16_f32 v169, v244, v245
v_mfma_f32_16x16x32_bf16 v[196:199], a[236:239], v[92:95], v[196:199]
ds_read_b64_tr_b16 a[226:227], v239 offset:33984
v_accvgpr_read_b32 v244, a88
v_accvgpr_read_b32 v245, a89
v_mfma_f32_16x16x32_bf16 v[192:195], a[236:239], v[88:91], v[192:195]
ds_read_b64_tr_b16 a[228:229], v239 offset:34112
v_mul_f32 v244, s31, v244
v_mul_f32 v245, s31, v245
v_mfma_f32_16x16x32_bf16 v[192:195], a[232:235], v[80:83], v[192:195]
s_waitcnt lgkmcnt(7)
ds_read_b64_tr_b16 a[230:231], v239 offset:34240
v_cvt_pk_bf16_f32 v170, v244, v245
v_accvgpr_read_b32 v244, a90
v_mfma_f32_16x16x32_bf16 v[200:203], a[240:243], v[64:67], v[200:203]
ds_read_b64_tr_b16 a[232:233], v239 offset:34368
buffer_load_dwordx4 v247, s[4:7], s29 offen offset:1056 nt lds
v_accvgpr_read_b32 v245, a91
v_mul_f32 v244, s31, v244
v_mfma_f32_16x16x32_bf16 v[200:203], a[244:247], v[72:75], v[200:203]
ds_read_b64_tr_b16 a[234:235], v239 offset:34496
v_mul_f32 v245, s31, v245
v_cvt_pk_bf16_f32 v171, v244, v245
v_mfma_f32_16x16x32_bf16 v[204:207], a[244:247], v[76:79], v[204:207]
ds_read_b64_tr_b16 a[236:237], v239 offset:34624
v_accvgpr_read_b32 v244, a84
v_accvgpr_read_b32 v245, a85
v_mfma_f32_16x16x32_bf16 v[204:207], a[240:243], v[68:71], v[204:207]
s_waitcnt lgkmcnt(7)
ds_read_b64_tr_b16 a[238:239], v239 offset:34752
v_mul_f32 v244, s31, v244
v_mul_f32 v245, s31, v245
v_mfma_f32_16x16x32_bf16 v[204:207], a[248:251], v[84:87], v[204:207]
ds_read_b64_tr_b16 a[240:241], v239 offset:33888
v_cvt_pk_bf16_f32 v172, v244, v245
v_accvgpr_read_b32 v244, a86
v_accvgpr_read_b32 v245, a87
v_mfma_f32_16x16x32_bf16 v[204:207], a[252:255], v[92:95], v[204:207]
ds_read_b64_tr_b16 a[242:243], v239 offset:34016
v_mul_f32 v244, s31, v244
v_mul_f32 v245, s31, v245
v_cvt_pk_bf16_f32 v173, v244, v245
v_mfma_f32_16x16x32_bf16 v[200:203], a[252:255], v[88:91], v[200:203]
ds_read_b64_tr_b16 a[244:245], v239 offset:34144
v_accvgpr_read_b32 v244, a92
v_accvgpr_read_b32 v245, a93
v_mul_f32 v244, s31, v244
v_mfma_f32_16x16x32_bf16 v[200:203], a[248:251], v[80:83], v[200:203]
s_waitcnt lgkmcnt(7)
ds_read_b64_tr_b16 a[246:247], v239 offset:34272
v_mul_f32 v245, s31, v245
v_cvt_pk_bf16_f32 v174, v244, v245
v_accvgpr_read_b32 v244, a94
v_mfma_f32_16x16x32_bf16 v[208:211], a[224:227], v[64:67], v[208:211]
ds_read_b64_tr_b16 a[248:249], v239 offset:34400
buffer_load_dwordx4 v248, s[4:7], s29 offen offset:2112 nt lds
v_accvgpr_read_b32 v245, a95
v_mul_f32 v244, s31, v244
v_mul_f32 v245, s31, v245
v_mfma_f32_16x16x32_bf16 v[208:211], a[228:231], v[72:75], v[208:211]
ds_read_b64_tr_b16 a[250:251], v239 offset:34528
v_cvt_pk_bf16_f32 v175, v244, v245
v_permlane32_swap_b32 v168, v170
v_mfma_f32_16x16x32_bf16 v[212:215], a[228:231], v[76:79], v[212:215]
s_waitcnt lgkmcnt(6)
ds_read_b64_tr_b16 a[252:253], v239 offset:34656
v_permlane32_swap_b32 v169, v171
v_mfma_f32_16x16x32_bf16 v[212:215], a[224:227], v[68:71], v[212:215]
s_waitcnt vmcnt(23)
ds_read_b64_tr_b16 a[254:255], v239 offset:34784
s_barrier
v_permlane32_swap_b32 v172, v174
v_mfma_f32_16x16x32_bf16 v[212:215], a[232:235], v[84:87], v[212:215]
ds_read_b64_tr_b16 a[224:225], v239 offset:50688
v_permlane32_swap_b32 v173, v175
v_mfma_f32_16x16x32_bf16 v[212:215], a[236:239], v[92:95], v[212:215]
ds_read_b64_tr_b16 a[226:227], v239 offset:50816
v_accvgpr_read_b32 v244, a96
v_accvgpr_read_b32 v245, a97
v_mfma_f32_16x16x32_bf16 v[208:211], a[236:239], v[88:91], v[208:211]
ds_read_b64_tr_b16 a[228:229], v239 offset:50944
v_mul_f32 v244, s31, v244
v_mul_f32 v245, s31, v245
v_mfma_f32_16x16x32_bf16 v[208:211], a[232:235], v[80:83], v[208:211]
s_waitcnt lgkmcnt(7)
ds_read_b64_tr_b16 a[230:231], v239 offset:51072
v_cvt_pk_bf16_f32 v176, v244, v245
v_accvgpr_read_b32 v244, a98
v_mfma_f32_16x16x32_bf16 v[216:219], a[240:243], v[64:67], v[216:219]
ds_read_b64_tr_b16 a[232:233], v239 offset:51200
buffer_load_dwordx4 v249, s[4:7], s29 offen offset:3168 nt lds
v_accvgpr_read_b32 v245, a99
v_mul_f32 v244, s31, v244
v_mfma_f32_16x16x32_bf16 v[216:219], a[244:247], v[72:75], v[216:219]
s_add_u32 m0, s28, 0
ds_read_b64_tr_b16 a[234:235], v239 offset:51328
v_mul_f32 v245, s31, v245
v_cvt_pk_bf16_f32 v177, v244, v245
v_mfma_f32_16x16x32_bf16 v[220:223], a[244:247], v[76:79], v[220:223]
s_mov_b32 s45, 28672
ds_read_b64_tr_b16 a[236:237], v239 offset:51456
v_accvgpr_read_b32 v244, a104
v_accvgpr_read_b32 v245, a105
v_mfma_f32_16x16x32_bf16 v[220:223], a[240:243], v[68:71], v[220:223]
s_waitcnt lgkmcnt(7)
ds_read_b64_tr_b16 a[238:239], v239 offset:51584
v_mul_f32 v244, s31, v244
v_mul_f32 v245, s31, v245
v_mfma_f32_16x16x32_bf16 v[220:223], a[248:251], v[84:87], v[220:223]
ds_read_b64_tr_b16 a[240:241], v239 offset:50720
v_cvt_pk_bf16_f32 v178, v244, v245
v_accvgpr_read_b32 v244, a106
v_mfma_f32_16x16x32_bf16 v[220:223], a[252:255], v[92:95], v[220:223]
ds_read_b64_tr_b16 a[242:243], v239 offset:50848
v_accvgpr_read_b32 v245, a107
v_mul_f32 v244, s31, v244
v_mfma_f32_16x16x32_bf16 v[216:219], a[252:255], v[88:91], v[216:219]
ds_read_b64_tr_b16 a[244:245], v239 offset:50976
v_mul_f32 v245, s31, v245
v_cvt_pk_bf16_f32 v179, v244, v245
v_mfma_f32_16x16x32_bf16 v[216:219], a[248:251], v[80:83], v[216:219]
s_waitcnt lgkmcnt(7)
ds_read_b64_tr_b16 a[246:247], v239 offset:51104
v_accvgpr_read_b32 v244, a100
v_accvgpr_read_b32 v245, a101
v_mfma_f32_16x16x32_bf16 v[192:195], a[224:227], v[96:99], v[192:195]
ds_read_b64_tr_b16 a[248:249], v239 offset:51232
v_mul_f32 v244, s31, v244
v_mul_f32 v245, s31, v245
v_mfma_f32_16x16x32_bf16 v[192:195], a[228:231], v[104:107], v[192:195]
ds_read_b64_tr_b16 a[250:251], v239 offset:51360
buffer_load_dwordx4 v250, s[16:19], s45 offen offset:0 lds
v_cvt_pk_bf16_f32 v180, v244, v245
v_accvgpr_read_b32 v244, a102
v_accvgpr_read_b32 v245, a103
v_mfma_f32_16x16x32_bf16 v[196:199], a[228:231], v[108:111], v[196:199]
ds_read_b64_tr_b16 a[252:253], v239 offset:51488
v_mul_f32 v244, s31, v244
v_mul_f32 v245, s31, v245
v_cvt_pk_bf16_f32 v181, v244, v245
v_mfma_f32_16x16x32_bf16 v[196:199], a[224:227], v[100:103], v[196:199]
s_waitcnt lgkmcnt(7)
ds_read_b64_tr_b16 a[254:255], v239 offset:51616
v_accvgpr_read_b32 v244, a108
v_accvgpr_read_b32 v245, a109
v_mul_f32 v244, s31, v244
v_mfma_f32_16x16x32_bf16 v[196:199], a[232:235], v[116:119], v[196:199]
ds_read_b64_tr_b16 a[224:225], v239 offset:50752
buffer_load_dwordx4 v251, s[16:19], s45 offen offset:1056 lds
v_mul_f32 v245, s31, v245
v_cvt_pk_bf16_f32 v182, v244, v245
v_accvgpr_read_b32 v244, a110
v_mfma_f32_16x16x32_bf16 v[196:199], a[236:239], v[124:127], v[196:199]
ds_read_b64_tr_b16 a[226:227], v239 offset:50880
v_accvgpr_read_b32 v245, a111
v_mul_f32 v244, s31, v244
v_mul_f32 v245, s31, v245
v_mfma_f32_16x16x32_bf16 v[192:195], a[236:239], v[120:123], v[192:195]
ds_read_b64_tr_b16 a[228:229], v239 offset:51008
v_cvt_pk_bf16_f32 v183, v244, v245
v_permlane32_swap_b32 v176, v178
v_mfma_f32_16x16x32_bf16 v[192:195], a[232:235], v[112:115], v[192:195]
s_waitcnt lgkmcnt(7)
ds_read_b64_tr_b16 a[230:231], v239 offset:51136
v_permlane32_swap_b32 v177, v179
v_mfma_f32_16x16x32_bf16 v[200:203], a[240:243], v[96:99], v[200:203]
ds_read_b64_tr_b16 a[232:233], v239 offset:51264
buffer_load_dwordx4 v252, s[16:19], s45 offen offset:2112 lds
v_permlane32_swap_b32 v180, v182
v_mfma_f32_16x16x32_bf16 v[200:203], a[244:247], v[104:107], v[200:203]
ds_read_b64_tr_b16 a[234:235], v239 offset:51392
v_permlane32_swap_b32 v181, v183
v_mfma_f32_16x16x32_bf16 v[204:207], a[244:247], v[108:111], v[204:207]
ds_read_b64_tr_b16 a[236:237], v239 offset:51520
v_accvgpr_read_b32 v244, a112
v_accvgpr_read_b32 v245, a113
v_mfma_f32_16x16x32_bf16 v[204:207], a[240:243], v[100:103], v[204:207]
s_waitcnt lgkmcnt(7)
ds_read_b64_tr_b16 a[238:239], v239 offset:51648
v_mul_f32 v244, s31, v244
v_mul_f32 v245, s31, v245
v_mfma_f32_16x16x32_bf16 v[204:207], a[248:251], v[116:119], v[204:207]
ds_read_b64_tr_b16 a[240:241], v239 offset:50784
buffer_load_dwordx4 v253, s[16:19], s45 offen offset:3168 lds
v_cvt_pk_bf16_f32 v184, v244, v245
v_accvgpr_read_b32 v244, a114
v_mfma_f32_16x16x32_bf16 v[204:207], a[252:255], v[124:127], v[204:207]
s_add_u32 m0, s28, 33792
ds_read_b64_tr_b16 a[242:243], v239 offset:50912
v_accvgpr_read_b32 v245, a115
v_mul_f32 v244, s31, v244
v_mul_f32 v245, s31, v245
v_mfma_f32_16x16x32_bf16 v[200:203], a[252:255], v[120:123], v[200:203]
s_mov_b32 s29, 327680
ds_read_b64_tr_b16 a[244:245], v239 offset:51040
v_cvt_pk_bf16_f32 v185, v244, v245
v_accvgpr_read_b32 v244, a120
v_accvgpr_read_b32 v245, a121
v_mfma_f32_16x16x32_bf16 v[200:203], a[248:251], v[112:115], v[200:203]
s_waitcnt lgkmcnt(7)
ds_read_b64_tr_b16 a[246:247], v239 offset:51168
v_mul_f32 v244, s31, v244
v_mul_f32 v245, s31, v245
v_cvt_pk_bf16_f32 v186, v244, v245
v_mfma_f32_16x16x32_bf16 v[208:211], a[224:227], v[96:99], v[208:211]
ds_read_b64_tr_b16 a[248:249], v239 offset:51296
buffer_load_dwordx4 v246, s[4:7], s29 offen offset:0 nt lds
v_accvgpr_read_b32 v244, a122
v_accvgpr_read_b32 v245, a123
v_mul_f32 v244, s31, v244
v_mfma_f32_16x16x32_bf16 v[208:211], a[228:231], v[104:107], v[208:211]
ds_read_b64_tr_b16 a[250:251], v239 offset:51424
v_mul_f32 v245, s31, v245
v_cvt_pk_bf16_f32 v187, v244, v245
v_accvgpr_read_b32 v244, a116
v_mfma_f32_16x16x32_bf16 v[212:215], a[228:231], v[108:111], v[212:215]
s_waitcnt lgkmcnt(6)
ds_read_b64_tr_b16 a[252:253], v239 offset:51552
v_accvgpr_read_b32 v245, a117
v_mul_f32 v244, s31, v244
v_mul_f32 v245, s31, v245
v_mfma_f32_16x16x32_bf16 v[212:215], a[224:227], v[100:103], v[212:215]
s_waitcnt vmcnt(17)
ds_read_b64_tr_b16 a[254:255], v239 offset:51680
s_barrier
v_cvt_pk_bf16_f32 v188, v244, v245
v_accvgpr_read_b32 v244, a118
v_mfma_f32_16x16x32_bf16 v[212:215], a[232:235], v[116:119], v[212:215]
ds_read_b128 a[224:227], v237 offset:16896
buffer_load_dwordx4 v247, s[4:7], s29 offen offset:1056 nt lds
v_mul_f32 v192, v192, v242
v_accvgpr_read_b32 v245, a119
v_mul_f32 v244, s31, v244
v_mfma_f32_16x16x32_bf16 v[212:215], a[236:239], v[124:127], v[212:215]
v_mul_f32 v193, v193, v242
v_mul_f32 v194, v194, v242
v_mul_f32 v245, s31, v245
v_cvt_pk_bf16_f32 v189, v244, v245
v_mfma_f32_16x16x32_bf16 v[208:211], a[236:239], v[120:123], v[208:211]
ds_read_b128 a[228:231], v237 offset:16960
v_mul_f32 v195, v195, v242
v_accvgpr_read_b32 v244, a124
v_accvgpr_read_b32 v245, a125
v_mfma_f32_16x16x32_bf16 v[208:211], a[232:235], v[112:115], v[208:211]
s_waitcnt lgkmcnt(6)
v_mul_f32 v196, v196, v243
v_mul_f32 v197, v197, v243
v_mul_f32 v244, s31, v244
v_mul_f32 v245, s31, v245
v_mfma_f32_16x16x32_bf16 v[216:219], a[240:243], v[96:99], v[216:219]
ds_read_b128 a[232:235], v237 offset:17024
buffer_load_dwordx4 v248, s[4:7], s29 offen offset:2112 nt lds
v_mul_f32 v198, v198, v243
v_cvt_pk_bf16_f32 v190, v244, v245
v_accvgpr_read_b32 v244, a126
v_mfma_f32_16x16x32_bf16 v[216:219], a[244:247], v[104:107], v[216:219]
v_mul_f32 v199, v199, v243
v_mul_f32 v200, v200, v242
v_accvgpr_read_b32 v245, a127
v_mul_f32 v244, s31, v244
v_mfma_f32_16x16x32_bf16 v[220:223], a[244:247], v[108:111], v[220:223]
ds_read_b128 a[236:239], v237 offset:17088
v_mul_f32 v201, v201, v242
v_mul_f32 v245, s31, v245
v_cvt_pk_bf16_f32 v191, v244, v245
v_mfma_f32_16x16x32_bf16 v[220:223], a[240:243], v[100:103], v[220:223]
s_waitcnt lgkmcnt(4)
v_mul_f32 v202, v202, v242
v_mul_f32 v203, v203, v242
v_permlane32_swap_b32 v184, v186
v_mfma_f32_16x16x32_bf16 v[220:223], a[248:251], v[116:119], v[220:223]
ds_read_b128 a[240:243], v237 offset:17152
buffer_load_dwordx4 v249, s[4:7], s29 offen offset:3168 nt lds
v_mul_f32 v204, v204, v243
v_permlane32_swap_b32 v185, v187
v_mfma_f32_16x16x32_bf16 v[220:223], a[252:255], v[124:127], v[220:223]
s_add_u32 m0, s28, 50688
v_mul_f32 v205, v205, v243
v_mul_f32 v206, v206, v243
v_permlane32_swap_b32 v188, v190
v_mfma_f32_16x16x32_bf16 v[216:219], a[252:255], v[120:123], v[216:219]
s_mov_b32 s45, 29120
ds_read_b128 a[244:247], v237 offset:17216
v_mul_f32 v207, v207, v243
v_permlane32_swap_b32 v189, v191
v_mfma_f32_16x16x32_bf16 v[216:219], a[248:251], v[112:115], v[216:219]
s_waitcnt lgkmcnt(4)
v_cvt_pk_bf16_f32 v112, v192, v193
v_cvt_pk_bf16_f32 v113, v194, v195
v_cvt_pk_bf16_f32 v116, v196, v197
v_cvt_pk_bf16_f32 v117, v198, v199
v_cvt_pk_bf16_f32 v114, v200, v201
v_cvt_pk_bf16_f32 v115, v202, v203
v_cvt_pk_bf16_f32 v118, v204, v205
v_cvt_pk_bf16_f32 v119, v206, v207
v_mfma_f32_16x16x32_bf16 v[192:195], a[224:227], v[128:131], 0
ds_read_b128 a[248:251], v237 offset:17280
v_accvgpr_read_b32 v64, a128
v_mfma_f32_16x16x32_bf16 v[192:195], a[228:231], v[136:139], v[192:195]
buffer_load_dwordx4 v250, s[16:19], s45 offen offset:0 lds
v_accvgpr_read_b32 v65, a129
v_accvgpr_read_b32 v66, a130
v_mfma_f32_16x16x32_bf16 v[196:199], a[228:231], v[140:143], 0
ds_read_b128 a[252:255], v237 offset:17344
v_mul_f32 v208, v208, v242
v_mfma_f32_16x16x32_bf16 v[196:199], a[224:227], v[132:135], v[196:199]
s_waitcnt lgkmcnt(4)
v_mul_f32 v209, v209, v242
v_mul_f32 v210, v210, v242
v_mfma_f32_16x16x32_bf16 v[196:199], a[232:235], v[148:151], v[196:199]
ds_read_b128 a[224:227], v237 offset:17408
v_mul_f32 v211, v211, v242
v_mfma_f32_16x16x32_bf16 v[196:199], a[236:239], v[156:159], v[196:199]
v_cvt_pk_bf16_f32 v120, v208, v209
v_cvt_pk_bf16_f32 v121, v210, v211
v_mfma_f32_16x16x32_bf16 v[192:195], a[236:239], v[152:155], v[192:195]
ds_read_b128 a[228:231], v237 offset:17472
v_mul_f32 v212, v212, v243
v_mfma_f32_16x16x32_bf16 v[192:195], a[232:235], v[144:147], v[192:195]
s_waitcnt lgkmcnt(4)
v_mul_f32 v213, v213, v243
v_mul_f32 v214, v214, v243
v_mfma_f32_16x16x32_bf16 v[192:195], a[240:243], v[160:163], v[192:195]
ds_read_b128 a[232:235], v237 offset:17536
v_mul_f32 v215, v215, v243
v_mfma_f32_16x16x32_bf16 v[192:195], a[244:247], v[168:171], v[192:195]
v_cvt_pk_bf16_f32 v124, v212, v213
v_cvt_pk_bf16_f32 v125, v214, v215
v_mfma_f32_16x16x32_bf16 v[196:199], a[244:247], v[172:175], v[196:199]
ds_read_b128 a[236:239], v237 offset:17600
v_mul_f32 v216, v216, v242
v_mfma_f32_16x16x32_bf16 v[196:199], a[240:243], v[164:167], v[196:199]
s_waitcnt lgkmcnt(4)
v_mul_f32 v217, v217, v242
v_mul_f32 v218, v218, v242
v_mfma_f32_16x16x32_bf16 v[196:199], a[248:251], v[180:183], v[196:199]
ds_read_b128 a[240:243], v237 offset:17664
v_mul_f32 v219, v219, v242
v_mfma_f32_16x16x32_bf16 v[196:199], a[252:255], v[188:191], v[196:199]
v_cvt_pk_bf16_f32 v122, v216, v217
v_cvt_pk_bf16_f32 v123, v218, v219
v_mfma_f32_16x16x32_bf16 v[192:195], a[252:255], v[184:187], v[192:195]
ds_read_b128 a[244:247], v237 offset:17728
v_mul_f32 v220, v220, v243
v_mfma_f32_16x16x32_bf16 v[192:195], a[248:251], v[176:179], v[192:195]
s_waitcnt lgkmcnt(4)
buffer_load_dwordx4 v251, s[16:19], s45 offen offset:1056 lds
v_mul_f32 v221, v221, v243
v_mul_f32 v222, v222, v243
v_mfma_f32_16x16x32_bf16 v[200:203], a[224:227], v[128:131], 0
ds_read_b128 a[248:251], v237 offset:17792
v_mul_f32 v223, v223, v243
v_mfma_f32_16x16x32_bf16 v[200:203], a[228:231], v[136:139], v[200:203]
v_cvt_pk_bf16_f32 v126, v220, v221
v_cvt_pk_bf16_f32 v127, v222, v223
v_mfma_f32_16x16x32_bf16 v[204:207], a[228:231], v[140:143], 0
ds_read_b128 a[252:255], v237 offset:17856
v_accvgpr_read_b32 v67, a131
v_mfma_f32_16x16x32_bf16 v[204:207], a[224:227], v[132:135], v[204:207]
s_waitcnt lgkmcnt(4)
v_accvgpr_read_b32 v68, a132
v_accvgpr_read_b32 v69, a133
v_mfma_f32_16x16x32_bf16 v[204:207], a[232:235], v[148:151], v[204:207]
ds_read_b64_tr_b16 a[224:225], v240 offset:0
v_accvgpr_read_b32 v70, a134
v_max3_f32 v242, v192, v193, v194
v_max3_f32 v243, v196, v197, v198
v_mfma_f32_16x16x32_bf16 v[204:207], a[236:239], v[156:159], v[204:207]
ds_read_b64_tr_b16 a[226:227], v240 offset:512
v_accvgpr_read_b32 v71, a135
v_mfma_f32_16x16x32_bf16 v[200:203], a[236:239], v[152:155], v[200:203]
ds_read_b64_tr_b16 a[228:229], v240 offset:32
v_accvgpr_read_b32 v72, a136
v_mfma_f32_16x16x32_bf16 v[200:203], a[232:235], v[144:147], v[200:203]
s_waitcnt lgkmcnt(5)
ds_read_b64_tr_b16 a[230:231], v240 offset:544
v_accvgpr_read_b32 v73, a137
v_mfma_f32_16x16x32_bf16 v[200:203], a[240:243], v[160:163], v[200:203]
ds_read_b64_tr_b16 a[232:233], v240 offset:64
v_accvgpr_read_b32 v74, a138
v_mfma_f32_16x16x32_bf16 v[200:203], a[244:247], v[168:171], v[200:203]
ds_read_b64_tr_b16 a[234:235], v240 offset:576
v_accvgpr_read_b32 v75, a139
v_mfma_f32_16x16x32_bf16 v[204:207], a[244:247], v[172:175], v[204:207]
ds_read_b64_tr_b16 a[236:237], v240 offset:96
v_accvgpr_read_b32 v76, a140
v_mfma_f32_16x16x32_bf16 v[204:207], a[240:243], v[164:167], v[204:207]
s_waitcnt lgkmcnt(7)
ds_read_b64_tr_b16 a[238:239], v240 offset:608
v_accvgpr_read_b32 v77, a141
v_mfma_f32_16x16x32_bf16 v[204:207], a[248:251], v[180:183], v[204:207]
ds_read_b64_tr_b16 a[240:241], v240 offset:128
v_accvgpr_read_b32 v78, a142
v_mfma_f32_16x16x32_bf16 v[204:207], a[252:255], v[188:191], v[204:207]
ds_read_b64_tr_b16 a[242:243], v240 offset:640
v_accvgpr_read_b32 v79, a143
v_mfma_f32_16x16x32_bf16 v[200:203], a[252:255], v[184:187], v[200:203]
ds_read_b64_tr_b16 a[244:245], v240 offset:160
buffer_load_dwordx4 v252, s[16:19], s45 offen offset:2112 lds
v_accvgpr_read_b32 v80, a144
v_mfma_f32_16x16x32_bf16 v[200:203], a[248:251], v[176:179], v[200:203]
s_waitcnt lgkmcnt(7)
ds_read_b64_tr_b16 a[246:247], v240 offset:672
v_accvgpr_read_b32 v81, a145
v_mfma_f32_16x16x32_bf16 a[0:3], a[224:227], v[64:67], 0
ds_read_b64_tr_b16 a[248:249], v240 offset:192
v_accvgpr_read_b32 v82, a146
v_mfma_f32_16x16x32_bf16 a[4:7], a[224:227], v[68:71], 0
ds_read_b64_tr_b16 a[250:251], v240 offset:704
v_accvgpr_read_b32 v83, a147
v_mfma_f32_16x16x32_bf16 a[8:11], a[228:231], v[64:67], 0
ds_read_b64_tr_b16 a[252:253], v240 offset:224
v_accvgpr_read_b32 v84, a148
v_mfma_f32_16x16x32_bf16 a[12:15], a[228:231], v[68:71], 0
s_waitcnt lgkmcnt(7)
ds_read_b64_tr_b16 a[254:255], v240 offset:736
v_accvgpr_read_b32 v85, a149
v_max3_f32 v242, v242, v195, v200
v_max3_f32 v243, v243, v199, v204
v_mfma_f32_16x16x32_bf16 a[16:19], a[232:235], v[64:67], 0
ds_read_b64_tr_b16 a[224:225], v240 offset:256
v_accvgpr_read_b32 v86, a150
v_max3_f32 v242, v242, v201, v202
v_max3_f32 v243, v243, v205, v206
v_mfma_f32_16x16x32_bf16 a[20:23], a[232:235], v[68:71], 0
ds_read_b64_tr_b16 a[226:227], v240 offset:768
v_accvgpr_read_b32 v87, a151
v_max_f32 v242, v242, v203
v_max_f32 v243, v243, v207
v_mfma_f32_16x16x32_bf16 a[24:27], a[236:239], v[64:67], 0
ds_read_b64_tr_b16 a[228:229], v240 offset:288
v_accvgpr_read_b32 v88, a152
v_mov_b32 v244, v242
v_mov_b32 v245, v243
v_mfma_f32_16x16x32_bf16 a[28:31], a[236:239], v[68:71], 0
s_waitcnt lgkmcnt(7)
ds_read_b64_tr_b16 a[230:231], v240 offset:800
v_accvgpr_read_b32 v89, a153
v_nop
v_mfma_f32_16x16x32_bf16 a[32:35], a[240:243], v[64:67], 0
ds_read_b64_tr_b16 a[232:233], v240 offset:320
v_accvgpr_read_b32 v90, a154
v_permlane32_swap_b32 v242, v244
v_mfma_f32_16x16x32_bf16 a[36:39], a[240:243], v[68:71], 0
ds_read_b64_tr_b16 a[234:235], v240 offset:832
v_accvgpr_read_b32 v91, a155
v_permlane32_swap_b32 v243, v245
v_mfma_f32_16x16x32_bf16 a[40:43], a[244:247], v[64:67], 0
ds_read_b64_tr_b16 a[236:237], v240 offset:352
v_accvgpr_read_b32 v92, a156
v_max_f32 v242, v242, v244
v_max_f32 v243, v243, v245
v_mfma_f32_16x16x32_bf16 a[44:47], a[244:247], v[68:71], 0
s_waitcnt lgkmcnt(7)
ds_read_b64_tr_b16 a[238:239], v240 offset:864
v_accvgpr_read_b32 v93, a157
v_mov_b32 v244, v242
v_mov_b32 v245, v243
v_mfma_f32_16x16x32_bf16 a[48:51], a[248:251], v[64:67], 0
ds_read_b64_tr_b16 a[240:241], v240 offset:384
v_accvgpr_read_b32 v94, a158
v_nop
v_mfma_f32_16x16x32_bf16 a[52:55], a[248:251], v[68:71], 0
ds_read_b64_tr_b16 a[242:243], v240 offset:896
buffer_load_dwordx4 v253, s[16:19], s45 offen offset:3168 lds
v_accvgpr_read_b32 v95, a159
v_permlane16_swap_b32 v242, v244
v_mfma_f32_16x16x32_bf16 a[56:59], a[252:255], v[64:67], 0
s_waitcnt lgkmcnt(6)
ds_read_b64_tr_b16 a[244:245], v240 offset:416
v_accvgpr_read_b32 v96, a160
v_permlane16_swap_b32 v243, v245
v_mfma_f32_16x16x32_bf16 a[60:63], a[252:255], v[68:71], 0
s_waitcnt vmcnt(20)
ds_read_b64_tr_b16 a[246:247], v240 offset:928
s_barrier
v_max_f32 v242, v242, v244
v_max_f32 v243, v243, v245
v_mfma_f32_16x16x32_bf16 a[64:67], a[224:227], v[64:67], 0
ds_read_b128 a[248:251], v237 offset:33792
v_accvgpr_read_b32 v97, a161
v_sub_f32 v224, 0, v242
v_sub_f32 v225, 0, v242
v_mfma_f32_16x16x32_bf16 a[68:71], a[224:227], v[68:71], 0
v_accvgpr_read_b32 v98, a162
v_accvgpr_read_b32 v99, a163
v_sub_f32 v226, 0, v242
v_sub_f32 v227, 0, v242
v_mfma_f32_16x16x32_bf16 a[72:75], a[228:231], v[64:67], 0
ds_read_b128 a[252:255], v237 offset:33856
v_accvgpr_read_b32 v100, a164
v_sub_f32 v228, 0, v243
v_sub_f32 v229, 0, v243
v_mfma_f32_16x16x32_bf16 a[76:79], a[228:231], v[68:71], 0
s_waitcnt lgkmcnt(6)
v_accvgpr_read_b32 v101, a165
v_accvgpr_read_b32 v102, a166
v_sub_f32 v230, 0, v243
v_sub_f32 v231, 0, v243
v_mfma_f32_16x16x32_bf16 a[80:83], a[232:235], v[64:67], 0
ds_read_b128 a[224:227], v237 offset:33920
v_accvgpr_read_b32 v103, a167
v_sub_f32 v192, v192, v242
v_sub_f32 v193, v193, v242
v_mfma_f32_16x16x32_bf16 a[84:87], a[232:235], v[68:71], 0
s_add_u32 m0, s28, 84480
v_accvgpr_read_b32 v104, a168
v_accvgpr_read_b32 v105, a169
v_sub_f32 v194, v194, v242
v_sub_f32 v195, v195, v242
v_mfma_f32_16x16x32_bf16 a[88:91], a[236:239], v[64:67], 0
s_mov_b32 s45, 57344
ds_read_b128 a[228:231], v237 offset:33984
v_accvgpr_read_b32 v106, a170
v_sub_f32 v196, v196, v243
v_sub_f32 v197, v197, v243
v_mfma_f32_16x16x32_bf16 a[92:95], a[236:239], v[68:71], 0
s_waitcnt lgkmcnt(4)
v_accvgpr_read_b32 v107, a171
v_accvgpr_read_b32 v108, a172
v_sub_f32 v198, v198, v243
v_sub_f32 v199, v199, v243
v_mfma_f32_16x16x32_bf16 a[96:99], a[240:243], v[64:67], 0
ds_read_b128 a[232:235], v237 offset:34048
v_accvgpr_read_b32 v109, a173
v_sub_f32 v200, v200, v242
v_sub_f32 v201, v201, v242
v_mfma_f32_16x16x32_bf16 a[100:103], a[240:243], v[68:71], 0
v_accvgpr_read_b32 v110, a174
v_accvgpr_read_b32 v111, a175
v_sub_f32 v202, v202, v242
v_sub_f32 v203, v203, v242
v_mfma_f32_16x16x32_bf16 a[104:107], a[244:247], v[64:67], 0
ds_read_b128 a[236:239], v237 offset:34112
v_sub_f32 v204, v204, v243
v_sub_f32 v205, v205, v243
v_sub_f32 v206, v206, v243
v_sub_f32 v207, v207, v243
v_mfma_f32_16x16x32_bf16 a[108:111], a[244:247], v[68:71], 0
s_waitcnt lgkmcnt(4)
v_exp_f32 v192, v192
v_exp_f32 v193, v193
v_mfma_f32_16x16x32_bf16 v[208:211], a[248:251], v[128:131], v[224:227]
ds_read_b128 a[240:243], v237 offset:34176
v_exp_f32 v194, v194
v_cvt_pk_bf16_f32 v0, v192, v193
v_mfma_f32_16x16x32_bf16 v[208:211], a[252:255], v[136:139], v[208:211]
buffer_load_dwordx4 v250, s[16:19], s45 offen offset:0 lds
v_exp_f32 v195, v195
v_exp_f32 v196, v196
v_cvt_pk_bf16_f32 v1, v194, v195
v_mfma_f32_16x16x32_bf16 v[212:215], a[252:255], v[140:143], v[228:231]
ds_read_b128 a[244:247], v237 offset:34240
v_exp_f32 v197, v197
v_exp_f32 v198, v198
v_mfma_f32_16x16x32_bf16 v[212:215], a[248:251], v[132:135], v[212:215]
s_waitcnt lgkmcnt(4)
v_cvt_pk_bf16_f32 v4, v196, v197
v_exp_f32 v199, v199
v_exp_f32 v200, v200
v_mfma_f32_16x16x32_bf16 v[212:215], a[224:227], v[148:151], v[212:215]
ds_read_b128 a[248:251], v237 offset:34304
v_cvt_pk_bf16_f32 v5, v198, v199
v_exp_f32 v201, v201
v_mfma_f32_16x16x32_bf16 v[212:215], a[228:231], v[156:159], v[212:215]
v_exp_f32 v202, v202
v_cvt_pk_bf16_f32 v2, v200, v201
v_exp_f32 v203, v203
v_mfma_f32_16x16x32_bf16 v[208:211], a[228:231], v[152:155], v[208:211]
ds_read_b128 a[252:255], v237 offset:34368
v_exp_f32 v204, v204
v_cvt_pk_bf16_f32 v3, v202, v203
v_mfma_f32_16x16x32_bf16 v[208:211], a[224:227], v[144:147], v[208:211]
s_waitcnt lgkmcnt(4)
v_exp_f32 v205, v205
v_exp_f32 v206, v206
v_cvt_pk_bf16_f32 v6, v204, v205
v_mfma_f32_16x16x32_bf16 v[208:211], a[232:235], v[160:163], v[208:211]
ds_read_b128 a[224:227], v237 offset:34432
v_exp_f32 v207, v207
v_mfma_f32_16x16x32_bf16 v[208:211], a[236:239], v[168:171], v[208:211]
v_cvt_pk_bf16_f32 v7, v206, v207
v_mfma_f32_16x16x32_bf16 v[212:215], a[236:239], v[172:175], v[212:215]
ds_read_b128 a[228:231], v237 offset:34496
v_mfma_f32_16x16x32_bf16 v[212:215], a[232:235], v[164:167], v[212:215]
s_waitcnt lgkmcnt(4)
buffer_load_dwordx4 v251, s[16:19], s45 offen offset:1056 lds
v_mfma_f32_16x16x32_bf16 v[212:215], a[240:243], v[180:183], v[212:215]
ds_read_b128 a[232:235], v237 offset:34560
v_mfma_f32_16x16x32_bf16 v[212:215], a[244:247], v[188:191], v[212:215]
v_mfma_f32_16x16x32_bf16 v[208:211], a[244:247], v[184:187], v[208:211]
ds_read_b128 a[236:239], v237 offset:34624
v_mfma_f32_16x16x32_bf16 v[208:211], a[240:243], v[176:179], v[208:211]
s_waitcnt lgkmcnt(4)
buffer_load_dwordx4 v252, s[16:19], s45 offen offset:2112 lds
v_mfma_f32_16x16x32_bf16 v[216:219], a[248:251], v[128:131], v[224:227]
ds_read_b128 a[240:243], v237 offset:34688
v_mfma_f32_16x16x32_bf16 v[216:219], a[252:255], v[136:139], v[216:219]
v_mfma_f32_16x16x32_bf16 v[220:223], a[252:255], v[140:143], v[228:231]
ds_read_b128 a[244:247], v237 offset:34752
v_mfma_f32_16x16x32_bf16 v[220:223], a[248:251], v[132:135], v[220:223]
s_waitcnt lgkmcnt(4)
v_mfma_f32_16x16x32_bf16 v[220:223], a[224:227], v[148:151], v[220:223]
ds_read_b64_tr_b16 a[248:249], v240 offset:50688
v_max3_f32 v242, v208, v209, v210
v_mfma_f32_16x16x32_bf16 v[220:223], a[228:231], v[156:159], v[220:223]
ds_read_b64_tr_b16 a[250:251], v240 offset:51200
v_max3_f32 v242, v242, v211, v212
v_mfma_f32_16x16x32_bf16 v[216:219], a[228:231], v[152:155], v[216:219]
ds_read_b64_tr_b16 a[252:253], v240 offset:50720
v_max3_f32 v242, v242, v213, v214
v_mfma_f32_16x16x32_bf16 v[216:219], a[224:227], v[144:147], v[216:219]
s_waitcnt lgkmcnt(5)
ds_read_b64_tr_b16 a[254:255], v240 offset:51232
buffer_load_dwordx4 v253, s[16:19], s45 offen offset:3168 lds
v_mfma_f32_16x16x32_bf16 v[216:219], a[232:235], v[160:163], v[216:219]
s_add_u32 m0, s28, 67584
ds_read_b64_tr_b16 a[224:225], v240 offset:50752
s_mov_b32 s29, 344064
v_mfma_f32_16x16x32_bf16 v[216:219], a[236:239], v[168:171], v[216:219]
ds_read_b64_tr_b16 a[226:227], v240 offset:51264
v_mfma_f32_16x16x32_bf16 v[220:223], a[236:239], v[172:175], v[220:223]
ds_read_b64_tr_b16 a[228:229], v240 offset:50784
v_mfma_f32_16x16x32_bf16 v[220:223], a[232:235], v[164:167], v[220:223]
s_waitcnt lgkmcnt(7)
ds_read_b64_tr_b16 a[230:231], v240 offset:51296
v_mfma_f32_16x16x32_bf16 v[220:223], a[240:243], v[180:183], v[220:223]
ds_read_b64_tr_b16 a[232:233], v240 offset:50816
v_mfma_f32_16x16x32_bf16 v[220:223], a[244:247], v[188:191], v[220:223]
ds_read_b64_tr_b16 a[234:235], v240 offset:51328
v_mfma_f32_16x16x32_bf16 v[216:219], a[244:247], v[184:187], v[216:219]
ds_read_b64_tr_b16 a[236:237], v240 offset:50848
buffer_load_dwordx4 v246, s[4:7], s29 offen offset:0 nt lds
v_mfma_f32_16x16x32_bf16 v[216:219], a[240:243], v[176:179], v[216:219]
s_waitcnt lgkmcnt(7)
ds_read_b64_tr_b16 a[238:239], v240 offset:51360
v_mfma_f32_16x16x32_bf16 a[112:115], a[248:251], v[64:67], 0
ds_read_b64_tr_b16 a[240:241], v240 offset:50880
v_mfma_f32_16x16x32_bf16 a[116:119], a[248:251], v[68:71], 0
ds_read_b64_tr_b16 a[242:243], v240 offset:51392
v_mfma_f32_16x16x32_bf16 a[120:123], a[252:255], v[64:67], 0
ds_read_b64_tr_b16 a[244:245], v240 offset:50912
v_mfma_f32_16x16x32_bf16 a[124:127], a[252:255], v[68:71], 0
s_waitcnt lgkmcnt(7)
ds_read_b64_tr_b16 a[246:247], v240 offset:51424
v_max3_f32 v242, v242, v215, v216
v_mfma_f32_16x16x32_bf16 a[128:131], a[224:227], v[64:67], 0
ds_read_b64_tr_b16 a[248:249], v240 offset:50944
v_max3_f32 v242, v242, v217, v218
v_mfma_f32_16x16x32_bf16 a[132:135], a[224:227], v[68:71], 0
ds_read_b64_tr_b16 a[250:251], v240 offset:51456
v_max3_f32 v242, v242, v219, v220
v_mfma_f32_16x16x32_bf16 a[136:139], a[228:231], v[64:67], 0
ds_read_b64_tr_b16 a[252:253], v240 offset:50976
v_max3_f32 v242, v242, v221, v222
v_mfma_f32_16x16x32_bf16 a[140:143], a[228:231], v[68:71], 0
s_waitcnt lgkmcnt(7)
ds_read_b64_tr_b16 a[254:255], v240 offset:51488
v_max_f32 v242, v242, v223
v_mfma_f32_16x16x32_bf16 a[144:147], a[232:235], v[64:67], 0
ds_read_b64_tr_b16 a[224:225], v240 offset:51008
v_cmp_lt_f32 vcc, s32, v242
v_mfma_f32_16x16x32_bf16 a[148:151], a[232:235], v[68:71], 0
s_cbranch_vccnz L_rsD1
L_rbD1:
ds_read_b64_tr_b16 a[226:227], v240 offset:51520
buffer_load_dwordx4 v247, s[4:7], s29 offen offset:1056 nt lds
v_mfma_f32_16x16x32_bf16 a[152:155], a[236:239], v[64:67], 0
ds_read_b64_tr_b16 a[228:229], v240 offset:51040
v_mfma_f32_16x16x32_bf16 a[156:159], a[236:239], v[68:71], 0
s_waitcnt lgkmcnt(7)
ds_read_b64_tr_b16 a[230:231], v240 offset:51552
v_mfma_f32_16x16x32_bf16 a[160:163], a[240:243], v[64:67], 0
ds_read_b64_tr_b16 a[232:233], v240 offset:51072
v_mfma_f32_16x16x32_bf16 a[164:167], a[240:243], v[68:71], 0
ds_read_b64_tr_b16 a[234:235], v240 offset:51584
buffer_load_dwordx4 v248, s[4:7], s29 offen offset:2112 nt lds
v_mfma_f32_16x16x32_bf16 a[168:171], a[244:247], v[64:67], 0
s_waitcnt lgkmcnt(6)
ds_read_b64_tr_b16 a[236:237], v240 offset:51104
v_mfma_f32_16x16x32_bf16 a[172:175], a[244:247], v[68:71], 0
s_waitcnt vmcnt(15)
ds_read_b64_tr_b16 a[238:239], v240 offset:51616
s_barrier
v_mfma_f32_16x16x32_bf16 a[176:179], a[248:251], v[64:67], 0
ds_read_b128 a[240:243], v236 offset:16896
v_mfma_f32_16x16x32_bf16 a[180:183], a[248:251], v[68:71], 0
v_exp_f32 v208, v208
v_mfma_f32_16x16x32_bf16 a[184:187], a[252:255], v[64:67], 0
ds_read_b128 a[244:247], v236 offset:16960
v_mfma_f32_16x16x32_bf16 a[188:191], a[252:255], v[68:71], 0
s_waitcnt lgkmcnt(6)
v_exp_f32 v209, v209
v_mfma_f32_16x16x32_bf16 a[192:195], a[224:227], v[64:67], 0
ds_read_b128 a[248:251], v236 offset:17024
buffer_load_dwordx4 v249, s[4:7], s29 offen offset:3168 nt lds
v_mfma_f32_16x16x32_bf16 a[196:199], a[224:227], v[68:71], 0
v_exp_f32 v210, v210
v_mfma_f32_16x16x32_bf16 a[200:203], a[228:231], v[64:67], 0
ds_read_b128 a[252:255], v236 offset:17088
v_cvt_pk_bf16_f32 v8, v208, v209
v_mfma_f32_16x16x32_bf16 a[204:207], a[228:231], v[68:71], 0
s_waitcnt lgkmcnt(4)
v_exp_f32 v211, v211
v_mfma_f32_16x16x32_bf16 a[208:211], a[232:235], v[64:67], 0
s_add_u32 m0, s28, 101376
ds_read_b128 a[224:227], v236 offset:17152
s_mov_b32 s45, 57792
v_mfma_f32_16x16x32_bf16 a[212:215], a[232:235], v[68:71], 0
v_exp_f32 v212, v212
v_mfma_f32_16x16x32_bf16 a[216:219], a[236:239], v[64:67], 0
ds_read_b128 a[228:231], v236 offset:17216
v_cvt_pk_bf16_f32 v9, v210, v211
v_mfma_f32_16x16x32_bf16 a[220:223], a[236:239], v[68:71], 0
s_waitcnt lgkmcnt(4)
v_exp_f32 v213, v213
v_mfma_f32_16x16x32_bf16 v[192:195], a[240:243], v[128:131], v[224:227]
ds_read_b128 a[232:235], v236 offset:17280
v_mfma_f32_16x16x32_bf16 v[192:195], a[244:247], v[136:139], v[192:195]
v_exp_f32 v214, v214
v_mfma_f32_16x16x32_bf16 v[196:199], a[244:247], v[140:143], v[228:231]
ds_read_b128 a[236:239], v236 offset:17344
v_cvt_pk_bf16_f32 v12, v212, v213
v_mfma_f32_16x16x32_bf16 v[196:199], a[240:243], v[132:135], v[196:199]
s_waitcnt lgkmcnt(4)
v_exp_f32 v215, v215
v_mfma_f32_16x16x32_bf16 v[196:199], a[248:251], v[148:151], v[196:199]
ds_read_b128 a[240:243], v236 offset:17408
buffer_load_dwordx4 v250, s[16:19], s45 offen offset:0 lds
v_mfma_f32_16x16x32_bf16 v[196:199], a[252:255], v[156:159], v[196:199]
v_exp_f32 v216, v216
v_mfma_f32_16x16x32_bf16 v[192:195], a[252:255], v[152:155], v[192:195]
ds_read_b128 a[244:247], v236 offset:17472
v_cvt_pk_bf16_f32 v13, v214, v215
v_mfma_f32_16x16x32_bf16 v[192:195], a[248:251], v[144:147], v[192:195]
s_waitcnt lgkmcnt(4)
v_exp_f32 v217, v217
v_mfma_f32_16x16x32_bf16 v[192:195], a[224:227], v[160:163], v[192:195]
ds_read_b128 a[248:251], v236 offset:17536
buffer_load_dwordx4 v251, s[16:19], s45 offen offset:1056 lds
v_mfma_f32_16x16x32_bf16 v[192:195], a[228:231], v[168:171], v[192:195]
v_exp_f32 v218, v218
v_mfma_f32_16x16x32_bf16 v[196:199], a[228:231], v[172:175], v[196:199]
ds_read_b128 a[252:255], v236 offset:17600
v_cvt_pk_bf16_f32 v10, v216, v217
v_mfma_f32_16x16x32_bf16 v[196:199], a[224:227], v[164:167], v[196:199]
s_waitcnt lgkmcnt(4)
v_exp_f32 v219, v219
v_mfma_f32_16x16x32_bf16 v[196:199], a[232:235], v[180:183], v[196:199]
ds_read_b128 a[224:227], v236 offset:17664
v_mfma_f32_16x16x32_bf16 v[196:199], a[236:239], v[188:191], v[196:199]
v_exp_f32 v220, v220
v_mfma_f32_16x16x32_bf16 v[192:195], a[236:239], v[184:187], v[192:195]
ds_read_b128 a[228:231], v236 offset:17728
v_cvt_pk_bf16_f32 v11, v218, v219
v_mfma_f32_16x16x32_bf16 v[192:195], a[232:235], v[176:179], v[192:195]
s_waitcnt lgkmcnt(4)
v_exp_f32 v221, v221
v_mfma_f32_16x16x32_bf16 v[200:203], a[240:243], v[128:131], v[224:227]
ds_read_b128 a[232:235], v236 offset:17792
buffer_load_dwordx4 v252, s[16:19], s45 offen offset:2112 lds
v_mfma_f32_16x16x32_bf16 v[200:203], a[244:247], v[136:139], v[200:203]
v_exp_f32 v222, v222
v_cvt_pk_bf16_f32 v14, v220, v221
v_mfma_f32_16x16x32_bf16 v[204:207], a[244:247], v[140:143], v[228:231]
ds_read_b128 a[236:239], v236 offset:17856
v_exp_f32 v223, v223
v_mfma_f32_16x16x32_bf16 v[204:207], a[240:243], v[132:135], v[204:207]
s_waitcnt lgkmcnt(4)
v_cvt_pk_bf16_f32 v15, v222, v223
v_mfma_f32_16x16x32_bf16 v[204:207], a[248:251], v[148:151], v[204:207]
ds_read_b64_tr_b16 a[240:241], v239 offset:0
v_max3_f32 v242, v192, v193, v194
v_mfma_f32_16x16x32_bf16 v[204:207], a[252:255], v[156:159], v[204:207]
ds_read_b64_tr_b16 a[242:243], v239 offset:512
v_max3_f32 v242, v242, v195, v196
v_mfma_f32_16x16x32_bf16 v[200:203], a[252:255], v[152:155], v[200:203]
ds_read_b64_tr_b16 a[244:245], v239 offset:32
v_max3_f32 v242, v242, v197, v198
v_mfma_f32_16x16x32_bf16 v[200:203], a[248:251], v[144:147], v[200:203]
s_waitcnt lgkmcnt(5)
ds_read_b64_tr_b16 a[246:247], v239 offset:544
buffer_load_dwordx4 v253, s[16:19], s45 offen offset:3168 lds
v_mfma_f32_16x16x32_bf16 v[200:203], a[224:227], v[160:163], v[200:203]
s_add_u32 m0, s28, 118272
ds_read_b64_tr_b16 a[248:249], v239 offset:64
s_mov_b32 s29, 360448
v_mfma_f32_16x16x32_bf16 v[200:203], a[228:231], v[168:171], v[200:203]
ds_read_b64_tr_b16 a[250:251], v239 offset:576
v_mfma_f32_16x16x32_bf16 v[204:207], a[228:231], v[172:175], v[204:207]
ds_read_b64_tr_b16 a[252:253], v239 offset:96
v_mfma_f32_16x16x32_bf16 v[204:207], a[224:227], v[164:167], v[204:207]
s_waitcnt lgkmcnt(7)
ds_read_b64_tr_b16 a[254:255], v239 offset:608
v_mfma_f32_16x16x32_bf16 v[204:207], a[232:235], v[180:183], v[204:207]
ds_read_b64_tr_b16 a[224:225], v239 offset:128
v_mfma_f32_16x16x32_bf16 v[204:207], a[236:239], v[188:191], v[204:207]
ds_read_b64_tr_b16 a[226:227], v239 offset:640
v_mfma_f32_16x16x32_bf16 v[200:203], a[236:239], v[184:187], v[200:203]
ds_read_b64_tr_b16 a[228:229], v239 offset:160
buffer_load_dwordx4 v246, s[4:7], s29 offen offset:0 nt lds
v_mfma_f32_16x16x32_bf16 v[200:203], a[232:235], v[176:179], v[200:203]
s_waitcnt lgkmcnt(7)
ds_read_b64_tr_b16 a[230:231], v239 offset:672
v_mfma_f32_16x16x32_bf16 a[0:3], a[240:243], v[72:75], a[0:3]
ds_read_b64_tr_b16 a[232:233], v239 offset:192
v_mfma_f32_16x16x32_bf16 a[4:7], a[240:243], v[76:79], a[4:7]
ds_read_b64_tr_b16 a[234:235], v239 offset:704
v_mfma_f32_16x16x32_bf16 a[8:11], a[244:247], v[72:75], a[8:11]
ds_read_b64_tr_b16 a[236:237], v239 offset:224
v_mfma_f32_16x16x32_bf16 a[12:15], a[244:247], v[76:79], a[12:15]
s_waitcnt lgkmcnt(7)
ds_read_b64_tr_b16 a[238:239], v239 offset:736
v_max3_f32 v242, v242, v199, v200
v_mfma_f32_16x16x32_bf16 a[16:19], a[248:251], v[72:75], a[16:19]
ds_read_b64_tr_b16 a[240:241], v239 offset:256
v_max3_f32 v242, v242, v201, v202
v_mfma_f32_16x16x32_bf16 a[20:23], a[248:251], v[76:79], a[20:23]
ds_read_b64_tr_b16 a[242:243], v239 offset:768
v_max3_f32 v242, v242, v203, v204
v_mfma_f32_16x16x32_bf16 a[24:27], a[252:255], v[72:75], a[24:27]
ds_read_b64_tr_b16 a[244:245], v239 offset:288
v_max3_f32 v242, v242, v205, v206
v_mfma_f32_16x16x32_bf16 a[28:31], a[252:255], v[76:79], a[28:31]
s_waitcnt lgkmcnt(7)
ds_read_b64_tr_b16 a[246:247], v239 offset:800
v_max_f32 v242, v242, v207
v_mfma_f32_16x16x32_bf16 a[32:35], a[224:227], v[72:75], a[32:35]
ds_read_b64_tr_b16 a[248:249], v239 offset:320
v_cmp_lt_f32 vcc, s32, v242
v_mfma_f32_16x16x32_bf16 a[36:39], a[224:227], v[76:79], a[36:39]
s_cbranch_vccnz L_rsD2
L_rbD2:
ds_read_b64_tr_b16 a[250:251], v239 offset:832
buffer_load_dwordx4 v247, s[4:7], s29 offen offset:1056 nt lds
v_mfma_f32_16x16x32_bf16 a[40:43], a[228:231], v[72:75], a[40:43]
ds_read_b64_tr_b16 a[252:253], v239 offset:352
v_mfma_f32_16x16x32_bf16 a[44:47], a[228:231], v[76:79], a[44:47]
s_waitcnt lgkmcnt(7)
ds_read_b64_tr_b16 a[254:255], v239 offset:864
v_mfma_f32_16x16x32_bf16 a[48:51], a[232:235], v[72:75], a[48:51]
ds_read_b64_tr_b16 a[224:225], v239 offset:384
v_mfma_f32_16x16x32_bf16 a[52:55], a[232:235], v[76:79], a[52:55]
ds_read_b64_tr_b16 a[226:227], v239 offset:896
buffer_load_dwordx4 v248, s[4:7], s29 offen offset:2112 nt lds
v_mfma_f32_16x16x32_bf16 a[56:59], a[236:239], v[72:75], a[56:59]
s_waitcnt lgkmcnt(6)
ds_read_b64_tr_b16 a[228:229], v239 offset:416
v_mfma_f32_16x16x32_bf16 a[60:63], a[236:239], v[76:79], a[60:63]
s_waitcnt vmcnt(15)
ds_read_b64_tr_b16 a[230:231], v239 offset:928
s_barrier
v_mfma_f32_16x16x32_bf16 a[64:67], a[240:243], v[72:75], a[64:67]
ds_read_b128 a[232:235], v238 offset:0
v_mfma_f32_16x16x32_bf16 a[68:71], a[240:243], v[76:79], a[68:71]
v_exp_f32 v192, v192
v_mfma_f32_16x16x32_bf16 a[72:75], a[244:247], v[72:75], a[72:75]
ds_read_b128 a[236:239], v238 offset:64
v_mfma_f32_16x16x32_bf16 a[76:79], a[244:247], v[76:79], a[76:79]
s_waitcnt lgkmcnt(6)
v_exp_f32 v193, v193
v_mfma_f32_16x16x32_bf16 a[80:83], a[248:251], v[72:75], a[80:83]
ds_read_b128 a[240:243], v238 offset:128
buffer_load_dwordx4 v249, s[4:7], s29 offen offset:3168 nt lds
v_mfma_f32_16x16x32_bf16 a[84:87], a[248:251], v[76:79], a[84:87]
v_exp_f32 v194, v194
v_mfma_f32_16x16x32_bf16 a[88:91], a[252:255], v[72:75], a[88:91]
ds_read_b128 a[244:247], v238 offset:192
v_cvt_pk_bf16_f32 v16, v192, v193
v_mfma_f32_16x16x32_bf16 a[92:95], a[252:255], v[76:79], a[92:95]
s_waitcnt lgkmcnt(4)
v_exp_f32 v195, v195
v_mfma_f32_16x16x32_bf16 a[96:99], a[224:227], v[72:75], a[96:99]
s_add_u32 m0, s28, 16896
ds_read_b128 a[248:251], v238 offset:256
s_mov_b32 s45, 86016
v_mfma_f32_16x16x32_bf16 a[100:103], a[224:227], v[76:79], a[100:103]
v_exp_f32 v196, v196
v_mfma_f32_16x16x32_bf16 a[104:107], a[228:231], v[72:75], a[104:107]
ds_read_b128 a[252:255], v238 offset:320
v_cvt_pk_bf16_f32 v17, v194, v195
v_mfma_f32_16x16x32_bf16 a[108:111], a[228:231], v[76:79], a[108:111]
s_waitcnt lgkmcnt(4)
v_exp_f32 v197, v197
v_mfma_f32_16x16x32_bf16 v[208:211], a[232:235], v[128:131], v[224:227]
ds_read_b128 a[224:227], v238 offset:384
v_mfma_f32_16x16x32_bf16 v[208:211], a[236:239], v[136:139], v[208:211]
v_exp_f32 v198, v198
v_mfma_f32_16x16x32_bf16 v[212:215], a[236:239], v[140:143], v[228:231]
ds_read_b128 a[228:231], v238 offset:448
v_cvt_pk_bf16_f32 v20, v196, v197
v_mfma_f32_16x16x32_bf16 v[212:215], a[232:235], v[132:135], v[212:215]
s_waitcnt lgkmcnt(4)
v_exp_f32 v199, v199
v_mfma_f32_16x16x32_bf16 v[212:215], a[240:243], v[148:151], v[212:215]
ds_read_b128 a[232:235], v238 offset:512
buffer_load_dwordx4 v250, s[16:19], s45 offen offset:0 lds
v_mfma_f32_16x16x32_bf16 v[212:215], a[244:247], v[156:159], v[212:215]
v_exp_f32 v200, v200
v_mfma_f32_16x16x32_bf16 v[208:211], a[244:247], v[152:155], v[208:211]
ds_read_b128 a[236:239], v238 offset:576
v_cvt_pk_bf16_f32 v21, v198, v199
v_mfma_f32_16x16x32_bf16 v[208:211], a[240:243], v[144:147], v[208:211]
s_waitcnt lgkmcnt(4)
v_exp_f32 v201, v201
v_mfma_f32_16x16x32_bf16 v[208:211], a[248:251], v[160:163], v[208:211]
ds_read_b128 a[240:243], v238 offset:640
buffer_load_dwordx4 v251, s[16:19], s45 offen offset:1056 lds
v_mfma_f32_16x16x32_bf16 v[208:211], a[252:255], v[168:171], v[208:211]
v_exp_f32 v202, v202
v_mfma_f32_16x16x32_bf16 v[212:215], a[252:255], v[172:175], v[212:215]
ds_read_b128 a[244:247], v238 offset:704
v_cvt_pk_bf16_f32 v18, v200, v201
v_mfma_f32_16x16x32_bf16 v[212:215], a[248:251], v[164:167], v[212:215]
s_waitcnt lgkmcnt(4)
v_exp_f32 v203, v203
v_mfma_f32_16x16x32_bf16 v[212:215], a[224:227], v[180:183], v[212:215]
ds_read_b128 a[248:251], v238 offset:768
v_mfma_f32_16x16x32_bf16 v[212:215], a[228:231], v[188:191], v[212:215]
v_exp_f32 v204, v204
v_mfma_f32_16x16x32_bf16 v[208:211], a[228:231], v[184:187], v[208:211]
ds_read_b128 a[252:255], v238 offset:832
v_cvt_pk_bf16_f32 v19, v202, v203
v_mfma_f32_16x16x32_bf16 v[208:211], a[224:227], v[176:179], v[208:211]
s_waitcnt lgkmcnt(4)
v_exp_f32 v205, v205
v_mfma_f32_16x16x32_bf16 v[216:219], a[232:235], v[128:131], v[224:227]
ds_read_b128 a[224:227], v238 offset:896
buffer_load_dwordx4 v252, s[16:19], s45 offen offset:2112 lds
v_mfma_f32_16x16x32_bf16 v[216:219], a[236:239], v[136:139], v[216:219]
v_exp_f32 v206, v206
v_cvt_pk_bf16_f32 v22, v204, v205
v_mfma_f32_16x16x32_bf16 v[220:223], a[236:239], v[140:143], v[228:231]
ds_read_b128 a[228:231], v238 offset:960
v_exp_f32 v207, v207
v_mfma_f32_16x16x32_bf16 v[220:223], a[232:235], v[132:135], v[220:223]
s_waitcnt lgkmcnt(4)
v_cvt_pk_bf16_f32 v23, v206, v207
v_mfma_f32_16x16x32_bf16 v[220:223], a[240:243], v[148:151], v[220:223]
ds_read_b64_tr_b16 a[232:233], v239 offset:50688
v_max3_f32 v242, v208, v209, v210
v_mfma_f32_16x16x32_bf16 v[220:223], a[244:247], v[156:159], v[220:223]
ds_read_b64_tr_b16 a[234:235], v239 offset:51200
v_max3_f32 v242, v242, v211, v212
v_mfma_f32_16x16x32_bf16 v[216:219], a[244:247], v[152:155], v[216:219]
ds_read_b64_tr_b16 a[236:237], v239 offset:50720
v_max3_f32 v242, v242, v213, v214
v_mfma_f32_16x16x32_bf16 v[216:219], a[240:243], v[144:147], v[216:219]
s_waitcnt lgkmcnt(5)
ds_read_b64_tr_b16 a[238:239], v239 offset:51232
buffer_load_dwordx4 v253, s[16:19], s45 offen offset:3168 lds
v_mfma_f32_16x16x32_bf16 v[216:219], a[248:251], v[160:163], v[216:219]
s_add_u32 m0, s28, 0
ds_read_b64_tr_b16 a[240:241], v239 offset:50752
s_mov_b32 s29, 376832
v_mfma_f32_16x16x32_bf16 v[216:219], a[252:255], v[168:171], v[216:219]
ds_read_b64_tr_b16 a[242:243], v239 offset:51264
v_mfma_f32_16x16x32_bf16 v[220:223], a[252:255], v[172:175], v[220:223]
ds_read_b64_tr_b16 a[244:245], v239 offset:50784
v_mfma_f32_16x16x32_bf16 v[220:223], a[248:251], v[164:167], v[220:223]
s_waitcnt lgkmcnt(7)
ds_read_b64_tr_b16 a[246:247], v239 offset:51296
v_mfma_f32_16x16x32_bf16 v[220:223], a[224:227], v[180:183], v[220:223]
ds_read_b64_tr_b16 a[248:249], v239 offset:50816
v_mfma_f32_16x16x32_bf16 v[220:223], a[228:231], v[188:191], v[220:223]
ds_read_b64_tr_b16 a[250:251], v239 offset:51328
v_mfma_f32_16x16x32_bf16 v[216:219], a[228:231], v[184:187], v[216:219]
ds_read_b64_tr_b16 a[252:253], v239 offset:50848
buffer_load_dwordx4 v246, s[4:7], s29 offen offset:0 nt lds
v_mfma_f32_16x16x32_bf16 v[216:219], a[224:227], v[176:179], v[216:219]
s_waitcnt lgkmcnt(7)
ds_read_b64_tr_b16 a[254:255], v239 offset:51360
v_mfma_f32_16x16x32_bf16 a[112:115], a[232:235], v[72:75], a[112:115]
ds_read_b64_tr_b16 a[224:225], v239 offset:50880
v_mfma_f32_16x16x32_bf16 a[116:119], a[232:235], v[76:79], a[116:119]
ds_read_b64_tr_b16 a[226:227], v239 offset:51392
v_mfma_f32_16x16x32_bf16 a[120:123], a[236:239], v[72:75], a[120:123]
ds_read_b64_tr_b16 a[228:229], v239 offset:50912
v_mfma_f32_16x16x32_bf16 a[124:127], a[236:239], v[76:79], a[124:127]
s_waitcnt lgkmcnt(7)
ds_read_b64_tr_b16 a[230:231], v239 offset:51424
v_max3_f32 v242, v242, v215, v216
v_mfma_f32_16x16x32_bf16 a[128:131], a[240:243], v[72:75], a[128:131]
ds_read_b64_tr_b16 a[232:233], v239 offset:50944
v_max3_f32 v242, v242, v217, v218
v_mfma_f32_16x16x32_bf16 a[132:135], a[240:243], v[76:79], a[132:135]
ds_read_b64_tr_b16 a[234:235], v239 offset:51456
v_max3_f32 v242, v242, v219, v220
v_mfma_f32_16x16x32_bf16 a[136:139], a[244:247], v[72:75], a[136:139]
ds_read_b64_tr_b16 a[236:237], v239 offset:50976
v_max3_f32 v242, v242, v221, v222
v_mfma_f32_16x16x32_bf16 a[140:143], a[244:247], v[76:79], a[140:143]
s_waitcnt lgkmcnt(7)
ds_read_b64_tr_b16 a[238:239], v239 offset:51488
v_max_f32 v242, v242, v223
v_mfma_f32_16x16x32_bf16 a[144:147], a[248:251], v[72:75], a[144:147]
ds_read_b64_tr_b16 a[240:241], v239 offset:51008
v_cmp_lt_f32 vcc, s32, v242
v_mfma_f32_16x16x32_bf16 a[148:151], a[248:251], v[76:79], a[148:151]
s_cbranch_vccnz L_rsD3
L_rbD3:
ds_read_b64_tr_b16 a[242:243], v239 offset:51520
buffer_load_dwordx4 v247, s[4:7], s29 offen offset:1056 nt lds
v_mfma_f32_16x16x32_bf16 a[152:155], a[252:255], v[72:75], a[152:155]
ds_read_b64_tr_b16 a[244:245], v239 offset:51040
v_mfma_f32_16x16x32_bf16 a[156:159], a[252:255], v[76:79], a[156:159]
s_waitcnt lgkmcnt(7)
ds_read_b64_tr_b16 a[246:247], v239 offset:51552
v_mfma_f32_16x16x32_bf16 a[160:163], a[224:227], v[72:75], a[160:163]
ds_read_b64_tr_b16 a[248:249], v239 offset:51072
v_mfma_f32_16x16x32_bf16 a[164:167], a[224:227], v[76:79], a[164:167]
ds_read_b64_tr_b16 a[250:251], v239 offset:51584
buffer_load_dwordx4 v248, s[4:7], s29 offen offset:2112 nt lds
v_mfma_f32_16x16x32_bf16 a[168:171], a[228:231], v[72:75], a[168:171]
s_waitcnt lgkmcnt(6)
ds_read_b64_tr_b16 a[252:253], v239 offset:51104
v_mfma_f32_16x16x32_bf16 a[172:175], a[228:231], v[76:79], a[172:175]
s_waitcnt vmcnt(19)
ds_read_b64_tr_b16 a[254:255], v239 offset:51616
s_barrier
v_mfma_f32_16x16x32_bf16 a[176:179], a[232:235], v[72:75], a[176:179]
ds_read_b128 a[224:227], v236 offset:33792
v_mfma_f32_16x16x32_bf16 a[180:183], a[232:235], v[76:79], a[180:183]
v_exp_f32 v208, v208
v_mfma_f32_16x16x32_bf16 a[184:187], a[236:239], v[72:75], a[184:187]
ds_read_b128 a[228:231], v236 offset:33856
v_mfma_f32_16x16x32_bf16 a[188:191], a[236:239], v[76:79], a[188:191]
s_waitcnt lgkmcnt(6)
v_exp_f32 v209, v209
v_mfma_f32_16x16x32_bf16 a[192:195], a[240:243], v[72:75], a[192:195]
ds_read_b128 a[232:235], v236 offset:33920
buffer_load_dwordx4 v249, s[4:7], s29 offen offset:3168 nt lds
v_mfma_f32_16x16x32_bf16 a[196:199], a[240:243], v[76:79], a[196:199]
v_exp_f32 v210, v210
v_mfma_f32_16x16x32_bf16 a[200:203], a[244:247], v[72:75], a[200:203]
ds_read_b128 a[236:239], v236 offset:33984
v_cvt_pk_bf16_f32 v24, v208, v209
v_mfma_f32_16x16x32_bf16 a[204:207], a[244:247], v[76:79], a[204:207]
s_waitcnt lgkmcnt(4)
v_exp_f32 v211, v211
v_mfma_f32_16x16x32_bf16 a[208:211], a[248:251], v[72:75], a[208:211]
s_add_u32 m0, s28, 135168
ds_read_b128 a[240:243], v236 offset:34048
s_mov_b32 s45, 86464
v_mfma_f32_16x16x32_bf16 a[212:215], a[248:251], v[76:79], a[212:215]
v_exp_f32 v212, v212
v_mfma_f32_16x16x32_bf16 a[216:219], a[252:255], v[72:75], a[216:219]
ds_read_b128 a[244:247], v236 offset:34112
v_cvt_pk_bf16_f32 v25, v210, v211
v_mfma_f32_16x16x32_bf16 a[220:223], a[252:255], v[76:79], a[220:223]
s_waitcnt lgkmcnt(4)
v_exp_f32 v213, v213
v_mfma_f32_16x16x32_bf16 v[192:195], a[224:227], v[128:131], v[224:227]
ds_read_b128 a[248:251], v236 offset:34176
v_mfma_f32_16x16x32_bf16 v[192:195], a[228:231], v[136:139], v[192:195]
v_exp_f32 v214, v214
v_mfma_f32_16x16x32_bf16 v[196:199], a[228:231], v[140:143], v[228:231]
ds_read_b128 a[252:255], v236 offset:34240
v_cvt_pk_bf16_f32 v28, v212, v213
v_mfma_f32_16x16x32_bf16 v[196:199], a[224:227], v[132:135], v[196:199]
s_waitcnt lgkmcnt(4)
v_exp_f32 v215, v215
v_mfma_f32_16x16x32_bf16 v[196:199], a[232:235], v[148:151], v[196:199]
ds_read_b128 a[224:227], v236 offset:34304
buffer_load_dwordx4 v250, s[16:19], s45 offen offset:0 lds
v_mfma_f32_16x16x32_bf16 v[196:199], a[236:239], v[156:159], v[196:199]
v_exp_f32 v216, v216
v_mfma_f32_16x16x32_bf16 v[192:195], a[236:239], v[152:155], v[192:195]
ds_read_b128 a[228:231], v236 offset:34368
v_cvt_pk_bf16_f32 v29, v214, v215
v_mfma_f32_16x16x32_bf16 v[192:195], a[232:235], v[144:147], v[192:195]
s_waitcnt lgkmcnt(4)
v_exp_f32 v217, v217
v_mfma_f32_16x16x32_bf16 v[192:195], a[240:243], v[160:163], v[192:195]
ds_read_b128 a[232:235], v236 offset:34432
buffer_load_dwordx4 v251, s[16:19], s45 offen offset:1056 lds
v_mfma_f32_16x16x32_bf16 v[192:195], a[244:247], v[168:171], v[192:195]
v_exp_f32 v218, v218
v_mfma_f32_16x16x32_bf16 v[196:199], a[244:247], v[172:175], v[196:199]
ds_read_b128 a[236:239], v236 offset:34496
v_cvt_pk_bf16_f32 v26, v216, v217
v_mfma_f32_16x16x32_bf16 v[196:199], a[240:243], v[164:167], v[196:199]
s_waitcnt lgkmcnt(4)
v_exp_f32 v219, v219
v_mfma_f32_16x16x32_bf16 v[196:199], a[248:251], v[180:183], v[196:199]
ds_read_b128 a[240:243], v236 offset:34560
v_mfma_f32_16x16x32_bf16 v[196:199], a[252:255], v[188:191], v[196:199]
v_exp_f32 v220, v220
v_mfma_f32_16x16x32_bf16 v[192:195], a[252:255], v[184:187], v[192:195]
ds_read_b128 a[244:247], v236 offset:34624
v_cvt_pk_bf16_f32 v27, v218, v219
v_mfma_f32_16x16x32_bf16 v[192:195], a[248:251], v[176:179], v[192:195]
s_waitcnt lgkmcnt(4)
v_exp_f32 v221, v221
v_mfma_f32_16x16x32_bf16 v[200:203], a[224:227], v[128:131], v[224:227]
ds_read_b128 a[248:251], v236 offset:34688
buffer_load_dwordx4 v252, s[16:19], s45 offen offset:2112 lds
v_mfma_f32_16x16x32_bf16 v[200:203], a[228:231], v[136:139], v[200:203]
v_exp_f32 v222, v222
v_cvt_pk_bf16_f32 v30, v220, v221
v_mfma_f32_16x16x32_bf16 v[204:207], a[228:231], v[140:143], v[228:231]
ds_read_b128 a[252:255], v236 offset:34752
v_exp_f32 v223, v223
v_mfma_f32_16x16x32_bf16 v[204:207], a[224:227], v[132:135], v[204:207]
s_waitcnt lgkmcnt(4)
v_cvt_pk_bf16_f32 v31, v222, v223
v_mfma_f32_16x16x32_bf16 v[204:207], a[232:235], v[148:151], v[204:207]
ds_read_b64_tr_b16 a[224:225], v240 offset:16896
v_max3_f32 v242, v192, v193, v194
v_mfma_f32_16x16x32_bf16 v[204:207], a[236:239], v[156:159], v[204:207]
ds_read_b64_tr_b16 a[226:227], v240 offset:17408
v_max3_f32 v242, v242, v195, v196
v_mfma_f32_16x16x32_bf16 v[200:203], a[236:239], v[152:155], v[200:203]
ds_read_b64_tr_b16 a[228:229], v240 offset:16928
v_max3_f32 v242, v242, v197, v198
v_mfma_f32_16x16x32_bf16 v[200:203], a[232:235], v[144:147], v[200:203]
s_waitcnt lgkmcnt(5)
ds_read_b64_tr_b16 a[230:231], v240 offset:17440
buffer_load_dwordx4 v253, s[16:19], s45 offen offset:3168 lds
v_mfma_f32_16x16x32_bf16 v[200:203], a[240:243], v[160:163], v[200:203]
s_add_u32 m0, s28, 50688
ds_read_b64_tr_b16 a[232:233], v240 offset:16960
s_mov_b32 s29, 393216
v_mfma_f32_16x16x32_bf16 v[200:203], a[244:247], v[168:171], v[200:203]
ds_read_b64_tr_b16 a[234:235], v240 offset:17472
v_mfma_f32_16x16x32_bf16 v[204:207], a[244:247], v[172:175], v[204:207]
ds_read_b64_tr_b16 a[236:237], v240 offset:16992
v_mfma_f32_16x16x32_bf16 v[204:207], a[240:243], v[164:167], v[204:207]
s_waitcnt lgkmcnt(7)
ds_read_b64_tr_b16 a[238:239], v240 offset:17504
v_mfma_f32_16x16x32_bf16 v[204:207], a[248:251], v[180:183], v[204:207]
ds_read_b64_tr_b16 a[240:241], v240 offset:17024
v_mfma_f32_16x16x32_bf16 v[204:207], a[252:255], v[188:191], v[204:207]
ds_read_b64_tr_b16 a[242:243], v240 offset:17536
v_mfma_f32_16x16x32_bf16 v[200:203], a[252:255], v[184:187], v[200:203]
ds_read_b64_tr_b16 a[244:245], v240 offset:17056
buffer_load_dwordx4 v246, s[4:7], s29 offen offset:0 nt lds
v_mfma_f32_16x16x32_bf16 v[200:203], a[248:251], v[176:179], v[200:203]
s_waitcnt lgkmcnt(7)
ds_read_b64_tr_b16 a[246:247], v240 offset:17568
v_mfma_f32_16x16x32_bf16 a[0:3], a[224:227], v[80:83], a[0:3]
ds_read_b64_tr_b16 a[248:249], v240 offset:17088
v_mfma_f32_16x16x32_bf16 a[4:7], a[224:227], v[84:87], a[4:7]
ds_read_b64_tr_b16 a[250:251], v240 offset:17600
v_mfma_f32_16x16x32_bf16 a[8:11], a[228:231], v[80:83], a[8:11]
ds_read_b64_tr_b16 a[252:253], v240 offset:17120
v_mfma_f32_16x16x32_bf16 a[12:15], a[228:231], v[84:87], a[12:15]
s_waitcnt lgkmcnt(7)
ds_read_b64_tr_b16 a[254:255], v240 offset:17632
v_max3_f32 v242, v242, v199, v200
v_mfma_f32_16x16x32_bf16 a[16:19], a[232:235], v[80:83], a[16:19]
ds_read_b64_tr_b16 a[224:225], v240 offset:17152
v_max3_f32 v242, v242, v201, v202
v_mfma_f32_16x16x32_bf16 a[20:23], a[232:235], v[84:87], a[20:23]
ds_read_b64_tr_b16 a[226:227], v240 offset:17664
v_max3_f32 v242, v242, v203, v204
v_mfma_f32_16x16x32_bf16 a[24:27], a[236:239], v[80:83], a[24:27]
ds_read_b64_tr_b16 a[228:229], v240 offset:17184
v_max3_f32 v242, v242, v205, v206
v_mfma_f32_16x16x32_bf16 a[28:31], a[236:239], v[84:87], a[28:31]
s_waitcnt lgkmcnt(7)
ds_read_b64_tr_b16 a[230:231], v240 offset:17696
v_max_f32 v242, v242, v207
v_mfma_f32_16x16x32_bf16 a[32:35], a[240:243], v[80:83], a[32:35]
ds_read_b64_tr_b16 a[232:233], v240 offset:17216
v_cmp_lt_f32 vcc, s32, v242
v_mfma_f32_16x16x32_bf16 a[36:39], a[240:243], v[84:87], a[36:39]
s_cbranch_vccnz L_rsD4
L_rbD4:
ds_read_b64_tr_b16 a[234:235], v240 offset:17728
buffer_load_dwordx4 v247, s[4:7], s29 offen offset:1056 nt lds
v_mfma_f32_16x16x32_bf16 a[40:43], a[244:247], v[80:83], a[40:43]
ds_read_b64_tr_b16 a[236:237], v240 offset:17248
v_mfma_f32_16x16x32_bf16 a[44:47], a[244:247], v[84:87], a[44:47]
s_waitcnt lgkmcnt(7)
ds_read_b64_tr_b16 a[238:239], v240 offset:17760
v_mfma_f32_16x16x32_bf16 a[48:51], a[248:251], v[80:83], a[48:51]
ds_read_b64_tr_b16 a[240:241], v240 offset:17280
v_mfma_f32_16x16x32_bf16 a[52:55], a[248:251], v[84:87], a[52:55]
ds_read_b64_tr_b16 a[242:243], v240 offset:17792
buffer_load_dwordx4 v248, s[4:7], s29 offen offset:2112 nt lds
v_mfma_f32_16x16x32_bf16 a[56:59], a[252:255], v[80:83], a[56:59]
s_waitcnt lgkmcnt(6)
ds_read_b64_tr_b16 a[244:245], v240 offset:17312
v_mfma_f32_16x16x32_bf16 a[60:63], a[252:255], v[84:87], a[60:63]
s_waitcnt vmcnt(19)
ds_read_b64_tr_b16 a[246:247], v240 offset:17824
s_barrier
v_mfma_f32_16x16x32_bf16 a[64:67], a[224:227], v[80:83], a[64:67]
ds_read_b128 a[248:251], v237 offset:0
v_mfma_f32_16x16x32_bf16 a[68:71], a[224:227], v[84:87], a[68:71]
v_exp_f32 v192, v192
v_mfma_f32_16x16x32_bf16 a[72:75], a[228:231], v[80:83], a[72:75]
ds_read_b128 a[252:255], v237 offset:64
v_mfma_f32_16x16x32_bf16 a[76:79], a[228:231], v[84:87], a[76:79]
s_waitcnt lgkmcnt(6)
v_exp_f32 v193, v193
v_mfma_f32_16x16x32_bf16 a[80:83], a[232:235], v[80:83], a[80:83]
ds_read_b128 a[224:227], v237 offset:128
buffer_load_dwordx4 v249, s[4:7], s29 offen offset:3168 nt lds
v_mfma_f32_16x16x32_bf16 a[84:87], a[232:235], v[84:87], a[84:87]
v_exp_f32 v194, v194
v_mfma_f32_16x16x32_bf16 a[88:91], a[236:239], v[80:83], a[88:91]
ds_read_b128 a[228:231], v237 offset:192
v_cvt_pk_bf16_f32 v32, v192, v193
v_mfma_f32_16x16x32_bf16 a[92:95], a[236:239], v[84:87], a[92:95]
s_waitcnt lgkmcnt(4)
v_exp_f32 v195, v195
v_mfma_f32_16x16x32_bf16 a[96:99], a[240:243], v[80:83], a[96:99]
s_add_u32 m0, s28, 33792
ds_read_b128 a[232:235], v237 offset:256
s_mov_b32 s45, 114688
v_mfma_f32_16x16x32_bf16 a[100:103], a[240:243], v[84:87], a[100:103]
v_exp_f32 v196, v196
v_mfma_f32_16x16x32_bf16 a[104:107], a[244:247], v[80:83], a[104:107]
ds_read_b128 a[236:239], v237 offset:320
v_cvt_pk_bf16_f32 v33, v194, v195
v_mfma_f32_16x16x32_bf16 a[108:111], a[244:247], v[84:87], a[108:111]
s_waitcnt lgkmcnt(4)
v_exp_f32 v197, v197
v_mfma_f32_16x16x32_bf16 v[208:211], a[248:251], v[128:131], v[224:227]
ds_read_b128 a[240:243], v237 offset:384
v_mfma_f32_16x16x32_bf16 v[208:211], a[252:255], v[136:139], v[208:211]
v_exp_f32 v198, v198
v_mfma_f32_16x16x32_bf16 v[212:215], a[252:255], v[140:143], v[228:231]
ds_read_b128 a[244:247], v237 offset:448
v_cvt_pk_bf16_f32 v36, v196, v197
v_mfma_f32_16x16x32_bf16 v[212:215], a[248:251], v[132:135], v[212:215]
s_waitcnt lgkmcnt(4)
v_exp_f32 v199, v199
v_mfma_f32_16x16x32_bf16 v[212:215], a[224:227], v[148:151], v[212:215]
ds_read_b128 a[248:251], v237 offset:512
buffer_load_dwordx4 v250, s[16:19], s45 offen offset:0 lds
v_mfma_f32_16x16x32_bf16 v[212:215], a[228:231], v[156:159], v[212:215]
v_exp_f32 v200, v200
v_mfma_f32_16x16x32_bf16 v[208:211], a[228:231], v[152:155], v[208:211]
ds_read_b128 a[252:255], v237 offset:576
v_cvt_pk_bf16_f32 v37, v198, v199
v_mfma_f32_16x16x32_bf16 v[208:211], a[224:227], v[144:147], v[208:211]
s_waitcnt lgkmcnt(4)
v_exp_f32 v201, v201
v_mfma_f32_16x16x32_bf16 v[208:211], a[232:235], v[160:163], v[208:211]
ds_read_b128 a[224:227], v237 offset:640
buffer_load_dwordx4 v251, s[16:19], s45 offen offset:1056 lds
v_mfma_f32_16x16x32_bf16 v[208:211], a[236:239], v[168:171], v[208:211]
v_exp_f32 v202, v202
v_mfma_f32_16x16x32_bf16 v[212:215], a[236:239], v[172:175], v[212:215]
ds_read_b128 a[228:231], v237 offset:704
v_cvt_pk_bf16_f32 v34, v200, v201
v_mfma_f32_16x16x32_bf16 v[212:215], a[232:235], v[164:167], v[212:215]
s_waitcnt lgkmcnt(4)
v_exp_f32 v203, v203
v_mfma_f32_16x16x32_bf16 v[212:215], a[240:243], v[180:183], v[212:215]
ds_read_b128 a[232:235], v237 offset:768
v_mfma_f32_16x16x32_bf16 v[212:215], a[244:247], v[188:191], v[212:215]
v_exp_f32 v204, v204
v_mfma_f32_16x16x32_bf16 v[208:211], a[244:247], v[184:187], v[208:211]
ds_read_b128 a[236:239], v237 offset:832
v_cvt_pk_bf16_f32 v35, v202, v203
v_mfma_f32_16x16x32_bf16 v[208:211], a[240:243], v[176:179], v[208:211]
s_waitcnt lgkmcnt(4)
v_exp_f32 v205, v205
v_mfma_f32_16x16x32_bf16 v[216:219], a[248:251], v[128:131], v[224:227]
ds_read_b128 a[240:243], v237 offset:896
buffer_load_dwordx4 v252, s[16:19], s45 offen offset:2112 lds
v_mfma_f32_16x16x32_bf16 v[216:219], a[252:255], v[136:139], v[216:219]
v_exp_f32 v206, v206
v_cvt_pk_bf16_f32 v38, v204, v205
v_mfma_f32_16x16x32_bf16 v[220:223], a[252:255], v[140:143], v[228:231]
ds_read_b128 a[244:247], v237 offset:960
v_exp_f32 v207, v207
v_mfma_f32_16x16x32_bf16 v[220:223], a[248:251], v[132:135], v[220:223]
s_waitcnt lgkmcnt(4)
v_cvt_pk_bf16_f32 v39, v206, v207
v_mfma_f32_16x16x32_bf16 v[220:223], a[224:227], v[148:151], v[220:223]
ds_read_b64_tr_b16 a[248:249], v240 offset:33792
v_max3_f32 v242, v208, v209, v210
v_mfma_f32_16x16x32_bf16 v[220:223], a[228:231], v[156:159], v[220:223]
ds_read_b64_tr_b16 a[250:251], v240 offset:34304
v_max3_f32 v242, v242, v211, v212
v_mfma_f32_16x16x32_bf16 v[216:219], a[228:231], v[152:155], v[216:219]
ds_read_b64_tr_b16 a[252:253], v240 offset:33824
v_max3_f32 v242, v242, v213, v214
v_mfma_f32_16x16x32_bf16 v[216:219], a[224:227], v[144:147], v[216:219]
s_waitcnt lgkmcnt(5)
ds_read_b64_tr_b16 a[254:255], v240 offset:34336
buffer_load_dwordx4 v253, s[16:19], s45 offen offset:3168 lds
v_mfma_f32_16x16x32_bf16 v[216:219], a[232:235], v[160:163], v[216:219]
s_add_u32 m0, s28, 84480
ds_read_b64_tr_b16 a[224:225], v240 offset:33856
s_mov_b32 s29, 409600
v_mfma_f32_16x16x32_bf16 v[216:219], a[236:239], v[168:171], v[216:219]
ds_read_b64_tr_b16 a[226:227], v240 offset:34368
v_mfma_f32_16x16x32_bf16 v[220:223], a[236:239], v[172:175], v[220:223]
ds_read_b64_tr_b16 a[228:229], v240 offset:33888
v_mfma_f32_16x16x32_bf16 v[220:223], a[232:235], v[164:167], v[220:223]
s_waitcnt lgkmcnt(7)
ds_read_b64_tr_b16 a[230:231], v240 offset:34400
v_mfma_f32_16x16x32_bf16 v[220:223], a[240:243], v[180:183], v[220:223]
ds_read_b64_tr_b16 a[232:233], v240 offset:33920
v_mfma_f32_16x16x32_bf16 v[220:223], a[244:247], v[188:191], v[220:223]
ds_read_b64_tr_b16 a[234:235], v240 offset:34432
v_mfma_f32_16x16x32_bf16 v[216:219], a[244:247], v[184:187], v[216:219]
ds_read_b64_tr_b16 a[236:237], v240 offset:33952
buffer_load_dwordx4 v246, s[4:7], s29 offen offset:0 nt lds
v_mfma_f32_16x16x32_bf16 v[216:219], a[240:243], v[176:179], v[216:219]
s_waitcnt lgkmcnt(7)
ds_read_b64_tr_b16 a[238:239], v240 offset:34464
v_mfma_f32_16x16x32_bf16 a[112:115], a[248:251], v[80:83], a[112:115]
ds_read_b64_tr_b16 a[240:241], v240 offset:33984
v_mfma_f32_16x16x32_bf16 a[116:119], a[248:251], v[84:87], a[116:119]
ds_read_b64_tr_b16 a[242:243], v240 offset:34496
v_mfma_f32_16x16x32_bf16 a[120:123], a[252:255], v[80:83], a[120:123]
ds_read_b64_tr_b16 a[244:245], v240 offset:34016
v_mfma_f32_16x16x32_bf16 a[124:127], a[252:255], v[84:87], a[124:127]
s_waitcnt lgkmcnt(7)
ds_read_b64_tr_b16 a[246:247], v240 offset:34528
v_max3_f32 v242, v242, v215, v216
v_mfma_f32_16x16x32_bf16 a[128:131], a[224:227], v[80:83], a[128:131]
ds_read_b64_tr_b16 a[248:249], v240 offset:34048
v_max3_f32 v242, v242, v217, v218
v_mfma_f32_16x16x32_bf16 a[132:135], a[224:227], v[84:87], a[132:135]
ds_read_b64_tr_b16 a[250:251], v240 offset:34560
v_max3_f32 v242, v242, v219, v220
v_mfma_f32_16x16x32_bf16 a[136:139], a[228:231], v[80:83], a[136:139]
ds_read_b64_tr_b16 a[252:253], v240 offset:34080
v_max3_f32 v242, v242, v221, v222
v_mfma_f32_16x16x32_bf16 a[140:143], a[228:231], v[84:87], a[140:143]
s_waitcnt lgkmcnt(7)
ds_read_b64_tr_b16 a[254:255], v240 offset:34592
v_max_f32 v242, v242, v223
v_mfma_f32_16x16x32_bf16 a[144:147], a[232:235], v[80:83], a[144:147]
ds_read_b64_tr_b16 a[224:225], v240 offset:34112
v_cmp_lt_f32 vcc, s32, v242
v_mfma_f32_16x16x32_bf16 a[148:151], a[232:235], v[84:87], a[148:151]
s_cbranch_vccnz L_rsD5
L_rbD5:
ds_read_b64_tr_b16 a[226:227], v240 offset:34624
buffer_load_dwordx4 v247, s[4:7], s29 offen offset:1056 nt lds
v_mfma_f32_16x16x32_bf16 a[152:155], a[236:239], v[80:83], a[152:155]
ds_read_b64_tr_b16 a[228:229], v240 offset:34144
v_mfma_f32_16x16x32_bf16 a[156:159], a[236:239], v[84:87], a[156:159]
s_waitcnt lgkmcnt(7)
ds_read_b64_tr_b16 a[230:231], v240 offset:34656
v_mfma_f32_16x16x32_bf16 a[160:163], a[240:243], v[80:83], a[160:163]
ds_read_b64_tr_b16 a[232:233], v240 offset:34176
v_mfma_f32_16x16x32_bf16 a[164:167], a[240:243], v[84:87], a[164:167]
ds_read_b64_tr_b16 a[234:235], v240 offset:34688
buffer_load_dwordx4 v248, s[4:7], s29 offen offset:2112 nt lds
v_mfma_f32_16x16x32_bf16 a[168:171], a[244:247], v[80:83], a[168:171]
s_waitcnt lgkmcnt(6)
ds_read_b64_tr_b16 a[236:237], v240 offset:34208
v_mfma_f32_16x16x32_bf16 a[172:175], a[244:247], v[84:87], a[172:175]
s_waitcnt vmcnt(19)
ds_read_b64_tr_b16 a[238:239], v240 offset:34720
s_barrier
v_mfma_f32_16x16x32_bf16 a[176:179], a[248:251], v[80:83], a[176:179]
ds_read_b128 a[240:243], v237 offset:50688
v_mfma_f32_16x16x32_bf16 a[180:183], a[248:251], v[84:87], a[180:183]
v_exp_f32 v208, v208
v_mfma_f32_16x16x32_bf16 a[184:187], a[252:255], v[80:83], a[184:187]
ds_read_b128 a[244:247], v237 offset:50752
v_mfma_f32_16x16x32_bf16 a[188:191], a[252:255], v[84:87], a[188:191]
s_waitcnt lgkmcnt(6)
v_exp_f32 v209, v209
v_mfma_f32_16x16x32_bf16 a[192:195], a[224:227], v[80:83], a[192:195]
ds_read_b128 a[248:251], v237 offset:50816
buffer_load_dwordx4 v249, s[4:7], s29 offen offset:3168 nt lds
v_mfma_f32_16x16x32_bf16 a[196:199], a[224:227], v[84:87], a[196:199]
v_exp_f32 v210, v210
v_mfma_f32_16x16x32_bf16 a[200:203], a[228:231], v[80:83], a[200:203]
ds_read_b128 a[252:255], v237 offset:50880
v_cvt_pk_bf16_f32 v40, v208, v209
v_mfma_f32_16x16x32_bf16 a[204:207], a[228:231], v[84:87], a[204:207]
s_waitcnt lgkmcnt(4)
v_exp_f32 v211, v211
v_mfma_f32_16x16x32_bf16 a[208:211], a[232:235], v[80:83], a[208:211]
s_add_u32 m0, s28, 67584
ds_read_b128 a[224:227], v237 offset:50944
s_mov_b32 s45, 115136
v_mfma_f32_16x16x32_bf16 a[212:215], a[232:235], v[84:87], a[212:215]
v_exp_f32 v212, v212
v_mfma_f32_16x16x32_bf16 a[216:219], a[236:239], v[80:83], a[216:219]
ds_read_b128 a[228:231], v237 offset:51008
v_cvt_pk_bf16_f32 v41, v210, v211
v_mfma_f32_16x16x32_bf16 a[220:223], a[236:239], v[84:87], a[220:223]
s_waitcnt lgkmcnt(4)
v_exp_f32 v213, v213
v_mfma_f32_16x16x32_bf16 v[192:195], a[240:243], v[128:131], v[224:227]
ds_read_b128 a[232:235], v237 offset:51072
v_mfma_f32_16x16x32_bf16 v[192:195], a[244:247], v[136:139], v[192:195]
v_exp_f32 v214, v214
v_mfma_f32_16x16x32_bf16 v[196:199], a[244:247], v[140:143], v[228:231]
ds_read_b128 a[236:239], v237 offset:51136
v_cvt_pk_bf16_f32 v44, v212, v213
v_mfma_f32_16x16x32_bf16 v[196:199], a[240:243], v[132:135], v[196:199]
s_waitcnt lgkmcnt(4)
v_exp_f32 v215, v215
v_mfma_f32_16x16x32_bf16 v[196:199], a[248:251], v[148:151], v[196:199]
ds_read_b128 a[240:243], v237 offset:51200
buffer_load_dwordx4 v250, s[16:19], s45 offen offset:0 lds
v_mfma_f32_16x16x32_bf16 v[196:199], a[252:255], v[156:159], v[196:199]
v_exp_f32 v216, v216
v_mfma_f32_16x16x32_bf16 v[192:195], a[252:255], v[152:155], v[192:195]
ds_read_b128 a[244:247], v237 offset:51264
v_cvt_pk_bf16_f32 v45, v214, v215
v_mfma_f32_16x16x32_bf16 v[192:195], a[248:251], v[144:147], v[192:195]
s_waitcnt lgkmcnt(4)
v_exp_f32 v217, v217
v_mfma_f32_16x16x32_bf16 v[192:195], a[224:227], v[160:163], v[192:195]
ds_read_b128 a[248:251], v237 offset:51328
buffer_load_dwordx4 v251, s[16:19], s45 offen offset:1056 lds
v_mfma_f32_16x16x32_bf16 v[192:195], a[228:231], v[168:171], v[192:195]
v_exp_f32 v218, v218
v_mfma_f32_16x16x32_bf16 v[196:199], a[228:231], v[172:175], v[196:199]
ds_read_b128 a[252:255], v237 offset:51392
v_cvt_pk_bf16_f32 v42, v216, v217
v_mfma_f32_16x16x32_bf16 v[196:199], a[224:227], v[164:167], v[196:199]
s_waitcnt lgkmcnt(4)
v_exp_f32 v219, v219
v_mfma_f32_16x16x32_bf16 v[196:199], a[232:235], v[180:183], v[196:199]
ds_read_b128 a[224:227], v237 offset:51456
v_mfma_f32_16x16x32_bf16 v[196:199], a[236:239], v[188:191], v[196:199]
v_exp_f32 v220, v220
v_mfma_f32_16x16x32_bf16 v[192:195], a[236:239], v[184:187], v[192:195]
ds_read_b128 a[228:231], v237 offset:51520
v_cvt_pk_bf16_f32 v43, v218, v219
v_mfma_f32_16x16x32_bf16 v[192:195], a[232:235], v[176:179], v[192:195]
s_waitcnt lgkmcnt(4)
v_exp_f32 v221, v221
v_mfma_f32_16x16x32_bf16 v[200:203], a[240:243], v[128:131], v[224:227]
ds_read_b128 a[232:235], v237 offset:51584
buffer_load_dwordx4 v252, s[16:19], s45 offen offset:2112 lds
v_mfma_f32_16x16x32_bf16 v[200:203], a[244:247], v[136:139], v[200:203]
v_exp_f32 v222, v222
v_cvt_pk_bf16_f32 v46, v220, v221
v_mfma_f32_16x16x32_bf16 v[204:207], a[244:247], v[140:143], v[228:231]
ds_read_b128 a[236:239], v237 offset:51648
v_exp_f32 v223, v223
v_mfma_f32_16x16x32_bf16 v[204:207], a[240:243], v[132:135], v[204:207]
s_waitcnt lgkmcnt(4)
v_cvt_pk_bf16_f32 v47, v222, v223
v_mfma_f32_16x16x32_bf16 v[204:207], a[248:251], v[148:151], v[204:207]
ds_read_b64_tr_b16 a[240:241], v239 offset:16896
v_max3_f32 v242, v192, v193, v194
v_mfma_f32_16x16x32_bf16 v[204:207], a[252:255], v[156:159], v[204:207]
ds_read_b64_tr_b16 a[242:243], v239 offset:17408
v_max3_f32 v242, v242, v195, v196
v_mfma_f32_16x16x32_bf16 v[200:203], a[252:255], v[152:155], v[200:203]
ds_read_b64_tr_b16 a[244:245], v239 offset:16928
v_max3_f32 v242, v242, v197, v198
v_mfma_f32_16x16x32_bf16 v[200:203], a[248:251], v[144:147], v[200:203]
s_waitcnt lgkmcnt(5)
ds_read_b64_tr_b16 a[246:247], v239 offset:17440
buffer_load_dwordx4 v253, s[16:19], s45 offen offset:3168 lds
v_mfma_f32_16x16x32_bf16 v[200:203], a[224:227], v[160:163], v[200:203]
s_add_u32 m0, s28, 101376
ds_read_b64_tr_b16 a[248:249], v239 offset:16960
s_mov_b32 s29, 425984
v_mfma_f32_16x16x32_bf16 v[200:203], a[228:231], v[168:171], v[200:203]
ds_read_b64_tr_b16 a[250:251], v239 offset:17472
v_mfma_f32_16x16x32_bf16 v[204:207], a[228:231], v[172:175], v[204:207]
ds_read_b64_tr_b16 a[252:253], v239 offset:16992
v_mfma_f32_16x16x32_bf16 v[204:207], a[224:227], v[164:167], v[204:207]
s_waitcnt lgkmcnt(7)
ds_read_b64_tr_b16 a[254:255], v239 offset:17504
v_mfma_f32_16x16x32_bf16 v[204:207], a[232:235], v[180:183], v[204:207]
ds_read_b64_tr_b16 a[224:225], v239 offset:17024
v_mfma_f32_16x16x32_bf16 v[204:207], a[236:239], v[188:191], v[204:207]
ds_read_b64_tr_b16 a[226:227], v239 offset:17536
v_mfma_f32_16x16x32_bf16 v[200:203], a[236:239], v[184:187], v[200:203]
ds_read_b64_tr_b16 a[228:229], v239 offset:17056
buffer_load_dwordx4 v246, s[4:7], s29 offen offset:0 nt lds
v_mfma_f32_16x16x32_bf16 v[200:203], a[232:235], v[176:179], v[200:203]
s_waitcnt lgkmcnt(7)
ds_read_b64_tr_b16 a[230:231], v239 offset:17568
v_mfma_f32_16x16x32_bf16 a[0:3], a[240:243], v[88:91], a[0:3]
ds_read_b64_tr_b16 a[232:233], v239 offset:17088
v_mfma_f32_16x16x32_bf16 a[4:7], a[240:243], v[92:95], a[4:7]
ds_read_b64_tr_b16 a[234:235], v239 offset:17600
v_mfma_f32_16x16x32_bf16 a[8:11], a[244:247], v[88:91], a[8:11]
ds_read_b64_tr_b16 a[236:237], v239 offset:17120
v_mfma_f32_16x16x32_bf16 a[12:15], a[244:247], v[92:95], a[12:15]
s_waitcnt lgkmcnt(7)
ds_read_b64_tr_b16 a[238:239], v239 offset:17632
v_max3_f32 v242, v242, v199, v200
v_mfma_f32_16x16x32_bf16 a[16:19], a[248:251], v[88:91], a[16:19]
ds_read_b64_tr_b16 a[240:241], v239 offset:17152
v_max3_f32 v242, v242, v201, v202
v_mfma_f32_16x16x32_bf16 a[20:23], a[248:251], v[92:95], a[20:23]
ds_read_b64_tr_b16 a[242:243], v239 offset:17664
v_max3_f32 v242, v242, v203, v204
v_mfma_f32_16x16x32_bf16 a[24:27], a[252:255], v[88:91], a[24:27]
ds_read_b64_tr_b16 a[244:245], v239 offset:17184
v_max3_f32 v242, v242, v205, v206
v_mfma_f32_16x16x32_bf16 a[28:31], a[252:255], v[92:95], a[28:31]
s_waitcnt lgkmcnt(7)
ds_read_b64_tr_b16 a[246:247], v239 offset:17696
v_max_f32 v242, v242, v207
v_mfma_f32_16x16x32_bf16 a[32:35], a[224:227], v[88:91], a[32:35]
ds_read_b64_tr_b16 a[248:249], v239 offset:17216
v_cmp_lt_f32 vcc, s32, v242
v_mfma_f32_16x16x32_bf16 a[36:39], a[224:227], v[92:95], a[36:39]
s_cbranch_vccnz L_rsD6
L_rbD6:
ds_read_b64_tr_b16 a[250:251], v239 offset:17728
buffer_load_dwordx4 v247, s[4:7], s29 offen offset:1056 nt lds
v_mfma_f32_16x16x32_bf16 a[40:43], a[228:231], v[88:91], a[40:43]
ds_read_b64_tr_b16 a[252:253], v239 offset:17248
v_mfma_f32_16x16x32_bf16 a[44:47], a[228:231], v[92:95], a[44:47]
s_waitcnt lgkmcnt(7)
ds_read_b64_tr_b16 a[254:255], v239 offset:17760
v_mfma_f32_16x16x32_bf16 a[48:51], a[232:235], v[88:91], a[48:51]
ds_read_b64_tr_b16 a[224:225], v239 offset:17280
v_mfma_f32_16x16x32_bf16 a[52:55], a[232:235], v[92:95], a[52:55]
ds_read_b64_tr_b16 a[226:227], v239 offset:17792
buffer_load_dwordx4 v248, s[4:7], s29 offen offset:2112 nt lds
v_mfma_f32_16x16x32_bf16 a[56:59], a[236:239], v[88:91], a[56:59]
s_waitcnt lgkmcnt(6)
ds_read_b64_tr_b16 a[228:229], v239 offset:17312
v_mfma_f32_16x16x32_bf16 a[60:63], a[236:239], v[92:95], a[60:63]
s_waitcnt vmcnt(19)
ds_read_b64_tr_b16 a[230:231], v239 offset:17824
s_barrier
v_mfma_f32_16x16x32_bf16 a[64:67], a[240:243], v[88:91], a[64:67]
ds_read_b128 a[232:235], v236 offset:0
v_mfma_f32_16x16x32_bf16 a[68:71], a[240:243], v[92:95], a[68:71]
v_exp_f32 v192, v192
v_mfma_f32_16x16x32_bf16 a[72:75], a[244:247], v[88:91], a[72:75]
ds_read_b128 a[236:239], v236 offset:64
v_mfma_f32_16x16x32_bf16 a[76:79], a[244:247], v[92:95], a[76:79]
s_waitcnt lgkmcnt(6)
v_exp_f32 v193, v193
v_mfma_f32_16x16x32_bf16 a[80:83], a[248:251], v[88:91], a[80:83]
ds_read_b128 a[240:243], v236 offset:128
buffer_load_dwordx4 v249, s[4:7], s29 offen offset:3168 nt lds
v_mfma_f32_16x16x32_bf16 a[84:87], a[248:251], v[92:95], a[84:87]
v_exp_f32 v194, v194
v_mfma_f32_16x16x32_bf16 a[88:91], a[252:255], v[88:91], a[88:91]
ds_read_b128 a[244:247], v236 offset:192
v_cvt_pk_bf16_f32 v48, v192, v193
v_mfma_f32_16x16x32_bf16 a[92:95], a[252:255], v[92:95], a[92:95]
s_waitcnt lgkmcnt(4)
v_exp_f32 v195, v195
v_mfma_f32_16x16x32_bf16 a[96:99], a[224:227], v[88:91], a[96:99]
s_add_u32 m0, s28, 118272
ds_read_b128 a[248:251], v236 offset:256
s_mov_b32 s45, 143360
v_mfma_f32_16x16x32_bf16 a[100:103], a[224:227], v[92:95], a[100:103]
v_exp_f32 v196, v196
v_mfma_f32_16x16x32_bf16 a[104:107], a[228:231], v[88:91], a[104:107]
ds_read_b128 a[252:255], v236 offset:320
v_cvt_pk_bf16_f32 v49, v194, v195
v_mfma_f32_16x16x32_bf16 a[108:111], a[228:231], v[92:95], a[108:111]
s_waitcnt lgkmcnt(4)
v_exp_f32 v197, v197
v_mfma_f32_16x16x32_bf16 v[208:211], a[232:235], v[128:131], v[224:227]
ds_read_b128 a[224:227], v236 offset:384
v_mfma_f32_16x16x32_bf16 v[208:211], a[236:239], v[136:139], v[208:211]
v_exp_f32 v198, v198
v_mfma_f32_16x16x32_bf16 v[212:215], a[236:239], v[140:143], v[228:231]
ds_read_b128 a[228:231], v236 offset:448
v_cvt_pk_bf16_f32 v52, v196, v197
v_mfma_f32_16x16x32_bf16 v[212:215], a[232:235], v[132:135], v[212:215]
s_waitcnt lgkmcnt(4)
v_exp_f32 v199, v199
v_mfma_f32_16x16x32_bf16 v[212:215], a[240:243], v[148:151], v[212:215]
ds_read_b128 a[232:235], v236 offset:512
buffer_load_dwordx4 v250, s[16:19], s45 offen offset:0 lds
v_mfma_f32_16x16x32_bf16 v[212:215], a[244:247], v[156:159], v[212:215]
v_exp_f32 v200, v200
v_mfma_f32_16x16x32_bf16 v[208:211], a[244:247], v[152:155], v[208:211]
ds_read_b128 a[236:239], v236 offset:576
v_cvt_pk_bf16_f32 v53, v198, v199
v_mfma_f32_16x16x32_bf16 v[208:211], a[240:243], v[144:147], v[208:211]
s_waitcnt lgkmcnt(4)
v_exp_f32 v201, v201
v_mfma_f32_16x16x32_bf16 v[208:211], a[248:251], v[160:163], v[208:211]
ds_read_b128 a[240:243], v236 offset:640
buffer_load_dwordx4 v251, s[16:19], s45 offen offset:1056 lds
v_mfma_f32_16x16x32_bf16 v[208:211], a[252:255], v[168:171], v[208:211]
v_exp_f32 v202, v202
v_mfma_f32_16x16x32_bf16 v[212:215], a[252:255], v[172:175], v[212:215]
ds_read_b128 a[244:247], v236 offset:704
v_cvt_pk_bf16_f32 v50, v200, v201
v_mfma_f32_16x16x32_bf16 v[212:215], a[248:251], v[164:167], v[212:215]
s_waitcnt lgkmcnt(4)
v_exp_f32 v203, v203
v_mfma_f32_16x16x32_bf16 v[212:215], a[224:227], v[180:183], v[212:215]
ds_read_b128 a[248:251], v236 offset:768
v_mfma_f32_16x16x32_bf16 v[212:215], a[228:231], v[188:191], v[212:215]
v_exp_f32 v204, v204
v_mfma_f32_16x16x32_bf16 v[208:211], a[228:231], v[184:187], v[208:211]
ds_read_b128 a[252:255], v236 offset:832
v_cvt_pk_bf16_f32 v51, v202, v203
v_mfma_f32_16x16x32_bf16 v[208:211], a[224:227], v[176:179], v[208:211]
s_waitcnt lgkmcnt(4)
v_exp_f32 v205, v205
v_mfma_f32_16x16x32_bf16 v[216:219], a[232:235], v[128:131], v[224:227]
ds_read_b128 a[224:227], v236 offset:896
buffer_load_dwordx4 v252, s[16:19], s45 offen offset:2112 lds
v_mfma_f32_16x16x32_bf16 v[216:219], a[236:239], v[136:139], v[216:219]
v_exp_f32 v206, v206
v_cvt_pk_bf16_f32 v54, v204, v205
v_mfma_f32_16x16x32_bf16 v[220:223], a[236:239], v[140:143], v[228:231]
ds_read_b128 a[228:231], v236 offset:960
v_exp_f32 v207, v207
v_mfma_f32_16x16x32_bf16 v[220:223], a[232:235], v[132:135], v[220:223]
s_waitcnt lgkmcnt(4)
v_cvt_pk_bf16_f32 v55, v206, v207
v_mfma_f32_16x16x32_bf16 v[220:223], a[240:243], v[148:151], v[220:223]
ds_read_b64_tr_b16 a[232:233], v241 offset:0
v_max3_f32 v242, v208, v209, v210
v_mfma_f32_16x16x32_bf16 v[220:223], a[244:247], v[156:159], v[220:223]
ds_read_b64_tr_b16 a[234:235], v241 offset:512
v_max3_f32 v242, v242, v211, v212
v_mfma_f32_16x16x32_bf16 v[216:219], a[244:247], v[152:155], v[216:219]
ds_read_b64_tr_b16 a[236:237], v241 offset:32
v_max3_f32 v242, v242, v213, v214
v_mfma_f32_16x16x32_bf16 v[216:219], a[240:243], v[144:147], v[216:219]
s_waitcnt lgkmcnt(5)
ds_read_b64_tr_b16 a[238:239], v241 offset:544
buffer_load_dwordx4 v253, s[16:19], s45 offen offset:3168 lds
v_mfma_f32_16x16x32_bf16 v[216:219], a[248:251], v[160:163], v[216:219]
s_add_u32 m0, s28, 16896
ds_read_b64_tr_b16 a[240:241], v241 offset:64
s_mov_b32 s29, 442368
v_mfma_f32_16x16x32_bf16 v[216:219], a[252:255], v[168:171], v[216:219]
ds_read_b64_tr_b16 a[242:243], v241 offset:576
v_mfma_f32_16x16x32_bf16 v[220:223], a[252:255], v[172:175], v[220:223]
ds_read_b64_tr_b16 a[244:245], v241 offset:96
v_mfma_f32_16x16x32_bf16 v[220:223], a[248:251], v[164:167], v[220:223]
s_waitcnt lgkmcnt(7)
ds_read_b64_tr_b16 a[246:247], v241 offset:608
v_mfma_f32_16x16x32_bf16 v[220:223], a[224:227], v[180:183], v[220:223]
ds_read_b64_tr_b16 a[248:249], v241 offset:128
v_mfma_f32_16x16x32_bf16 v[220:223], a[228:231], v[188:191], v[220:223]
ds_read_b64_tr_b16 a[250:251], v241 offset:640
v_mfma_f32_16x16x32_bf16 v[216:219], a[228:231], v[184:187], v[216:219]
ds_read_b64_tr_b16 a[252:253], v241 offset:160
buffer_load_dwordx4 v246, s[4:7], s29 offen offset:0 nt lds
v_mfma_f32_16x16x32_bf16 v[216:219], a[224:227], v[176:179], v[216:219]
s_waitcnt lgkmcnt(7)
ds_read_b64_tr_b16 a[254:255], v241 offset:672
v_mfma_f32_16x16x32_bf16 a[112:115], a[232:235], v[88:91], a[112:115]
ds_read_b64_tr_b16 a[224:225], v241 offset:192
v_mfma_f32_16x16x32_bf16 a[116:119], a[232:235], v[92:95], a[116:119]
ds_read_b64_tr_b16 a[226:227], v241 offset:704
v_mfma_f32_16x16x32_bf16 a[120:123], a[236:239], v[88:91], a[120:123]
ds_read_b64_tr_b16 a[228:229], v241 offset:224
v_mfma_f32_16x16x32_bf16 a[124:127], a[236:239], v[92:95], a[124:127]
s_waitcnt lgkmcnt(7)
ds_read_b64_tr_b16 a[230:231], v241 offset:736
v_max3_f32 v242, v242, v215, v216
v_mfma_f32_16x16x32_bf16 a[128:131], a[240:243], v[88:91], a[128:131]
ds_read_b64_tr_b16 a[232:233], v241 offset:256
v_max3_f32 v242, v242, v217, v218
v_mfma_f32_16x16x32_bf16 a[132:135], a[240:243], v[92:95], a[132:135]
ds_read_b64_tr_b16 a[234:235], v241 offset:768
v_max3_f32 v242, v242, v219, v220
v_mfma_f32_16x16x32_bf16 a[136:139], a[244:247], v[88:91], a[136:139]
ds_read_b64_tr_b16 a[236:237], v241 offset:288
v_max3_f32 v242, v242, v221, v222
v_mfma_f32_16x16x32_bf16 a[140:143], a[244:247], v[92:95], a[140:143]
s_waitcnt lgkmcnt(7)
ds_read_b64_tr_b16 a[238:239], v241 offset:800
v_max_f32 v242, v242, v223
v_mfma_f32_16x16x32_bf16 a[144:147], a[248:251], v[88:91], a[144:147]
ds_read_b64_tr_b16 a[240:241], v241 offset:320
v_cmp_lt_f32 vcc, s32, v242
v_mfma_f32_16x16x32_bf16 a[148:151], a[248:251], v[92:95], a[148:151]
s_cbranch_vccnz L_rsD7
L_rbD7:
ds_read_b64_tr_b16 a[242:243], v241 offset:832
buffer_load_dwordx4 v247, s[4:7], s29 offen offset:1056 nt lds
v_mfma_f32_16x16x32_bf16 a[152:155], a[252:255], v[88:91], a[152:155]
ds_read_b64_tr_b16 a[244:245], v241 offset:352
v_mfma_f32_16x16x32_bf16 a[156:159], a[252:255], v[92:95], a[156:159]
s_waitcnt lgkmcnt(7)
ds_read_b64_tr_b16 a[246:247], v241 offset:864
v_mfma_f32_16x16x32_bf16 a[160:163], a[224:227], v[88:91], a[160:163]
ds_read_b64_tr_b16 a[248:249], v241 offset:384
v_mfma_f32_16x16x32_bf16 a[164:167], a[224:227], v[92:95], a[164:167]
ds_read_b64_tr_b16 a[250:251], v241 offset:896
buffer_load_dwordx4 v248, s[4:7], s29 offen offset:2112 nt lds
v_mfma_f32_16x16x32_bf16 a[168:171], a[228:231], v[88:91], a[168:171]
s_waitcnt lgkmcnt(6)
ds_read_b64_tr_b16 a[252:253], v241 offset:416
v_mfma_f32_16x16x32_bf16 a[172:175], a[228:231], v[92:95], a[172:175]
s_waitcnt vmcnt(19)
ds_read_b64_tr_b16 a[254:255], v241 offset:928
s_barrier
v_mfma_f32_16x16x32_bf16 a[176:179], a[232:235], v[88:91], a[176:179]
ds_read_b128 a[224:227], v236 offset:50688
v_mfma_f32_16x16x32_bf16 a[180:183], a[232:235], v[92:95], a[180:183]
v_exp_f32 v208, v208
v_mfma_f32_16x16x32_bf16 a[184:187], a[236:239], v[88:91], a[184:187]
ds_read_b128 a[228:231], v236 offset:50752
v_mfma_f32_16x16x32_bf16 a[188:191], a[236:239], v[92:95], a[188:191]
s_waitcnt lgkmcnt(6)
v_exp_f32 v209, v209
v_mfma_f32_16x16x32_bf16 a[192:195], a[240:243], v[88:91], a[192:195]
ds_read_b128 a[232:235], v236 offset:50816
buffer_load_dwordx4 v249, s[4:7], s29 offen offset:3168 nt lds
v_mfma_f32_16x16x32_bf16 a[196:199], a[240:243], v[92:95], a[196:199]
v_exp_f32 v210, v210
v_mfma_f32_16x16x32_bf16 a[200:203], a[244:247], v[88:91], a[200:203]
ds_read_b128 a[236:239], v236 offset:50880
v_cvt_pk_bf16_f32 v56, v208, v209
v_mfma_f32_16x16x32_bf16 a[204:207], a[244:247], v[92:95], a[204:207]
s_waitcnt lgkmcnt(4)
v_exp_f32 v211, v211
v_mfma_f32_16x16x32_bf16 a[208:211], a[248:251], v[88:91], a[208:211]
s_add_u32 m0, s28, 0
ds_read_b128 a[240:243], v236 offset:50944
s_mov_b32 s45, 143808
v_mfma_f32_16x16x32_bf16 a[212:215], a[248:251], v[92:95], a[212:215]
v_exp_f32 v212, v212
v_mfma_f32_16x16x32_bf16 a[216:219], a[252:255], v[88:91], a[216:219]
ds_read_b128 a[244:247], v236 offset:51008
v_cvt_pk_bf16_f32 v57, v210, v211
v_mfma_f32_16x16x32_bf16 a[220:223], a[252:255], v[92:95], a[220:223]
s_waitcnt lgkmcnt(4)
v_exp_f32 v213, v213
v_mfma_f32_16x16x32_bf16 v[192:195], a[224:227], v[128:131], v[224:227]
ds_read_b128 a[248:251], v236 offset:51072
v_mfma_f32_16x16x32_bf16 v[192:195], a[228:231], v[136:139], v[192:195]
v_exp_f32 v214, v214
v_mfma_f32_16x16x32_bf16 v[196:199], a[228:231], v[140:143], v[228:231]
ds_read_b128 a[252:255], v236 offset:51136
v_cvt_pk_bf16_f32 v60, v212, v213
v_mfma_f32_16x16x32_bf16 v[196:199], a[224:227], v[132:135], v[196:199]
s_waitcnt lgkmcnt(4)
v_exp_f32 v215, v215
v_mfma_f32_16x16x32_bf16 v[196:199], a[232:235], v[148:151], v[196:199]
ds_read_b128 a[224:227], v236 offset:51200
buffer_load_dwordx4 v250, s[16:19], s45 offen offset:0 lds
v_mfma_f32_16x16x32_bf16 v[196:199], a[236:239], v[156:159], v[196:199]
v_exp_f32 v216, v216
v_mfma_f32_16x16x32_bf16 v[192:195], a[236:239], v[152:155], v[192:195]
ds_read_b128 a[228:231], v236 offset:51264
v_cvt_pk_bf16_f32 v61, v214, v215
v_mfma_f32_16x16x32_bf16 v[192:195], a[232:235], v[144:147], v[192:195]
s_waitcnt lgkmcnt(4)
v_exp_f32 v217, v217
v_mfma_f32_16x16x32_bf16 v[192:195], a[240:243], v[160:163], v[192:195]
ds_read_b128 a[232:235], v236 offset:51328
buffer_load_dwordx4 v251, s[16:19], s45 offen offset:1056 lds
v_mfma_f32_16x16x32_bf16 v[192:195], a[244:247], v[168:171], v[192:195]
v_exp_f32 v218, v218
v_mfma_f32_16x16x32_bf16 v[196:199], a[244:247], v[172:175], v[196:199]
ds_read_b128 a[236:239], v236 offset:51392
v_cvt_pk_bf16_f32 v58, v216, v217
v_mfma_f32_16x16x32_bf16 v[196:199], a[240:243], v[164:167], v[196:199]
s_waitcnt lgkmcnt(4)
v_exp_f32 v219, v219
v_mfma_f32_16x16x32_bf16 v[196:199], a[248:251], v[180:183], v[196:199]
ds_read_b128 a[240:243], v236 offset:51456
v_mfma_f32_16x16x32_bf16 v[196:199], a[252:255], v[188:191], v[196:199]
v_exp_f32 v220, v220
v_mfma_f32_16x16x32_bf16 v[192:195], a[252:255], v[184:187], v[192:195]
ds_read_b128 a[244:247], v236 offset:51520
v_cvt_pk_bf16_f32 v59, v218, v219
v_mfma_f32_16x16x32_bf16 v[192:195], a[248:251], v[176:179], v[192:195]
s_waitcnt lgkmcnt(4)
v_exp_f32 v221, v221
v_mfma_f32_16x16x32_bf16 v[200:203], a[224:227], v[128:131], v[224:227]
ds_read_b128 a[248:251], v236 offset:51584
buffer_load_dwordx4 v252, s[16:19], s45 offen offset:2112 lds
v_mfma_f32_16x16x32_bf16 v[200:203], a[228:231], v[136:139], v[200:203]
v_exp_f32 v222, v222
v_cvt_pk_bf16_f32 v62, v220, v221
v_mfma_f32_16x16x32_bf16 v[204:207], a[228:231], v[140:143], v[228:231]
ds_read_b128 a[252:255], v236 offset:51648
v_exp_f32 v223, v223
v_mfma_f32_16x16x32_bf16 v[204:207], a[224:227], v[132:135], v[204:207]
s_waitcnt lgkmcnt(4)
v_cvt_pk_bf16_f32 v63, v222, v223
v_mfma_f32_16x16x32_bf16 v[204:207], a[232:235], v[148:151], v[204:207]
ds_read_b64_tr_b16 a[224:225], v239 offset:33792
v_max3_f32 v242, v192, v193, v194
v_mfma_f32_16x16x32_bf16 v[204:207], a[236:239], v[156:159], v[204:207]
ds_read_b64_tr_b16 a[226:227], v239 offset:34304
v_max3_f32 v242, v242, v195, v196
v_mfma_f32_16x16x32_bf16 v[200:203], a[236:239], v[152:155], v[200:203]
ds_read_b64_tr_b16 a[228:229], v239 offset:33824
v_max3_f32 v242, v242, v197, v198
v_mfma_f32_16x16x32_bf16 v[200:203], a[232:235], v[144:147], v[200:203]
s_waitcnt lgkmcnt(5)
ds_read_b64_tr_b16 a[230:231], v239 offset:34336
buffer_load_dwordx4 v253, s[16:19], s45 offen offset:3168 lds
v_mfma_f32_16x16x32_bf16 v[200:203], a[240:243], v[160:163], v[200:203]
s_add_u32 m0, s28, 135168
ds_read_b64_tr_b16 a[232:233], v239 offset:33856
s_mov_b32 s29, 458752
v_mfma_f32_16x16x32_bf16 v[200:203], a[244:247], v[168:171], v[200:203]
ds_read_b64_tr_b16 a[234:235], v239 offset:34368
v_mfma_f32_16x16x32_bf16 v[204:207], a[244:247], v[172:175], v[204:207]
ds_read_b64_tr_b16 a[236:237], v239 offset:33888
v_mfma_f32_16x16x32_bf16 v[204:207], a[240:243], v[164:167], v[204:207]
s_waitcnt lgkmcnt(7)
ds_read_b64_tr_b16 a[238:239], v239 offset:34400
v_mfma_f32_16x16x32_bf16 v[204:207], a[248:251], v[180:183], v[204:207]
ds_read_b64_tr_b16 a[240:241], v239 offset:33920
v_mfma_f32_16x16x32_bf16 v[204:207], a[252:255], v[188:191], v[204:207]
ds_read_b64_tr_b16 a[242:243], v239 offset:34432
v_mfma_f32_16x16x32_bf16 v[200:203], a[252:255], v[184:187], v[200:203]
ds_read_b64_tr_b16 a[244:245], v239 offset:33952
buffer_load_dwordx4 v246, s[4:7], s29 offen offset:0 nt lds
v_mfma_f32_16x16x32_bf16 v[200:203], a[248:251], v[176:179], v[200:203]
s_waitcnt lgkmcnt(7)
ds_read_b64_tr_b16 a[246:247], v239 offset:34464
v_mfma_f32_16x16x32_bf16 a[0:3], a[224:227], v[96:99], a[0:3]
ds_read_b64_tr_b16 a[248:249], v239 offset:33984
v_mfma_f32_16x16x32_bf16 a[4:7], a[224:227], v[100:103], a[4:7]
ds_read_b64_tr_b16 a[250:251], v239 offset:34496
v_mfma_f32_16x16x32_bf16 a[8:11], a[228:231], v[96:99], a[8:11]
ds_read_b64_tr_b16 a[252:253], v239 offset:34016
v_mfma_f32_16x16x32_bf16 a[12:15], a[228:231], v[100:103], a[12:15]
s_waitcnt lgkmcnt(7)
ds_read_b64_tr_b16 a[254:255], v239 offset:34528
v_max3_f32 v242, v242, v199, v200
v_mfma_f32_16x16x32_bf16 a[16:19], a[232:235], v[96:99], a[16:19]
ds_read_b64_tr_b16 a[224:225], v239 offset:34048
v_max3_f32 v242, v242, v201, v202
v_mfma_f32_16x16x32_bf16 a[20:23], a[232:235], v[100:103], a[20:23]
ds_read_b64_tr_b16 a[226:227], v239 offset:34560
v_max3_f32 v242, v242, v203, v204
v_mfma_f32_16x16x32_bf16 a[24:27], a[236:239], v[96:99], a[24:27]
ds_read_b64_tr_b16 a[228:229], v239 offset:34080
v_max3_f32 v242, v242, v205, v206
v_mfma_f32_16x16x32_bf16 a[28:31], a[236:239], v[100:103], a[28:31]
s_waitcnt lgkmcnt(7)
ds_read_b64_tr_b16 a[230:231], v239 offset:34592
v_max_f32 v242, v242, v207
v_mfma_f32_16x16x32_bf16 a[32:35], a[240:243], v[96:99], a[32:35]
ds_read_b64_tr_b16 a[232:233], v239 offset:34112
v_cmp_lt_f32 vcc, s32, v242
v_mfma_f32_16x16x32_bf16 a[36:39], a[240:243], v[100:103], a[36:39]
s_cbranch_vccnz L_rsD8
L_rbD8:
ds_read_b64_tr_b16 a[234:235], v239 offset:34624
buffer_load_dwordx4 v247, s[4:7], s29 offen offset:1056 nt lds
v_mfma_f32_16x16x32_bf16 a[40:43], a[244:247], v[96:99], a[40:43]
ds_read_b64_tr_b16 a[236:237], v239 offset:34144
v_mfma_f32_16x16x32_bf16 a[44:47], a[244:247], v[100:103], a[44:47]
s_waitcnt lgkmcnt(7)
ds_read_b64_tr_b16 a[238:239], v239 offset:34656
v_mfma_f32_16x16x32_bf16 a[48:51], a[248:251], v[96:99], a[48:51]
ds_read_b64_tr_b16 a[240:241], v239 offset:34176
v_mfma_f32_16x16x32_bf16 a[52:55], a[248:251], v[100:103], a[52:55]
ds_read_b64_tr_b16 a[242:243], v239 offset:34688
buffer_load_dwordx4 v248, s[4:7], s29 offen offset:2112 nt lds
v_mfma_f32_16x16x32_bf16 a[56:59], a[252:255], v[96:99], a[56:59]
s_waitcnt lgkmcnt(6)
ds_read_b64_tr_b16 a[244:245], v239 offset:34208
v_mfma_f32_16x16x32_bf16 a[60:63], a[252:255], v[100:103], a[60:63]
s_waitcnt vmcnt(19)
ds_read_b64_tr_b16 a[246:247], v239 offset:34720
s_barrier
v_mfma_f32_16x16x32_bf16 a[64:67], a[224:227], v[96:99], a[64:67]
ds_read_b128 a[248:251], v237 offset:16896
v_mfma_f32_16x16x32_bf16 a[68:71], a[224:227], v[100:103], a[68:71]
v_exp_f32 v192, v192
v_mfma_f32_16x16x32_bf16 a[72:75], a[228:231], v[96:99], a[72:75]
ds_read_b128 a[252:255], v237 offset:16960
v_mfma_f32_16x16x32_bf16 a[76:79], a[228:231], v[100:103], a[76:79]
s_waitcnt lgkmcnt(6)
v_exp_f32 v193, v193
v_mfma_f32_16x16x32_bf16 a[80:83], a[232:235], v[96:99], a[80:83]
ds_read_b128 a[224:227], v237 offset:17024
buffer_load_dwordx4 v249, s[4:7], s29 offen offset:3168 nt lds
v_mfma_f32_16x16x32_bf16 a[84:87], a[232:235], v[100:103], a[84:87]
v_exp_f32 v194, v194
v_mfma_f32_16x16x32_bf16 a[88:91], a[236:239], v[96:99], a[88:91]
ds_read_b128 a[228:231], v237 offset:17088
v_cvt_pk_bf16_f32 v64, v192, v193
v_mfma_f32_16x16x32_bf16 a[92:95], a[236:239], v[100:103], a[92:95]
s_waitcnt lgkmcnt(4)
v_exp_f32 v195, v195
v_mfma_f32_16x16x32_bf16 a[96:99], a[240:243], v[96:99], a[96:99]
s_add_u32 m0, s28, 50688
ds_read_b128 a[232:235], v237 offset:17152
s_mov_b32 s45, 172032
v_mfma_f32_16x16x32_bf16 a[100:103], a[240:243], v[100:103], a[100:103]
v_exp_f32 v196, v196
v_mfma_f32_16x16x32_bf16 a[104:107], a[244:247], v[96:99], a[104:107]
ds_read_b128 a[236:239], v237 offset:17216
v_cvt_pk_bf16_f32 v65, v194, v195
v_mfma_f32_16x16x32_bf16 a[108:111], a[244:247], v[100:103], a[108:111]
s_waitcnt lgkmcnt(4)
v_exp_f32 v197, v197
v_mfma_f32_16x16x32_bf16 v[208:211], a[248:251], v[128:131], v[224:227]
ds_read_b128 a[240:243], v237 offset:17280
v_mfma_f32_16x16x32_bf16 v[208:211], a[252:255], v[136:139], v[208:211]
v_exp_f32 v198, v198
v_mfma_f32_16x16x32_bf16 v[212:215], a[252:255], v[140:143], v[228:231]
ds_read_b128 a[244:247], v237 offset:17344
v_cvt_pk_bf16_f32 v68, v196, v197
v_mfma_f32_16x16x32_bf16 v[212:215], a[248:251], v[132:135], v[212:215]
s_waitcnt lgkmcnt(4)
v_exp_f32 v199, v199
v_mfma_f32_16x16x32_bf16 v[212:215], a[224:227], v[148:151], v[212:215]
ds_read_b128 a[248:251], v237 offset:17408
buffer_load_dwordx4 v250, s[16:19], s45 offen offset:0 lds
v_mfma_f32_16x16x32_bf16 v[212:215], a[228:231], v[156:159], v[212:215]
v_exp_f32 v200, v200
v_mfma_f32_16x16x32_bf16 v[208:211], a[228:231], v[152:155], v[208:211]
ds_read_b128 a[252:255], v237 offset:17472
v_cvt_pk_bf16_f32 v69, v198, v199
v_mfma_f32_16x16x32_bf16 v[208:211], a[224:227], v[144:147], v[208:211]
s_waitcnt lgkmcnt(4)
v_exp_f32 v201, v201
v_mfma_f32_16x16x32_bf16 v[208:211], a[232:235], v[160:163], v[208:211]
ds_read_b128 a[224:227], v237 offset:17536
buffer_load_dwordx4 v251, s[16:19], s45 offen offset:1056 lds
v_mfma_f32_16x16x32_bf16 v[208:211], a[236:239], v[168:171], v[208:211]
v_exp_f32 v202, v202
v_mfma_f32_16x16x32_bf16 v[212:215], a[236:239], v[172:175], v[212:215]
ds_read_b128 a[228:231], v237 offset:17600
v_cvt_pk_bf16_f32 v66, v200, v201
v_mfma_f32_16x16x32_bf16 v[212:215], a[232:235], v[164:167], v[212:215]
s_waitcnt lgkmcnt(4)
v_exp_f32 v203, v203
v_mfma_f32_16x16x32_bf16 v[212:215], a[240:243], v[180:183], v[212:215]
ds_read_b128 a[232:235], v237 offset:17664
v_mfma_f32_16x16x32_bf16 v[212:215], a[244:247], v[188:191], v[212:215]
v_exp_f32 v204, v204
v_mfma_f32_16x16x32_bf16 v[208:211], a[244:247], v[184:187], v[208:211]
ds_read_b128 a[236:239], v237 offset:17728
v_cvt_pk_bf16_f32 v67, v202, v203
v_mfma_f32_16x16x32_bf16 v[208:211], a[240:243], v[176:179], v[208:211]
s_waitcnt lgkmcnt(4)
v_exp_f32 v205, v205
v_mfma_f32_16x16x32_bf16 v[216:219], a[248:251], v[128:131], v[224:227]
ds_read_b128 a[240:243], v237 offset:17792
buffer_load_dwordx4 v252, s[16:19], s45 offen offset:2112 lds
v_mfma_f32_16x16x32_bf16 v[216:219], a[252:255], v[136:139], v[216:219]
v_exp_f32 v206, v206
v_cvt_pk_bf16_f32 v70, v204, v205
v_mfma_f32_16x16x32_bf16 v[220:223], a[252:255], v[140:143], v[228:231]
ds_read_b128 a[244:247], v237 offset:17856
v_exp_f32 v207, v207
v_mfma_f32_16x16x32_bf16 v[220:223], a[248:251], v[132:135], v[220:223]
s_waitcnt lgkmcnt(4)
v_cvt_pk_bf16_f32 v71, v206, v207
v_mfma_f32_16x16x32_bf16 v[220:223], a[224:227], v[148:151], v[220:223]
ds_read_b64_tr_b16 a[248:249], v240 offset:0
v_max3_f32 v242, v208, v209, v210
v_mfma_f32_16x16x32_bf16 v[220:223], a[228:231], v[156:159], v[220:223]
ds_read_b64_tr_b16 a[250:251], v240 offset:512
v_max3_f32 v242, v242, v211, v212
v_mfma_f32_16x16x32_bf16 v[216:219], a[228:231], v[152:155], v[216:219]
ds_read_b64_tr_b16 a[252:253], v240 offset:32
v_max3_f32 v242, v242, v213, v214
v_mfma_f32_16x16x32_bf16 v[216:219], a[224:227], v[144:147], v[216:219]
s_waitcnt lgkmcnt(5)
ds_read_b64_tr_b16 a[254:255], v240 offset:544
buffer_load_dwordx4 v253, s[16:19], s45 offen offset:3168 lds
v_mfma_f32_16x16x32_bf16 v[216:219], a[232:235], v[160:163], v[216:219]
s_add_u32 m0, s28, 33792
ds_read_b64_tr_b16 a[224:225], v240 offset:64
s_mov_b32 s29, 475136
v_mfma_f32_16x16x32_bf16 v[216:219], a[236:239], v[168:171], v[216:219]
ds_read_b64_tr_b16 a[226:227], v240 offset:576
v_mfma_f32_16x16x32_bf16 v[220:223], a[236:239], v[172:175], v[220:223]
ds_read_b64_tr_b16 a[228:229], v240 offset:96
v_mfma_f32_16x16x32_bf16 v[220:223], a[232:235], v[164:167], v[220:223]
s_waitcnt lgkmcnt(7)
ds_read_b64_tr_b16 a[230:231], v240 offset:608
v_mfma_f32_16x16x32_bf16 v[220:223], a[240:243], v[180:183], v[220:223]
ds_read_b64_tr_b16 a[232:233], v240 offset:128
v_mfma_f32_16x16x32_bf16 v[220:223], a[244:247], v[188:191], v[220:223]
ds_read_b64_tr_b16 a[234:235], v240 offset:640
v_mfma_f32_16x16x32_bf16 v[216:219], a[244:247], v[184:187], v[216:219]
ds_read_b64_tr_b16 a[236:237], v240 offset:160
buffer_load_dwordx4 v246, s[4:7], s29 offen offset:0 nt lds
v_mfma_f32_16x16x32_bf16 v[216:219], a[240:243], v[176:179], v[216:219]
s_waitcnt lgkmcnt(7)
ds_read_b64_tr_b16 a[238:239], v240 offset:672
v_mfma_f32_16x16x32_bf16 a[112:115], a[248:251], v[96:99], a[112:115]
ds_read_b64_tr_b16 a[240:241], v240 offset:192
v_mfma_f32_16x16x32_bf16 a[116:119], a[248:251], v[100:103], a[116:119]
ds_read_b64_tr_b16 a[242:243], v240 offset:704
v_mfma_f32_16x16x32_bf16 a[120:123], a[252:255], v[96:99], a[120:123]
ds_read_b64_tr_b16 a[244:245], v240 offset:224
v_mfma_f32_16x16x32_bf16 a[124:127], a[252:255], v[100:103], a[124:127]
s_waitcnt lgkmcnt(7)
ds_read_b64_tr_b16 a[246:247], v240 offset:736
v_max3_f32 v242, v242, v215, v216
v_mfma_f32_16x16x32_bf16 a[128:131], a[224:227], v[96:99], a[128:131]
ds_read_b64_tr_b16 a[248:249], v240 offset:256
v_max3_f32 v242, v242, v217, v218
v_mfma_f32_16x16x32_bf16 a[132:135], a[224:227], v[100:103], a[132:135]
ds_read_b64_tr_b16 a[250:251], v240 offset:768
v_max3_f32 v242, v242, v219, v220
v_mfma_f32_16x16x32_bf16 a[136:139], a[228:231], v[96:99], a[136:139]
ds_read_b64_tr_b16 a[252:253], v240 offset:288
v_max3_f32 v242, v242, v221, v222
v_mfma_f32_16x16x32_bf16 a[140:143], a[228:231], v[100:103], a[140:143]
s_waitcnt lgkmcnt(7)
ds_read_b64_tr_b16 a[254:255], v240 offset:800
v_max_f32 v242, v242, v223
v_mfma_f32_16x16x32_bf16 a[144:147], a[232:235], v[96:99], a[144:147]
ds_read_b64_tr_b16 a[224:225], v240 offset:320
v_cmp_lt_f32 vcc, s32, v242
v_mfma_f32_16x16x32_bf16 a[148:151], a[232:235], v[100:103], a[148:151]
s_cbranch_vccnz L_rsD9
L_rbD9:
ds_read_b64_tr_b16 a[226:227], v240 offset:832
buffer_load_dwordx4 v247, s[4:7], s29 offen offset:1056 nt lds
v_mfma_f32_16x16x32_bf16 a[152:155], a[236:239], v[96:99], a[152:155]
ds_read_b64_tr_b16 a[228:229], v240 offset:352
v_mfma_f32_16x16x32_bf16 a[156:159], a[236:239], v[100:103], a[156:159]
s_waitcnt lgkmcnt(7)
ds_read_b64_tr_b16 a[230:231], v240 offset:864
v_mfma_f32_16x16x32_bf16 a[160:163], a[240:243], v[96:99], a[160:163]
ds_read_b64_tr_b16 a[232:233], v240 offset:384
v_mfma_f32_16x16x32_bf16 a[164:167], a[240:243], v[100:103], a[164:167]
ds_read_b64_tr_b16 a[234:235], v240 offset:896
buffer_load_dwordx4 v248, s[4:7], s29 offen offset:2112 nt lds
v_mfma_f32_16x16x32_bf16 a[168:171], a[244:247], v[96:99], a[168:171]
s_waitcnt lgkmcnt(6)
ds_read_b64_tr_b16 a[236:237], v240 offset:416
v_mfma_f32_16x16x32_bf16 a[172:175], a[244:247], v[100:103], a[172:175]
s_waitcnt vmcnt(19)
ds_read_b64_tr_b16 a[238:239], v240 offset:928
s_barrier
v_mfma_f32_16x16x32_bf16 a[176:179], a[248:251], v[96:99], a[176:179]
ds_read_b128 a[240:243], v237 offset:33792
v_mfma_f32_16x16x32_bf16 a[180:183], a[248:251], v[100:103], a[180:183]
v_exp_f32 v208, v208
v_mfma_f32_16x16x32_bf16 a[184:187], a[252:255], v[96:99], a[184:187]
ds_read_b128 a[244:247], v237 offset:33856
v_mfma_f32_16x16x32_bf16 a[188:191], a[252:255], v[100:103], a[188:191]
s_waitcnt lgkmcnt(6)
v_exp_f32 v209, v209
v_mfma_f32_16x16x32_bf16 a[192:195], a[224:227], v[96:99], a[192:195]
ds_read_b128 a[248:251], v237 offset:33920
buffer_load_dwordx4 v249, s[4:7], s29 offen offset:3168 nt lds
v_mfma_f32_16x16x32_bf16 a[196:199], a[224:227], v[100:103], a[196:199]
v_exp_f32 v210, v210
v_mfma_f32_16x16x32_bf16 a[200:203], a[228:231], v[96:99], a[200:203]
ds_read_b128 a[252:255], v237 offset:33984
v_cvt_pk_bf16_f32 v72, v208, v209
v_mfma_f32_16x16x32_bf16 a[204:207], a[228:231], v[100:103], a[204:207]
s_waitcnt lgkmcnt(4)
v_exp_f32 v211, v211
v_mfma_f32_16x16x32_bf16 a[208:211], a[232:235], v[96:99], a[208:211]
s_add_u32 m0, s28, 84480
ds_read_b128 a[224:227], v237 offset:34048
s_mov_b32 s45, 172480
v_mfma_f32_16x16x32_bf16 a[212:215], a[232:235], v[100:103], a[212:215]
v_exp_f32 v212, v212
v_mfma_f32_16x16x32_bf16 a[216:219], a[236:239], v[96:99], a[216:219]
ds_read_b128 a[228:231], v237 offset:34112
v_cvt_pk_bf16_f32 v73, v210, v211
v_mfma_f32_16x16x32_bf16 a[220:223], a[236:239], v[100:103], a[220:223]
s_waitcnt lgkmcnt(4)
v_exp_f32 v213, v213
v_mfma_f32_16x16x32_bf16 v[192:195], a[240:243], v[128:131], v[224:227]
ds_read_b128 a[232:235], v237 offset:34176
v_mfma_f32_16x16x32_bf16 v[192:195], a[244:247], v[136:139], v[192:195]
v_exp_f32 v214, v214
v_mfma_f32_16x16x32_bf16 v[196:199], a[244:247], v[140:143], v[228:231]
ds_read_b128 a[236:239], v237 offset:34240
v_cvt_pk_bf16_f32 v76, v212, v213
v_mfma_f32_16x16x32_bf16 v[196:199], a[240:243], v[132:135], v[196:199]
s_waitcnt lgkmcnt(4)
v_exp_f32 v215, v215
v_mfma_f32_16x16x32_bf16 v[196:199], a[248:251], v[148:151], v[196:199]
ds_read_b128 a[240:243], v237 offset:34304
buffer_load_dwordx4 v250, s[16:19], s45 offen offset:0 lds
v_mfma_f32_16x16x32_bf16 v[196:199], a[252:255], v[156:159], v[196:199]
v_exp_f32 v216, v216
v_mfma_f32_16x16x32_bf16 v[192:195], a[252:255], v[152:155], v[192:195]
ds_read_b128 a[244:247], v237 offset:34368
v_cvt_pk_bf16_f32 v77, v214, v215
v_mfma_f32_16x16x32_bf16 v[192:195], a[248:251], v[144:147], v[192:195]
s_waitcnt lgkmcnt(4)
v_exp_f32 v217, v217
v_mfma_f32_16x16x32_bf16 v[192:195], a[224:227], v[160:163], v[192:195]
ds_read_b128 a[248:251], v237 offset:34432
buffer_load_dwordx4 v251, s[16:19], s45 offen offset:1056 lds
v_mfma_f32_16x16x32_bf16 v[192:195], a[228:231], v[168:171], v[192:195]
v_exp_f32 v218, v218
v_mfma_f32_16x16x32_bf16 v[196:199], a[228:231], v[172:175], v[196:199]
ds_read_b128 a[252:255], v237 offset:34496
v_cvt_pk_bf16_f32 v74, v216, v217
v_mfma_f32_16x16x32_bf16 v[196:199], a[224:227], v[164:167], v[196:199]
s_waitcnt lgkmcnt(4)
v_exp_f32 v219, v219
v_mfma_f32_16x16x32_bf16 v[196:199], a[232:235], v[180:183], v[196:199]
ds_read_b128 a[224:227], v237 offset:34560
v_mfma_f32_16x16x32_bf16 v[196:199], a[236:239], v[188:191], v[196:199]
v_exp_f32 v220, v220
v_mfma_f32_16x16x32_bf16 v[192:195], a[236:239], v[184:187], v[192:195]
ds_read_b128 a[228:231], v237 offset:34624
v_cvt_pk_bf16_f32 v75, v218, v219
v_mfma_f32_16x16x32_bf16 v[192:195], a[232:235], v[176:179], v[192:195]
s_waitcnt lgkmcnt(4)
v_exp_f32 v221, v221
v_mfma_f32_16x16x32_bf16 v[200:203], a[240:243], v[128:131], v[224:227]
ds_read_b128 a[232:235], v237 offset:34688
buffer_load_dwordx4 v252, s[16:19], s45 offen offset:2112 lds
v_mfma_f32_16x16x32_bf16 v[200:203], a[244:247], v[136:139], v[200:203]
v_exp_f32 v222, v222
v_cvt_pk_bf16_f32 v78, v220, v221
v_mfma_f32_16x16x32_bf16 v[204:207], a[244:247], v[140:143], v[228:231]
ds_read_b128 a[236:239], v237 offset:34752
v_exp_f32 v223, v223
v_mfma_f32_16x16x32_bf16 v[204:207], a[240:243], v[132:135], v[204:207]
s_waitcnt lgkmcnt(4)
v_cvt_pk_bf16_f32 v79, v222, v223
v_mfma_f32_16x16x32_bf16 v[204:207], a[248:251], v[148:151], v[204:207]
ds_read_b64_tr_b16 a[240:241], v240 offset:50688
v_max3_f32 v242, v192, v193, v194
v_mfma_f32_16x16x32_bf16 v[204:207], a[252:255], v[156:159], v[204:207]
ds_read_b64_tr_b16 a[242:243], v240 offset:51200
v_max3_f32 v242, v242, v195, v196
v_mfma_f32_16x16x32_bf16 v[200:203], a[252:255], v[152:155], v[200:203]
ds_read_b64_tr_b16 a[244:245], v240 offset:50720
v_max3_f32 v242, v242, v197, v198
v_mfma_f32_16x16x32_bf16 v[200:203], a[248:251], v[144:147], v[200:203]
s_waitcnt lgkmcnt(5)
ds_read_b64_tr_b16 a[246:247], v240 offset:51232
buffer_load_dwordx4 v253, s[16:19], s45 offen offset:3168 lds
v_mfma_f32_16x16x32_bf16 v[200:203], a[224:227], v[160:163], v[200:203]
s_add_u32 m0, s28, 67584
ds_read_b64_tr_b16 a[248:249], v240 offset:50752
s_mov_b32 s29, 491520
v_mfma_f32_16x16x32_bf16 v[200:203], a[228:231], v[168:171], v[200:203]
ds_read_b64_tr_b16 a[250:251], v240 offset:51264
v_mfma_f32_16x16x32_bf16 v[204:207], a[228:231], v[172:175], v[204:207]
ds_read_b64_tr_b16 a[252:253], v240 offset:50784
v_mfma_f32_16x16x32_bf16 v[204:207], a[224:227], v[164:167], v[204:207]
s_waitcnt lgkmcnt(7)
ds_read_b64_tr_b16 a[254:255], v240 offset:51296
v_mfma_f32_16x16x32_bf16 v[204:207], a[232:235], v[180:183], v[204:207]
ds_read_b64_tr_b16 a[224:225], v240 offset:50816
v_mfma_f32_16x16x32_bf16 v[204:207], a[236:239], v[188:191], v[204:207]
ds_read_b64_tr_b16 a[226:227], v240 offset:51328
v_mfma_f32_16x16x32_bf16 v[200:203], a[236:239], v[184:187], v[200:203]
ds_read_b64_tr_b16 a[228:229], v240 offset:50848
buffer_load_dwordx4 v246, s[4:7], s29 offen offset:0 nt lds
v_mfma_f32_16x16x32_bf16 v[200:203], a[232:235], v[176:179], v[200:203]
s_waitcnt lgkmcnt(7)
ds_read_b64_tr_b16 a[230:231], v240 offset:51360
v_mfma_f32_16x16x32_bf16 a[0:3], a[240:243], v[104:107], a[0:3]
ds_read_b64_tr_b16 a[232:233], v240 offset:50880
v_mfma_f32_16x16x32_bf16 a[4:7], a[240:243], v[108:111], a[4:7]
ds_read_b64_tr_b16 a[234:235], v240 offset:51392
v_mfma_f32_16x16x32_bf16 a[8:11], a[244:247], v[104:107], a[8:11]
ds_read_b64_tr_b16 a[236:237], v240 offset:50912
v_mfma_f32_16x16x32_bf16 a[12:15], a[244:247], v[108:111], a[12:15]
s_waitcnt lgkmcnt(7)
ds_read_b64_tr_b16 a[238:239], v240 offset:51424
v_max3_f32 v242, v242, v199, v200
v_mfma_f32_16x16x32_bf16 a[16:19], a[248:251], v[104:107], a[16:19]
ds_read_b64_tr_b16 a[240:241], v240 offset:50944
v_max3_f32 v242, v242, v201, v202
v_mfma_f32_16x16x32_bf16 a[20:23], a[248:251], v[108:111], a[20:23]
ds_read_b64_tr_b16 a[242:243], v240 offset:51456
v_max3_f32 v242, v242, v203, v204
v_mfma_f32_16x16x32_bf16 a[24:27], a[252:255], v[104:107], a[24:27]
ds_read_b64_tr_b16 a[244:245], v240 offset:50976
v_max3_f32 v242, v242, v205, v206
v_mfma_f32_16x16x32_bf16 a[28:31], a[252:255], v[108:111], a[28:31]
s_waitcnt lgkmcnt(7)
ds_read_b64_tr_b16 a[246:247], v240 offset:51488
v_max_f32 v242, v242, v207
v_mfma_f32_16x16x32_bf16 a[32:35], a[224:227], v[104:107], a[32:35]
ds_read_b64_tr_b16 a[248:249], v240 offset:51008
v_cmp_lt_f32 vcc, s32, v242
v_mfma_f32_16x16x32_bf16 a[36:39], a[224:227], v[108:111], a[36:39]
s_cbranch_vccnz L_rsD10
L_rbD10:
ds_read_b64_tr_b16 a[250:251], v240 offset:51520
buffer_load_dwordx4 v247, s[4:7], s29 offen offset:1056 nt lds
v_mfma_f32_16x16x32_bf16 a[40:43], a[228:231], v[104:107], a[40:43]
ds_read_b64_tr_b16 a[252:253], v240 offset:51040
v_mfma_f32_16x16x32_bf16 a[44:47], a[228:231], v[108:111], a[44:47]
s_waitcnt lgkmcnt(7)
ds_read_b64_tr_b16 a[254:255], v240 offset:51552
v_mfma_f32_16x16x32_bf16 a[48:51], a[232:235], v[104:107], a[48:51]
ds_read_b64_tr_b16 a[224:225], v240 offset:51072
v_mfma_f32_16x16x32_bf16 a[52:55], a[232:235], v[108:111], a[52:55]
ds_read_b64_tr_b16 a[226:227], v240 offset:51584
buffer_load_dwordx4 v248, s[4:7], s29 offen offset:2112 nt lds
v_mfma_f32_16x16x32_bf16 a[56:59], a[236:239], v[104:107], a[56:59]
s_waitcnt lgkmcnt(6)
ds_read_b64_tr_b16 a[228:229], v240 offset:51104
v_mfma_f32_16x16x32_bf16 a[60:63], a[236:239], v[108:111], a[60:63]
s_waitcnt vmcnt(19)
ds_read_b64_tr_b16 a[230:231], v240 offset:51616
s_barrier
v_mfma_f32_16x16x32_bf16 a[64:67], a[240:243], v[104:107], a[64:67]
ds_read_b128 a[232:235], v236 offset:16896
v_mfma_f32_16x16x32_bf16 a[68:71], a[240:243], v[108:111], a[68:71]
v_exp_f32 v192, v192
v_mfma_f32_16x16x32_bf16 a[72:75], a[244:247], v[104:107], a[72:75]
ds_read_b128 a[236:239], v236 offset:16960
v_mfma_f32_16x16x32_bf16 a[76:79], a[244:247], v[108:111], a[76:79]
s_waitcnt lgkmcnt(6)
v_exp_f32 v193, v193
v_mfma_f32_16x16x32_bf16 a[80:83], a[248:251], v[104:107], a[80:83]
ds_read_b128 a[240:243], v236 offset:17024
buffer_load_dwordx4 v249, s[4:7], s29 offen offset:3168 nt lds
v_mfma_f32_16x16x32_bf16 a[84:87], a[248:251], v[108:111], a[84:87]
v_exp_f32 v194, v194
v_mfma_f32_16x16x32_bf16 a[88:91], a[252:255], v[104:107], a[88:91]
ds_read_b128 a[244:247], v236 offset:17088
v_cvt_pk_bf16_f32 v80, v192, v193
v_mfma_f32_16x16x32_bf16 a[92:95], a[252:255], v[108:111], a[92:95]
s_waitcnt lgkmcnt(4)
v_exp_f32 v195, v195
v_mfma_f32_16x16x32_bf16 a[96:99], a[224:227], v[104:107], a[96:99]
s_add_u32 m0, s28, 101376
ds_read_b128 a[248:251], v236 offset:17152
s_mov_b32 s45, 200704
v_mfma_f32_16x16x32_bf16 a[100:103], a[224:227], v[108:111], a[100:103]
v_exp_f32 v196, v196
v_mfma_f32_16x16x32_bf16 a[104:107], a[228:231], v[104:107], a[104:107]
ds_read_b128 a[252:255], v236 offset:17216
v_cvt_pk_bf16_f32 v81, v194, v195
v_mfma_f32_16x16x32_bf16 a[108:111], a[228:231], v[108:111], a[108:111]
s_waitcnt lgkmcnt(4)
v_exp_f32 v197, v197
v_mfma_f32_16x16x32_bf16 v[208:211], a[232:235], v[128:131], v[224:227]
ds_read_b128 a[224:227], v236 offset:17280
v_mfma_f32_16x16x32_bf16 v[208:211], a[236:239], v[136:139], v[208:211]
v_exp_f32 v198, v198
v_mfma_f32_16x16x32_bf16 v[212:215], a[236:239], v[140:143], v[228:231]
ds_read_b128 a[228:231], v236 offset:17344
v_cvt_pk_bf16_f32 v84, v196, v197
v_mfma_f32_16x16x32_bf16 v[212:215], a[232:235], v[132:135], v[212:215]
s_waitcnt lgkmcnt(4)
v_exp_f32 v199, v199
v_mfma_f32_16x16x32_bf16 v[212:215], a[240:243], v[148:151], v[212:215]
ds_read_b128 a[232:235], v236 offset:17408
buffer_load_dwordx4 v250, s[16:19], s45 offen offset:0 lds
v_mfma_f32_16x16x32_bf16 v[212:215], a[244:247], v[156:159], v[212:215]
v_exp_f32 v200, v200
v_mfma_f32_16x16x32_bf16 v[208:211], a[244:247], v[152:155], v[208:211]
ds_read_b128 a[236:239], v236 offset:17472
v_cvt_pk_bf16_f32 v85, v198, v199
v_mfma_f32_16x16x32_bf16 v[208:211], a[240:243], v[144:147], v[208:211]
s_waitcnt lgkmcnt(4)
v_exp_f32 v201, v201
v_mfma_f32_16x16x32_bf16 v[208:211], a[248:251], v[160:163], v[208:211]
ds_read_b128 a[240:243], v236 offset:17536
buffer_load_dwordx4 v251, s[16:19], s45 offen offset:1056 lds
v_mfma_f32_16x16x32_bf16 v[208:211], a[252:255], v[168:171], v[208:211]
v_exp_f32 v202, v202
v_mfma_f32_16x16x32_bf16 v[212:215], a[252:255], v[172:175], v[212:215]
ds_read_b128 a[244:247], v236 offset:17600
v_cvt_pk_bf16_f32 v82, v200, v201
v_mfma_f32_16x16x32_bf16 v[212:215], a[248:251], v[164:167], v[212:215]
s_waitcnt lgkmcnt(4)
v_exp_f32 v203, v203
v_mfma_f32_16x16x32_bf16 v[212:215], a[224:227], v[180:183], v[212:215]
ds_read_b128 a[248:251], v236 offset:17664
v_mfma_f32_16x16x32_bf16 v[212:215], a[228:231], v[188:191], v[212:215]
v_exp_f32 v204, v204
v_mfma_f32_16x16x32_bf16 v[208:211], a[228:231], v[184:187], v[208:211]
ds_read_b128 a[252:255], v236 offset:17728
v_cvt_pk_bf16_f32 v83, v202, v203
v_mfma_f32_16x16x32_bf16 v[208:211], a[224:227], v[176:179], v[208:211]
s_waitcnt lgkmcnt(4)
v_exp_f32 v205, v205
v_mfma_f32_16x16x32_bf16 v[216:219], a[232:235], v[128:131], v[224:227]
ds_read_b128 a[224:227], v236 offset:17792
buffer_load_dwordx4 v252, s[16:19], s45 offen offset:2112 lds
v_mfma_f32_16x16x32_bf16 v[216:219], a[236:239], v[136:139], v[216:219]
v_exp_f32 v206, v206
v_cvt_pk_bf16_f32 v86, v204, v205
v_mfma_f32_16x16x32_bf16 v[220:223], a[236:239], v[140:143], v[228:231]
ds_read_b128 a[228:231], v236 offset:17856
v_exp_f32 v207, v207
v_mfma_f32_16x16x32_bf16 v[220:223], a[232:235], v[132:135], v[220:223]
s_waitcnt lgkmcnt(4)
v_cvt_pk_bf16_f32 v87, v206, v207
v_mfma_f32_16x16x32_bf16 v[220:223], a[240:243], v[148:151], v[220:223]
ds_read_b64_tr_b16 a[232:233], v239 offset:0
v_max3_f32 v242, v208, v209, v210
v_mfma_f32_16x16x32_bf16 v[220:223], a[244:247], v[156:159], v[220:223]
ds_read_b64_tr_b16 a[234:235], v239 offset:512
v_max3_f32 v242, v242, v211, v212
v_mfma_f32_16x16x32_bf16 v[216:219], a[244:247], v[152:155], v[216:219]
ds_read_b64_tr_b16 a[236:237], v239 offset:32
v_max3_f32 v242, v242, v213, v214
v_mfma_f32_16x16x32_bf16 v[216:219], a[240:243], v[144:147], v[216:219]
s_waitcnt lgkmcnt(5)
ds_read_b64_tr_b16 a[238:239], v239 offset:544
buffer_load_dwordx4 v253, s[16:19], s45 offen offset:3168 lds
v_mfma_f32_16x16x32_bf16 v[216:219], a[248:251], v[160:163], v[216:219]
s_add_u32 m0, s28, 118272
ds_read_b64_tr_b16 a[240:241], v239 offset:64
s_mov_b32 s29, 507904
v_mfma_f32_16x16x32_bf16 v[216:219], a[252:255], v[168:171], v[216:219]
ds_read_b64_tr_b16 a[242:243], v239 offset:576
v_mfma_f32_16x16x32_bf16 v[220:223], a[252:255], v[172:175], v[220:223]
ds_read_b64_tr_b16 a[244:245], v239 offset:96
v_mfma_f32_16x16x32_bf16 v[220:223], a[248:251], v[164:167], v[220:223]
s_waitcnt lgkmcnt(7)
ds_read_b64_tr_b16 a[246:247], v239 offset:608
v_mfma_f32_16x16x32_bf16 v[220:223], a[224:227], v[180:183], v[220:223]
ds_read_b64_tr_b16 a[248:249], v239 offset:128
v_mfma_f32_16x16x32_bf16 v[220:223], a[228:231], v[188:191], v[220:223]
ds_read_b64_tr_b16 a[250:251], v239 offset:640
v_mfma_f32_16x16x32_bf16 v[216:219], a[228:231], v[184:187], v[216:219]
ds_read_b64_tr_b16 a[252:253], v239 offset:160
buffer_load_dwordx4 v246, s[4:7], s29 offen offset:0 nt lds
v_mfma_f32_16x16x32_bf16 v[216:219], a[224:227], v[176:179], v[216:219]
s_waitcnt lgkmcnt(7)
ds_read_b64_tr_b16 a[254:255], v239 offset:672
v_mfma_f32_16x16x32_bf16 a[112:115], a[232:235], v[104:107], a[112:115]
ds_read_b64_tr_b16 a[224:225], v239 offset:192
v_mfma_f32_16x16x32_bf16 a[116:119], a[232:235], v[108:111], a[116:119]
ds_read_b64_tr_b16 a[226:227], v239 offset:704
v_mfma_f32_16x16x32_bf16 a[120:123], a[236:239], v[104:107], a[120:123]
ds_read_b64_tr_b16 a[228:229], v239 offset:224
v_mfma_f32_16x16x32_bf16 a[124:127], a[236:239], v[108:111], a[124:127]
s_waitcnt lgkmcnt(7)
ds_read_b64_tr_b16 a[230:231], v239 offset:736
v_max3_f32 v242, v242, v215, v216
v_mfma_f32_16x16x32_bf16 a[128:131], a[240:243], v[104:107], a[128:131]
ds_read_b64_tr_b16 a[232:233], v239 offset:256
v_max3_f32 v242, v242, v217, v218
v_mfma_f32_16x16x32_bf16 a[132:135], a[240:243], v[108:111], a[132:135]
ds_read_b64_tr_b16 a[234:235], v239 offset:768
v_max3_f32 v242, v242, v219, v220
v_mfma_f32_16x16x32_bf16 a[136:139], a[244:247], v[104:107], a[136:139]
ds_read_b64_tr_b16 a[236:237], v239 offset:288
v_max3_f32 v242, v242, v221, v222
v_mfma_f32_16x16x32_bf16 a[140:143], a[244:247], v[108:111], a[140:143]
s_waitcnt lgkmcnt(7)
ds_read_b64_tr_b16 a[238:239], v239 offset:800
v_max_f32 v242, v242, v223
v_mfma_f32_16x16x32_bf16 a[144:147], a[248:251], v[104:107], a[144:147]
ds_read_b64_tr_b16 a[240:241], v239 offset:320
v_cmp_lt_f32 vcc, s32, v242
v_mfma_f32_16x16x32_bf16 a[148:151], a[248:251], v[108:111], a[148:151]
s_cbranch_vccnz L_rsD11
L_rbD11:
ds_read_b64_tr_b16 a[242:243], v239 offset:832
buffer_load_dwordx4 v247, s[4:7], s29 offen offset:1056 nt lds
v_mfma_f32_16x16x32_bf16 a[152:155], a[252:255], v[104:107], a[152:155]
ds_read_b64_tr_b16 a[244:245], v239 offset:352
v_mfma_f32_16x16x32_bf16 a[156:159], a[252:255], v[108:111], a[156:159]
s_waitcnt lgkmcnt(7)
ds_read_b64_tr_b16 a[246:247], v239 offset:864
v_mfma_f32_16x16x32_bf16 a[160:163], a[224:227], v[104:107], a[160:163]
ds_read_b64_tr_b16 a[248:249], v239 offset:384
v_mfma_f32_16x16x32_bf16 a[164:167], a[224:227], v[108:111], a[164:167]
ds_read_b64_tr_b16 a[250:251], v239 offset:896
buffer_load_dwordx4 v248, s[4:7], s29 offen offset:2112 nt lds
v_mfma_f32_16x16x32_bf16 a[168:171], a[228:231], v[104:107], a[168:171]
s_waitcnt lgkmcnt(6)
ds_read_b64_tr_b16 a[252:253], v239 offset:416
v_mfma_f32_16x16x32_bf16 a[172:175], a[228:231], v[108:111], a[172:175]
s_waitcnt vmcnt(19)
ds_read_b64_tr_b16 a[254:255], v239 offset:928
s_barrier
v_mfma_f32_16x16x32_bf16 a[176:179], a[232:235], v[104:107], a[176:179]
ds_read_b128 a[224:227], v238 offset:0
v_mfma_f32_16x16x32_bf16 a[180:183], a[232:235], v[108:111], a[180:183]
v_exp_f32 v208, v208
v_mfma_f32_16x16x32_bf16 a[184:187], a[236:239], v[104:107], a[184:187]
ds_read_b128 a[228:231], v238 offset:64
v_mfma_f32_16x16x32_bf16 a[188:191], a[236:239], v[108:111], a[188:191]
s_waitcnt lgkmcnt(6)
v_exp_f32 v209, v209
v_mfma_f32_16x16x32_bf16 a[192:195], a[240:243], v[104:107], a[192:195]
ds_read_b128 a[232:235], v238 offset:128
buffer_load_dwordx4 v249, s[4:7], s29 offen offset:3168 nt lds
v_mfma_f32_16x16x32_bf16 a[196:199], a[240:243], v[108:111], a[196:199]
v_exp_f32 v210, v210
v_mfma_f32_16x16x32_bf16 a[200:203], a[244:247], v[104:107], a[200:203]
ds_read_b128 a[236:239], v238 offset:192
v_cvt_pk_bf16_f32 v88, v208, v209
v_mfma_f32_16x16x32_bf16 a[204:207], a[244:247], v[108:111], a[204:207]
s_waitcnt lgkmcnt(4)
v_exp_f32 v211, v211
v_mfma_f32_16x16x32_bf16 a[208:211], a[248:251], v[104:107], a[208:211]
s_add_u32 m0, s28, 16896
ds_read_b128 a[240:243], v238 offset:256
s_mov_b32 s45, 201152
v_mfma_f32_16x16x32_bf16 a[212:215], a[248:251], v[108:111], a[212:215]
v_exp_f32 v212, v212
v_mfma_f32_16x16x32_bf16 a[216:219], a[252:255], v[104:107], a[216:219]
ds_read_b128 a[244:247], v238 offset:320
v_cvt_pk_bf16_f32 v89, v210, v211
v_mfma_f32_16x16x32_bf16 a[220:223], a[252:255], v[108:111], a[220:223]
s_waitcnt lgkmcnt(4)
v_exp_f32 v213, v213
v_mfma_f32_16x16x32_bf16 v[192:195], a[224:227], v[128:131], v[224:227]
ds_read_b128 a[248:251], v238 offset:384
v_mfma_f32_16x16x32_bf16 v[192:195], a[228:231], v[136:139], v[192:195]
v_exp_f32 v214, v214
v_mfma_f32_16x16x32_bf16 v[196:199], a[228:231], v[140:143], v[228:231]
ds_read_b128 a[252:255], v238 offset:448
v_cvt_pk_bf16_f32 v92, v212, v213
v_mfma_f32_16x16x32_bf16 v[196:199], a[224:227], v[132:135], v[196:199]
s_waitcnt lgkmcnt(4)
v_exp_f32 v215, v215
v_mfma_f32_16x16x32_bf16 v[196:199], a[232:235], v[148:151], v[196:199]
ds_read_b128 a[224:227], v238 offset:512
buffer_load_dwordx4 v250, s[16:19], s45 offen offset:0 lds
v_mfma_f32_16x16x32_bf16 v[196:199], a[236:239], v[156:159], v[196:199]
v_exp_f32 v216, v216
v_mfma_f32_16x16x32_bf16 v[192:195], a[236:239], v[152:155], v[192:195]
ds_read_b128 a[228:231], v238 offset:576
v_cvt_pk_bf16_f32 v93, v214, v215
v_mfma_f32_16x16x32_bf16 v[192:195], a[232:235], v[144:147], v[192:195]
s_waitcnt lgkmcnt(4)
v_exp_f32 v217, v217
v_mfma_f32_16x16x32_bf16 v[192:195], a[240:243], v[160:163], v[192:195]
ds_read_b128 a[232:235], v238 offset:640
buffer_load_dwordx4 v251, s[16:19], s45 offen offset:1056 lds
v_mfma_f32_16x16x32_bf16 v[192:195], a[244:247], v[168:171], v[192:195]
v_exp_f32 v218, v218
v_mfma_f32_16x16x32_bf16 v[196:199], a[244:247], v[172:175], v[196:199]
ds_read_b128 a[236:239], v238 offset:704
v_cvt_pk_bf16_f32 v90, v216, v217
v_mfma_f32_16x16x32_bf16 v[196:199], a[240:243], v[164:167], v[196:199]
s_waitcnt lgkmcnt(4)
v_exp_f32 v219, v219
v_mfma_f32_16x16x32_bf16 v[196:199], a[248:251], v[180:183], v[196:199]
ds_read_b128 a[240:243], v238 offset:768
v_mfma_f32_16x16x32_bf16 v[196:199], a[252:255], v[188:191], v[196:199]
v_exp_f32 v220, v220
v_mfma_f32_16x16x32_bf16 v[192:195], a[252:255], v[184:187], v[192:195]
ds_read_b128 a[244:247], v238 offset:832
v_cvt_pk_bf16_f32 v91, v218, v219
v_mfma_f32_16x16x32_bf16 v[192:195], a[248:251], v[176:179], v[192:195]
s_waitcnt lgkmcnt(4)
v_exp_f32 v221, v221
v_mfma_f32_16x16x32_bf16 v[200:203], a[224:227], v[128:131], v[224:227]
ds_read_b128 a[248:251], v238 offset:896
buffer_load_dwordx4 v252, s[16:19], s45 offen offset:2112 lds
v_mfma_f32_16x16x32_bf16 v[200:203], a[228:231], v[136:139], v[200:203]
v_exp_f32 v222, v222
v_cvt_pk_bf16_f32 v94, v220, v221
v_mfma_f32_16x16x32_bf16 v[204:207], a[228:231], v[140:143], v[228:231]
ds_read_b128 a[252:255], v238 offset:960
v_exp_f32 v223, v223
v_mfma_f32_16x16x32_bf16 v[204:207], a[224:227], v[132:135], v[204:207]
s_waitcnt lgkmcnt(4)
v_cvt_pk_bf16_f32 v95, v222, v223
v_mfma_f32_16x16x32_bf16 v[204:207], a[232:235], v[148:151], v[204:207]
ds_read_b64_tr_b16 a[224:225], v239 offset:50688
v_max3_f32 v242, v192, v193, v194
v_mfma_f32_16x16x32_bf16 v[204:207], a[236:239], v[156:159], v[204:207]
ds_read_b64_tr_b16 a[226:227], v239 offset:51200
v_max3_f32 v242, v242, v195, v196
v_mfma_f32_16x16x32_bf16 v[200:203], a[236:239], v[152:155], v[200:203]
ds_read_b64_tr_b16 a[228:229], v239 offset:50720
v_max3_f32 v242, v242, v197, v198
v_mfma_f32_16x16x32_bf16 v[200:203], a[232:235], v[144:147], v[200:203]
s_waitcnt lgkmcnt(5)
ds_read_b64_tr_b16 a[230:231], v239 offset:51232
buffer_load_dwordx4 v253, s[16:19], s45 offen offset:3168 lds
v_mfma_f32_16x16x32_bf16 v[200:203], a[240:243], v[160:163], v[200:203]
ds_read_b64_tr_b16 a[232:233], v239 offset:50752
v_add_u32 v246, v246, v254
v_mfma_f32_16x16x32_bf16 v[200:203], a[244:247], v[168:171], v[200:203]
ds_read_b64_tr_b16 a[234:235], v239 offset:51264
v_add_u32 v247, v247, v254
v_mfma_f32_16x16x32_bf16 v[204:207], a[244:247], v[172:175], v[204:207]
ds_read_b64_tr_b16 a[236:237], v239 offset:50784
v_add_u32 v248, v248, v254
v_mfma_f32_16x16x32_bf16 v[204:207], a[240:243], v[164:167], v[204:207]
s_waitcnt lgkmcnt(7)
ds_read_b64_tr_b16 a[238:239], v239 offset:51296
v_add_u32 v249, v249, v254
v_mfma_f32_16x16x32_bf16 v[204:207], a[248:251], v[180:183], v[204:207]
s_add_u32 m0, s28, 0
ds_read_b64_tr_b16 a[240:241], v239 offset:50816
s_mov_b32 s29, 262144
v_mfma_f32_16x16x32_bf16 v[204:207], a[252:255], v[188:191], v[204:207]
ds_read_b64_tr_b16 a[242:243], v239 offset:51328
v_mfma_f32_16x16x32_bf16 v[200:203], a[252:255], v[184:187], v[200:203]
ds_read_b64_tr_b16 a[244:245], v239 offset:50848
buffer_load_dwordx4 v246, s[8:11], s29 offen offset:0 nt lds
v_mfma_f32_16x16x32_bf16 v[200:203], a[248:251], v[176:179], v[200:203]
s_waitcnt lgkmcnt(7)
ds_read_b64_tr_b16 a[246:247], v239 offset:51360
v_mfma_f32_16x16x32_bf16 a[0:3], a[224:227], v[112:115], a[0:3]
ds_read_b64_tr_b16 a[248:249], v239 offset:50880
v_mfma_f32_16x16x32_bf16 a[4:7], a[224:227], v[116:119], a[4:7]
ds_read_b64_tr_b16 a[250:251], v239 offset:51392
v_mfma_f32_16x16x32_bf16 a[8:11], a[228:231], v[112:115], a[8:11]
ds_read_b64_tr_b16 a[252:253], v239 offset:50912
v_mfma_f32_16x16x32_bf16 a[12:15], a[228:231], v[116:119], a[12:15]
s_waitcnt lgkmcnt(7)
ds_read_b64_tr_b16 a[254:255], v239 offset:51424
v_max3_f32 v242, v242, v199, v200
v_mfma_f32_16x16x32_bf16 a[16:19], a[232:235], v[112:115], a[16:19]
ds_read_b64_tr_b16 a[224:225], v239 offset:50944
v_max3_f32 v242, v242, v201, v202
v_mfma_f32_16x16x32_bf16 a[20:23], a[232:235], v[116:119], a[20:23]
ds_read_b64_tr_b16 a[226:227], v239 offset:51456
v_max3_f32 v242, v242, v203, v204
v_mfma_f32_16x16x32_bf16 a[24:27], a[236:239], v[112:115], a[24:27]
ds_read_b64_tr_b16 a[228:229], v239 offset:50976
v_max3_f32 v242, v242, v205, v206
v_mfma_f32_16x16x32_bf16 a[28:31], a[236:239], v[116:119], a[28:31]
s_waitcnt lgkmcnt(7)
ds_read_b64_tr_b16 a[230:231], v239 offset:51488
v_max_f32 v242, v242, v207
v_mfma_f32_16x16x32_bf16 a[32:35], a[240:243], v[112:115], a[32:35]
ds_read_b64_tr_b16 a[232:233], v239 offset:51008
v_cmp_lt_f32 vcc, s32, v242
v_mfma_f32_16x16x32_bf16 a[36:39], a[240:243], v[116:119], a[36:39]
s_cbranch_vccnz L_rsD12
L_rbD12:
ds_read_b64_tr_b16 a[234:235], v239 offset:51520
buffer_load_dwordx4 v247, s[8:11], s29 offen offset:1056 nt lds
v_mfma_f32_16x16x32_bf16 a[40:43], a[244:247], v[112:115], a[40:43]
ds_read_b64_tr_b16 a[236:237], v239 offset:51040
v_mfma_f32_16x16x32_bf16 a[44:47], a[244:247], v[116:119], a[44:47]
s_waitcnt lgkmcnt(7)
ds_read_b64_tr_b16 a[238:239], v239 offset:51552
v_mfma_f32_16x16x32_bf16 a[48:51], a[248:251], v[112:115], a[48:51]
ds_read_b64_tr_b16 a[240:241], v239 offset:51072
v_mfma_f32_16x16x32_bf16 a[52:55], a[248:251], v[116:119], a[52:55]
ds_read_b64_tr_b16 a[242:243], v239 offset:51584
buffer_load_dwordx4 v248, s[8:11], s29 offen offset:2112 nt lds
v_mfma_f32_16x16x32_bf16 a[56:59], a[252:255], v[112:115], a[56:59]
s_waitcnt lgkmcnt(6)
ds_read_b64_tr_b16 a[244:245], v239 offset:51104
v_mfma_f32_16x16x32_bf16 a[60:63], a[252:255], v[116:119], a[60:63]
s_waitcnt vmcnt(19)
ds_read_b64_tr_b16 a[246:247], v239 offset:51616
s_barrier
v_mfma_f32_16x16x32_bf16 a[64:67], a[224:227], v[112:115], a[64:67]
ds_read_b128 a[248:251], v236 offset:33792
v_mfma_f32_16x16x32_bf16 a[68:71], a[224:227], v[116:119], a[68:71]
v_exp_f32 v192, v192
v_mfma_f32_16x16x32_bf16 a[72:75], a[228:231], v[112:115], a[72:75]
ds_read_b128 a[252:255], v236 offset:33856
v_mfma_f32_16x16x32_bf16 a[76:79], a[228:231], v[116:119], a[76:79]
s_waitcnt lgkmcnt(6)
v_exp_f32 v193, v193
v_mfma_f32_16x16x32_bf16 a[80:83], a[232:235], v[112:115], a[80:83]
ds_read_b128 a[224:227], v236 offset:33920
buffer_load_dwordx4 v249, s[8:11], s29 offen offset:3168 nt lds
v_mfma_f32_16x16x32_bf16 a[84:87], a[232:235], v[116:119], a[84:87]
v_exp_f32 v194, v194
v_mfma_f32_16x16x32_bf16 a[88:91], a[236:239], v[112:115], a[88:91]
ds_read_b128 a[228:231], v236 offset:33984
v_cvt_pk_bf16_f32 v96, v192, v193
v_mfma_f32_16x16x32_bf16 a[92:95], a[236:239], v[116:119], a[92:95]
s_waitcnt lgkmcnt(4)
v_exp_f32 v195, v195
v_mfma_f32_16x16x32_bf16 a[96:99], a[240:243], v[112:115], a[96:99]
s_add_u32 m0, s28, 135168
ds_read_b128 a[232:235], v236 offset:34048
s_mov_b32 s29, 327680
v_mfma_f32_16x16x32_bf16 a[100:103], a[240:243], v[116:119], a[100:103]
v_exp_f32 v196, v196
v_mfma_f32_16x16x32_bf16 a[104:107], a[244:247], v[112:115], a[104:107]
ds_read_b128 a[236:239], v236 offset:34112
v_cvt_pk_bf16_f32 v97, v194, v195
v_mfma_f32_16x16x32_bf16 a[108:111], a[244:247], v[116:119], a[108:111]
s_waitcnt lgkmcnt(4)
v_exp_f32 v197, v197
v_mfma_f32_16x16x32_bf16 v[208:211], a[248:251], v[128:131], v[224:227]
ds_read_b128 a[240:243], v236 offset:34176
v_mfma_f32_16x16x32_bf16 v[208:211], a[252:255], v[136:139], v[208:211]
v_exp_f32 v198, v198
v_mfma_f32_16x16x32_bf16 v[212:215], a[252:255], v[140:143], v[228:231]
ds_read_b128 a[244:247], v236 offset:34240
v_cvt_pk_bf16_f32 v100, v196, v197
v_mfma_f32_16x16x32_bf16 v[212:215], a[248:251], v[132:135], v[212:215]
s_waitcnt lgkmcnt(4)
v_exp_f32 v199, v199
v_mfma_f32_16x16x32_bf16 v[212:215], a[224:227], v[148:151], v[212:215]
ds_read_b128 a[248:251], v236 offset:34304
buffer_load_dwordx4 v246, s[8:11], s29 offen offset:0 nt lds
v_mfma_f32_16x16x32_bf16 v[212:215], a[228:231], v[156:159], v[212:215]
v_exp_f32 v200, v200
v_mfma_f32_16x16x32_bf16 v[208:211], a[228:231], v[152:155], v[208:211]
ds_read_b128 a[252:255], v236 offset:34368
v_cvt_pk_bf16_f32 v101, v198, v199
v_mfma_f32_16x16x32_bf16 v[208:211], a[224:227], v[144:147], v[208:211]
s_waitcnt lgkmcnt(4)
v_exp_f32 v201, v201
v_mfma_f32_16x16x32_bf16 v[208:211], a[232:235], v[160:163], v[208:211]
ds_read_b128 a[224:227], v236 offset:34432
v_mfma_f32_16x16x32_bf16 v[208:211], a[236:239], v[168:171], v[208:211]
v_exp_f32 v202, v202
v_mfma_f32_16x16x32_bf16 v[212:215], a[236:239], v[172:175], v[212:215]
ds_read_b128 a[228:231], v236 offset:34496
v_cvt_pk_bf16_f32 v98, v200, v201
v_mfma_f32_16x16x32_bf16 v[212:215], a[232:235], v[164:167], v[212:215]
s_waitcnt lgkmcnt(4)
v_exp_f32 v203, v203
v_mfma_f32_16x16x32_bf16 v[212:215], a[240:243], v[180:183], v[212:215]
ds_read_b128 a[232:235], v236 offset:34560
v_mfma_f32_16x16x32_bf16 v[212:215], a[244:247], v[188:191], v[212:215]
v_exp_f32 v204, v204
v_mfma_f32_16x16x32_bf16 v[208:211], a[244:247], v[184:187], v[208:211]
ds_read_b128 a[236:239], v236 offset:34624
v_cvt_pk_bf16_f32 v99, v202, v203
v_mfma_f32_16x16x32_bf16 v[208:211], a[240:243], v[176:179], v[208:211]
s_waitcnt lgkmcnt(4)
v_exp_f32 v205, v205
v_mfma_f32_16x16x32_bf16 v[216:219], a[248:251], v[128:131], v[224:227]
ds_read_b128 a[240:243], v236 offset:34688
buffer_load_dwordx4 v247, s[8:11], s29 offen offset:1056 nt lds
v_mfma_f32_16x16x32_bf16 v[216:219], a[252:255], v[136:139], v[216:219]
v_exp_f32 v206, v206
v_cvt_pk_bf16_f32 v102, v204, v205
v_mfma_f32_16x16x32_bf16 v[220:223], a[252:255], v[140:143], v[228:231]
ds_read_b128 a[244:247], v236 offset:34752
v_exp_f32 v207, v207
v_mfma_f32_16x16x32_bf16 v[220:223], a[248:251], v[132:135], v[220:223]
s_waitcnt lgkmcnt(4)
v_cvt_pk_bf16_f32 v103, v206, v207
v_mfma_f32_16x16x32_bf16 v[220:223], a[224:227], v[148:151], v[220:223]
ds_read_b64_tr_b16 a[248:249], v240 offset:16896
v_max3_f32 v242, v208, v209, v210
v_mfma_f32_16x16x32_bf16 v[220:223], a[228:231], v[156:159], v[220:223]
ds_read_b64_tr_b16 a[250:251], v240 offset:17408
v_max3_f32 v242, v242, v211, v212
v_mfma_f32_16x16x32_bf16 v[216:219], a[228:231], v[152:155], v[216:219]
ds_read_b64_tr_b16 a[252:253], v240 offset:16928
v_max3_f32 v242, v242, v213, v214
v_mfma_f32_16x16x32_bf16 v[216:219], a[224:227], v[144:147], v[216:219]
s_waitcnt lgkmcnt(5)
ds_read_b64_tr_b16 a[254:255], v240 offset:17440
v_mfma_f32_16x16x32_bf16 v[216:219], a[232:235], v[160:163], v[216:219]
ds_read_b64_tr_b16 a[224:225], v240 offset:16960
v_mfma_f32_16x16x32_bf16 v[216:219], a[236:239], v[168:171], v[216:219]
ds_read_b64_tr_b16 a[226:227], v240 offset:17472
v_mfma_f32_16x16x32_bf16 v[220:223], a[236:239], v[172:175], v[220:223]
ds_read_b64_tr_b16 a[228:229], v240 offset:16992
v_mfma_f32_16x16x32_bf16 v[220:223], a[232:235], v[164:167], v[220:223]
s_waitcnt lgkmcnt(7)
ds_read_b64_tr_b16 a[230:231], v240 offset:17504
v_mfma_f32_16x16x32_bf16 v[220:223], a[240:243], v[180:183], v[220:223]
ds_read_b64_tr_b16 a[232:233], v240 offset:17024
v_mfma_f32_16x16x32_bf16 v[220:223], a[244:247], v[188:191], v[220:223]
ds_read_b64_tr_b16 a[234:235], v240 offset:17536
v_mfma_f32_16x16x32_bf16 v[216:219], a[244:247], v[184:187], v[216:219]
ds_read_b64_tr_b16 a[236:237], v240 offset:17056
buffer_load_dwordx4 v248, s[8:11], s29 offen offset:2112 nt lds
v_mfma_f32_16x16x32_bf16 v[216:219], a[240:243], v[176:179], v[216:219]
s_waitcnt lgkmcnt(7)
ds_read_b64_tr_b16 a[238:239], v240 offset:17568
v_mfma_f32_16x16x32_bf16 a[112:115], a[248:251], v[112:115], a[112:115]
ds_read_b64_tr_b16 a[240:241], v240 offset:17088
v_mfma_f32_16x16x32_bf16 a[116:119], a[248:251], v[116:119], a[116:119]
ds_read_b64_tr_b16 a[242:243], v240 offset:17600
v_mfma_f32_16x16x32_bf16 a[120:123], a[252:255], v[112:115], a[120:123]
ds_read_b64_tr_b16 a[244:245], v240 offset:17120
v_mfma_f32_16x16x32_bf16 a[124:127], a[252:255], v[116:119], a[124:127]
s_waitcnt lgkmcnt(7)
ds_read_b64_tr_b16 a[246:247], v240 offset:17632
v_max3_f32 v242, v242, v215, v216
v_mfma_f32_16x16x32_bf16 a[128:131], a[224:227], v[112:115], a[128:131]
ds_read_b64_tr_b16 a[248:249], v240 offset:17152
v_max3_f32 v242, v242, v217, v218
v_mfma_f32_16x16x32_bf16 a[132:135], a[224:227], v[116:119], a[132:135]
ds_read_b64_tr_b16 a[250:251], v240 offset:17664
v_max3_f32 v242, v242, v219, v220
v_mfma_f32_16x16x32_bf16 a[136:139], a[228:231], v[112:115], a[136:139]
ds_read_b64_tr_b16 a[252:253], v240 offset:17184
v_max3_f32 v242, v242, v221, v222
v_mfma_f32_16x16x32_bf16 a[140:143], a[228:231], v[116:119], a[140:143]
s_waitcnt lgkmcnt(7)
ds_read_b64_tr_b16 a[254:255], v240 offset:17696
v_max_f32 v242, v242, v223
v_mfma_f32_16x16x32_bf16 a[144:147], a[232:235], v[112:115], a[144:147]
ds_read_b64_tr_b16 a[224:225], v240 offset:17216
v_cmp_lt_f32 vcc, s32, v242
v_mfma_f32_16x16x32_bf16 a[148:151], a[232:235], v[116:119], a[148:151]
s_cbranch_vccnz L_rsD13
L_rbD13:
ds_read_b64_tr_b16 a[226:227], v240 offset:17728
v_mfma_f32_16x16x32_bf16 a[152:155], a[236:239], v[112:115], a[152:155]
ds_read_b64_tr_b16 a[228:229], v240 offset:17248
v_mfma_f32_16x16x32_bf16 a[156:159], a[236:239], v[116:119], a[156:159]
s_waitcnt lgkmcnt(7)
ds_read_b64_tr_b16 a[230:231], v240 offset:17760
v_mfma_f32_16x16x32_bf16 a[160:163], a[240:243], v[112:115], a[160:163]
ds_read_b64_tr_b16 a[232:233], v240 offset:17280
v_mfma_f32_16x16x32_bf16 a[164:167], a[240:243], v[116:119], a[164:167]
ds_read_b64_tr_b16 a[234:235], v240 offset:17792
buffer_load_dwordx4 v249, s[8:11], s29 offen offset:3168 nt lds
v_mfma_f32_16x16x32_bf16 a[168:171], a[244:247], v[112:115], a[168:171]
s_waitcnt lgkmcnt(6)
ds_read_b64_tr_b16 a[236:237], v240 offset:17312
v_mfma_f32_16x16x32_bf16 a[172:175], a[244:247], v[116:119], a[172:175]
s_waitcnt vmcnt(16)
ds_read_b64_tr_b16 a[238:239], v240 offset:17824
s_barrier
v_mfma_f32_16x16x32_bf16 a[176:179], a[248:251], v[112:115], a[176:179]
ds_read_b128 a[240:243], v237 offset:0
v_mfma_f32_16x16x32_bf16 a[180:183], a[248:251], v[116:119], a[180:183]
v_exp_f32 v208, v208
v_mfma_f32_16x16x32_bf16 a[184:187], a[252:255], v[112:115], a[184:187]
ds_read_b128 a[244:247], v237 offset:64
v_mfma_f32_16x16x32_bf16 a[188:191], a[252:255], v[116:119], a[188:191]
s_waitcnt lgkmcnt(6)
v_exp_f32 v209, v209
v_mfma_f32_16x16x32_bf16 a[192:195], a[224:227], v[112:115], a[192:195]
ds_read_b128 a[248:251], v237 offset:128
v_mfma_f32_16x16x32_bf16 a[196:199], a[224:227], v[116:119], a[196:199]
v_exp_f32 v210, v210
v_mfma_f32_16x16x32_bf16 a[200:203], a[228:231], v[112:115], a[200:203]
ds_read_b128 a[252:255], v237 offset:192
v_cvt_pk_bf16_f32 v104, v208, v209
v_mfma_f32_16x16x32_bf16 a[204:207], a[228:231], v[116:119], a[204:207]
s_waitcnt lgkmcnt(4)
v_exp_f32 v211, v211
v_mfma_f32_16x16x32_bf16 a[208:211], a[232:235], v[112:115], a[208:211]
s_add_u32 m0, s28, 50688
ds_read_b128 a[224:227], v237 offset:256
s_mov_b32 s29, 393216
v_mfma_f32_16x16x32_bf16 a[212:215], a[232:235], v[116:119], a[212:215]
v_exp_f32 v212, v212
v_mfma_f32_16x16x32_bf16 a[216:219], a[236:239], v[112:115], a[216:219]
ds_read_b128 a[228:231], v237 offset:320
v_cvt_pk_bf16_f32 v105, v210, v211
v_mfma_f32_16x16x32_bf16 a[220:223], a[236:239], v[116:119], a[220:223]
s_waitcnt lgkmcnt(4)
v_exp_f32 v213, v213
v_mfma_f32_16x16x32_bf16 v[192:195], a[240:243], v[128:131], v[224:227]
ds_read_b128 a[232:235], v237 offset:384
v_mfma_f32_16x16x32_bf16 v[192:195], a[244:247], v[136:139], v[192:195]
v_exp_f32 v214, v214
v_mfma_f32_16x16x32_bf16 v[196:199], a[244:247], v[140:143], v[228:231]
ds_read_b128 a[236:239], v237 offset:448
v_cvt_pk_bf16_f32 v108, v212, v213
v_mfma_f32_16x16x32_bf16 v[196:199], a[240:243], v[132:135], v[196:199]
s_waitcnt lgkmcnt(4)
v_exp_f32 v215, v215
v_mfma_f32_16x16x32_bf16 v[196:199], a[248:251], v[148:151], v[196:199]
ds_read_b128 a[240:243], v237 offset:512
buffer_load_dwordx4 v246, s[8:11], s29 offen offset:0 nt lds
v_mfma_f32_16x16x32_bf16 v[196:199], a[252:255], v[156:159], v[196:199]
v_exp_f32 v216, v216
v_mfma_f32_16x16x32_bf16 v[192:195], a[252:255], v[152:155], v[192:195]
ds_read_b128 a[244:247], v237 offset:576
v_cvt_pk_bf16_f32 v109, v214, v215
v_mfma_f32_16x16x32_bf16 v[192:195], a[248:251], v[144:147], v[192:195]
s_waitcnt lgkmcnt(4)
v_exp_f32 v217, v217
v_mfma_f32_16x16x32_bf16 v[192:195], a[224:227], v[160:163], v[192:195]
ds_read_b128 a[248:251], v237 offset:640
v_mfma_f32_16x16x32_bf16 v[192:195], a[228:231], v[168:171], v[192:195]
v_exp_f32 v218, v218
v_mfma_f32_16x16x32_bf16 v[196:199], a[228:231], v[172:175], v[196:199]
ds_read_b128 a[252:255], v237 offset:704
v_cvt_pk_bf16_f32 v106, v216, v217
v_mfma_f32_16x16x32_bf16 v[196:199], a[224:227], v[164:167], v[196:199]
s_waitcnt lgkmcnt(4)
v_exp_f32 v219, v219
v_mfma_f32_16x16x32_bf16 v[196:199], a[232:235], v[180:183], v[196:199]
ds_read_b128 a[224:227], v237 offset:768
v_mfma_f32_16x16x32_bf16 v[196:199], a[236:239], v[188:191], v[196:199]
v_exp_f32 v220, v220
v_mfma_f32_16x16x32_bf16 v[192:195], a[236:239], v[184:187], v[192:195]
ds_read_b128 a[228:231], v237 offset:832
v_cvt_pk_bf16_f32 v107, v218, v219
v_mfma_f32_16x16x32_bf16 v[192:195], a[232:235], v[176:179], v[192:195]
s_waitcnt lgkmcnt(4)
v_exp_f32 v221, v221
v_mfma_f32_16x16x32_bf16 v[200:203], a[240:243], v[128:131], v[224:227]
ds_read_b128 a[232:235], v237 offset:896
buffer_load_dwordx4 v247, s[8:11], s29 offen offset:1056 nt lds
v_mfma_f32_16x16x32_bf16 v[200:203], a[244:247], v[136:139], v[200:203]
v_exp_f32 v222, v222
v_cvt_pk_bf16_f32 v110, v220, v221
v_mfma_f32_16x16x32_bf16 v[204:207], a[244:247], v[140:143], v[228:231]
ds_read_b128 a[236:239], v237 offset:960
v_exp_f32 v223, v223
v_mfma_f32_16x16x32_bf16 v[204:207], a[240:243], v[132:135], v[204:207]
s_waitcnt lgkmcnt(4)
v_cvt_pk_bf16_f32 v111, v222, v223
v_mfma_f32_16x16x32_bf16 v[204:207], a[248:251], v[148:151], v[204:207]
ds_read_b64_tr_b16 a[240:241], v240 offset:33792
v_max3_f32 v242, v192, v193, v194
v_mfma_f32_16x16x32_bf16 v[204:207], a[252:255], v[156:159], v[204:207]
ds_read_b64_tr_b16 a[242:243], v240 offset:34304
v_max3_f32 v242, v242, v195, v196
v_mfma_f32_16x16x32_bf16 v[200:203], a[252:255], v[152:155], v[200:203]
ds_read_b64_tr_b16 a[244:245], v240 offset:33824
v_max3_f32 v242, v242, v197, v198
v_mfma_f32_16x16x32_bf16 v[200:203], a[248:251], v[144:147], v[200:203]
s_waitcnt lgkmcnt(5)
ds_read_b64_tr_b16 a[246:247], v240 offset:34336
v_mfma_f32_16x16x32_bf16 v[200:203], a[224:227], v[160:163], v[200:203]
ds_read_b64_tr_b16 a[248:249], v240 offset:33856
v_mfma_f32_16x16x32_bf16 v[200:203], a[228:231], v[168:171], v[200:203]
ds_read_b64_tr_b16 a[250:251], v240 offset:34368
v_mfma_f32_16x16x32_bf16 v[204:207], a[228:231], v[172:175], v[204:207]
ds_read_b64_tr_b16 a[252:253], v240 offset:33888
v_mfma_f32_16x16x32_bf16 v[204:207], a[224:227], v[164:167], v[204:207]
s_waitcnt lgkmcnt(7)
ds_read_b64_tr_b16 a[254:255], v240 offset:34400
v_mfma_f32_16x16x32_bf16 v[204:207], a[232:235], v[180:183], v[204:207]
ds_read_b64_tr_b16 a[224:225], v240 offset:33920
v_mfma_f32_16x16x32_bf16 v[204:207], a[236:239], v[188:191], v[204:207]
ds_read_b64_tr_b16 a[226:227], v240 offset:34432
v_mfma_f32_16x16x32_bf16 v[200:203], a[236:239], v[184:187], v[200:203]
ds_read_b64_tr_b16 a[228:229], v240 offset:33952
buffer_load_dwordx4 v248, s[8:11], s29 offen offset:2112 nt lds
v_mfma_f32_16x16x32_bf16 v[200:203], a[232:235], v[176:179], v[200:203]
s_waitcnt lgkmcnt(7)
ds_read_b64_tr_b16 a[230:231], v240 offset:34464
v_mfma_f32_16x16x32_bf16 a[0:3], a[240:243], v[120:123], a[0:3]
ds_read_b64_tr_b16 a[232:233], v240 offset:33984
v_mfma_f32_16x16x32_bf16 a[4:7], a[240:243], v[124:127], a[4:7]
ds_read_b64_tr_b16 a[234:235], v240 offset:34496
v_mfma_f32_16x16x32_bf16 a[8:11], a[244:247], v[120:123], a[8:11]
ds_read_b64_tr_b16 a[236:237], v240 offset:34016
v_mfma_f32_16x16x32_bf16 a[12:15], a[244:247], v[124:127], a[12:15]
s_waitcnt lgkmcnt(7)
ds_read_b64_tr_b16 a[238:239], v240 offset:34528
v_max3_f32 v242, v242, v199, v200
v_mfma_f32_16x16x32_bf16 a[16:19], a[248:251], v[120:123], a[16:19]
ds_read_b64_tr_b16 a[240:241], v240 offset:34048
v_max3_f32 v242, v242, v201, v202
v_mfma_f32_16x16x32_bf16 a[20:23], a[248:251], v[124:127], a[20:23]
ds_read_b64_tr_b16 a[242:243], v240 offset:34560
v_max3_f32 v242, v242, v203, v204
v_mfma_f32_16x16x32_bf16 a[24:27], a[252:255], v[120:123], a[24:27]
ds_read_b64_tr_b16 a[244:245], v240 offset:34080
v_max3_f32 v242, v242, v205, v206
v_mfma_f32_16x16x32_bf16 a[28:31], a[252:255], v[124:127], a[28:31]
s_waitcnt lgkmcnt(7)
ds_read_b64_tr_b16 a[246:247], v240 offset:34592
v_max_f32 v242, v242, v207
v_mfma_f32_16x16x32_bf16 a[32:35], a[224:227], v[120:123], a[32:35]
ds_read_b64_tr_b16 a[248:249], v240 offset:34112
v_cmp_lt_f32 vcc, s32, v242
v_mfma_f32_16x16x32_bf16 a[36:39], a[224:227], v[124:127], a[36:39]
s_cbranch_vccnz L_rsD14
L_rbD14:
ds_read_b64_tr_b16 a[250:251], v240 offset:34624
v_mfma_f32_16x16x32_bf16 a[40:43], a[228:231], v[120:123], a[40:43]
ds_read_b64_tr_b16 a[252:253], v240 offset:34144
v_mfma_f32_16x16x32_bf16 a[44:47], a[228:231], v[124:127], a[44:47]
s_waitcnt lgkmcnt(7)
ds_read_b64_tr_b16 a[254:255], v240 offset:34656
v_mfma_f32_16x16x32_bf16 a[48:51], a[232:235], v[120:123], a[48:51]
ds_read_b64_tr_b16 a[224:225], v240 offset:34176
v_mfma_f32_16x16x32_bf16 a[52:55], a[232:235], v[124:127], a[52:55]
ds_read_b64_tr_b16 a[226:227], v240 offset:34688
buffer_load_dwordx4 v249, s[8:11], s29 offen offset:3168 nt lds
v_mfma_f32_16x16x32_bf16 a[56:59], a[236:239], v[120:123], a[56:59]
s_waitcnt lgkmcnt(6)
ds_read_b64_tr_b16 a[228:229], v240 offset:34208
v_mfma_f32_16x16x32_bf16 a[60:63], a[236:239], v[124:127], a[60:63]
s_waitcnt vmcnt(12)
ds_read_b64_tr_b16 a[230:231], v240 offset:34720
s_barrier
v_mfma_f32_16x16x32_bf16 a[64:67], a[240:243], v[120:123], a[64:67]
ds_read_b128 a[232:235], v237 offset:50688
v_mfma_f32_16x16x32_bf16 a[68:71], a[240:243], v[124:127], a[68:71]
v_exp_f32 v192, v192
v_mfma_f32_16x16x32_bf16 a[72:75], a[244:247], v[120:123], a[72:75]
ds_read_b128 a[236:239], v237 offset:50752
v_mfma_f32_16x16x32_bf16 a[76:79], a[244:247], v[124:127], a[76:79]
s_waitcnt lgkmcnt(6)
v_exp_f32 v193, v193
v_mfma_f32_16x16x32_bf16 a[80:83], a[248:251], v[120:123], a[80:83]
ds_read_b128 a[240:243], v237 offset:50816
v_mfma_f32_16x16x32_bf16 a[84:87], a[248:251], v[124:127], a[84:87]
v_exp_f32 v194, v194
v_mfma_f32_16x16x32_bf16 a[88:91], a[252:255], v[120:123], a[88:91]
ds_read_b128 a[244:247], v237 offset:50880
v_cvt_pk_bf16_f32 v112, v192, v193
v_mfma_f32_16x16x32_bf16 a[92:95], a[252:255], v[124:127], a[92:95]
s_waitcnt lgkmcnt(4)
v_exp_f32 v195, v195
v_mfma_f32_16x16x32_bf16 a[96:99], a[224:227], v[120:123], a[96:99]
s_add_u32 m0, s28, 33792
ds_read_b128 a[248:251], v237 offset:50944
s_mov_b32 s29, 458752
v_mfma_f32_16x16x32_bf16 a[100:103], a[224:227], v[124:127], a[100:103]
v_exp_f32 v196, v196
v_mfma_f32_16x16x32_bf16 a[104:107], a[228:231], v[120:123], a[104:107]
ds_read_b128 a[252:255], v237 offset:51008
v_cvt_pk_bf16_f32 v113, v194, v195
v_mfma_f32_16x16x32_bf16 a[108:111], a[228:231], v[124:127], a[108:111]
s_waitcnt lgkmcnt(4)
v_exp_f32 v197, v197
v_mfma_f32_16x16x32_bf16 v[208:211], a[232:235], v[128:131], v[224:227]
ds_read_b128 a[224:227], v237 offset:51072
v_mfma_f32_16x16x32_bf16 v[208:211], a[236:239], v[136:139], v[208:211]
v_exp_f32 v198, v198
v_mfma_f32_16x16x32_bf16 v[212:215], a[236:239], v[140:143], v[228:231]
ds_read_b128 a[228:231], v237 offset:51136
v_cvt_pk_bf16_f32 v116, v196, v197
v_mfma_f32_16x16x32_bf16 v[212:215], a[232:235], v[132:135], v[212:215]
s_waitcnt lgkmcnt(4)
v_exp_f32 v199, v199
v_mfma_f32_16x16x32_bf16 v[212:215], a[240:243], v[148:151], v[212:215]
ds_read_b128 a[232:235], v237 offset:51200
buffer_load_dwordx4 v246, s[8:11], s29 offen offset:0 nt lds
v_mfma_f32_16x16x32_bf16 v[212:215], a[244:247], v[156:159], v[212:215]
v_exp_f32 v200, v200
v_mfma_f32_16x16x32_bf16 v[208:211], a[244:247], v[152:155], v[208:211]
ds_read_b128 a[236:239], v237 offset:51264
v_cvt_pk_bf16_f32 v117, v198, v199
v_mfma_f32_16x16x32_bf16 v[208:211], a[240:243], v[144:147], v[208:211]
s_waitcnt lgkmcnt(4)
v_exp_f32 v201, v201
v_mfma_f32_16x16x32_bf16 v[208:211], a[248:251], v[160:163], v[208:211]
ds_read_b128 a[240:243], v237 offset:51328
v_mfma_f32_16x16x32_bf16 v[208:211], a[252:255], v[168:171], v[208:211]
v_exp_f32 v202, v202
v_mfma_f32_16x16x32_bf16 v[212:215], a[252:255], v[172:175], v[212:215]
ds_read_b128 a[244:247], v237 offset:51392
v_cvt_pk_bf16_f32 v114, v200, v201
v_mfma_f32_16x16x32_bf16 v[212:215], a[248:251], v[164:167], v[212:215]
s_waitcnt lgkmcnt(4)
v_exp_f32 v203, v203
v_mfma_f32_16x16x32_bf16 v[212:215], a[224:227], v[180:183], v[212:215]
ds_read_b128 a[248:251], v237 offset:51456
v_mfma_f32_16x16x32_bf16 v[212:215], a[228:231], v[188:191], v[212:215]
v_exp_f32 v204, v204
v_mfma_f32_16x16x32_bf16 v[208:211], a[228:231], v[184:187], v[208:211]
ds_read_b128 a[252:255], v237 offset:51520
v_cvt_pk_bf16_f32 v115, v202, v203
v_mfma_f32_16x16x32_bf16 v[208:211], a[224:227], v[176:179], v[208:211]
s_waitcnt lgkmcnt(4)
v_exp_f32 v205, v205
v_mfma_f32_16x16x32_bf16 v[216:219], a[232:235], v[128:131], v[224:227]
ds_read_b128 a[224:227], v237 offset:51584
buffer_load_dwordx4 v247, s[8:11], s29 offen offset:1056 nt lds
v_mfma_f32_16x16x32_bf16 v[216:219], a[236:239], v[136:139], v[216:219]
v_exp_f32 v206, v206
v_cvt_pk_bf16_f32 v118, v204, v205
v_mfma_f32_16x16x32_bf16 v[220:223], a[236:239], v[140:143], v[228:231]
ds_read_b128 a[228:231], v237 offset:51648
v_exp_f32 v207, v207
v_mfma_f32_16x16x32_bf16 v[220:223], a[232:235], v[132:135], v[220:223]
s_waitcnt lgkmcnt(4)
v_cvt_pk_bf16_f32 v119, v206, v207
v_mfma_f32_16x16x32_bf16 v[220:223], a[240:243], v[148:151], v[220:223]
ds_read_b64_tr_b16 a[232:233], v239 offset:16896
v_max3_f32 v242, v208, v209, v210
v_mfma_f32_16x16x32_bf16 v[220:223], a[244:247], v[156:159], v[220:223]
ds_read_b64_tr_b16 a[234:235], v239 offset:17408
v_max3_f32 v242, v242, v211, v212
v_mfma_f32_16x16x32_bf16 v[216:219], a[244:247], v[152:155], v[216:219]
ds_read_b64_tr_b16 a[236:237], v239 offset:16928
v_max3_f32 v242, v242, v213, v214
v_mfma_f32_16x16x32_bf16 v[216:219], a[240:243], v[144:147], v[216:219]
s_waitcnt lgkmcnt(5)
ds_read_b64_tr_b16 a[238:239], v239 offset:17440
v_mfma_f32_16x16x32_bf16 v[216:219], a[248:251], v[160:163], v[216:219]
ds_read_b64_tr_b16 a[240:241], v239 offset:16960
v_mfma_f32_16x16x32_bf16 v[216:219], a[252:255], v[168:171], v[216:219]
ds_read_b64_tr_b16 a[242:243], v239 offset:17472
v_mfma_f32_16x16x32_bf16 v[220:223], a[252:255], v[172:175], v[220:223]
ds_read_b64_tr_b16 a[244:245], v239 offset:16992
v_mfma_f32_16x16x32_bf16 v[220:223], a[248:251], v[164:167], v[220:223]
s_waitcnt lgkmcnt(7)
ds_read_b64_tr_b16 a[246:247], v239 offset:17504
v_mfma_f32_16x16x32_bf16 v[220:223], a[224:227], v[180:183], v[220:223]
ds_read_b64_tr_b16 a[248:249], v239 offset:17024
v_mfma_f32_16x16x32_bf16 v[220:223], a[228:231], v[188:191], v[220:223]
ds_read_b64_tr_b16 a[250:251], v239 offset:17536
v_mfma_f32_16x16x32_bf16 v[216:219], a[228:231], v[184:187], v[216:219]
ds_read_b64_tr_b16 a[252:253], v239 offset:17056
buffer_load_dwordx4 v248, s[8:11], s29 offen offset:2112 nt lds
v_mfma_f32_16x16x32_bf16 v[216:219], a[224:227], v[176:179], v[216:219]
s_waitcnt lgkmcnt(7)
ds_read_b64_tr_b16 a[254:255], v239 offset:17568
v_mfma_f32_16x16x32_bf16 a[112:115], a[232:235], v[120:123], a[112:115]
ds_read_b64_tr_b16 a[224:225], v239 offset:17088
v_mfma_f32_16x16x32_bf16 a[116:119], a[232:235], v[124:127], a[116:119]
ds_read_b64_tr_b16 a[226:227], v239 offset:17600
v_mfma_f32_16x16x32_bf16 a[120:123], a[236:239], v[120:123], a[120:123]
ds_read_b64_tr_b16 a[228:229], v239 offset:17120
v_mfma_f32_16x16x32_bf16 a[124:127], a[236:239], v[124:127], a[124:127]
s_waitcnt lgkmcnt(7)
ds_read_b64_tr_b16 a[230:231], v239 offset:17632
v_max3_f32 v242, v242, v215, v216
v_mfma_f32_16x16x32_bf16 a[128:131], a[240:243], v[120:123], a[128:131]
ds_read_b64_tr_b16 a[232:233], v239 offset:17152
v_max3_f32 v242, v242, v217, v218
v_mfma_f32_16x16x32_bf16 a[132:135], a[240:243], v[124:127], a[132:135]
ds_read_b64_tr_b16 a[234:235], v239 offset:17664
v_max3_f32 v242, v242, v219, v220
v_mfma_f32_16x16x32_bf16 a[136:139], a[244:247], v[120:123], a[136:139]
ds_read_b64_tr_b16 a[236:237], v239 offset:17184
v_max3_f32 v242, v242, v221, v222
v_mfma_f32_16x16x32_bf16 a[140:143], a[244:247], v[124:127], a[140:143]
s_waitcnt lgkmcnt(7)
ds_read_b64_tr_b16 a[238:239], v239 offset:17696
v_max_f32 v242, v242, v223
v_mfma_f32_16x16x32_bf16 a[144:147], a[248:251], v[120:123], a[144:147]
ds_read_b64_tr_b16 a[240:241], v239 offset:17216
v_cmp_lt_f32 vcc, s32, v242
v_mfma_f32_16x16x32_bf16 a[148:151], a[248:251], v[124:127], a[148:151]
s_cbranch_vccnz L_rsD15
L_rbD15:
ds_read_b64_tr_b16 a[242:243], v239 offset:17728
v_mfma_f32_16x16x32_bf16 a[152:155], a[252:255], v[120:123], a[152:155]
ds_read_b64_tr_b16 a[244:245], v239 offset:17248
v_mfma_f32_16x16x32_bf16 a[156:159], a[252:255], v[124:127], a[156:159]
s_waitcnt lgkmcnt(7)
ds_read_b64_tr_b16 a[246:247], v239 offset:17760
v_mfma_f32_16x16x32_bf16 a[160:163], a[224:227], v[120:123], a[160:163]
ds_read_b64_tr_b16 a[248:249], v239 offset:17280
v_mfma_f32_16x16x32_bf16 a[164:167], a[224:227], v[124:127], a[164:167]
ds_read_b64_tr_b16 a[250:251], v239 offset:17792
buffer_load_dwordx4 v249, s[8:11], s29 offen offset:3168 nt lds
v_mfma_f32_16x16x32_bf16 a[168:171], a[228:231], v[120:123], a[168:171]
s_waitcnt lgkmcnt(6)
ds_read_b64_tr_b16 a[252:253], v239 offset:17312
v_mfma_f32_16x16x32_bf16 a[172:175], a[228:231], v[124:127], a[172:175]
s_waitcnt vmcnt(12)
ds_read_b64_tr_b16 a[254:255], v239 offset:17824
s_barrier
v_mfma_f32_16x16x32_bf16 a[176:179], a[232:235], v[120:123], a[176:179]
ds_read_b64_tr_b16 a[224:225], v239 offset:0
v_mfma_f32_16x16x32_bf16 a[180:183], a[232:235], v[124:127], a[180:183]
ds_read_b64_tr_b16 a[226:227], v239 offset:128
v_mfma_f32_16x16x32_bf16 a[184:187], a[236:239], v[120:123], a[184:187]
ds_read_b64_tr_b16 a[228:229], v239 offset:256
v_mfma_f32_16x16x32_bf16 a[188:191], a[236:239], v[124:127], a[188:191]
s_waitcnt lgkmcnt(7)
ds_read_b64_tr_b16 a[230:231], v239 offset:384
v_mfma_f32_16x16x32_bf16 a[192:195], a[240:243], v[120:123], a[192:195]
ds_read_b64_tr_b16 a[232:233], v239 offset:512
v_mfma_f32_16x16x32_bf16 a[196:199], a[240:243], v[124:127], a[196:199]
ds_read_b64_tr_b16 a[234:235], v239 offset:640
v_mfma_f32_16x16x32_bf16 a[200:203], a[244:247], v[120:123], a[200:203]
ds_read_b64_tr_b16 a[236:237], v239 offset:768
v_mfma_f32_16x16x32_bf16 a[204:207], a[244:247], v[124:127], a[204:207]
s_waitcnt lgkmcnt(7)
ds_read_b64_tr_b16 a[238:239], v239 offset:896
s_add_u32 m0, s28, 84480
v_mfma_f32_16x16x32_bf16 a[208:211], a[248:251], v[120:123], a[208:211]
s_mov_b32 s29, 262272
ds_read_b64_tr_b16 a[240:241], v239 offset:32
v_mfma_f32_16x16x32_bf16 a[212:215], a[248:251], v[124:127], a[212:215]
ds_read_b64_tr_b16 a[242:243], v239 offset:160
v_mfma_f32_16x16x32_bf16 a[216:219], a[252:255], v[120:123], a[216:219]
ds_read_b64_tr_b16 a[244:245], v239 offset:288
v_mfma_f32_16x16x32_bf16 a[220:223], a[252:255], v[124:127], a[220:223]
ds_read_b64_tr_b16 a[246:247], v239 offset:416
v_mfma_f32_16x16x32_bf16 v[224:227], v[232:235], v[0:3], 0
v_exp_f32 v208, v208
v_mfma_f32_16x16x32_bf16 v[224:227], v[232:235], v[8:11], v[224:227]
v_exp_f32 v209, v209
v_mfma_f32_16x16x32_bf16 v[224:227], v[232:235], v[16:19], v[224:227]
v_exp_f32 v210, v210
v_mfma_f32_16x16x32_bf16 v[224:227], v[232:235], v[24:27], v[224:227]
s_waitcnt lgkmcnt(8)
buffer_load_dwordx4 v246, s[8:11], s29 offen offset:0 nt lds
v_cvt_pk_bf16_f32 v120, v208, v209
v_mfma_f32_16x16x32_bf16 v[160:163], a[224:227], v[0:3], 0
ds_read_b64_tr_b16 a[248:249], v239 offset:544
v_mfma_f32_16x16x32_bf16 v[160:163], a[228:231], v[8:11], v[160:163]
ds_read_b64_tr_b16 a[250:251], v239 offset:672
v_mfma_f32_16x16x32_bf16 v[164:167], a[228:231], v[12:15], 0
ds_read_b64_tr_b16 a[252:253], v239 offset:800
v_mfma_f32_16x16x32_bf16 v[164:167], a[224:227], v[4:7], v[164:167]
s_waitcnt lgkmcnt(7)
ds_read_b64_tr_b16 a[254:255], v239 offset:928
v_mfma_f32_16x16x32_bf16 v[164:167], a[232:235], v[20:23], v[164:167]
ds_read_b64_tr_b16 a[224:225], v239 offset:64
v_mfma_f32_16x16x32_bf16 v[164:167], a[236:239], v[28:31], v[164:167]
ds_read_b64_tr_b16 a[226:227], v239 offset:192
v_mfma_f32_16x16x32_bf16 v[160:163], a[236:239], v[24:27], v[160:163]
ds_read_b64_tr_b16 a[228:229], v239 offset:320
buffer_load_dwordx4 v247, s[8:11], s29 offen offset:1056 nt lds
v_mfma_f32_16x16x32_bf16 v[160:163], a[232:235], v[16:19], v[160:163]
s_waitcnt lgkmcnt(7)
ds_read_b64_tr_b16 a[230:231], v239 offset:448
v_mfma_f32_16x16x32_bf16 v[168:171], a[240:243], v[0:3], 0
ds_read_b64_tr_b16 a[232:233], v239 offset:576
v_mfma_f32_16x16x32_bf16 v[168:171], a[244:247], v[8:11], v[168:171]
ds_read_b64_tr_b16 a[234:235], v239 offset:704
v_mfma_f32_16x16x32_bf16 v[172:175], a[244:247], v[12:15], 0
ds_read_b64_tr_b16 a[236:237], v239 offset:832
v_mfma_f32_16x16x32_bf16 v[172:175], a[240:243], v[4:7], v[172:175]
s_waitcnt lgkmcnt(7)
ds_read_b64_tr_b16 a[238:239], v239 offset:960
v_mfma_f32_16x16x32_bf16 v[172:175], a[248:251], v[20:23], v[172:175]
ds_read_b64_tr_b16 a[240:241], v239 offset:96
v_mfma_f32_16x16x32_bf16 v[172:175], a[252:255], v[28:31], v[172:175]
ds_read_b64_tr_b16 a[242:243], v239 offset:224
v_mfma_f32_16x16x32_bf16 v[168:171], a[252:255], v[24:27], v[168:171]
ds_read_b64_tr_b16 a[244:245], v239 offset:352
v_mfma_f32_16x16x32_bf16 v[168:171], a[248:251], v[16:19], v[168:171]
ds_read_b64_tr_b16 a[246:247], v239 offset:480
v_mfma_f32_16x16x32_bf16 v[228:231], v[232:235], v[4:7], 0
v_exp_f32 v211, v211
v_mfma_f32_16x16x32_bf16 v[228:231], v[232:235], v[12:15], v[228:231]
v_exp_f32 v212, v212
v_mfma_f32_16x16x32_bf16 v[228:231], v[232:235], v[20:23], v[228:231]
buffer_load_dwordx4 v248, s[8:11], s29 offen offset:2112 nt lds
v_cvt_pk_bf16_f32 v121, v210, v211
v_mfma_f32_16x16x32_bf16 v[228:231], v[232:235], v[28:31], v[228:231]
s_waitcnt lgkmcnt(8)
v_exp_f32 v213, v213
v_mfma_f32_16x16x32_bf16 v[176:179], a[224:227], v[0:3], 0
ds_read_b64_tr_b16 a[248:249], v239 offset:608
v_mfma_f32_16x16x32_bf16 v[176:179], a[228:231], v[8:11], v[176:179]
ds_read_b64_tr_b16 a[250:251], v239 offset:736
v_mfma_f32_16x16x32_bf16 v[180:183], a[228:231], v[12:15], 0
s_waitcnt lgkmcnt(6)
ds_read_b64_tr_b16 a[252:253], v239 offset:864
v_mfma_f32_16x16x32_bf16 v[180:183], a[224:227], v[4:7], v[180:183]
s_waitcnt vmcnt(11)
ds_read_b64_tr_b16 a[254:255], v239 offset:992
s_barrier
v_mfma_f32_16x16x32_bf16 v[180:183], a[232:235], v[20:23], v[180:183]
ds_read_b64_tr_b16 a[224:225], v241 offset:0
v_mfma_f32_16x16x32_bf16 v[180:183], a[236:239], v[28:31], v[180:183]
ds_read_b64_tr_b16 a[226:227], v241 offset:128
v_mfma_f32_16x16x32_bf16 v[176:179], a[236:239], v[24:27], v[176:179]
ds_read_b64_tr_b16 a[228:229], v241 offset:256
buffer_load_dwordx4 v249, s[8:11], s29 offen offset:3168 nt lds
v_mfma_f32_16x16x32_bf16 v[176:179], a[232:235], v[16:19], v[176:179]
s_waitcnt lgkmcnt(7)
ds_read_b64_tr_b16 a[230:231], v241 offset:384
v_mfma_f32_16x16x32_bf16 v[184:187], a[240:243], v[0:3], 0
ds_read_b64_tr_b16 a[232:233], v241 offset:512
v_mfma_f32_16x16x32_bf16 v[184:187], a[244:247], v[8:11], v[184:187]
s_add_u32 m0, s28, 67584
ds_read_b64_tr_b16 a[234:235], v241 offset:640
s_mov_b32 s29, 327808
v_mfma_f32_16x16x32_bf16 v[188:191], a[244:247], v[12:15], 0
ds_read_b64_tr_b16 a[236:237], v241 offset:768
v_mfma_f32_16x16x32_bf16 v[188:191], a[240:243], v[4:7], v[188:191]
s_waitcnt lgkmcnt(7)
ds_read_b64_tr_b16 a[238:239], v241 offset:896
v_mfma_f32_16x16x32_bf16 v[188:191], a[248:251], v[20:23], v[188:191]
ds_read_b64_tr_b16 a[240:241], v241 offset:32
v_mfma_f32_16x16x32_bf16 v[188:191], a[252:255], v[28:31], v[188:191]
ds_read_b64_tr_b16 a[242:243], v241 offset:160
v_mfma_f32_16x16x32_bf16 v[184:187], a[252:255], v[24:27], v[184:187]
ds_read_b64_tr_b16 a[244:245], v241 offset:288
v_mfma_f32_16x16x32_bf16 v[184:187], a[248:251], v[16:19], v[184:187]
ds_read_b64_tr_b16 a[246:247], v241 offset:416
v_mfma_f32_16x16x32_bf16 v[224:227], v[232:235], v[32:35], v[224:227]
v_exp_f32 v214, v214
v_mfma_f32_16x16x32_bf16 v[224:227], v[232:235], v[40:43], v[224:227]
buffer_load_dwordx4 v246, s[8:11], s29 offen offset:0 nt lds
v_cvt_pk_bf16_f32 v124, v212, v213
v_mfma_f32_16x16x32_bf16 v[224:227], v[232:235], v[48:51], v[224:227]
v_exp_f32 v215, v215
v_mfma_f32_16x16x32_bf16 v[224:227], v[232:235], v[56:59], v[224:227]
s_waitcnt lgkmcnt(8)
v_exp_f32 v216, v216
v_mfma_f32_16x16x32_bf16 v[160:163], a[224:227], v[32:35], v[160:163]
ds_read_b64_tr_b16 a[248:249], v241 offset:544
v_cvt_pk_bf16_f32 v125, v214, v215
v_mfma_f32_16x16x32_bf16 v[160:163], a[228:231], v[40:43], v[160:163]
ds_read_b64_tr_b16 a[250:251], v241 offset:672
v_mfma_f32_16x16x32_bf16 v[164:167], a[228:231], v[44:47], v[164:167]
ds_read_b64_tr_b16 a[252:253], v241 offset:800
v_mfma_f32_16x16x32_bf16 v[164:167], a[224:227], v[36:39], v[164:167]
s_waitcnt lgkmcnt(7)
ds_read_b64_tr_b16 a[254:255], v241 offset:928
v_mfma_f32_16x16x32_bf16 v[164:167], a[232:235], v[52:55], v[164:167]
ds_read_b64_tr_b16 a[224:225], v241 offset:64
buffer_load_dwordx4 v247, s[8:11], s29 offen offset:1056 nt lds
v_mfma_f32_16x16x32_bf16 v[164:167], a[236:239], v[60:63], v[164:167]
ds_read_b64_tr_b16 a[226:227], v241 offset:192
v_mfma_f32_16x16x32_bf16 v[160:163], a[236:239], v[56:59], v[160:163]
ds_read_b64_tr_b16 a[228:229], v241 offset:320
v_mfma_f32_16x16x32_bf16 v[160:163], a[232:235], v[48:51], v[160:163]
s_waitcnt lgkmcnt(7)
ds_read_b64_tr_b16 a[230:231], v241 offset:448
v_mfma_f32_16x16x32_bf16 v[168:171], a[240:243], v[32:35], v[168:171]
ds_read_b64_tr_b16 a[232:233], v241 offset:576
v_mfma_f32_16x16x32_bf16 v[168:171], a[244:247], v[40:43], v[168:171]
ds_read_b64_tr_b16 a[234:235], v241 offset:704
v_mfma_f32_16x16x32_bf16 v[172:175], a[244:247], v[44:47], v[172:175]
ds_read_b64_tr_b16 a[236:237], v241 offset:832
v_mfma_f32_16x16x32_bf16 v[172:175], a[240:243], v[36:39], v[172:175]
s_waitcnt lgkmcnt(7)
ds_read_b64_tr_b16 a[238:239], v241 offset:960
v_mfma_f32_16x16x32_bf16 v[172:175], a[248:251], v[52:55], v[172:175]
ds_read_b64_tr_b16 a[240:241], v241 offset:96
buffer_load_dwordx4 v248, s[8:11], s29 offen offset:2112 nt lds
v_mfma_f32_16x16x32_bf16 v[172:175], a[252:255], v[60:63], v[172:175]
ds_read_b64_tr_b16 a[242:243], v241 offset:224
v_mfma_f32_16x16x32_bf16 v[168:171], a[252:255], v[56:59], v[168:171]
ds_read_b64_tr_b16 a[244:245], v241 offset:352
v_mfma_f32_16x16x32_bf16 v[168:171], a[248:251], v[48:51], v[168:171]
ds_read_b64_tr_b16 a[246:247], v241 offset:480
v_mfma_f32_16x16x32_bf16 v[228:231], v[232:235], v[36:39], v[228:231]
v_exp_f32 v217, v217
v_mfma_f32_16x16x32_bf16 v[228:231], v[232:235], v[44:47], v[228:231]
v_exp_f32 v218, v218
v_mfma_f32_16x16x32_bf16 v[228:231], v[232:235], v[52:55], v[228:231]
v_cvt_pk_bf16_f32 v122, v216, v217
v_mfma_f32_16x16x32_bf16 v[228:231], v[232:235], v[60:63], v[228:231]
s_waitcnt lgkmcnt(8)
v_exp_f32 v219, v219
v_mfma_f32_16x16x32_bf16 v[176:179], a[224:227], v[32:35], v[176:179]
ds_read_b64_tr_b16 a[248:249], v241 offset:608
buffer_load_dwordx4 v249, s[8:11], s29 offen offset:3168 nt lds
v_mfma_f32_16x16x32_bf16 v[176:179], a[228:231], v[40:43], v[176:179]
ds_read_b64_tr_b16 a[250:251], v241 offset:736
v_mbcnt_lo_u32_b32 v255, -1, 0
v_mfma_f32_16x16x32_bf16 v[180:183], a[228:231], v[44:47], v[180:183]
s_waitcnt lgkmcnt(6)
ds_read_b64_tr_b16 a[252:253], v241 offset:864
v_mbcnt_hi_u32_b32 v255, -1, v255
v_mfma_f32_16x16x32_bf16 v[180:183], a[224:227], v[36:39], v[180:183]
s_waitcnt vmcnt(12)
ds_read_b64_tr_b16 a[254:255], v241 offset:992
s_barrier
v_mfma_f32_16x16x32_bf16 v[180:183], a[232:235], v[52:55], v[180:183]
ds_read_b64_tr_b16 a[224:225], v239 offset:50688
v_min_u32 v255, 13, v255
v_mfma_f32_16x16x32_bf16 v[180:183], a[236:239], v[60:63], v[180:183]
s_add_u32 s30, s44, 229376
ds_read_b64_tr_b16 a[226:227], v239 offset:50816
v_lshlrev_b32 v255, 7, v255
v_mfma_f32_16x16x32_bf16 v[176:179], a[236:239], v[56:59], v[176:179]
ds_read_b64_tr_b16 a[228:229], v239 offset:50944
v_mfma_f32_16x16x32_bf16 v[176:179], a[232:235], v[48:51], v[176:179]
s_waitcnt lgkmcnt(7)
ds_read_b64_tr_b16 a[230:231], v239 offset:51072
v_mfma_f32_16x16x32_bf16 v[184:187], a[240:243], v[32:35], v[184:187]
ds_read_b64_tr_b16 a[232:233], v239 offset:51200
buffer_load_dword v255, v255, s[40:43], s30 offen
v_mfma_f32_16x16x32_bf16 v[184:187], a[244:247], v[40:43], v[184:187]
s_add_u32 m0, s28, 101376
ds_read_b64_tr_b16 a[234:235], v239 offset:51328
s_mov_b32 s29, 393344
v_mfma_f32_16x16x32_bf16 v[188:191], a[244:247], v[44:47], v[188:191]
ds_read_b64_tr_b16 a[236:237], v239 offset:51456
v_mfma_f32_16x16x32_bf16 v[188:191], a[240:243], v[36:39], v[188:191]
s_waitcnt lgkmcnt(7)
ds_read_b64_tr_b16 a[238:239], v239 offset:51584
v_mfma_f32_16x16x32_bf16 v[188:191], a[248:251], v[52:55], v[188:191]
ds_read_b64_tr_b16 a[240:241], v239 offset:50720
v_mfma_f32_16x16x32_bf16 v[188:191], a[252:255], v[60:63], v[188:191]
ds_read_b64_tr_b16 a[242:243], v239 offset:50848
v_mfma_f32_16x16x32_bf16 v[184:187], a[252:255], v[56:59], v[184:187]
ds_read_b64_tr_b16 a[244:245], v239 offset:50976
v_mfma_f32_16x16x32_bf16 v[184:187], a[248:251], v[48:51], v[184:187]
ds_read_b64_tr_b16 a[246:247], v239 offset:51104
v_mfma_f32_16x16x32_bf16 v[224:227], v[232:235], v[64:67], v[224:227]
v_exp_f32 v220, v220
v_mfma_f32_16x16x32_bf16 v[224:227], v[232:235], v[72:75], v[224:227]
buffer_load_dwordx4 v246, s[8:11], s29 offen offset:0 nt lds
v_cvt_pk_bf16_f32 v123, v218, v219
v_mfma_f32_16x16x32_bf16 v[224:227], v[232:235], v[80:83], v[224:227]
v_exp_f32 v221, v221
v_mfma_f32_16x16x32_bf16 v[224:227], v[232:235], v[88:91], v[224:227]
s_waitcnt lgkmcnt(8)
v_exp_f32 v222, v222
v_mfma_f32_16x16x32_bf16 v[160:163], a[224:227], v[64:67], v[160:163]
ds_read_b64_tr_b16 a[248:249], v239 offset:51232
v_cvt_pk_bf16_f32 v126, v220, v221
v_mfma_f32_16x16x32_bf16 v[160:163], a[228:231], v[72:75], v[160:163]
ds_read_b64_tr_b16 a[250:251], v239 offset:51360
v_mfma_f32_16x16x32_bf16 v[164:167], a[228:231], v[76:79], v[164:167]
ds_read_b64_tr_b16 a[252:253], v239 offset:51488
v_mfma_f32_16x16x32_bf16 v[164:167], a[224:227], v[68:71], v[164:167]
s_waitcnt lgkmcnt(7)
ds_read_b64_tr_b16 a[254:255], v239 offset:51616
v_mfma_f32_16x16x32_bf16 v[164:167], a[232:235], v[84:87], v[164:167]
ds_read_b64_tr_b16 a[224:225], v239 offset:50752
v_mfma_f32_16x16x32_bf16 v[164:167], a[236:239], v[92:95], v[164:167]
ds_read_b64_tr_b16 a[226:227], v239 offset:50880
v_mfma_f32_16x16x32_bf16 v[160:163], a[236:239], v[88:91], v[160:163]
ds_read_b64_tr_b16 a[228:229], v239 offset:51008
buffer_load_dwordx4 v247, s[8:11], s29 offen offset:1056 nt lds
v_mfma_f32_16x16x32_bf16 v[160:163], a[232:235], v[80:83], v[160:163]
s_waitcnt lgkmcnt(7)
ds_read_b64_tr_b16 a[230:231], v239 offset:51136
v_mfma_f32_16x16x32_bf16 v[168:171], a[240:243], v[64:67], v[168:171]
ds_read_b64_tr_b16 a[232:233], v239 offset:51264
v_mfma_f32_16x16x32_bf16 v[168:171], a[244:247], v[72:75], v[168:171]
ds_read_b64_tr_b16 a[234:235], v239 offset:51392
v_mfma_f32_16x16x32_bf16 v[172:175], a[244:247], v[76:79], v[172:175]
ds_read_b64_tr_b16 a[236:237], v239 offset:51520
v_mfma_f32_16x16x32_bf16 v[172:175], a[240:243], v[68:71], v[172:175]
s_waitcnt lgkmcnt(7)
ds_read_b64_tr_b16 a[238:239], v239 offset:51648
v_mfma_f32_16x16x32_bf16 v[172:175], a[248:251], v[84:87], v[172:175]
ds_read_b64_tr_b16 a[240:241], v239 offset:50784
v_mfma_f32_16x16x32_bf16 v[172:175], a[252:255], v[92:95], v[172:175]
ds_read_b64_tr_b16 a[242:243], v239 offset:50912
v_mfma_f32_16x16x32_bf16 v[168:171], a[252:255], v[88:91], v[168:171]
ds_read_b64_tr_b16 a[244:245], v239 offset:51040
v_mfma_f32_16x16x32_bf16 v[168:171], a[248:251], v[80:83], v[168:171]
ds_read_b64_tr_b16 a[246:247], v239 offset:51168
v_mfma_f32_16x16x32_bf16 v[228:231], v[232:235], v[68:71], v[228:231]
v_exp_f32 v223, v223
v_mfma_f32_16x16x32_bf16 v[228:231], v[232:235], v[76:79], v[228:231]
v_cvt_pk_bf16_f32 v127, v222, v223
v_mfma_f32_16x16x32_bf16 v[228:231], v[232:235], v[84:87], v[228:231]
buffer_load_dwordx4 v248, s[8:11], s29 offen offset:2112 nt lds
v_mfma_f32_16x16x32_bf16 v[228:231], v[232:235], v[92:95], v[228:231]
s_waitcnt lgkmcnt(8)
v_mfma_f32_16x16x32_bf16 v[176:179], a[224:227], v[64:67], v[176:179]
ds_read_b64_tr_b16 a[248:249], v239 offset:51296
v_mfma_f32_16x16x32_bf16 v[176:179], a[228:231], v[72:75], v[176:179]
ds_read_b64_tr_b16 a[250:251], v239 offset:51424
v_mfma_f32_16x16x32_bf16 v[180:183], a[228:231], v[76:79], v[180:183]
s_waitcnt lgkmcnt(6)
ds_read_b64_tr_b16 a[252:253], v239 offset:51552
v_mfma_f32_16x16x32_bf16 v[180:183], a[224:227], v[68:71], v[180:183]
s_waitcnt vmcnt(12)
ds_read_b64_tr_b16 a[254:255], v239 offset:51680
s_barrier
v_mfma_f32_16x16x32_bf16 v[180:183], a[232:235], v[84:87], v[180:183]
ds_read_b64_tr_b16 a[224:225], v239 offset:33792
v_mfma_f32_16x16x32_bf16 v[180:183], a[236:239], v[92:95], v[180:183]
ds_read_b64_tr_b16 a[226:227], v239 offset:33920
v_mfma_f32_16x16x32_bf16 v[176:179], a[236:239], v[88:91], v[176:179]
ds_read_b64_tr_b16 a[228:229], v239 offset:34048
buffer_load_dwordx4 v249, s[8:11], s29 offen offset:3168 nt lds
v_mfma_f32_16x16x32_bf16 v[176:179], a[232:235], v[80:83], v[176:179]
s_waitcnt lgkmcnt(7)
ds_read_b64_tr_b16 a[230:231], v239 offset:34176
v_mfma_f32_16x16x32_bf16 v[184:187], a[240:243], v[64:67], v[184:187]
ds_read_b64_tr_b16 a[232:233], v239 offset:34304
v_mfma_f32_16x16x32_bf16 v[184:187], a[244:247], v[72:75], v[184:187]
s_add_u32 m0, s28, 118272
ds_read_b64_tr_b16 a[234:235], v239 offset:34432
s_mov_b32 s29, 458880
v_mfma_f32_16x16x32_bf16 v[188:191], a[244:247], v[76:79], v[188:191]
ds_read_b64_tr_b16 a[236:237], v239 offset:34560
v_mfma_f32_16x16x32_bf16 v[188:191], a[240:243], v[68:71], v[188:191]
s_waitcnt lgkmcnt(7)
ds_read_b64_tr_b16 a[238:239], v239 offset:34688
v_mfma_f32_16x16x32_bf16 v[188:191], a[248:251], v[84:87], v[188:191]
ds_read_b64_tr_b16 a[240:241], v239 offset:33824
v_mfma_f32_16x16x32_bf16 v[188:191], a[252:255], v[92:95], v[188:191]
ds_read_b64_tr_b16 a[242:243], v239 offset:33952
v_mfma_f32_16x16x32_bf16 v[184:187], a[252:255], v[88:91], v[184:187]
ds_read_b64_tr_b16 a[244:245], v239 offset:34080
v_mfma_f32_16x16x32_bf16 v[184:187], a[248:251], v[80:83], v[184:187]
ds_read_b64_tr_b16 a[246:247], v239 offset:34208
v_mfma_f32_16x16x32_bf16 v[224:227], v[232:235], v[96:99], v[224:227]
v_mfma_f32_16x16x32_bf16 v[224:227], v[232:235], v[104:107], v[224:227]
buffer_load_dwordx4 v246, s[8:11], s29 offen offset:0 nt lds
v_mfma_f32_16x16x32_bf16 v[224:227], v[232:235], v[112:115], v[224:227]
v_mfma_f32_16x16x32_bf16 v[224:227], v[232:235], v[120:123], v[224:227]
s_waitcnt lgkmcnt(8)
v_mfma_f32_16x16x32_bf16 v[160:163], a[224:227], v[96:99], v[160:163]
ds_read_b64_tr_b16 a[248:249], v239 offset:34336
v_mfma_f32_16x16x32_bf16 v[160:163], a[228:231], v[104:107], v[160:163]
ds_read_b64_tr_b16 a[250:251], v239 offset:34464
v_mfma_f32_16x16x32_bf16 v[164:167], a[228:231], v[108:111], v[164:167]
ds_read_b64_tr_b16 a[252:253], v239 offset:34592
v_mfma_f32_16x16x32_bf16 v[164:167], a[224:227], v[100:103], v[164:167]
s_waitcnt lgkmcnt(7)
ds_read_b64_tr_b16 a[254:255], v239 offset:34720
v_mfma_f32_16x16x32_bf16 v[164:167], a[232:235], v[116:119], v[164:167]
ds_read_b64_tr_b16 a[224:225], v239 offset:33856
buffer_load_dwordx4 v247, s[8:11], s29 offen offset:1056 nt lds
v_mfma_f32_16x16x32_bf16 v[164:167], a[236:239], v[124:127], v[164:167]
ds_read_b64_tr_b16 a[226:227], v239 offset:33984
v_mfma_f32_16x16x32_bf16 v[160:163], a[236:239], v[120:123], v[160:163]
ds_read_b64_tr_b16 a[228:229], v239 offset:34112
v_mfma_f32_16x16x32_bf16 v[160:163], a[232:235], v[112:115], v[160:163]
s_waitcnt lgkmcnt(7)
ds_read_b64_tr_b16 a[230:231], v239 offset:34240
v_mfma_f32_16x16x32_bf16 v[168:171], a[240:243], v[96:99], v[168:171]
ds_read_b64_tr_b16 a[232:233], v239 offset:34368
v_mfma_f32_16x16x32_bf16 v[168:171], a[244:247], v[104:107], v[168:171]
ds_read_b64_tr_b16 a[234:235], v239 offset:34496
v_mfma_f32_16x16x32_bf16 v[172:175], a[244:247], v[108:111], v[172:175]
ds_read_b64_tr_b16 a[236:237], v239 offset:34624
v_mfma_f32_16x16x32_bf16 v[172:175], a[240:243], v[100:103], v[172:175]
s_waitcnt lgkmcnt(7)
ds_read_b64_tr_b16 a[238:239], v239 offset:34752
v_mfma_f32_16x16x32_bf16 v[172:175], a[248:251], v[116:119], v[172:175]
ds_read_b64_tr_b16 a[240:241], v239 offset:33888
v_mfma_f32_16x16x32_bf16 v[172:175], a[252:255], v[124:127], v[172:175]
ds_read_b64_tr_b16 a[242:243], v239 offset:34016
v_mfma_f32_16x16x32_bf16 v[168:171], a[252:255], v[120:123], v[168:171]
ds_read_b64_tr_b16 a[244:245], v239 offset:34144
v_mfma_f32_16x16x32_bf16 v[168:171], a[248:251], v[112:115], v[168:171]
ds_read_b64_tr_b16 a[246:247], v239 offset:34272
v_mfma_f32_16x16x32_bf16 v[228:231], v[232:235], v[100:103], v[228:231]
buffer_load_dwordx4 v248, s[8:11], s29 offen offset:2112 nt lds
v_mfma_f32_16x16x32_bf16 v[228:231], v[232:235], v[108:111], v[228:231]
v_mfma_f32_16x16x32_bf16 v[228:231], v[232:235], v[116:119], v[228:231]
v_mfma_f32_16x16x32_bf16 v[228:231], v[232:235], v[124:127], v[228:231]
s_waitcnt lgkmcnt(8)
v_mfma_f32_16x16x32_bf16 v[176:179], a[224:227], v[96:99], v[176:179]
ds_read_b64_tr_b16 a[248:249], v239 offset:34400
buffer_load_dwordx4 v249, s[8:11], s29 offen offset:3168 nt lds
v_mfma_f32_16x16x32_bf16 v[176:179], a[228:231], v[104:107], v[176:179]
ds_read_b64_tr_b16 a[250:251], v239 offset:34528
v_mbcnt_lo_u32_b32 v255, -1, 0
v_mfma_f32_16x16x32_bf16 v[180:183], a[228:231], v[108:111], v[180:183]
s_waitcnt lgkmcnt(6)
ds_read_b64_tr_b16 a[252:253], v239 offset:34656
v_mbcnt_hi_u32_b32 v255, -1, v255
v_mfma_f32_16x16x32_bf16 v[180:183], a[224:227], v[100:103], v[180:183]
s_waitcnt vmcnt(13)
ds_read_b64_tr_b16 a[254:255], v239 offset:34784
s_barrier
v_mfma_f32_16x16x32_bf16 v[180:183], a[232:235], v[116:119], v[180:183]
ds_read_b64_tr_b16 a[224:225], v240 offset:16896
v_min_u32 v255, 13, v255
v_mfma_f32_16x16x32_bf16 v[180:183], a[236:239], v[124:127], v[180:183]
ds_read_b64_tr_b16 a[226:227], v240 offset:17024
v_rcp_f32 v242, v224
v_mfma_f32_16x16x32_bf16 v[176:179], a[236:239], v[120:123], v[176:179]
ds_read_b64_tr_b16 a[228:229], v240 offset:17152
v_rcp_f32 v243, v228
v_mfma_f32_16x16x32_bf16 v[176:179], a[232:235], v[112:115], v[176:179]
s_waitcnt lgkmcnt(7)
ds_read_b64_tr_b16 a[230:231], v240 offset:17280
s_add_u32 s30, s44, 231168
v_lshlrev_b32 v255, 7, v255
v_mfma_f32_16x16x32_bf16 v[184:187], a[240:243], v[96:99], v[184:187]
ds_read_b64_tr_b16 a[232:233], v240 offset:17408
buffer_load_dword v255, v255, s[40:43], s30 offen
v_mul_f32 v160, v160, v242
v_mfma_f32_16x16x32_bf16 v[184:187], a[244:247], v[104:107], v[184:187]
ds_read_b64_tr_b16 a[234:235], v240 offset:17536
v_mul_f32 v161, v161, v242
v_mbcnt_lo_u32_b32 v250, -1, 0
v_mfma_f32_16x16x32_bf16 v[188:191], a[244:247], v[108:111], v[188:191]
ds_read_b64_tr_b16 a[236:237], v240 offset:17664
v_mul_f32 v162, v162, v242
v_mbcnt_hi_u32_b32 v250, -1, v250
v_mfma_f32_16x16x32_bf16 v[188:191], a[240:243], v[100:103], v[188:191]
s_waitcnt lgkmcnt(7)
ds_read_b64_tr_b16 a[238:239], v240 offset:17792
v_mul_f32 v163, v163, v242
v_lshrrev_b32 v251, 3, v250
v_mfma_f32_16x16x32_bf16 v[188:191], a[248:251], v[116:119], v[188:191]
ds_read_b64_tr_b16 a[240:241], v240 offset:16928
v_cvt_pk_bf16_f32 v128, v160, v161
v_and_b32 v252, 7, v250
v_mfma_f32_16x16x32_bf16 v[188:191], a[252:255], v[124:127], v[188:191]
ds_read_b64_tr_b16 a[242:243], v240 offset:17056
v_cvt_pk_bf16_f32 v129, v162, v163
v_mul_u32_u24 v251, 14336, v251
v_mfma_f32_16x16x32_bf16 v[184:187], a[252:255], v[120:123], v[184:187]
ds_read_b64_tr_b16 a[244:245], v240 offset:17184
v_mul_f32 v164, v164, v243
v_lshl_add_u32 v253, v252, 4, v251
v_add_u32 v253, s34, v253
v_mfma_f32_16x16x32_bf16 v[184:187], a[248:251], v[112:115], v[184:187]
s_waitcnt lgkmcnt(7)
ds_read_b64_tr_b16 a[246:247], v240 offset:17312
v_mul_f32 v165, v165, v243
v_add_u32 v250, 480, v253
v_add_u32 v251, 320, v253
v_mfma_f32_16x16x32_bf16 v[192:195], a[224:227], v[0:3], 0
s_add_u32 m0, s28, 16896
ds_read_b64_tr_b16 a[248:249], v240 offset:17440
s_mov_b32 s45, 229376
v_mul_f32 v166, v166, v243
v_add_u32 v252, 160, v253
v_mfma_f32_16x16x32_bf16 v[192:195], a[228:231], v[8:11], v[192:195]
ds_read_b64_tr_b16 a[250:251], v240 offset:17568
buffer_load_dwordx4 v250, s[16:19], s45 offen offset:0 lds
v_mul_f32 v167, v167, v243
v_mfma_f32_16x16x32_bf16 v[196:199], a[228:231], v[12:15], 0
ds_read_b64_tr_b16 a[252:253], v240 offset:17696
v_cvt_pk_bf16_f32 v132, v164, v165
v_mfma_f32_16x16x32_bf16 v[196:199], a[224:227], v[4:7], v[196:199]
s_waitcnt lgkmcnt(7)
ds_read_b64_tr_b16 a[254:255], v240 offset:17824
v_cvt_pk_bf16_f32 v133, v166, v167
v_mfma_f32_16x16x32_bf16 v[196:199], a[232:235], v[20:23], v[196:199]
ds_read_b64_tr_b16 a[224:225], v240 offset:16960
v_mul_f32 v168, v168, v242
v_mfma_f32_16x16x32_bf16 v[196:199], a[236:239], v[28:31], v[196:199]
ds_read_b64_tr_b16 a[226:227], v240 offset:17088
v_mul_f32 v169, v169, v242
v_mfma_f32_16x16x32_bf16 v[192:195], a[236:239], v[24:27], v[192:195]
ds_read_b64_tr_b16 a[228:229], v240 offset:17216
v_mul_f32 v170, v170, v242
v_mfma_f32_16x16x32_bf16 v[192:195], a[232:235], v[16:19], v[192:195]
s_waitcnt lgkmcnt(7)
ds_read_b64_tr_b16 a[230:231], v240 offset:17344
v_mul_f32 v171, v171, v242
v_mfma_f32_16x16x32_bf16 v[200:203], a[240:243], v[0:3], 0
ds_read_b64_tr_b16 a[232:233], v240 offset:17472
buffer_load_dwordx4 v251, s[16:19], s45 offen offset:1056 lds
v_cvt_pk_bf16_f32 v130, v168, v169
v_mfma_f32_16x16x32_bf16 v[200:203], a[244:247], v[8:11], v[200:203]
ds_read_b64_tr_b16 a[234:235], v240 offset:17600
v_cvt_pk_bf16_f32 v131, v170, v171
v_mfma_f32_16x16x32_bf16 v[204:207], a[244:247], v[12:15], 0
ds_read_b64_tr_b16 a[236:237], v240 offset:17728
v_mul_f32 v172, v172, v243
v_mfma_f32_16x16x32_bf16 v[204:207], a[240:243], v[4:7], v[204:207]
s_waitcnt lgkmcnt(7)
ds_read_b64_tr_b16 a[238:239], v240 offset:17856
v_mul_f32 v173, v173, v243
v_mfma_f32_16x16x32_bf16 v[204:207], a[248:251], v[20:23], v[204:207]
ds_read_b64_tr_b16 a[240:241], v240 offset:16992
v_mul_f32 v174, v174, v243
v_mfma_f32_16x16x32_bf16 v[204:207], a[252:255], v[28:31], v[204:207]
ds_read_b64_tr_b16 a[242:243], v240 offset:17120
v_mul_f32 v175, v175, v243
v_mfma_f32_16x16x32_bf16 v[200:203], a[252:255], v[24:27], v[200:203]
ds_read_b64_tr_b16 a[244:245], v240 offset:17248
v_cvt_pk_bf16_f32 v134, v172, v173
v_mfma_f32_16x16x32_bf16 v[200:203], a[248:251], v[16:19], v[200:203]
s_waitcnt lgkmcnt(7)
ds_read_b64_tr_b16 a[246:247], v240 offset:17376
v_cvt_pk_bf16_f32 v135, v174, v175
v_mfma_f32_16x16x32_bf16 v[208:211], a[224:227], v[0:3], 0
ds_read_b64_tr_b16 a[248:249], v240 offset:17504
buffer_load_dwordx4 v252, s[16:19], s45 offen offset:2112 lds
v_mul_f32 v176, v176, v242
v_mfma_f32_16x16x32_bf16 v[208:211], a[228:231], v[8:11], v[208:211]
ds_read_b64_tr_b16 a[250:251], v240 offset:17632
v_mul_f32 v177, v177, v242
v_mfma_f32_16x16x32_bf16 v[212:215], a[228:231], v[12:15], 0
s_waitcnt lgkmcnt(6)
ds_read_b64_tr_b16 a[252:253], v240 offset:17760
v_mul_f32 v178, v178, v242
v_mfma_f32_16x16x32_bf16 v[212:215], a[224:227], v[4:7], v[212:215]
s_waitcnt vmcnt(13)
ds_read_b64_tr_b16 a[254:255], v240 offset:17888
s_barrier
v_mfma_f32_16x16x32_bf16 v[212:215], a[232:235], v[20:23], v[212:215]
ds_read_b64_tr_b16 a[224:225], v240 offset:0
v_mul_f32 v179, v179, v242
v_mfma_f32_16x16x32_bf16 v[212:215], a[236:239], v[28:31], v[212:215]
ds_read_b64_tr_b16 a[226:227], v240 offset:128
v_cvt_pk_bf16_f32 v136, v176, v177
v_mfma_f32_16x16x32_bf16 v[208:211], a[236:239], v[24:27], v[208:211]
ds_read_b64_tr_b16 a[228:229], v240 offset:256
v_cvt_pk_bf16_f32 v137, v178, v179
v_mfma_f32_16x16x32_bf16 v[208:211], a[232:235], v[16:19], v[208:211]
s_waitcnt lgkmcnt(7)
ds_read_b64_tr_b16 a[230:231], v240 offset:384
v_mul_f32 v180, v180, v243
v_mfma_f32_16x16x32_bf16 v[216:219], a[240:243], v[0:3], 0
ds_read_b64_tr_b16 a[232:233], v240 offset:512
buffer_load_dwordx4 v253, s[16:19], s45 offen offset:3168 lds
v_mul_f32 v181, v181, v243
v_mfma_f32_16x16x32_bf16 v[216:219], a[244:247], v[8:11], v[216:219]
s_add_u32 m0, s28, 0
ds_read_b64_tr_b16 a[234:235], v240 offset:640
v_mul_f32 v182, v182, v243
v_mfma_f32_16x16x32_bf16 v[220:223], a[244:247], v[12:15], 0
s_mov_b32 s29, 262400
ds_read_b64_tr_b16 a[236:237], v240 offset:768
v_mul_f32 v183, v183, v243
v_mfma_f32_16x16x32_bf16 v[220:223], a[240:243], v[4:7], v[220:223]
s_waitcnt lgkmcnt(7)
ds_read_b64_tr_b16 a[238:239], v240 offset:896
v_cvt_pk_bf16_f32 v140, v180, v181
v_mfma_f32_16x16x32_bf16 v[220:223], a[248:251], v[20:23], v[220:223]
ds_read_b64_tr_b16 a[240:241], v240 offset:32
v_cvt_pk_bf16_f32 v141, v182, v183
v_mfma_f32_16x16x32_bf16 v[220:223], a[252:255], v[28:31], v[220:223]
ds_read_b64_tr_b16 a[242:243], v240 offset:160
v_mul_f32 v184, v184, v242
v_mfma_f32_16x16x32_bf16 v[216:219], a[252:255], v[24:27], v[216:219]
ds_read_b64_tr_b16 a[244:245], v240 offset:288
v_mul_f32 v185, v185, v242
v_mfma_f32_16x16x32_bf16 v[216:219], a[248:251], v[16:19], v[216:219]
s_waitcnt lgkmcnt(7)
ds_read_b64_tr_b16 a[246:247], v240 offset:416
v_mul_f32 v186, v186, v242
v_mfma_f32_16x16x32_bf16 v[192:195], a[224:227], v[32:35], v[192:195]
ds_read_b64_tr_b16 a[248:249], v240 offset:544
v_mul_f32 v187, v187, v242
v_mfma_f32_16x16x32_bf16 v[192:195], a[228:231], v[40:43], v[192:195]
ds_read_b64_tr_b16 a[250:251], v240 offset:672
buffer_load_dwordx4 v246, s[8:11], s29 offen offset:0 nt lds
v_cvt_pk_bf16_f32 v138, v184, v185
v_mfma_f32_16x16x32_bf16 v[196:199], a[228:231], v[44:47], v[196:199]
ds_read_b64_tr_b16 a[252:253], v240 offset:800
v_cvt_pk_bf16_f32 v139, v186, v187
v_mfma_f32_16x16x32_bf16 v[196:199], a[224:227], v[36:39], v[196:199]
s_waitcnt lgkmcnt(7)
ds_read_b64_tr_b16 a[254:255], v240 offset:928
v_mul_f32 v188, v188, v243
v_mfma_f32_16x16x32_bf16 v[196:199], a[232:235], v[52:55], v[196:199]
ds_read_b64_tr_b16 a[224:225], v240 offset:64
v_mul_f32 v189, v189, v243
v_mfma_f32_16x16x32_bf16 v[196:199], a[236:239], v[60:63], v[196:199]
ds_read_b64_tr_b16 a[226:227], v240 offset:192
v_mul_f32 v190, v190, v243
v_mfma_f32_16x16x32_bf16 v[192:195], a[236:239], v[56:59], v[192:195]
ds_read_b64_tr_b16 a[228:229], v240 offset:320
v_mul_f32 v191, v191, v243
v_mfma_f32_16x16x32_bf16 v[192:195], a[232:235], v[48:51], v[192:195]
s_waitcnt lgkmcnt(7)
ds_read_b64_tr_b16 a[230:231], v240 offset:448
v_cvt_pk_bf16_f32 v142, v188, v189
v_mfma_f32_16x16x32_bf16 v[200:203], a[240:243], v[32:35], v[200:203]
ds_read_b64_tr_b16 a[232:233], v240 offset:576
buffer_load_dwordx4 v247, s[8:11], s29 offen offset:1056 nt lds
v_cvt_pk_bf16_f32 v143, v190, v191
v_mfma_f32_16x16x32_bf16 v[200:203], a[244:247], v[40:43], v[200:203]
ds_read_b64_tr_b16 a[234:235], v240 offset:704
v_mbcnt_lo_u32_b32 v244, -1, 0
v_mfma_f32_16x16x32_bf16 v[204:207], a[244:247], v[44:47], v[204:207]
ds_read_b64_tr_b16 a[236:237], v240 offset:832
v_mbcnt_hi_u32_b32 v244, -1, v244
v_mfma_f32_16x16x32_bf16 v[204:207], a[240:243], v[36:39], v[204:207]
s_waitcnt lgkmcnt(7)
ds_read_b64_tr_b16 a[238:239], v240 offset:960
v_and_b32 v238, 7, v244
v_mfma_f32_16x16x32_bf16 v[204:207], a[248:251], v[52:55], v[204:207]
ds_read_b64_tr_b16 a[240:241], v240 offset:96
v_lshlrev_b32 v238, 2, v238
v_mfma_f32_16x16x32_bf16 v[204:207], a[252:255], v[60:63], v[204:207]
s_lshl_b32 s35, s100, 3
ds_read_b64_tr_b16 a[242:243], v240 offset:224
v_lshlrev_b32 v244, 4, v244
v_mfma_f32_16x16x32_bf16 v[200:203], a[252:255], v[56:59], v[200:203]
ds_read_b64_tr_b16 a[244:245], v240 offset:352
v_mov_b32 v237, s35
v_mfma_f32_16x16x32_bf16 v[200:203], a[248:251], v[48:51], v[200:203]
s_waitcnt lgkmcnt(7)
ds_read_b64_tr_b16 a[246:247], v240 offset:480
global_load_dwordx2 v[232:233], v237, s[80:81] sc1
v_mfma_f32_16x16x32_bf16 v[208:211], a[224:227], v[32:35], v[208:211]
s_lshl_b32 s35, s100, 9
ds_read_b64_tr_b16 a[248:249], v240 offset:608
s_add_u32 s35, s35, 0x2000000
v_mfma_f32_16x16x32_bf16 v[208:211], a[228:231], v[40:43], v[208:211]
ds_read_b64_tr_b16 a[250:251], v240 offset:736
buffer_load_dwordx4 v248, s[8:11], s29 offen offset:2112 nt lds
v_mfma_f32_16x16x32_bf16 v[212:215], a[228:231], v[44:47], v[212:215]
s_waitcnt lgkmcnt(6)
ds_read_b64_tr_b16 a[252:253], v240 offset:864
v_mfma_f32_16x16x32_bf16 v[212:215], a[224:227], v[36:39], v[212:215]
s_waitcnt vmcnt(13)
ds_read_b64_tr_b16 a[254:255], v240 offset:992
s_barrier
v_mfma_f32_16x16x32_bf16 v[212:215], a[232:235], v[52:55], v[212:215]
ds_read_b64_tr_b16 a[224:225], v240 offset:33792
v_mfma_f32_16x16x32_bf16 v[212:215], a[236:239], v[60:63], v[212:215]
ds_read_b64_tr_b16 a[226:227], v240 offset:33920
v_mfma_f32_16x16x32_bf16 v[208:211], a[236:239], v[56:59], v[208:211]
ds_read_b64_tr_b16 a[228:229], v240 offset:34048
v_mfma_f32_16x16x32_bf16 v[208:211], a[232:235], v[48:51], v[208:211]
s_waitcnt lgkmcnt(7)
ds_read_b64_tr_b16 a[230:231], v240 offset:34176
v_mfma_f32_16x16x32_bf16 v[216:219], a[240:243], v[32:35], v[216:219]
ds_read_b64_tr_b16 a[232:233], v240 offset:34304
buffer_load_dwordx4 v249, s[8:11], s29 offen offset:3168 nt lds
v_mfma_f32_16x16x32_bf16 v[216:219], a[244:247], v[40:43], v[216:219]
s_add_u32 m0, s28, 135168
ds_read_b64_tr_b16 a[234:235], v240 offset:34432
s_mov_b32 s45, 229504
v_mfma_f32_16x16x32_bf16 v[220:223], a[244:247], v[44:47], v[220:223]
ds_read_b64_tr_b16 a[236:237], v240 offset:34560
v_mfma_f32_16x16x32_bf16 v[220:223], a[240:243], v[36:39], v[220:223]
s_waitcnt lgkmcnt(7)
ds_read_b64_tr_b16 a[238:239], v240 offset:34688
v_mfma_f32_16x16x32_bf16 v[220:223], a[248:251], v[52:55], v[220:223]
ds_read_b64_tr_b16 a[240:241], v240 offset:33824
v_mfma_f32_16x16x32_bf16 v[220:223], a[252:255], v[60:63], v[220:223]
ds_read_b64_tr_b16 a[242:243], v240 offset:33952
v_mfma_f32_16x16x32_bf16 v[216:219], a[252:255], v[56:59], v[216:219]
ds_read_b64_tr_b16 a[244:245], v240 offset:34080
v_mfma_f32_16x16x32_bf16 v[216:219], a[248:251], v[48:51], v[216:219]
s_waitcnt lgkmcnt(7)
ds_read_b64_tr_b16 a[246:247], v240 offset:34208
v_mfma_f32_16x16x32_bf16 v[192:195], a[224:227], v[64:67], v[192:195]
ds_read_b64_tr_b16 a[248:249], v240 offset:34336
s_add_u32 s20, s82, s35
s_addc_u32 s21, s83, 0
s_mov_b32 s22, 512
s_mul_i32 s35, s100, 917504
s_add_u32 s4, s82, s35
s_addc_u32 s5, s83, 0
s_mov_b32 s6, 917504
v_mov_b32 v234, 0
s_lshr_b32 s46, s101, 1
s_lshl_b32 s47, s46, 7
s_lshl_b32 s46, s46, 3
v_add_u32 v238, s47, v238
s_lshl_b32 s47, s33, 3
v_mfma_f32_16x16x32_bf16 v[192:195], a[228:231], v[72:75], v[192:195]
ds_read_b64_tr_b16 a[250:251], v240 offset:34464
buffer_load_dwordx4 v250, s[16:19], s45 offen offset:0 lds
v_mfma_f32_16x16x32_bf16 v[196:199], a[228:231], v[76:79], v[196:199]
ds_read_b64_tr_b16 a[252:253], v240 offset:34592
v_mfma_f32_16x16x32_bf16 v[196:199], a[224:227], v[68:71], v[196:199]
s_waitcnt lgkmcnt(7)
ds_read_b64_tr_b16 a[254:255], v240 offset:34720
v_mfma_f32_16x16x32_bf16 v[196:199], a[232:235], v[84:87], v[196:199]
ds_read_b64_tr_b16 a[224:225], v240 offset:33856
buffer_load_dwordx4 v251, s[16:19], s45 offen offset:1056 lds
v_mfma_f32_16x16x32_bf16 v[196:199], a[236:239], v[92:95], v[196:199]
ds_read_b64_tr_b16 a[226:227], v240 offset:33984
v_mfma_f32_16x16x32_bf16 v[192:195], a[236:239], v[88:91], v[192:195]
ds_read_b64_tr_b16 a[228:229], v240 offset:34112
v_mfma_f32_16x16x32_bf16 v[192:195], a[232:235], v[80:83], v[192:195]
s_waitcnt lgkmcnt(7)
ds_read_b64_tr_b16 a[230:231], v240 offset:34240
v_mfma_f32_16x16x32_bf16 v[200:203], a[240:243], v[64:67], v[200:203]
ds_read_b64_tr_b16 a[232:233], v240 offset:34368
buffer_load_dwordx4 v252, s[16:19], s45 offen offset:2112 lds
v_mfma_f32_16x16x32_bf16 v[200:203], a[244:247], v[72:75], v[200:203]
ds_read_b64_tr_b16 a[234:235], v240 offset:34496
v_mfma_f32_16x16x32_bf16 v[204:207], a[244:247], v[76:79], v[204:207]
ds_read_b64_tr_b16 a[236:237], v240 offset:34624
v_mfma_f32_16x16x32_bf16 v[204:207], a[240:243], v[68:71], v[204:207]
s_waitcnt lgkmcnt(7)
ds_read_b64_tr_b16 a[238:239], v240 offset:34752
v_mfma_f32_16x16x32_bf16 v[204:207], a[248:251], v[84:87], v[204:207]
ds_read_b64_tr_b16 a[240:241], v240 offset:33888
buffer_load_dwordx4 v253, s[16:19], s45 offen offset:3168 lds
v_mfma_f32_16x16x32_bf16 v[204:207], a[252:255], v[92:95], v[204:207]
s_add_u32 m0, s28, 50688
ds_read_b64_tr_b16 a[242:243], v240 offset:34016
s_mov_b32 s29, 327936
v_mfma_f32_16x16x32_bf16 v[200:203], a[252:255], v[88:91], v[200:203]
ds_read_b64_tr_b16 a[244:245], v240 offset:34144
v_mfma_f32_16x16x32_bf16 v[200:203], a[248:251], v[80:83], v[200:203]
s_waitcnt lgkmcnt(7)
ds_read_b64_tr_b16 a[246:247], v240 offset:34272
v_mfma_f32_16x16x32_bf16 v[208:211], a[224:227], v[64:67], v[208:211]
ds_read_b64_tr_b16 a[248:249], v240 offset:34400
buffer_load_dwordx4 v246, s[8:11], s29 offen offset:0 nt lds
v_mfma_f32_16x16x32_bf16 v[208:211], a[228:231], v[72:75], v[208:211]
ds_read_b64_tr_b16 a[250:251], v240 offset:34528
v_mfma_f32_16x16x32_bf16 v[212:215], a[228:231], v[76:79], v[212:215]
s_waitcnt lgkmcnt(6)
ds_read_b64_tr_b16 a[252:253], v240 offset:34656
v_mfma_f32_16x16x32_bf16 v[212:215], a[224:227], v[68:71], v[212:215]
s_waitcnt vmcnt(15)
ds_read_b64_tr_b16 a[254:255], v240 offset:34784
s_barrier
v_mfma_f32_16x16x32_bf16 v[212:215], a[232:235], v[84:87], v[212:215]
ds_read_b64_tr_b16 a[224:225], v240 offset:50688
buffer_load_dwordx4 v247, s[8:11], s29 offen offset:1056 nt lds
v_mfma_f32_16x16x32_bf16 v[212:215], a[236:239], v[92:95], v[212:215]
ds_read_b64_tr_b16 a[226:227], v240 offset:50816
v_mfma_f32_16x16x32_bf16 v[208:211], a[236:239], v[88:91], v[208:211]
ds_read_b64_tr_b16 a[228:229], v240 offset:50944
v_mfma_f32_16x16x32_bf16 v[208:211], a[232:235], v[80:83], v[208:211]
s_waitcnt lgkmcnt(7)
ds_read_b64_tr_b16 a[230:231], v240 offset:51072
v_mfma_f32_16x16x32_bf16 v[216:219], a[240:243], v[64:67], v[216:219]
ds_read_b64_tr_b16 a[232:233], v240 offset:51200
buffer_load_dwordx4 v248, s[8:11], s29 offen offset:2112 nt lds
v_mfma_f32_16x16x32_bf16 v[216:219], a[244:247], v[72:75], v[216:219]
ds_read_b64_tr_b16 a[234:235], v240 offset:51328
v_mfma_f32_16x16x32_bf16 v[220:223], a[244:247], v[76:79], v[220:223]
ds_read_b64_tr_b16 a[236:237], v240 offset:51456
v_mfma_f32_16x16x32_bf16 v[220:223], a[240:243], v[68:71], v[220:223]
s_waitcnt lgkmcnt(7)
ds_read_b64_tr_b16 a[238:239], v240 offset:51584
v_mfma_f32_16x16x32_bf16 v[220:223], a[248:251], v[84:87], v[220:223]
ds_read_b64_tr_b16 a[240:241], v240 offset:50720
buffer_load_dwordx4 v249, s[8:11], s29 offen offset:3168 nt lds
v_mfma_f32_16x16x32_bf16 v[220:223], a[252:255], v[92:95], v[220:223]
ds_read_b64_tr_b16 a[242:243], v240 offset:50848
v_mfma_f32_16x16x32_bf16 v[216:219], a[252:255], v[88:91], v[216:219]
ds_read_b64_tr_b16 a[244:245], v240 offset:50976
v_mfma_f32_16x16x32_bf16 v[216:219], a[248:251], v[80:83], v[216:219]
s_waitcnt lgkmcnt(7)
ds_read_b64_tr_b16 a[246:247], v240 offset:51104
v_mfma_f32_16x16x32_bf16 v[192:195], a[224:227], v[96:99], v[192:195]
ds_read_b64_tr_b16 a[248:249], v240 offset:51232
v_mfma_f32_16x16x32_bf16 v[192:195], a[228:231], v[104:107], v[192:195]
ds_read_b64_tr_b16 a[250:251], v240 offset:51360
v_mfma_f32_16x16x32_bf16 v[196:199], a[228:231], v[108:111], v[196:199]
ds_read_b64_tr_b16 a[252:253], v240 offset:51488
v_mfma_f32_16x16x32_bf16 v[196:199], a[224:227], v[100:103], v[196:199]
s_waitcnt lgkmcnt(7)
ds_read_b64_tr_b16 a[254:255], v240 offset:51616
v_mfma_f32_16x16x32_bf16 v[196:199], a[232:235], v[116:119], v[196:199]
ds_read_b64_tr_b16 a[224:225], v240 offset:50752
v_mfma_f32_16x16x32_bf16 v[196:199], a[236:239], v[124:127], v[196:199]
ds_read_b64_tr_b16 a[226:227], v240 offset:50880
v_mfma_f32_16x16x32_bf16 v[192:195], a[236:239], v[120:123], v[192:195]
ds_read_b64_tr_b16 a[228:229], v240 offset:51008
v_mfma_f32_16x16x32_bf16 v[192:195], a[232:235], v[112:115], v[192:195]
s_waitcnt lgkmcnt(7)
ds_read_b64_tr_b16 a[230:231], v240 offset:51136
v_mfma_f32_16x16x32_bf16 v[200:203], a[240:243], v[96:99], v[200:203]
ds_read_b64_tr_b16 a[232:233], v240 offset:51264
v_mfma_f32_16x16x32_bf16 v[200:203], a[244:247], v[104:107], v[200:203]
ds_read_b64_tr_b16 a[234:235], v240 offset:51392
v_mfma_f32_16x16x32_bf16 v[204:207], a[244:247], v[108:111], v[204:207]
ds_read_b64_tr_b16 a[236:237], v240 offset:51520
v_mfma_f32_16x16x32_bf16 v[204:207], a[240:243], v[100:103], v[204:207]
s_waitcnt lgkmcnt(7)
ds_read_b64_tr_b16 a[238:239], v240 offset:51648
v_mfma_f32_16x16x32_bf16 v[204:207], a[248:251], v[116:119], v[204:207]
ds_read_b64_tr_b16 a[240:241], v240 offset:50784
v_mfma_f32_16x16x32_bf16 v[204:207], a[252:255], v[124:127], v[204:207]
ds_read_b64_tr_b16 a[242:243], v240 offset:50912
v_mfma_f32_16x16x32_bf16 v[200:203], a[252:255], v[120:123], v[200:203]
ds_read_b64_tr_b16 a[244:245], v240 offset:51040
v_mfma_f32_16x16x32_bf16 v[200:203], a[248:251], v[112:115], v[200:203]
s_waitcnt lgkmcnt(7)
ds_read_b64_tr_b16 a[246:247], v240 offset:51168
v_mfma_f32_16x16x32_bf16 v[208:211], a[224:227], v[96:99], v[208:211]
ds_read_b64_tr_b16 a[248:249], v240 offset:51296
v_mfma_f32_16x16x32_bf16 v[208:211], a[228:231], v[104:107], v[208:211]
ds_read_b64_tr_b16 a[250:251], v240 offset:51424
v_mfma_f32_16x16x32_bf16 v[212:215], a[228:231], v[108:111], v[212:215]
s_waitcnt lgkmcnt(6)
ds_read_b64_tr_b16 a[252:253], v240 offset:51552
v_mfma_f32_16x16x32_bf16 v[212:215], a[224:227], v[100:103], v[212:215]
s_waitcnt vmcnt(8)
ds_read_b64_tr_b16 a[254:255], v240 offset:51680
s_barrier
v_mfma_f32_16x16x32_bf16 v[212:215], a[232:235], v[116:119], v[212:215]
ds_read_b64_tr_b16 a[224:225], v239 offset:0
v_mul_f32 v192, v192, v242
v_mfma_f32_16x16x32_bf16 v[212:215], a[236:239], v[124:127], v[212:215]
ds_read_b64_tr_b16 a[226:227], v239 offset:128
v_mul_f32 v193, v193, v242
v_mfma_f32_16x16x32_bf16 v[208:211], a[236:239], v[120:123], v[208:211]
ds_read_b64_tr_b16 a[228:229], v239 offset:256
v_mul_f32 v194, v194, v242
v_mfma_f32_16x16x32_bf16 v[208:211], a[232:235], v[112:115], v[208:211]
s_waitcnt lgkmcnt(7)
ds_read_b64_tr_b16 a[230:231], v239 offset:384
v_mul_f32 v195, v195, v242
v_mfma_f32_16x16x32_bf16 v[216:219], a[240:243], v[96:99], v[216:219]
ds_read_b64_tr_b16 a[232:233], v239 offset:512
v_cvt_pk_bf16_f32 v144, v192, v193
v_mfma_f32_16x16x32_bf16 v[216:219], a[244:247], v[104:107], v[216:219]
s_add_u32 m0, s28, 33792
ds_read_b64_tr_b16 a[234:235], v239 offset:640
v_cvt_pk_bf16_f32 v145, v194, v195
v_mfma_f32_16x16x32_bf16 v[220:223], a[244:247], v[108:111], v[220:223]
s_mov_b32 s45, 229632
ds_read_b64_tr_b16 a[236:237], v239 offset:768
v_mul_f32 v196, v196, v243
v_mfma_f32_16x16x32_bf16 v[220:223], a[240:243], v[100:103], v[220:223]
s_waitcnt lgkmcnt(7)
ds_read_b64_tr_b16 a[238:239], v239 offset:896
v_mul_f32 v197, v197, v243
v_mfma_f32_16x16x32_bf16 v[220:223], a[248:251], v[116:119], v[220:223]
ds_read_b64_tr_b16 a[240:241], v239 offset:32
v_mul_f32 v198, v198, v243
v_mfma_f32_16x16x32_bf16 v[220:223], a[252:255], v[124:127], v[220:223]
ds_read_b64_tr_b16 a[242:243], v239 offset:160
v_mul_f32 v199, v199, v243
v_mfma_f32_16x16x32_bf16 v[216:219], a[252:255], v[120:123], v[216:219]
ds_read_b64_tr_b16 a[244:245], v239 offset:288
v_cvt_pk_bf16_f32 v148, v196, v197
v_mfma_f32_16x16x32_bf16 v[216:219], a[248:251], v[112:115], v[216:219]
s_waitcnt lgkmcnt(7)
ds_read_b64_tr_b16 a[246:247], v239 offset:416
v_cvt_pk_bf16_f32 v149, v198, v199
v_mfma_f32_16x16x32_bf16 v[160:163], a[224:227], v[0:3], 0
ds_read_b64_tr_b16 a[248:249], v239 offset:544
v_mul_f32 v200, v200, v242
v_mfma_f32_16x16x32_bf16 v[160:163], a[228:231], v[8:11], v[160:163]
ds_read_b64_tr_b16 a[250:251], v239 offset:672
buffer_load_dwordx4 v250, s[16:19], s45 offen offset:0 lds
v_mul_f32 v201, v201, v242
v_mfma_f32_16x16x32_bf16 v[164:167], a[228:231], v[12:15], 0
ds_read_b64_tr_b16 a[252:253], v239 offset:800
v_mul_f32 v202, v202, v242
v_mfma_f32_16x16x32_bf16 v[164:167], a[224:227], v[4:7], v[164:167]
s_waitcnt lgkmcnt(7)
ds_read_b64_tr_b16 a[254:255], v239 offset:928
v_mul_f32 v203, v203, v242
v_mfma_f32_16x16x32_bf16 v[164:167], a[232:235], v[20:23], v[164:167]
ds_read_b64_tr_b16 a[224:225], v239 offset:64
buffer_load_dwordx4 v251, s[16:19], s45 offen offset:1056 lds
v_cvt_pk_bf16_f32 v146, v200, v201
v_mfma_f32_16x16x32_bf16 v[164:167], a[236:239], v[28:31], v[164:167]
ds_read_b64_tr_b16 a[226:227], v239 offset:192
v_cvt_pk_bf16_f32 v147, v202, v203
v_mfma_f32_16x16x32_bf16 v[160:163], a[236:239], v[24:27], v[160:163]
ds_read_b64_tr_b16 a[228:229], v239 offset:320
v_mul_f32 v204, v204, v243
v_mfma_f32_16x16x32_bf16 v[160:163], a[232:235], v[16:19], v[160:163]
s_waitcnt lgkmcnt(7)
ds_read_b64_tr_b16 a[230:231], v239 offset:448
v_mul_f32 v205, v205, v243
v_mfma_f32_16x16x32_bf16 v[168:171], a[240:243], v[0:3], 0
ds_read_b64_tr_b16 a[232:233], v239 offset:576
buffer_load_dwordx4 v252, s[16:19], s45 offen offset:2112 lds
v_mul_f32 v206, v206, v243
v_mfma_f32_16x16x32_bf16 v[168:171], a[244:247], v[8:11], v[168:171]
ds_read_b64_tr_b16 a[234:235], v239 offset:704
v_mul_f32 v207, v207, v243
v_mfma_f32_16x16x32_bf16 v[172:175], a[244:247], v[12:15], 0
ds_read_b64_tr_b16 a[236:237], v239 offset:832
v_cvt_pk_bf16_f32 v150, v204, v205
v_mfma_f32_16x16x32_bf16 v[172:175], a[240:243], v[4:7], v[172:175]
s_waitcnt lgkmcnt(7)
ds_read_b64_tr_b16 a[238:239], v239 offset:960
v_cvt_pk_bf16_f32 v151, v206, v207
v_mfma_f32_16x16x32_bf16 v[172:175], a[248:251], v[20:23], v[172:175]
ds_read_b64_tr_b16 a[240:241], v239 offset:96
buffer_load_dwordx4 v253, s[16:19], s45 offen offset:3168 lds
v_mul_f32 v208, v208, v242
v_mfma_f32_16x16x32_bf16 v[172:175], a[252:255], v[28:31], v[172:175]
s_add_u32 m0, s28, 84480
ds_read_b64_tr_b16 a[242:243], v239 offset:224
v_mul_f32 v209, v209, v242
v_mfma_f32_16x16x32_bf16 v[168:171], a[252:255], v[24:27], v[168:171]
s_mov_b32 s29, 393472
ds_read_b64_tr_b16 a[244:245], v239 offset:352
v_mul_f32 v210, v210, v242
v_mfma_f32_16x16x32_bf16 v[168:171], a[248:251], v[16:19], v[168:171]
s_waitcnt lgkmcnt(7)
ds_read_b64_tr_b16 a[246:247], v239 offset:480
v_mul_f32 v211, v211, v242
v_mfma_f32_16x16x32_bf16 v[176:179], a[224:227], v[0:3], 0
ds_read_b64_tr_b16 a[248:249], v239 offset:608
buffer_load_dwordx4 v246, s[8:11], s29 offen offset:0 nt lds
v_cvt_pk_bf16_f32 v152, v208, v209
v_mfma_f32_16x16x32_bf16 v[176:179], a[228:231], v[8:11], v[176:179]
ds_read_b64_tr_b16 a[250:251], v239 offset:736
v_cvt_pk_bf16_f32 v153, v210, v211
v_mfma_f32_16x16x32_bf16 v[180:183], a[228:231], v[12:15], 0
s_waitcnt lgkmcnt(6)
ds_read_b64_tr_b16 a[252:253], v239 offset:864
v_mul_f32 v212, v212, v243
v_mfma_f32_16x16x32_bf16 v[180:183], a[224:227], v[4:7], v[180:183]
s_waitcnt vmcnt(5)
ds_read_b64_tr_b16 a[254:255], v239 offset:992
s_barrier
v_mfma_f32_16x16x32_bf16 v[180:183], a[232:235], v[20:23], v[180:183]
ds_read_b64_tr_b16 a[224:225], v239 offset:50688
buffer_load_dwordx4 v247, s[8:11], s29 offen offset:1056 nt lds
v_mul_f32 v213, v213, v243
v_mfma_f32_16x16x32_bf16 v[180:183], a[236:239], v[28:31], v[180:183]
ds_read_b64_tr_b16 a[226:227], v239 offset:50816
v_mul_f32 v214, v214, v243
v_mfma_f32_16x16x32_bf16 v[176:179], a[236:239], v[24:27], v[176:179]
ds_read_b64_tr_b16 a[228:229], v239 offset:50944
v_mul_f32 v215, v215, v243
v_mfma_f32_16x16x32_bf16 v[176:179], a[232:235], v[16:19], v[176:179]
s_waitcnt lgkmcnt(7)
ds_read_b64_tr_b16 a[230:231], v239 offset:51072
v_cvt_pk_bf16_f32 v156, v212, v213
v_mfma_f32_16x16x32_bf16 v[184:187], a[240:243], v[0:3], 0
ds_read_b64_tr_b16 a[232:233], v239 offset:51200
buffer_load_dwordx4 v248, s[8:11], s29 offen offset:2112 nt lds
v_cvt_pk_bf16_f32 v157, v214, v215
v_mfma_f32_16x16x32_bf16 v[184:187], a[244:247], v[8:11], v[184:187]
ds_read_b64_tr_b16 a[234:235], v239 offset:51328
v_mul_f32 v216, v216, v242
v_mfma_f32_16x16x32_bf16 v[188:191], a[244:247], v[12:15], 0
ds_read_b64_tr_b16 a[236:237], v239 offset:51456
v_mul_f32 v217, v217, v242
v_mfma_f32_16x16x32_bf16 v[188:191], a[240:243], v[4:7], v[188:191]
s_waitcnt lgkmcnt(7)
ds_read_b64_tr_b16 a[238:239], v239 offset:51584
v_mul_f32 v218, v218, v242
v_mfma_f32_16x16x32_bf16 v[188:191], a[248:251], v[20:23], v[188:191]
ds_read_b64_tr_b16 a[240:241], v239 offset:50720
buffer_load_dwordx4 v249, s[8:11], s29 offen offset:3168 nt lds
v_mul_f32 v219, v219, v242
v_mfma_f32_16x16x32_bf16 v[188:191], a[252:255], v[28:31], v[188:191]
s_add_u32 m0, s28, 67584
ds_read_b64_tr_b16 a[242:243], v239 offset:50848
v_cvt_pk_bf16_f32 v154, v216, v217
v_mfma_f32_16x16x32_bf16 v[184:187], a[252:255], v[24:27], v[184:187]
s_mov_b32 s45, 229760
ds_read_b64_tr_b16 a[244:245], v239 offset:50976
v_cvt_pk_bf16_f32 v155, v218, v219
v_mfma_f32_16x16x32_bf16 v[184:187], a[248:251], v[16:19], v[184:187]
s_waitcnt lgkmcnt(7)
ds_read_b64_tr_b16 a[246:247], v239 offset:51104
v_mul_f32 v220, v220, v243
v_mfma_f32_16x16x32_bf16 v[160:163], a[224:227], v[32:35], v[160:163]
ds_read_b64_tr_b16 a[248:249], v239 offset:51232
v_mul_f32 v221, v221, v243
v_mfma_f32_16x16x32_bf16 v[160:163], a[228:231], v[40:43], v[160:163]
ds_read_b64_tr_b16 a[250:251], v239 offset:51360
v_mul_f32 v222, v222, v243
v_mfma_f32_16x16x32_bf16 v[164:167], a[228:231], v[44:47], v[164:167]
ds_read_b64_tr_b16 a[252:253], v239 offset:51488
v_mul_f32 v223, v223, v243
v_mfma_f32_16x16x32_bf16 v[164:167], a[224:227], v[36:39], v[164:167]
s_waitcnt lgkmcnt(7)
ds_read_b64_tr_b16 a[254:255], v239 offset:51616
v_cvt_pk_bf16_f32 v158, v220, v221
v_mfma_f32_16x16x32_bf16 v[164:167], a[232:235], v[52:55], v[164:167]
ds_read_b64_tr_b16 a[224:225], v239 offset:50752
v_cvt_pk_bf16_f32 v159, v222, v223
v_mfma_f32_16x16x32_bf16 v[164:167], a[236:239], v[60:63], v[164:167]
ds_read_b64_tr_b16 a[226:227], v239 offset:50880
buffer_load_dwordx4 v250, s[16:19], s45 offen offset:0 lds
v_mfma_f32_16x16x32_bf16 v[160:163], a[236:239], v[56:59], v[160:163]
ds_read_b64_tr_b16 a[228:229], v239 offset:51008
v_mfma_f32_16x16x32_bf16 v[160:163], a[232:235], v[48:51], v[160:163]
s_waitcnt lgkmcnt(7)
ds_read_b64_tr_b16 a[230:231], v239 offset:51136
v_mfma_f32_16x16x32_bf16 v[168:171], a[240:243], v[32:35], v[168:171]
ds_read_b64_tr_b16 a[232:233], v239 offset:51264
buffer_load_dwordx4 v251, s[16:19], s45 offen offset:1056 lds
v_mfma_f32_16x16x32_bf16 v[168:171], a[244:247], v[40:43], v[168:171]
ds_read_b64_tr_b16 a[234:235], v239 offset:51392
v_mfma_f32_16x16x32_bf16 v[172:175], a[244:247], v[44:47], v[172:175]
ds_read_b64_tr_b16 a[236:237], v239 offset:51520
v_mfma_f32_16x16x32_bf16 v[172:175], a[240:243], v[36:39], v[172:175]
s_waitcnt lgkmcnt(7)
ds_read_b64_tr_b16 a[238:239], v239 offset:51648
v_mfma_f32_16x16x32_bf16 v[172:175], a[248:251], v[52:55], v[172:175]
ds_read_b64_tr_b16 a[240:241], v239 offset:50784
v_mfma_f32_16x16x32_bf16 v[172:175], a[252:255], v[60:63], v[172:175]
ds_read_b64_tr_b16 a[242:243], v239 offset:50912
v_mfma_f32_16x16x32_bf16 v[168:171], a[252:255], v[56:59], v[168:171]
ds_read_b64_tr_b16 a[244:245], v239 offset:51040
v_mfma_f32_16x16x32_bf16 v[168:171], a[248:251], v[48:51], v[168:171]
s_waitcnt lgkmcnt(7)
ds_read_b64_tr_b16 a[246:247], v239 offset:51168
v_mfma_f32_16x16x32_bf16 v[176:179], a[224:227], v[32:35], v[176:179]
ds_read_b64_tr_b16 a[248:249], v239 offset:51296
buffer_load_dwordx4 v252, s[16:19], s45 offen offset:2112 lds
v_mfma_f32_16x16x32_bf16 v[176:179], a[228:231], v[40:43], v[176:179]
ds_read_b64_tr_b16 a[250:251], v239 offset:51424
v_mfma_f32_16x16x32_bf16 v[180:183], a[228:231], v[44:47], v[180:183]
ds_read_b64_tr_b16 a[252:253], v239 offset:51552
v_mfma_f32_16x16x32_bf16 v[180:183], a[224:227], v[36:39], v[180:183]
s_waitcnt lgkmcnt(7)
ds_read_b64_tr_b16 a[254:255], v239 offset:51680
v_mfma_f32_16x16x32_bf16 v[180:183], a[232:235], v[52:55], v[180:183]
ds_read_b64_tr_b16 a[224:225], v239 offset:16896
v_mfma_f32_16x16x32_bf16 v[180:183], a[236:239], v[60:63], v[180:183]
ds_read_b64_tr_b16 a[226:227], v239 offset:17024
v_mfma_f32_16x16x32_bf16 v[176:179], a[236:239], v[56:59], v[176:179]
ds_read_b64_tr_b16 a[228:229], v239 offset:17152
v_mfma_f32_16x16x32_bf16 v[176:179], a[232:235], v[48:51], v[176:179]
s_waitcnt lgkmcnt(7)
ds_read_b64_tr_b16 a[230:231], v239 offset:17280
v_mfma_f32_16x16x32_bf16 v[184:187], a[240:243], v[32:35], v[184:187]
ds_read_b64_tr_b16 a[232:233], v239 offset:17408
buffer_load_dwordx4 v253, s[16:19], s45 offen offset:3168 lds
v_mfma_f32_16x16x32_bf16 v[184:187], a[244:247], v[40:43], v[184:187]
s_add_u32 m0, s28, 101376
ds_read_b64_tr_b16 a[234:235], v239 offset:17536
s_mov_b32 s29, 459008
v_mfma_f32_16x16x32_bf16 v[188:191], a[244:247], v[44:47], v[188:191]
ds_read_b64_tr_b16 a[236:237], v239 offset:17664
v_mfma_f32_16x16x32_bf16 v[188:191], a[240:243], v[36:39], v[188:191]
s_waitcnt lgkmcnt(7)
ds_read_b64_tr_b16 a[238:239], v239 offset:17792
v_mfma_f32_16x16x32_bf16 v[188:191], a[248:251], v[52:55], v[188:191]
ds_read_b64_tr_b16 a[240:241], v239 offset:16928
v_mfma_f32_16x16x32_bf16 v[188:191], a[252:255], v[60:63], v[188:191]
ds_read_b64_tr_b16 a[242:243], v239 offset:17056
v_mfma_f32_16x16x32_bf16 v[184:187], a[252:255], v[56:59], v[184:187]
ds_read_b64_tr_b16 a[244:245], v239 offset:17184
v_mfma_f32_16x16x32_bf16 v[184:187], a[248:251], v[48:51], v[184:187]
s_waitcnt lgkmcnt(7)
ds_read_b64_tr_b16 a[246:247], v239 offset:17312
v_mfma_f32_16x16x32_bf16 a[0:3], a[224:227], v[128:131], a[0:3]
ds_read_b64_tr_b16 a[248:249], v239 offset:17440
buffer_load_dwordx4 v246, s[8:11], s29 offen offset:0 nt lds
v_mfma_f32_16x16x32_bf16 a[0:3], a[228:231], v[136:139], a[0:3]
ds_read_b64_tr_b16 a[250:251], v239 offset:17568
v_mfma_f32_16x16x32_bf16 a[4:7], a[228:231], v[140:143], a[4:7]
ds_read_b64_tr_b16 a[252:253], v239 offset:17696
v_mfma_f32_16x16x32_bf16 a[4:7], a[224:227], v[132:135], a[4:7]
s_waitcnt lgkmcnt(7)
ds_read_b64_tr_b16 a[254:255], v239 offset:17824
v_mfma_f32_16x16x32_bf16 a[4:7], a[232:235], v[148:151], a[4:7]
ds_read_b64_tr_b16 a[224:225], v239 offset:16960
v_mfma_f32_16x16x32_bf16 a[4:7], a[236:239], v[156:159], a[4:7]
ds_read_b64_tr_b16 a[226:227], v239 offset:17088
v_mfma_f32_16x16x32_bf16 a[0:3], a[236:239], v[152:155], a[0:3]
ds_read_b64_tr_b16 a[228:229], v239 offset:17216
v_mfma_f32_16x16x32_bf16 a[0:3], a[232:235], v[144:147], a[0:3]
s_waitcnt lgkmcnt(7)
ds_read_b64_tr_b16 a[230:231], v239 offset:17344
v_mfma_f32_16x16x32_bf16 a[8:11], a[240:243], v[128:131], a[8:11]
ds_read_b64_tr_b16 a[232:233], v239 offset:17472
buffer_load_dwordx4 v247, s[8:11], s29 offen offset:1056 nt lds
v_mfma_f32_16x16x32_bf16 a[8:11], a[244:247], v[136:139], a[8:11]
ds_read_b64_tr_b16 a[234:235], v239 offset:17600
v_mfma_f32_16x16x32_bf16 a[12:15], a[244:247], v[140:143], a[12:15]
ds_read_b64_tr_b16 a[236:237], v239 offset:17728
v_mfma_f32_16x16x32_bf16 a[12:15], a[240:243], v[132:135], a[12:15]
s_waitcnt lgkmcnt(7)
ds_read_b64_tr_b16 a[238:239], v239 offset:17856
v_mfma_f32_16x16x32_bf16 a[12:15], a[248:251], v[148:151], a[12:15]
ds_read_b64_tr_b16 a[240:241], v239 offset:16992
v_mfma_f32_16x16x32_bf16 a[12:15], a[252:255], v[156:159], a[12:15]
ds_read_b64_tr_b16 a[242:243], v239 offset:17120
v_mfma_f32_16x16x32_bf16 a[8:11], a[252:255], v[152:155], a[8:11]
ds_read_b64_tr_b16 a[244:245], v239 offset:17248
v_mfma_f32_16x16x32_bf16 a[8:11], a[248:251], v[144:147], a[8:11]
s_waitcnt lgkmcnt(7)
ds_read_b64_tr_b16 a[246:247], v239 offset:17376
v_mfma_f32_16x16x32_bf16 a[16:19], a[224:227], v[128:131], a[16:19]
ds_read_b64_tr_b16 a[248:249], v239 offset:17504
buffer_load_dwordx4 v248, s[8:11], s29 offen offset:2112 nt lds
v_mfma_f32_16x16x32_bf16 a[16:19], a[228:231], v[136:139], a[16:19]
ds_read_b64_tr_b16 a[250:251], v239 offset:17632
v_mfma_f32_16x16x32_bf16 a[20:23], a[228:231], v[140:143], a[20:23]
s_waitcnt lgkmcnt(6)
ds_read_b64_tr_b16 a[252:253], v239 offset:17760
v_mfma_f32_16x16x32_bf16 a[20:23], a[224:227], v[132:135], a[20:23]
s_waitcnt vmcnt(7)
ds_read_b64_tr_b16 a[254:255], v239 offset:17888
s_barrier
v_mfma_f32_16x16x32_bf16 a[20:23], a[232:235], v[148:151], a[20:23]
ds_read_b64_tr_b16 a[224:225], v240 offset:16896
v_mfma_f32_16x16x32_bf16 a[20:23], a[236:239], v[156:159], a[20:23]
ds_read_b64_tr_b16 a[226:227], v240 offset:17024
v_mfma_f32_16x16x32_bf16 a[16:19], a[236:239], v[152:155], a[16:19]
ds_read_b64_tr_b16 a[228:229], v240 offset:17152
v_mfma_f32_16x16x32_bf16 a[16:19], a[232:235], v[144:147], a[16:19]
s_waitcnt lgkmcnt(7)
ds_read_b64_tr_b16 a[230:231], v240 offset:17280
v_mfma_f32_16x16x32_bf16 a[24:27], a[240:243], v[128:131], a[24:27]
ds_read_b64_tr_b16 a[232:233], v240 offset:17408
buffer_load_dwordx4 v249, s[8:11], s29 offen offset:3168 nt lds
v_mfma_f32_16x16x32_bf16 a[24:27], a[244:247], v[136:139], a[24:27]
ds_read_b64_tr_b16 a[234:235], v240 offset:17536
v_mfma_f32_16x16x32_bf16 a[28:31], a[244:247], v[140:143], a[28:31]
ds_read_b64_tr_b16 a[236:237], v240 offset:17664
v_mfma_f32_16x16x32_bf16 a[28:31], a[240:243], v[132:135], a[28:31]
s_waitcnt lgkmcnt(7)
ds_read_b64_tr_b16 a[238:239], v240 offset:17792
s_add_u32 m0, s28, 118272
v_mfma_f32_16x16x32_bf16 a[28:31], a[248:251], v[148:151], a[28:31]
s_mov_b32 s29, 262528
ds_read_b64_tr_b16 a[240:241], v240 offset:16928
v_mfma_f32_16x16x32_bf16 a[28:31], a[252:255], v[156:159], a[28:31]
ds_read_b64_tr_b16 a[242:243], v240 offset:17056
v_mfma_f32_16x16x32_bf16 a[24:27], a[252:255], v[152:155], a[24:27]
ds_read_b64_tr_b16 a[244:245], v240 offset:17184
v_mfma_f32_16x16x32_bf16 a[24:27], a[248:251], v[144:147], a[24:27]
s_waitcnt lgkmcnt(7)
ds_read_b64_tr_b16 a[246:247], v240 offset:17312
v_mfma_f32_16x16x32_bf16 v[160:163], a[224:227], v[64:67], v[160:163]
s_waitcnt vmcnt(26)
ds_read_b64_tr_b16 a[248:249], v240 offset:17440
v_cmp_eq_u32 vcc, 0, v233
v_mfma_f32_16x16x32_bf16 v[160:163], a[228:231], v[72:75], v[160:163]
s_cbranch_vccnz L_spin_tag
L_back_tag:
ds_read_b64_tr_b16 a[250:251], v240 offset:17568
v_bfe_u32 v236, v232, s46, 8
v_mfma_f32_16x16x32_bf16 v[164:167], a[228:231], v[76:79], v[164:167]
ds_read_b64_tr_b16 a[252:253], v240 offset:17696
v_bfe_u32 v232, v232, s47, 8
v_mfma_f32_16x16x32_bf16 v[164:167], a[224:227], v[68:71], v[164:167]
s_waitcnt lgkmcnt(7)
ds_read_b64_tr_b16 a[254:255], v240 offset:17824
buffer_load_dwordx4 v246, s[8:11], s29 offen offset:0 nt lds
v_mfma_f32_16x16x32_bf16 v[164:167], a[232:235], v[84:87], v[164:167]
ds_read_b64_tr_b16 a[224:225], v240 offset:16960
v_mfma_f32_16x16x32_bf16 v[164:167], a[236:239], v[92:95], v[164:167]
ds_read_b64_tr_b16 a[226:227], v240 offset:17088
v_mfma_f32_16x16x32_bf16 v[160:163], a[236:239], v[88:91], v[160:163]
ds_read_b64_tr_b16 a[228:229], v240 offset:17216
v_mfma_f32_16x16x32_bf16 v[160:163], a[232:235], v[80:83], v[160:163]
s_waitcnt lgkmcnt(7)
ds_read_b64_tr_b16 a[230:231], v240 offset:17344
v_mfma_f32_16x16x32_bf16 v[168:171], a[240:243], v[64:67], v[168:171]
ds_read_b64_tr_b16 a[232:233], v240 offset:17472
buffer_load_dwordx4 v247, s[8:11], s29 offen offset:1056 nt lds
v_mfma_f32_16x16x32_bf16 v[168:171], a[244:247], v[72:75], v[168:171]
ds_read_b64_tr_b16 a[234:235], v240 offset:17600
v_mfma_f32_16x16x32_bf16 v[172:175], a[244:247], v[76:79], v[172:175]
ds_read_b64_tr_b16 a[236:237], v240 offset:17728
v_mfma_f32_16x16x32_bf16 v[172:175], a[240:243], v[68:71], v[172:175]
s_waitcnt lgkmcnt(7)
ds_read_b64_tr_b16 a[238:239], v240 offset:17856
v_mfma_f32_16x16x32_bf16 v[172:175], a[248:251], v[84:87], v[172:175]
ds_read_b64_tr_b16 a[240:241], v240 offset:16992
v_mfma_f32_16x16x32_bf16 v[172:175], a[252:255], v[92:95], v[172:175]
ds_read_b64_tr_b16 a[242:243], v240 offset:17120
v_mfma_f32_16x16x32_bf16 v[168:171], a[252:255], v[88:91], v[168:171]
ds_read_b64_tr_b16 a[244:245], v240 offset:17248
v_mfma_f32_16x16x32_bf16 v[168:171], a[248:251], v[80:83], v[168:171]
s_waitcnt lgkmcnt(7)
ds_read_b64_tr_b16 a[246:247], v240 offset:17376
v_mfma_f32_16x16x32_bf16 v[176:179], a[224:227], v[64:67], v[176:179]
ds_read_b64_tr_b16 a[248:249], v240 offset:17504
buffer_load_dwordx4 v248, s[8:11], s29 offen offset:2112 nt lds
v_mfma_f32_16x16x32_bf16 v[176:179], a[228:231], v[72:75], v[176:179]
ds_read_b64_tr_b16 a[250:251], v240 offset:17632
v_mfma_f32_16x16x32_bf16 v[180:183], a[228:231], v[76:79], v[180:183]
ds_read_b64_tr_b16 a[252:253], v240 offset:17760
v_mfma_f32_16x16x32_bf16 v[180:183], a[224:227], v[68:71], v[180:183]
s_waitcnt lgkmcnt(7)
ds_read_b64_tr_b16 a[254:255], v240 offset:17888
v_mfma_f32_16x16x32_bf16 v[180:183], a[232:235], v[84:87], v[180:183]
ds_read_b64_tr_b16 a[224:225], v241 offset:0
v_mfma_f32_16x16x32_bf16 v[180:183], a[236:239], v[92:95], v[180:183]
ds_read_b64_tr_b16 a[226:227], v241 offset:128
v_mfma_f32_16x16x32_bf16 v[176:179], a[236:239], v[88:91], v[176:179]
ds_read_b64_tr_b16 a[228:229], v241 offset:256
v_mfma_f32_16x16x32_bf16 v[176:179], a[232:235], v[80:83], v[176:179]
s_waitcnt lgkmcnt(7)
ds_read_b64_tr_b16 a[230:231], v241 offset:384
v_mfma_f32_16x16x32_bf16 v[184:187], a[240:243], v[64:67], v[184:187]
ds_read_b64_tr_b16 a[232:233], v241 offset:512
buffer_load_dwordx4 v249, s[8:11], s29 offen offset:3168 nt lds
v_mfma_f32_16x16x32_bf16 v[184:187], a[244:247], v[72:75], v[184:187]
s_add_u32 m0, s28, 0
ds_read_b64_tr_b16 a[234:235], v241 offset:640
s_mov_b32 s29, 328064
v_mfma_f32_16x16x32_bf16 v[188:191], a[244:247], v[76:79], v[188:191]
ds_read_b64_tr_b16 a[236:237], v241 offset:768
v_mfma_f32_16x16x32_bf16 v[188:191], a[240:243], v[68:71], v[188:191]
s_waitcnt lgkmcnt(7)
ds_read_b64_tr_b16 a[238:239], v241 offset:896
v_mfma_f32_16x16x32_bf16 v[188:191], a[248:251], v[84:87], v[188:191]
ds_read_b64_tr_b16 a[240:241], v241 offset:32
v_mfma_f32_16x16x32_bf16 v[188:191], a[252:255], v[92:95], v[188:191]
ds_read_b64_tr_b16 a[242:243], v241 offset:160
v_mfma_f32_16x16x32_bf16 v[184:187], a[252:255], v[88:91], v[184:187]
ds_read_b64_tr_b16 a[244:245], v241 offset:288
v_mfma_f32_16x16x32_bf16 v[184:187], a[248:251], v[80:83], v[184:187]
s_waitcnt lgkmcnt(7)
ds_read_b64_tr_b16 a[246:247], v241 offset:416
v_mfma_f32_16x16x32_bf16 a[32:35], a[224:227], v[128:131], a[32:35]
ds_read_b64_tr_b16 a[248:249], v241 offset:544
buffer_load_dwordx4 v246, s[8:11], s29 offen offset:0 nt lds
v_mfma_f32_16x16x32_bf16 a[32:35], a[228:231], v[136:139], a[32:35]
ds_read_b64_tr_b16 a[250:251], v241 offset:672
v_mfma_f32_16x16x32_bf16 a[36:39], a[228:231], v[140:143], a[36:39]
ds_read_b64_tr_b16 a[252:253], v241 offset:800
v_mfma_f32_16x16x32_bf16 a[36:39], a[224:227], v[132:135], a[36:39]
s_waitcnt lgkmcnt(7)
ds_read_b64_tr_b16 a[254:255], v241 offset:928
v_mfma_f32_16x16x32_bf16 a[36:39], a[232:235], v[148:151], a[36:39]
ds_read_b64_tr_b16 a[224:225], v241 offset:64
v_mfma_f32_16x16x32_bf16 a[36:39], a[236:239], v[156:159], a[36:39]
ds_read_b64_tr_b16 a[226:227], v241 offset:192
v_mfma_f32_16x16x32_bf16 a[32:35], a[236:239], v[152:155], a[32:35]
ds_read_b64_tr_b16 a[228:229], v241 offset:320
v_mfma_f32_16x16x32_bf16 a[32:35], a[232:235], v[144:147], a[32:35]
s_waitcnt lgkmcnt(7)
ds_read_b64_tr_b16 a[230:231], v241 offset:448
v_mfma_f32_16x16x32_bf16 a[40:43], a[240:243], v[128:131], a[40:43]
ds_read_b64_tr_b16 a[232:233], v241 offset:576
buffer_load_dwordx4 v247, s[8:11], s29 offen offset:1056 nt lds
v_mfma_f32_16x16x32_bf16 a[40:43], a[244:247], v[136:139], a[40:43]
ds_read_b64_tr_b16 a[234:235], v241 offset:704
v_mfma_f32_16x16x32_bf16 a[44:47], a[244:247], v[140:143], a[44:47]
ds_read_b64_tr_b16 a[236:237], v241 offset:832
v_mfma_f32_16x16x32_bf16 a[44:47], a[240:243], v[132:135], a[44:47]
s_waitcnt lgkmcnt(7)
ds_read_b64_tr_b16 a[238:239], v241 offset:960
v_mfma_f32_16x16x32_bf16 a[44:47], a[248:251], v[148:151], a[44:47]
ds_read_b64_tr_b16 a[240:241], v241 offset:96
v_mfma_f32_16x16x32_bf16 a[44:47], a[252:255], v[156:159], a[44:47]
ds_read_b64_tr_b16 a[242:243], v241 offset:224
v_mfma_f32_16x16x32_bf16 a[40:43], a[252:255], v[152:155], a[40:43]
ds_read_b64_tr_b16 a[244:245], v241 offset:352
v_mfma_f32_16x16x32_bf16 a[40:43], a[248:251], v[144:147], a[40:43]
s_waitcnt lgkmcnt(7)
ds_read_b64_tr_b16 a[246:247], v241 offset:480
v_mfma_f32_16x16x32_bf16 a[48:51], a[224:227], v[128:131], a[48:51]
ds_read_b64_tr_b16 a[248:249], v241 offset:608
buffer_load_dwordx4 v248, s[8:11], s29 offen offset:2112 nt lds
v_mfma_f32_16x16x32_bf16 a[48:51], a[228:231], v[136:139], a[48:51]
ds_read_b64_tr_b16 a[250:251], v241 offset:736
v_mfma_f32_16x16x32_bf16 a[52:55], a[228:231], v[140:143], a[52:55]
s_waitcnt lgkmcnt(6)
ds_read_b64_tr_b16 a[252:253], v241 offset:864
v_mfma_f32_16x16x32_bf16 a[52:55], a[224:227], v[132:135], a[52:55]
s_waitcnt vmcnt(7)
ds_read_b64_tr_b16 a[254:255], v241 offset:992
s_barrier
v_mfma_f32_16x16x32_bf16 a[52:55], a[232:235], v[148:151], a[52:55]
ds_read_b64_tr_b16 a[224:225], v240 offset:33792
v_mfma_f32_16x16x32_bf16 a[52:55], a[236:239], v[156:159], a[52:55]
ds_read_b64_tr_b16 a[226:227], v240 offset:33920
v_mfma_f32_16x16x32_bf16 a[48:51], a[236:239], v[152:155], a[48:51]
ds_read_b64_tr_b16 a[228:229], v240 offset:34048
v_mfma_f32_16x16x32_bf16 a[48:51], a[232:235], v[144:147], a[48:51]
s_waitcnt lgkmcnt(7)
ds_read_b64_tr_b16 a[230:231], v240 offset:34176
v_mfma_f32_16x16x32_bf16 a[56:59], a[240:243], v[128:131], a[56:59]
ds_read_b64_tr_b16 a[232:233], v240 offset:34304
buffer_load_dwordx4 v249, s[8:11], s29 offen offset:3168 nt lds
v_mfma_f32_16x16x32_bf16 a[56:59], a[244:247], v[136:139], a[56:59]
s_add_u32 m0, s28, 50688
ds_read_b64_tr_b16 a[234:235], v240 offset:34432
s_mov_b32 s29, 393600
v_mfma_f32_16x16x32_bf16 a[60:63], a[244:247], v[140:143], a[60:63]
ds_read_b64_tr_b16 a[236:237], v240 offset:34560
v_mfma_f32_16x16x32_bf16 a[60:63], a[240:243], v[132:135], a[60:63]
s_waitcnt lgkmcnt(7)
ds_read_b64_tr_b16 a[238:239], v240 offset:34688
v_mfma_f32_16x16x32_bf16 a[60:63], a[248:251], v[148:151], a[60:63]
ds_read_b64_tr_b16 a[240:241], v240 offset:33824
v_mfma_f32_16x16x32_bf16 a[60:63], a[252:255], v[156:159], a[60:63]
ds_read_b64_tr_b16 a[242:243], v240 offset:33952
v_mfma_f32_16x16x32_bf16 a[56:59], a[252:255], v[152:155], a[56:59]
ds_read_b64_tr_b16 a[244:245], v240 offset:34080
v_mfma_f32_16x16x32_bf16 a[56:59], a[248:251], v[144:147], a[56:59]
s_waitcnt lgkmcnt(7)
ds_read_b64_tr_b16 a[246:247], v240 offset:34208
v_mfma_f32_16x16x32_bf16 v[160:163], a[224:227], v[96:99], v[160:163]
ds_read_b64_tr_b16 a[248:249], v240 offset:34336
v_mfma_f32_16x16x32_bf16 v[160:163], a[228:231], v[104:107], v[160:163]
ds_read_b64_tr_b16 a[250:251], v240 offset:34464
buffer_load_dwordx4 v246, s[8:11], s29 offen offset:0 nt lds
v_mfma_f32_16x16x32_bf16 v[164:167], a[228:231], v[108:111], v[164:167]
ds_read_b64_tr_b16 a[252:253], v240 offset:34592
v_mfma_f32_16x16x32_bf16 v[164:167], a[224:227], v[100:103], v[164:167]
s_waitcnt lgkmcnt(7)
ds_read_b64_tr_b16 a[254:255], v240 offset:34720
v_mfma_f32_16x16x32_bf16 v[164:167], a[232:235], v[116:119], v[164:167]
ds_read_b64_tr_b16 a[224:225], v240 offset:33856
v_mfma_f32_16x16x32_bf16 v[164:167], a[236:239], v[124:127], v[164:167]
ds_read_b64_tr_b16 a[226:227], v240 offset:33984
v_mfma_f32_16x16x32_bf16 v[160:163], a[236:239], v[120:123], v[160:163]
ds_read_b64_tr_b16 a[228:229], v240 offset:34112
v_mfma_f32_16x16x32_bf16 v[160:163], a[232:235], v[112:115], v[160:163]
s_waitcnt lgkmcnt(7)
ds_read_b64_tr_b16 a[230:231], v240 offset:34240
v_mfma_f32_16x16x32_bf16 v[168:171], a[240:243], v[96:99], v[168:171]
ds_read_b64_tr_b16 a[232:233], v240 offset:34368
v_mfma_f32_16x16x32_bf16 v[168:171], a[244:247], v[104:107], v[168:171]
ds_read_b64_tr_b16 a[234:235], v240 offset:34496
v_mfma_f32_16x16x32_bf16 v[172:175], a[244:247], v[108:111], v[172:175]
ds_read_b64_tr_b16 a[236:237], v240 offset:34624
v_mfma_f32_16x16x32_bf16 v[172:175], a[240:243], v[100:103], v[172:175]
s_waitcnt lgkmcnt(7)
ds_read_b64_tr_b16 a[238:239], v240 offset:34752
v_mfma_f32_16x16x32_bf16 v[172:175], a[248:251], v[116:119], v[172:175]
ds_read_b64_tr_b16 a[240:241], v240 offset:33888
v_mfma_f32_16x16x32_bf16 v[172:175], a[252:255], v[124:127], v[172:175]
ds_read_b64_tr_b16 a[242:243], v240 offset:34016
v_mfma_f32_16x16x32_bf16 v[168:171], a[252:255], v[120:123], v[168:171]
ds_read_b64_tr_b16 a[244:245], v240 offset:34144
v_mfma_f32_16x16x32_bf16 v[168:171], a[248:251], v[112:115], v[168:171]
s_waitcnt lgkmcnt(7)
ds_read_b64_tr_b16 a[246:247], v240 offset:34272
v_mfma_f32_16x16x32_bf16 v[176:179], a[224:227], v[96:99], v[176:179]
ds_read_b64_tr_b16 a[248:249], v240 offset:34400
buffer_load_dwordx4 v247, s[8:11], s29 offen offset:1056 nt lds
v_mfma_f32_16x16x32_bf16 v[176:179], a[228:231], v[104:107], v[176:179]
ds_read_b64_tr_b16 a[250:251], v240 offset:34528
v_mfma_f32_16x16x32_bf16 v[180:183], a[228:231], v[108:111], v[180:183]
ds_read_b64_tr_b16 a[252:253], v240 offset:34656
v_mfma_f32_16x16x32_bf16 v[180:183], a[224:227], v[100:103], v[180:183]
s_waitcnt lgkmcnt(7)
ds_read_b64_tr_b16 a[254:255], v240 offset:34784
v_mfma_f32_16x16x32_bf16 v[180:183], a[232:235], v[116:119], v[180:183]
ds_read_b64_tr_b16 a[224:225], v239 offset:33792
v_mul_f32 v160, v160, v242
v_mfma_f32_16x16x32_bf16 v[180:183], a[236:239], v[124:127], v[180:183]
ds_read_b64_tr_b16 a[226:227], v239 offset:33920
v_mul_f32 v161, v161, v242
v_mfma_f32_16x16x32_bf16 v[176:179], a[236:239], v[120:123], v[176:179]
ds_read_b64_tr_b16 a[228:229], v239 offset:34048
v_mul_f32 v162, v162, v242
v_mfma_f32_16x16x32_bf16 v[176:179], a[232:235], v[112:115], v[176:179]
s_waitcnt lgkmcnt(7)
ds_read_b64_tr_b16 a[230:231], v239 offset:34176
v_mul_f32 v163, v163, v242
v_mfma_f32_16x16x32_bf16 v[184:187], a[240:243], v[96:99], v[184:187]
ds_read_b64_tr_b16 a[232:233], v239 offset:34304
v_cvt_pk_bf16_f32 v160, v160, v161
v_mfma_f32_16x16x32_bf16 v[184:187], a[244:247], v[104:107], v[184:187]
ds_read_b64_tr_b16 a[234:235], v239 offset:34432
v_cvt_pk_bf16_f32 v161, v162, v163
v_mfma_f32_16x16x32_bf16 v[188:191], a[244:247], v[108:111], v[188:191]
ds_read_b64_tr_b16 a[236:237], v239 offset:34560
v_mul_f32 v164, v164, v243
v_mfma_f32_16x16x32_bf16 v[188:191], a[240:243], v[100:103], v[188:191]
s_waitcnt lgkmcnt(7)
ds_read_b64_tr_b16 a[238:239], v239 offset:34688
v_mul_f32 v165, v165, v243
v_mfma_f32_16x16x32_bf16 v[188:191], a[248:251], v[116:119], v[188:191]
ds_read_b64_tr_b16 a[240:241], v239 offset:33824
v_mul_f32 v166, v166, v243
v_mfma_f32_16x16x32_bf16 v[188:191], a[252:255], v[124:127], v[188:191]
ds_read_b64_tr_b16 a[242:243], v239 offset:33952
v_mul_f32 v167, v167, v243
v_mfma_f32_16x16x32_bf16 v[184:187], a[252:255], v[120:123], v[184:187]
ds_read_b64_tr_b16 a[244:245], v239 offset:34080
v_cvt_pk_bf16_f32 v164, v164, v165
v_mfma_f32_16x16x32_bf16 v[184:187], a[248:251], v[112:115], v[184:187]
s_waitcnt lgkmcnt(7)
ds_read_b64_tr_b16 a[246:247], v239 offset:34208
v_cvt_pk_bf16_f32 v165, v166, v167
v_mfma_f32_16x16x32_bf16 a[64:67], a[224:227], v[128:131], a[64:67]
ds_read_b64_tr_b16 a[248:249], v239 offset:34336
buffer_load_dwordx4 v248, s[8:11], s29 offen offset:2112 nt lds
v_mul_f32 v168, v168, v242
v_mfma_f32_16x16x32_bf16 a[64:67], a[228:231], v[136:139], a[64:67]
ds_read_b64_tr_b16 a[250:251], v239 offset:34464
v_mul_f32 v169, v169, v242
v_mfma_f32_16x16x32_bf16 a[68:71], a[228:231], v[140:143], a[68:71]
ds_read_b64_tr_b16 a[252:253], v239 offset:34592
v_mul_f32 v170, v170, v242
v_mfma_f32_16x16x32_bf16 a[68:71], a[224:227], v[132:135], a[68:71]
s_waitcnt lgkmcnt(7)
ds_read_b64_tr_b16 a[254:255], v239 offset:34720
v_mul_f32 v171, v171, v242
v_mfma_f32_16x16x32_bf16 a[68:71], a[232:235], v[148:151], a[68:71]
ds_read_b64_tr_b16 a[224:225], v239 offset:33856
v_cvt_pk_bf16_f32 v162, v168, v169
v_mfma_f32_16x16x32_bf16 a[68:71], a[236:239], v[156:159], a[68:71]
ds_read_b64_tr_b16 a[226:227], v239 offset:33984
v_cvt_pk_bf16_f32 v163, v170, v171
v_mfma_f32_16x16x32_bf16 a[64:67], a[236:239], v[152:155], a[64:67]
ds_read_b64_tr_b16 a[228:229], v239 offset:34112
v_mul_f32 v172, v172, v243
v_mfma_f32_16x16x32_bf16 a[64:67], a[232:235], v[144:147], a[64:67]
s_waitcnt lgkmcnt(7)
ds_read_b64_tr_b16 a[230:231], v239 offset:34240
v_mul_f32 v173, v173, v243
v_mfma_f32_16x16x32_bf16 a[72:75], a[240:243], v[128:131], a[72:75]
ds_read_b64_tr_b16 a[232:233], v239 offset:34368
v_mul_f32 v174, v174, v243
v_mfma_f32_16x16x32_bf16 a[72:75], a[244:247], v[136:139], a[72:75]
ds_read_b64_tr_b16 a[234:235], v239 offset:34496
v_mul_f32 v175, v175, v243
v_mfma_f32_16x16x32_bf16 a[76:79], a[244:247], v[140:143], a[76:79]
ds_read_b64_tr_b16 a[236:237], v239 offset:34624
v_cvt_pk_bf16_f32 v166, v172, v173
v_mfma_f32_16x16x32_bf16 a[76:79], a[240:243], v[132:135], a[76:79]
s_waitcnt lgkmcnt(7)
ds_read_b64_tr_b16 a[238:239], v239 offset:34752
v_cvt_pk_bf16_f32 v167, v174, v175
v_mfma_f32_16x16x32_bf16 a[76:79], a[248:251], v[148:151], a[76:79]
ds_read_b64_tr_b16 a[240:241], v239 offset:33888
v_mul_f32 v176, v176, v242
v_mfma_f32_16x16x32_bf16 a[76:79], a[252:255], v[156:159], a[76:79]
ds_read_b64_tr_b16 a[242:243], v239 offset:34016
v_mul_f32 v177, v177, v242
v_mfma_f32_16x16x32_bf16 a[72:75], a[252:255], v[152:155], a[72:75]
ds_read_b64_tr_b16 a[244:245], v239 offset:34144
v_mul_f32 v178, v178, v242
v_mfma_f32_16x16x32_bf16 a[72:75], a[248:251], v[144:147], a[72:75]
s_waitcnt lgkmcnt(7)
ds_read_b64_tr_b16 a[246:247], v239 offset:34272
v_mul_f32 v179, v179, v242
v_mfma_f32_16x16x32_bf16 a[80:83], a[224:227], v[128:131], a[80:83]
ds_read_b64_tr_b16 a[248:249], v239 offset:34400
buffer_load_dwordx4 v249, s[8:11], s29 offen offset:3168 nt lds
v_cvt_pk_bf16_f32 v176, v176, v177
v_mfma_f32_16x16x32_bf16 a[80:83], a[228:231], v[136:139], a[80:83]
ds_read_b64_tr_b16 a[250:251], v239 offset:34528
v_cvt_pk_bf16_f32 v177, v178, v179
v_mfma_f32_16x16x32_bf16 a[84:87], a[228:231], v[140:143], a[84:87]
s_waitcnt lgkmcnt(6)
ds_read_b64_tr_b16 a[252:253], v239 offset:34656
v_mul_f32 v180, v180, v243
v_mfma_f32_16x16x32_bf16 a[84:87], a[224:227], v[132:135], a[84:87]
s_waitcnt vmcnt(8)
ds_read_b64_tr_b16 a[254:255], v239 offset:34784
s_barrier
v_mfma_f32_16x16x32_bf16 a[84:87], a[232:235], v[148:151], a[84:87]
ds_read_b64_tr_b16 a[224:225], v240 offset:50688
v_mul_f32 v181, v181, v243
v_mfma_f32_16x16x32_bf16 a[84:87], a[236:239], v[156:159], a[84:87]
ds_read_b64_tr_b16 a[226:227], v240 offset:50816
v_mul_f32 v182, v182, v243
v_mfma_f32_16x16x32_bf16 a[80:83], a[236:239], v[152:155], a[80:83]
ds_read_b64_tr_b16 a[228:229], v240 offset:50944
v_mul_f32 v183, v183, v243
v_mfma_f32_16x16x32_bf16 a[80:83], a[232:235], v[144:147], a[80:83]
s_waitcnt lgkmcnt(7)
ds_read_b64_tr_b16 a[230:231], v240 offset:51072
v_cvt_pk_bf16_f32 v180, v180, v181
v_mfma_f32_16x16x32_bf16 a[88:91], a[240:243], v[128:131], a[88:91]
ds_read_b64_tr_b16 a[232:233], v240 offset:51200
v_cvt_pk_bf16_f32 v181, v182, v183
v_mfma_f32_16x16x32_bf16 a[88:91], a[244:247], v[136:139], a[88:91]
ds_read_b64_tr_b16 a[234:235], v240 offset:51328
v_mul_f32 v184, v184, v242
v_mfma_f32_16x16x32_bf16 a[92:95], a[244:247], v[140:143], a[92:95]
ds_read_b64_tr_b16 a[236:237], v240 offset:51456
v_mul_f32 v185, v185, v242
v_mfma_f32_16x16x32_bf16 a[92:95], a[240:243], v[132:135], a[92:95]
s_waitcnt lgkmcnt(7)
ds_read_b64_tr_b16 a[238:239], v240 offset:51584
v_mul_f32 v186, v186, v242
v_mfma_f32_16x16x32_bf16 a[92:95], a[248:251], v[148:151], a[92:95]
ds_read_b64_tr_b16 a[240:241], v240 offset:50720
v_mul_f32 v187, v187, v242
v_mfma_f32_16x16x32_bf16 a[92:95], a[252:255], v[156:159], a[92:95]
s_add_u32 m0, s28, 16896
ds_read_b64_tr_b16 a[242:243], v240 offset:50848
v_cvt_pk_bf16_f32 v178, v184, v185
v_mfma_f32_16x16x32_bf16 a[88:91], a[252:255], v[152:155], a[88:91]
s_mov_b32 s45, 229888
ds_read_b64_tr_b16 a[244:245], v240 offset:50976
v_cvt_pk_bf16_f32 v179, v186, v187
v_mfma_f32_16x16x32_bf16 a[88:91], a[248:251], v[144:147], a[88:91]
s_waitcnt lgkmcnt(7)
ds_read_b64_tr_b16 a[246:247], v240 offset:51104
v_mul_f32 v188, v188, v243
v_mfma_f32_16x16x32_bf16 v[192:195], a[224:227], v[0:3], 0
ds_read_b64_tr_b16 a[248:249], v240 offset:51232
v_mul_f32 v189, v189, v243
v_mfma_f32_16x16x32_bf16 v[192:195], a[228:231], v[8:11], v[192:195]
ds_read_b64_tr_b16 a[250:251], v240 offset:51360
v_mul_f32 v190, v190, v243
v_mfma_f32_16x16x32_bf16 v[196:199], a[228:231], v[12:15], 0
ds_read_b64_tr_b16 a[252:253], v240 offset:51488
v_mul_f32 v191, v191, v243
v_mfma_f32_16x16x32_bf16 v[196:199], a[224:227], v[4:7], v[196:199]
s_waitcnt lgkmcnt(7)
ds_read_b64_tr_b16 a[254:255], v240 offset:51616
v_cvt_pk_bf16_f32 v182, v188, v189
v_mfma_f32_16x16x32_bf16 v[196:199], a[232:235], v[20:23], v[196:199]
ds_read_b64_tr_b16 a[224:225], v240 offset:50752
v_cvt_pk_bf16_f32 v183, v190, v191
v_mfma_f32_16x16x32_bf16 v[196:199], a[236:239], v[28:31], v[196:199]
ds_read_b64_tr_b16 a[226:227], v240 offset:50880
buffer_load_dwordx4 v250, s[16:19], s45 offen offset:0 lds
v_mfma_f32_16x16x32_bf16 v[192:195], a[236:239], v[24:27], v[192:195]
ds_read_b64_tr_b16 a[228:229], v240 offset:51008
buffer_load_dwordx4 v251, s[16:19], s45 offen offset:1056 lds
v_mfma_f32_16x16x32_bf16 v[192:195], a[232:235], v[16:19], v[192:195]
s_waitcnt lgkmcnt(7)
ds_read_b64_tr_b16 a[230:231], v240 offset:51136
v_mfma_f32_16x16x32_bf16 v[200:203], a[240:243], v[0:3], 0
ds_read_b64_tr_b16 a[232:233], v240 offset:51264
v_mfma_f32_16x16x32_bf16 v[200:203], a[244:247], v[8:11], v[200:203]
ds_read_b64_tr_b16 a[234:235], v240 offset:51392
v_mfma_f32_16x16x32_bf16 v[204:207], a[244:247], v[12:15], 0
ds_read_b64_tr_b16 a[236:237], v240 offset:51520
v_mfma_f32_16x16x32_bf16 v[204:207], a[240:243], v[4:7], v[204:207]
s_waitcnt lgkmcnt(7)
ds_read_b64_tr_b16 a[238:239], v240 offset:51648
buffer_load_dwordx4 v252, s[16:19], s45 offen offset:2112 lds
v_mfma_f32_16x16x32_bf16 v[204:207], a[248:251], v[20:23], v[204:207]
ds_read_b64_tr_b16 a[240:241], v240 offset:50784
v_mfma_f32_16x16x32_bf16 v[204:207], a[252:255], v[28:31], v[204:207]
ds_read_b64_tr_b16 a[242:243], v240 offset:50912
v_mfma_f32_16x16x32_bf16 v[200:203], a[252:255], v[24:27], v[200:203]
ds_read_b64_tr_b16 a[244:245], v240 offset:51040
v_mfma_f32_16x16x32_bf16 v[200:203], a[248:251], v[16:19], v[200:203]
s_waitcnt lgkmcnt(7)
ds_read_b64_tr_b16 a[246:247], v240 offset:51168
v_mfma_f32_16x16x32_bf16 v[208:211], a[224:227], v[0:3], 0
ds_read_b64_tr_b16 a[248:249], v240 offset:51296
buffer_load_dwordx4 v253, s[16:19], s45 offen offset:3168 lds
v_mfma_f32_16x16x32_bf16 v[208:211], a[228:231], v[8:11], v[208:211]
s_add_u32 m0, s28, 84480
ds_read_b64_tr_b16 a[250:251], v240 offset:51424
s_mov_b32 s45, 344064
v_mfma_f32_16x16x32_bf16 v[212:215], a[228:231], v[12:15], 0
ds_read_b64_tr_b16 a[252:253], v240 offset:51552
v_mfma_f32_16x16x32_bf16 v[212:215], a[224:227], v[4:7], v[212:215]
s_waitcnt lgkmcnt(7)
ds_read_b64_tr_b16 a[254:255], v240 offset:51680
v_mfma_f32_16x16x32_bf16 v[212:215], a[232:235], v[20:23], v[212:215]
ds_read_b64_tr_b16 a[224:225], v240 offset:0
v_mfma_f32_16x16x32_bf16 v[212:215], a[236:239], v[28:31], v[212:215]
ds_read_b64_tr_b16 a[226:227], v240 offset:128
v_mfma_f32_16x16x32_bf16 v[208:211], a[236:239], v[24:27], v[208:211]
ds_read_b64_tr_b16 a[228:229], v240 offset:256
buffer_load_dwordx4 v250, s[16:19], s45 offen offset:0 lds
v_mfma_f32_16x16x32_bf16 v[208:211], a[232:235], v[16:19], v[208:211]
s_waitcnt lgkmcnt(7)
ds_read_b64_tr_b16 a[230:231], v240 offset:384
v_mfma_f32_16x16x32_bf16 v[216:219], a[240:243], v[0:3], 0
ds_read_b64_tr_b16 a[232:233], v240 offset:512
v_mfma_f32_16x16x32_bf16 v[216:219], a[244:247], v[8:11], v[216:219]
ds_read_b64_tr_b16 a[234:235], v240 offset:640
v_mfma_f32_16x16x32_bf16 v[220:223], a[244:247], v[12:15], 0
ds_read_b64_tr_b16 a[236:237], v240 offset:768
v_mfma_f32_16x16x32_bf16 v[220:223], a[240:243], v[4:7], v[220:223]
s_waitcnt lgkmcnt(7)
ds_read_b64_tr_b16 a[238:239], v240 offset:896
buffer_load_dwordx4 v251, s[16:19], s45 offen offset:1056 lds
v_mfma_f32_16x16x32_bf16 v[220:223], a[248:251], v[20:23], v[220:223]
ds_read_b64_tr_b16 a[240:241], v240 offset:32
v_mfma_f32_16x16x32_bf16 v[220:223], a[252:255], v[28:31], v[220:223]
ds_read_b64_tr_b16 a[242:243], v240 offset:160
v_mfma_f32_16x16x32_bf16 v[216:219], a[252:255], v[24:27], v[216:219]
ds_read_b64_tr_b16 a[244:245], v240 offset:288
v_mfma_f32_16x16x32_bf16 v[216:219], a[248:251], v[16:19], v[216:219]
s_waitcnt lgkmcnt(7)
ds_read_b64_tr_b16 a[246:247], v240 offset:416
v_mfma_f32_16x16x32_bf16 a[96:99], a[224:227], v[128:131], a[96:99]
ds_read_b64_tr_b16 a[248:249], v240 offset:544
buffer_load_dwordx4 v252, s[16:19], s45 offen offset:2112 lds
v_mfma_f32_16x16x32_bf16 a[96:99], a[228:231], v[136:139], a[96:99]
ds_read_b64_tr_b16 a[250:251], v240 offset:672
v_mfma_f32_16x16x32_bf16 a[100:103], a[228:231], v[140:143], a[100:103]
ds_read_b64_tr_b16 a[252:253], v240 offset:800
v_mfma_f32_16x16x32_bf16 a[100:103], a[224:227], v[132:135], a[100:103]
s_waitcnt lgkmcnt(7)
ds_read_b64_tr_b16 a[254:255], v240 offset:928
v_mfma_f32_16x16x32_bf16 a[100:103], a[232:235], v[148:151], a[100:103]
ds_read_b64_tr_b16 a[224:225], v240 offset:64
v_mfma_f32_16x16x32_bf16 a[100:103], a[236:239], v[156:159], a[100:103]
ds_read_b64_tr_b16 a[226:227], v240 offset:192
buffer_load_dwordx4 v253, s[16:19], s45 offen offset:3168 lds
v_mfma_f32_16x16x32_bf16 a[96:99], a[236:239], v[152:155], a[96:99]
s_add_u32 m0, s28, 135168
ds_read_b64_tr_b16 a[228:229], v240 offset:320
s_mov_b32 s29, 459136
v_mfma_f32_16x16x32_bf16 a[96:99], a[232:235], v[144:147], a[96:99]
s_waitcnt lgkmcnt(7)
ds_read_b64_tr_b16 a[230:231], v240 offset:448
v_mfma_f32_16x16x32_bf16 a[104:107], a[240:243], v[128:131], a[104:107]
ds_read_b64_tr_b16 a[232:233], v240 offset:576
v_mfma_f32_16x16x32_bf16 a[104:107], a[244:247], v[136:139], a[104:107]
ds_read_b64_tr_b16 a[234:235], v240 offset:704
v_mfma_f32_16x16x32_bf16 a[108:111], a[244:247], v[140:143], a[108:111]
ds_read_b64_tr_b16 a[236:237], v240 offset:832
v_mfma_f32_16x16x32_bf16 a[108:111], a[240:243], v[132:135], a[108:111]
s_waitcnt lgkmcnt(7)
ds_read_b64_tr_b16 a[238:239], v240 offset:960
buffer_load_dwordx4 v246, s[8:11], s29 offen offset:0 nt lds
v_mfma_f32_16x16x32_bf16 a[108:111], a[248:251], v[148:151], a[108:111]
ds_read_b64_tr_b16 a[240:241], v240 offset:96
v_mfma_f32_16x16x32_bf16 a[108:111], a[252:255], v[156:159], a[108:111]
ds_read_b64_tr_b16 a[242:243], v240 offset:224
v_mfma_f32_16x16x32_bf16 a[104:107], a[252:255], v[152:155], a[104:107]
ds_read_b64_tr_b16 a[244:245], v240 offset:352
v_mfma_f32_16x16x32_bf16 a[104:107], a[248:251], v[144:147], a[104:107]
s_waitcnt lgkmcnt(7)
ds_read_b64_tr_b16 a[246:247], v240 offset:480
v_mfma_f32_16x16x32_bf16 a[112:115], a[224:227], v[128:131], a[112:115]
ds_read_b64_tr_b16 a[248:249], v240 offset:608
buffer_load_dwordx4 v247, s[8:11], s29 offen offset:1056 nt lds
v_mfma_f32_16x16x32_bf16 a[112:115], a[228:231], v[136:139], a[112:115]
ds_read_b64_tr_b16 a[250:251], v240 offset:736
v_mfma_f32_16x16x32_bf16 a[116:119], a[228:231], v[140:143], a[116:119]
s_waitcnt lgkmcnt(6)
ds_read_b64_tr_b16 a[252:253], v240 offset:864
v_mfma_f32_16x16x32_bf16 a[116:119], a[224:227], v[132:135], a[116:119]
s_waitcnt vmcnt(14)
ds_read_b64_tr_b16 a[254:255], v240 offset:992
s_barrier
v_mfma_f32_16x16x32_bf16 a[116:119], a[232:235], v[148:151], a[116:119]
ds_read_b64_tr_b16 a[224:225], v239 offset:0
v_mfma_f32_16x16x32_bf16 a[116:119], a[236:239], v[156:159], a[116:119]
ds_read_b64_tr_b16 a[226:227], v239 offset:128
buffer_load_dwordx4 v248, s[8:11], s29 offen offset:2112 nt lds
v_mfma_f32_16x16x32_bf16 a[112:115], a[236:239], v[152:155], a[112:115]
ds_read_b64_tr_b16 a[228:229], v239 offset:256
v_mfma_f32_16x16x32_bf16 a[112:115], a[232:235], v[144:147], a[112:115]
s_waitcnt lgkmcnt(7)
ds_read_b64_tr_b16 a[230:231], v239 offset:384
v_mfma_f32_16x16x32_bf16 a[120:123], a[240:243], v[128:131], a[120:123]
ds_read_b64_tr_b16 a[232:233], v239 offset:512
v_mfma_f32_16x16x32_bf16 a[120:123], a[244:247], v[136:139], a[120:123]
ds_read_b64_tr_b16 a[234:235], v239 offset:640
v_mfma_f32_16x16x32_bf16 a[124:127], a[244:247], v[140:143], a[124:127]
ds_read_b64_tr_b16 a[236:237], v239 offset:768
buffer_load_dwordx4 v249, s[8:11], s29 offen offset:3168 nt lds
v_mfma_f32_16x16x32_bf16 a[124:127], a[240:243], v[132:135], a[124:127]
s_waitcnt lgkmcnt(7)
ds_read_b64_tr_b16 a[238:239], v239 offset:896
s_add_u32 m0, s28, 101376
v_mfma_f32_16x16x32_bf16 a[124:127], a[248:251], v[148:151], a[124:127]
s_mov_b32 s45, 344192
ds_read_b64_tr_b16 a[240:241], v239 offset:32
v_mfma_f32_16x16x32_bf16 a[124:127], a[252:255], v[156:159], a[124:127]
ds_read_b64_tr_b16 a[242:243], v239 offset:160
v_mfma_f32_16x16x32_bf16 a[120:123], a[252:255], v[152:155], a[120:123]
ds_read_b64_tr_b16 a[244:245], v239 offset:288
v_mfma_f32_16x16x32_bf16 a[120:123], a[248:251], v[144:147], a[120:123]
s_waitcnt lgkmcnt(7)
ds_read_b64_tr_b16 a[246:247], v239 offset:416
v_mfma_f32_16x16x32_bf16 v[192:195], a[224:227], v[32:35], v[192:195]
ds_read_b64_tr_b16 a[248:249], v239 offset:544
v_mfma_f32_16x16x32_bf16 v[192:195], a[228:231], v[40:43], v[192:195]
ds_read_b64_tr_b16 a[250:251], v239 offset:672
buffer_load_dwordx4 v250, s[16:19], s45 offen offset:0 lds
v_mfma_f32_16x16x32_bf16 v[196:199], a[228:231], v[44:47], v[196:199]
ds_read_b64_tr_b16 a[252:253], v239 offset:800
v_mfma_f32_16x16x32_bf16 v[196:199], a[224:227], v[36:39], v[196:199]
s_waitcnt lgkmcnt(7)
ds_read_b64_tr_b16 a[254:255], v239 offset:928
v_mfma_f32_16x16x32_bf16 v[196:199], a[232:235], v[52:55], v[196:199]
ds_read_b64_tr_b16 a[224:225], v239 offset:64
s_mov_b32 s46, 0
s_cmp_ge_u32 s72, 0x40000000
s_cselect_b32 s46, s46, 163840
v_add_u32 v233, s46, v244
v_mfma_f32_16x16x32_bf16 v[196:199], a[236:239], v[60:63], v[196:199]
ds_read_b64_tr_b16 a[226:227], v239 offset:192
buffer_load_dwordx4 v251, s[16:19], s45 offen offset:1056 lds
v_mfma_f32_16x16x32_bf16 v[192:195], a[236:239], v[56:59], v[192:195]
ds_read_b64_tr_b16 a[228:229], v239 offset:320
v_mfma_f32_16x16x32_bf16 v[192:195], a[232:235], v[48:51], v[192:195]
s_waitcnt lgkmcnt(7)
ds_read_b64_tr_b16 a[230:231], v239 offset:448
v_mfma_f32_16x16x32_bf16 v[200:203], a[240:243], v[32:35], v[200:203]
ds_read_b64_tr_b16 a[232:233], v239 offset:576
s_mov_b32 s46, 0
s_cmp_ge_u32 s3, 0x40000000
s_cselect_b32 s46, s46, 163840
v_add_u32 v235, s46, v244
v_mfma_f32_16x16x32_bf16 v[200:203], a[244:247], v[40:43], v[200:203]
ds_read_b64_tr_b16 a[234:235], v239 offset:704
buffer_load_dwordx4 v252, s[16:19], s45 offen offset:2112 lds
v_mfma_f32_16x16x32_bf16 v[204:207], a[244:247], v[44:47], v[204:207]
ds_read_b64_tr_b16 a[236:237], v239 offset:832
v_mfma_f32_16x16x32_bf16 v[204:207], a[240:243], v[36:39], v[204:207]
s_waitcnt lgkmcnt(7)
ds_read_b64_tr_b16 a[238:239], v239 offset:960
v_mfma_f32_16x16x32_bf16 v[204:207], a[248:251], v[52:55], v[204:207]
ds_read_b64_tr_b16 a[240:241], v239 offset:96
buffer_load_dwordx4 v253, s[16:19], s45 offen offset:3168 lds
v_mfma_f32_16x16x32_bf16 v[204:207], a[252:255], v[60:63], v[204:207]
s_add_u32 m0, s28, 33792
ds_read_b64_tr_b16 a[242:243], v239 offset:224
s_mov_b32 s45, 344320
v_mfma_f32_16x16x32_bf16 v[200:203], a[252:255], v[56:59], v[200:203]
ds_read_b64_tr_b16 a[244:245], v239 offset:352
v_mfma_f32_16x16x32_bf16 v[200:203], a[248:251], v[48:51], v[200:203]
s_waitcnt lgkmcnt(7)
ds_read_b64_tr_b16 a[246:247], v239 offset:480
v_mfma_f32_16x16x32_bf16 v[208:211], a[224:227], v[32:35], v[208:211]
ds_read_b64_tr_b16 a[248:249], v239 offset:608
buffer_load_dwordx4 v250, s[16:19], s45 offen offset:0 lds
v_mfma_f32_16x16x32_bf16 v[208:211], a[228:231], v[40:43], v[208:211]
ds_read_b64_tr_b16 a[250:251], v239 offset:736
v_mfma_f32_16x16x32_bf16 v[212:215], a[228:231], v[44:47], v[212:215]
s_waitcnt lgkmcnt(6)
ds_read_b64_tr_b16 a[252:253], v239 offset:864
v_mfma_f32_16x16x32_bf16 v[212:215], a[224:227], v[36:39], v[212:215]
s_waitcnt vmcnt(17)
ds_read_b64_tr_b16 a[254:255], v239 offset:992
s_barrier
v_mfma_f32_16x16x32_bf16 v[212:215], a[232:235], v[52:55], v[212:215]
ds_read_b64_tr_b16 a[224:225], v239 offset:50688
buffer_load_dwordx4 v251, s[16:19], s45 offen offset:1056 lds
v_mfma_f32_16x16x32_bf16 v[212:215], a[236:239], v[60:63], v[212:215]
ds_read_b64_tr_b16 a[226:227], v239 offset:50816
v_mfma_f32_16x16x32_bf16 v[208:211], a[236:239], v[56:59], v[208:211]
ds_read_b64_tr_b16 a[228:229], v239 offset:50944
v_mfma_f32_16x16x32_bf16 v[208:211], a[232:235], v[48:51], v[208:211]
s_waitcnt lgkmcnt(7)
ds_read_b64_tr_b16 a[230:231], v239 offset:51072
v_mfma_f32_16x16x32_bf16 v[216:219], a[240:243], v[32:35], v[216:219]
ds_read_b64_tr_b16 a[232:233], v239 offset:51200
buffer_load_dwordx4 v252, s[16:19], s45 offen offset:2112 lds
v_mfma_f32_16x16x32_bf16 v[216:219], a[244:247], v[40:43], v[216:219]
ds_read_b64_tr_b16 a[234:235], v239 offset:51328
v_mfma_f32_16x16x32_bf16 v[220:223], a[244:247], v[44:47], v[220:223]
ds_read_b64_tr_b16 a[236:237], v239 offset:51456
v_mfma_f32_16x16x32_bf16 v[220:223], a[240:243], v[36:39], v[220:223]
s_waitcnt lgkmcnt(7)
ds_read_b64_tr_b16 a[238:239], v239 offset:51584
v_mfma_f32_16x16x32_bf16 v[220:223], a[248:251], v[52:55], v[220:223]
ds_read_b64_tr_b16 a[240:241], v239 offset:50720
buffer_load_dwordx4 v253, s[16:19], s45 offen offset:3168 lds
v_mfma_f32_16x16x32_bf16 v[220:223], a[252:255], v[60:63], v[220:223]
ds_read_b64_tr_b16 a[242:243], v239 offset:50848
v_mfma_f32_16x16x32_bf16 v[216:219], a[252:255], v[56:59], v[216:219]
ds_read_b64_tr_b16 a[244:245], v239 offset:50976
v_mfma_f32_16x16x32_bf16 v[216:219], a[248:251], v[48:51], v[216:219]
s_waitcnt lgkmcnt(7)
ds_read_b64_tr_b16 a[246:247], v239 offset:51104
v_mfma_f32_16x16x32_bf16 v[192:195], a[224:227], v[64:67], v[192:195]
ds_read_b64_tr_b16 a[248:249], v239 offset:51232
v_mfma_f32_16x16x32_bf16 v[192:195], a[228:231], v[72:75], v[192:195]
ds_read_b64_tr_b16 a[250:251], v239 offset:51360
v_mfma_f32_16x16x32_bf16 v[196:199], a[228:231], v[76:79], v[196:199]
ds_read_b64_tr_b16 a[252:253], v239 offset:51488
v_mfma_f32_16x16x32_bf16 v[196:199], a[224:227], v[68:71], v[196:199]
s_waitcnt lgkmcnt(7)
ds_read_b64_tr_b16 a[254:255], v239 offset:51616
v_mfma_f32_16x16x32_bf16 v[196:199], a[232:235], v[84:87], v[196:199]
ds_read_b64_tr_b16 a[224:225], v239 offset:50752
v_mfma_f32_16x16x32_bf16 v[196:199], a[236:239], v[92:95], v[196:199]
ds_read_b64_tr_b16 a[226:227], v239 offset:50880
v_mfma_f32_16x16x32_bf16 v[192:195], a[236:239], v[88:91], v[192:195]
ds_read_b64_tr_b16 a[228:229], v239 offset:51008
v_mfma_f32_16x16x32_bf16 v[192:195], a[232:235], v[80:83], v[192:195]
s_waitcnt lgkmcnt(7)
ds_read_b64_tr_b16 a[230:231], v239 offset:51136
v_mfma_f32_16x16x32_bf16 v[200:203], a[240:243], v[64:67], v[200:203]
ds_read_b64_tr_b16 a[232:233], v239 offset:51264
v_mfma_f32_16x16x32_bf16 v[200:203], a[244:247], v[72:75], v[200:203]
ds_read_b64_tr_b16 a[234:235], v239 offset:51392
v_mfma_f32_16x16x32_bf16 v[204:207], a[244:247], v[76:79], v[204:207]
ds_read_b64_tr_b16 a[236:237], v239 offset:51520
v_mfma_f32_16x16x32_bf16 v[204:207], a[240:243], v[68:71], v[204:207]
s_waitcnt lgkmcnt(7)
ds_read_b64_tr_b16 a[238:239], v239 offset:51648
v_mfma_f32_16x16x32_bf16 v[204:207], a[248:251], v[84:87], v[204:207]
ds_read_b64_tr_b16 a[240:241], v239 offset:50784
v_mfma_f32_16x16x32_bf16 v[204:207], a[252:255], v[92:95], v[204:207]
ds_read_b64_tr_b16 a[242:243], v239 offset:50912
v_mfma_f32_16x16x32_bf16 v[200:203], a[252:255], v[88:91], v[200:203]
ds_read_b64_tr_b16 a[244:245], v239 offset:51040
v_mfma_f32_16x16x32_bf16 v[200:203], a[248:251], v[80:83], v[200:203]
s_waitcnt lgkmcnt(7)
ds_read_b64_tr_b16 a[246:247], v239 offset:51168
v_mfma_f32_16x16x32_bf16 v[208:211], a[224:227], v[64:67], v[208:211]
ds_read_b64_tr_b16 a[248:249], v239 offset:51296
v_mfma_f32_16x16x32_bf16 v[208:211], a[228:231], v[72:75], v[208:211]
ds_read_b64_tr_b16 a[250:251], v239 offset:51424
v_mfma_f32_16x16x32_bf16 v[212:215], a[228:231], v[76:79], v[212:215]
s_waitcnt lgkmcnt(6)
ds_read_b64_tr_b16 a[252:253], v239 offset:51552
v_mfma_f32_16x16x32_bf16 v[212:215], a[224:227], v[68:71], v[212:215]
s_waitcnt vmcnt(8)
ds_read_b64_tr_b16 a[254:255], v239 offset:51680
s_barrier
v_mfma_f32_16x16x32_bf16 v[212:215], a[232:235], v[84:87], v[212:215]
ds_read_b64_tr_b16 a[224:225], v241 offset:0
v_mfma_f32_16x16x32_bf16 v[212:215], a[236:239], v[92:95], v[212:215]
ds_read_b64_tr_b16 a[226:227], v241 offset:128
v_mfma_f32_16x16x32_bf16 v[208:211], a[236:239], v[88:91], v[208:211]
ds_read_b64_tr_b16 a[228:229], v241 offset:256
v_mfma_f32_16x16x32_bf16 v[208:211], a[232:235], v[80:83], v[208:211]
s_waitcnt lgkmcnt(7)
ds_read_b64_tr_b16 a[230:231], v241 offset:384
v_mfma_f32_16x16x32_bf16 v[216:219], a[240:243], v[64:67], v[216:219]
ds_read_b64_tr_b16 a[232:233], v241 offset:512
v_mfma_f32_16x16x32_bf16 v[216:219], a[244:247], v[72:75], v[216:219]
s_add_u32 m0, s28, 118272
ds_read_b64_tr_b16 a[234:235], v241 offset:640
s_mov_b32 s45, 344448
v_mfma_f32_16x16x32_bf16 v[220:223], a[244:247], v[76:79], v[220:223]
ds_read_b64_tr_b16 a[236:237], v241 offset:768
v_mfma_f32_16x16x32_bf16 v[220:223], a[240:243], v[68:71], v[220:223]
s_waitcnt lgkmcnt(7)
ds_read_b64_tr_b16 a[238:239], v241 offset:896
v_mfma_f32_16x16x32_bf16 v[220:223], a[248:251], v[84:87], v[220:223]
ds_read_b64_tr_b16 a[240:241], v241 offset:32
v_mfma_f32_16x16x32_bf16 v[220:223], a[252:255], v[92:95], v[220:223]
ds_read_b64_tr_b16 a[242:243], v241 offset:160
v_mfma_f32_16x16x32_bf16 v[216:219], a[252:255], v[88:91], v[216:219]
ds_read_b64_tr_b16 a[244:245], v241 offset:288
v_mfma_f32_16x16x32_bf16 v[216:219], a[248:251], v[80:83], v[216:219]
s_waitcnt lgkmcnt(7)
ds_read_b64_tr_b16 a[246:247], v241 offset:416
v_mfma_f32_16x16x32_bf16 v[192:195], a[224:227], v[96:99], v[192:195]
ds_read_b64_tr_b16 a[248:249], v241 offset:544
v_mfma_f32_16x16x32_bf16 v[192:195], a[228:231], v[104:107], v[192:195]
ds_read_b64_tr_b16 a[250:251], v241 offset:672
buffer_load_dwordx4 v250, s[16:19], s45 offen offset:0 lds
v_mfma_f32_16x16x32_bf16 v[196:199], a[228:231], v[108:111], v[196:199]
ds_read_b64_tr_b16 a[252:253], v241 offset:800
v_mfma_f32_16x16x32_bf16 v[196:199], a[224:227], v[100:103], v[196:199]
s_waitcnt lgkmcnt(7)
ds_read_b64_tr_b16 a[254:255], v241 offset:928
v_mfma_f32_16x16x32_bf16 v[196:199], a[232:235], v[116:119], v[196:199]
ds_read_b64_tr_b16 a[224:225], v241 offset:64
buffer_load_dwordx4 v251, s[16:19], s45 offen offset:1056 lds
v_mfma_f32_16x16x32_bf16 v[196:199], a[236:239], v[124:127], v[196:199]
ds_read_b64_tr_b16 a[226:227], v241 offset:192
v_mfma_f32_16x16x32_bf16 v[192:195], a[236:239], v[120:123], v[192:195]
ds_read_b64_tr_b16 a[228:229], v241 offset:320
v_mfma_f32_16x16x32_bf16 v[192:195], a[232:235], v[112:115], v[192:195]
s_waitcnt lgkmcnt(7)
ds_read_b64_tr_b16 a[230:231], v241 offset:448
v_mfma_f32_16x16x32_bf16 v[200:203], a[240:243], v[96:99], v[200:203]
ds_read_b64_tr_b16 a[232:233], v241 offset:576
buffer_load_dwordx4 v252, s[16:19], s45 offen offset:2112 lds
v_mfma_f32_16x16x32_bf16 v[200:203], a[244:247], v[104:107], v[200:203]
ds_read_b64_tr_b16 a[234:235], v241 offset:704
v_mfma_f32_16x16x32_bf16 v[204:207], a[244:247], v[108:111], v[204:207]
ds_read_b64_tr_b16 a[236:237], v241 offset:832
v_mfma_f32_16x16x32_bf16 v[204:207], a[240:243], v[100:103], v[204:207]
s_waitcnt lgkmcnt(7)
ds_read_b64_tr_b16 a[238:239], v241 offset:960
v_mfma_f32_16x16x32_bf16 v[204:207], a[248:251], v[116:119], v[204:207]
ds_read_b64_tr_b16 a[240:241], v241 offset:96
buffer_load_dwordx4 v253, s[16:19], s45 offen offset:3168 lds
v_mfma_f32_16x16x32_bf16 v[204:207], a[252:255], v[124:127], v[204:207]
s_add_u32 m0, s28, 67584
ds_read_b64_tr_b16 a[242:243], v241 offset:224
s_mov_b32 s45, 344576
v_mfma_f32_16x16x32_bf16 v[200:203], a[252:255], v[120:123], v[200:203]
ds_read_b64_tr_b16 a[244:245], v241 offset:352
v_mfma_f32_16x16x32_bf16 v[200:203], a[248:251], v[112:115], v[200:203]
s_waitcnt lgkmcnt(7)
ds_read_b64_tr_b16 a[246:247], v241 offset:480
v_mfma_f32_16x16x32_bf16 v[208:211], a[224:227], v[96:99], v[208:211]
ds_read_b64_tr_b16 a[248:249], v241 offset:608
buffer_load_dwordx4 v250, s[16:19], s45 offen offset:0 lds
v_mfma_f32_16x16x32_bf16 v[208:211], a[228:231], v[104:107], v[208:211]
ds_read_b64_tr_b16 a[250:251], v241 offset:736
v_mfma_f32_16x16x32_bf16 v[212:215], a[228:231], v[108:111], v[212:215]
s_waitcnt lgkmcnt(6)
ds_read_b64_tr_b16 a[252:253], v241 offset:864
v_mfma_f32_16x16x32_bf16 v[212:215], a[224:227], v[100:103], v[212:215]
s_waitcnt vmcnt(17)
ds_read_b64_tr_b16 a[254:255], v241 offset:992
s_barrier
v_mfma_f32_16x16x32_bf16 v[212:215], a[232:235], v[116:119], v[212:215]
ds_read_b64_tr_b16 a[224:225], v239 offset:16896
buffer_load_dwordx4 v251, s[16:19], s45 offen offset:1056 lds
v_mul_f32 v192, v192, v242
v_mfma_f32_16x16x32_bf16 v[212:215], a[236:239], v[124:127], v[212:215]
ds_read_b64_tr_b16 a[226:227], v239 offset:17024
v_mul_f32 v193, v193, v242
v_mfma_f32_16x16x32_bf16 v[208:211], a[236:239], v[120:123], v[208:211]
ds_read_b64_tr_b16 a[228:229], v239 offset:17152
v_mul_f32 v194, v194, v242
v_mfma_f32_16x16x32_bf16 v[208:211], a[232:235], v[112:115], v[208:211]
s_waitcnt lgkmcnt(7)
ds_read_b64_tr_b16 a[230:231], v239 offset:17280
v_mul_f32 v195, v195, v242
v_mfma_f32_16x16x32_bf16 v[216:219], a[240:243], v[96:99], v[216:219]
ds_read_b64_tr_b16 a[232:233], v239 offset:17408
buffer_load_dwordx4 v252, s[16:19], s45 offen offset:2112 lds
v_cvt_pk_bf16_f32 v168, v192, v193
v_mfma_f32_16x16x32_bf16 v[216:219], a[244:247], v[104:107], v[216:219]
ds_read_b64_tr_b16 a[234:235], v239 offset:17536
v_cvt_pk_bf16_f32 v169, v194, v195
v_mfma_f32_16x16x32_bf16 v[220:223], a[244:247], v[108:111], v[220:223]
ds_read_b64_tr_b16 a[236:237], v239 offset:17664
v_mul_f32 v196, v196, v243
v_mfma_f32_16x16x32_bf16 v[220:223], a[240:243], v[100:103], v[220:223]
s_waitcnt lgkmcnt(7)
ds_read_b64_tr_b16 a[238:239], v239 offset:17792
v_mul_f32 v197, v197, v243
v_mfma_f32_16x16x32_bf16 v[220:223], a[248:251], v[116:119], v[220:223]
ds_read_b64_tr_b16 a[240:241], v239 offset:16928
buffer_load_dwordx4 v253, s[16:19], s45 offen offset:3168 lds
v_mul_f32 v198, v198, v243
v_mfma_f32_16x16x32_bf16 v[220:223], a[252:255], v[124:127], v[220:223]
s_add_u32 m0, s28, 50688
ds_read_b64_tr_b16 a[242:243], v239 offset:17056
v_mul_f32 v199, v199, v243
v_mfma_f32_16x16x32_bf16 v[216:219], a[252:255], v[120:123], v[216:219]
s_mov_b32 s45, 230016
ds_read_b64_tr_b16 a[244:245], v239 offset:17184
v_cvt_pk_bf16_f32 v172, v196, v197
v_mfma_f32_16x16x32_bf16 v[216:219], a[248:251], v[112:115], v[216:219]
s_waitcnt lgkmcnt(7)
ds_read_b64_tr_b16 a[246:247], v239 offset:17312
v_cvt_pk_bf16_f32 v173, v198, v199
v_mfma_f32_16x16x32_bf16 a[128:131], a[224:227], v[128:131], a[128:131]
ds_read_b64_tr_b16 a[248:249], v239 offset:17440
v_mul_f32 v200, v200, v242
v_mfma_f32_16x16x32_bf16 a[128:131], a[228:231], v[136:139], a[128:131]
ds_read_b64_tr_b16 a[250:251], v239 offset:17568
buffer_load_dwordx4 v250, s[16:19], s45 offen offset:0 lds
v_mul_f32 v201, v201, v242
v_mfma_f32_16x16x32_bf16 a[132:135], a[228:231], v[140:143], a[132:135]
ds_read_b64_tr_b16 a[252:253], v239 offset:17696
v_mul_f32 v202, v202, v242
v_mfma_f32_16x16x32_bf16 a[132:135], a[224:227], v[132:135], a[132:135]
s_waitcnt lgkmcnt(7)
ds_read_b64_tr_b16 a[254:255], v239 offset:17824
v_mul_f32 v203, v203, v242
v_mfma_f32_16x16x32_bf16 a[132:135], a[232:235], v[148:151], a[132:135]
ds_read_b64_tr_b16 a[224:225], v239 offset:16960
v_cvt_pk_bf16_f32 v170, v200, v201
v_mfma_f32_16x16x32_bf16 a[132:135], a[236:239], v[156:159], a[132:135]
ds_read_b64_tr_b16 a[226:227], v239 offset:17088
v_cvt_pk_bf16_f32 v171, v202, v203
v_mfma_f32_16x16x32_bf16 a[128:131], a[236:239], v[152:155], a[128:131]
ds_read_b64_tr_b16 a[228:229], v239 offset:17216
v_mul_f32 v204, v204, v243
v_mfma_f32_16x16x32_bf16 a[128:131], a[232:235], v[144:147], a[128:131]
s_waitcnt lgkmcnt(7)
ds_read_b64_tr_b16 a[230:231], v239 offset:17344
v_mul_f32 v205, v205, v243
v_mfma_f32_16x16x32_bf16 a[136:139], a[240:243], v[128:131], a[136:139]
ds_read_b64_tr_b16 a[232:233], v239 offset:17472
buffer_load_dwordx4 v251, s[16:19], s45 offen offset:1056 lds
v_mul_f32 v206, v206, v243
v_mfma_f32_16x16x32_bf16 a[136:139], a[244:247], v[136:139], a[136:139]
ds_read_b64_tr_b16 a[234:235], v239 offset:17600
v_mul_f32 v207, v207, v243
v_mfma_f32_16x16x32_bf16 a[140:143], a[244:247], v[140:143], a[140:143]
ds_read_b64_tr_b16 a[236:237], v239 offset:17728
v_cvt_pk_bf16_f32 v174, v204, v205
v_mfma_f32_16x16x32_bf16 a[140:143], a[240:243], v[132:135], a[140:143]
s_waitcnt lgkmcnt(7)
ds_read_b64_tr_b16 a[238:239], v239 offset:17856
v_cvt_pk_bf16_f32 v175, v206, v207
v_mfma_f32_16x16x32_bf16 a[140:143], a[248:251], v[148:151], a[140:143]
ds_read_b64_tr_b16 a[240:241], v239 offset:16992
v_mul_f32 v208, v208, v242
v_mfma_f32_16x16x32_bf16 a[140:143], a[252:255], v[156:159], a[140:143]
ds_read_b64_tr_b16 a[242:243], v239 offset:17120
v_mul_f32 v209, v209, v242
v_mfma_f32_16x16x32_bf16 a[136:139], a[252:255], v[152:155], a[136:139]
ds_read_b64_tr_b16 a[244:245], v239 offset:17248
v_mul_f32 v210, v210, v242
v_mfma_f32_16x16x32_bf16 a[136:139], a[248:251], v[144:147], a[136:139]
s_waitcnt lgkmcnt(7)
ds_read_b64_tr_b16 a[246:247], v239 offset:17376
v_mul_f32 v211, v211, v242
v_mfma_f32_16x16x32_bf16 a[144:147], a[224:227], v[128:131], a[144:147]
ds_read_b64_tr_b16 a[248:249], v239 offset:17504
buffer_load_dwordx4 v252, s[16:19], s45 offen offset:2112 lds
v_cvt_pk_bf16_f32 v184, v208, v209
v_mfma_f32_16x16x32_bf16 a[144:147], a[228:231], v[136:139], a[144:147]
ds_read_b64_tr_b16 a[250:251], v239 offset:17632
v_cvt_pk_bf16_f32 v185, v210, v211
v_mfma_f32_16x16x32_bf16 a[148:151], a[228:231], v[140:143], a[148:151]
ds_read_b64_tr_b16 a[252:253], v239 offset:17760
v_mul_f32 v212, v212, v243
v_mfma_f32_16x16x32_bf16 a[148:151], a[224:227], v[132:135], a[148:151]
s_waitcnt lgkmcnt(7)
ds_read_b64_tr_b16 a[254:255], v239 offset:17888
v_mul_f32 v213, v213, v243
v_mfma_f32_16x16x32_bf16 a[148:151], a[232:235], v[148:151], a[148:151]
ds_read_b64_tr_b16 a[224:225], v240 offset:16896
v_mul_f32 v214, v214, v243
v_mfma_f32_16x16x32_bf16 a[148:151], a[236:239], v[156:159], a[148:151]
ds_read_b64_tr_b16 a[226:227], v240 offset:17024
v_mul_f32 v215, v215, v243
v_mfma_f32_16x16x32_bf16 a[144:147], a[236:239], v[152:155], a[144:147]
ds_read_b64_tr_b16 a[228:229], v240 offset:17152
v_cvt_pk_bf16_f32 v188, v212, v213
v_mfma_f32_16x16x32_bf16 a[144:147], a[232:235], v[144:147], a[144:147]
s_waitcnt lgkmcnt(7)
ds_read_b64_tr_b16 a[230:231], v240 offset:17280
v_cvt_pk_bf16_f32 v189, v214, v215
v_mfma_f32_16x16x32_bf16 a[152:155], a[240:243], v[128:131], a[152:155]
ds_read_b64_tr_b16 a[232:233], v240 offset:17408
buffer_load_dwordx4 v253, s[16:19], s45 offen offset:3168 lds
v_mul_f32 v216, v216, v242
v_mfma_f32_16x16x32_bf16 a[152:155], a[244:247], v[136:139], a[152:155]
ds_read_b64_tr_b16 a[234:235], v240 offset:17536
v_mul_f32 v217, v217, v242
v_mfma_f32_16x16x32_bf16 a[156:159], a[244:247], v[140:143], a[156:159]
s_add_u32 m0, s28, 135168
ds_read_b64_tr_b16 a[236:237], v240 offset:17664
v_mul_f32 v218, v218, v242
v_mfma_f32_16x16x32_bf16 a[156:159], a[240:243], v[132:135], a[156:159]
s_waitcnt lgkmcnt(7)
ds_read_b64_tr_b16 a[238:239], v240 offset:17792
v_mul_f32 v219, v219, v242
v_mfma_f32_16x16x32_bf16 a[156:159], a[248:251], v[148:151], a[156:159]
s_mov_b32 s45, 344704
ds_read_b64_tr_b16 a[240:241], v240 offset:16928
v_cvt_pk_bf16_f32 v186, v216, v217
v_mfma_f32_16x16x32_bf16 a[156:159], a[252:255], v[156:159], a[156:159]
ds_read_b64_tr_b16 a[242:243], v240 offset:17056
v_cvt_pk_bf16_f32 v187, v218, v219
v_mfma_f32_16x16x32_bf16 a[152:155], a[252:255], v[152:155], a[152:155]
ds_read_b64_tr_b16 a[244:245], v240 offset:17184
v_mul_f32 v220, v220, v243
v_mfma_f32_16x16x32_bf16 a[152:155], a[248:251], v[144:147], a[152:155]
s_waitcnt lgkmcnt(7)
ds_read_b64_tr_b16 a[246:247], v240 offset:17312
v_mul_f32 v221, v221, v243
v_mfma_f32_16x16x32_bf16 a[0:3], a[224:227], v[160:163], a[0:3]
ds_read_b64_tr_b16 a[248:249], v240 offset:17440
v_mul_f32 v222, v222, v243
v_mul_f32 v223, v223, v243
v_mfma_f32_16x16x32_bf16 a[0:3], a[228:231], v[176:179], a[0:3]
ds_read_b64_tr_b16 a[250:251], v240 offset:17568
v_cvt_pk_bf16_f32 v190, v220, v221
v_cvt_pk_bf16_f32 v191, v222, v223
v_mfma_f32_16x16x32_bf16 a[4:7], a[228:231], v[180:183], a[4:7]
ds_read_b64_tr_b16 a[252:253], v240 offset:17696
buffer_load_dwordx4 v250, s[16:19], s45 offen offset:0 lds
v_mfma_f32_16x16x32_bf16 a[4:7], a[224:227], v[164:167], a[4:7]
s_waitcnt lgkmcnt(7)
ds_read_b64_tr_b16 a[254:255], v240 offset:17824
v_mfma_f32_16x16x32_bf16 a[4:7], a[232:235], v[172:175], a[4:7]
ds_read_b64_tr_b16 a[224:225], v240 offset:16960
v_mfma_f32_16x16x32_bf16 a[4:7], a[236:239], v[188:191], a[4:7]
ds_read_b64_tr_b16 a[226:227], v240 offset:17088
v_mfma_f32_16x16x32_bf16 a[0:3], a[236:239], v[184:187], a[0:3]
ds_read_b64_tr_b16 a[228:229], v240 offset:17216
v_mfma_f32_16x16x32_bf16 a[0:3], a[232:235], v[168:171], a[0:3]
s_waitcnt lgkmcnt(7)
ds_read_b64_tr_b16 a[230:231], v240 offset:17344
v_mfma_f32_16x16x32_bf16 a[8:11], a[240:243], v[160:163], a[8:11]
ds_read_b64_tr_b16 a[232:233], v240 offset:17472
buffer_load_dwordx4 v251, s[16:19], s45 offen offset:1056 lds
v_mfma_f32_16x16x32_bf16 a[8:11], a[244:247], v[176:179], a[8:11]
ds_read_b64_tr_b16 a[234:235], v240 offset:17600
v_mfma_f32_16x16x32_bf16 a[12:15], a[244:247], v[180:183], a[12:15]
ds_read_b64_tr_b16 a[236:237], v240 offset:17728
v_mfma_f32_16x16x32_bf16 a[12:15], a[240:243], v[164:167], a[12:15]
s_waitcnt lgkmcnt(7)
ds_read_b64_tr_b16 a[238:239], v240 offset:17856
v_mfma_f32_16x16x32_bf16 a[12:15], a[248:251], v[172:175], a[12:15]
ds_read_b64_tr_b16 a[240:241], v240 offset:16992
v_mfma_f32_16x16x32_bf16 a[12:15], a[252:255], v[188:191], a[12:15]
ds_read_b64_tr_b16 a[242:243], v240 offset:17120
v_mfma_f32_16x16x32_bf16 a[8:11], a[252:255], v[184:187], a[8:11]
ds_read_b64_tr_b16 a[244:245], v240 offset:17248
v_mfma_f32_16x16x32_bf16 a[8:11], a[248:251], v[168:171], a[8:11]
s_waitcnt lgkmcnt(7)
ds_read_b64_tr_b16 a[246:247], v240 offset:17376
v_mfma_f32_16x16x32_bf16 a[16:19], a[224:227], v[160:163], a[16:19]
ds_read_b64_tr_b16 a[248:249], v240 offset:17504
buffer_load_dwordx4 v252, s[16:19], s45 offen offset:2112 lds
v_mfma_f32_16x16x32_bf16 a[16:19], a[228:231], v[176:179], a[16:19]
ds_read_b64_tr_b16 a[250:251], v240 offset:17632
v_mfma_f32_16x16x32_bf16 a[20:23], a[228:231], v[180:183], a[20:23]
s_waitcnt lgkmcnt(6)
ds_read_b64_tr_b16 a[252:253], v240 offset:17760
v_mfma_f32_16x16x32_bf16 a[20:23], a[224:227], v[164:167], a[20:23]
s_waitcnt vmcnt(15)
ds_read_b64_tr_b16 a[254:255], v240 offset:17888
s_barrier
v_accvgpr_read_b32 v192, a0
v_mfma_f32_16x16x32_bf16 a[20:23], a[232:235], v[172:175], a[20:23]
ds_read_b64_tr_b16 a[224:225], v240 offset:33792
v_accvgpr_read_b32 v193, a1
v_accvgpr_read_b32 v194, a2
v_mfma_f32_16x16x32_bf16 a[20:23], a[236:239], v[188:191], a[20:23]
ds_read_b64_tr_b16 a[226:227], v240 offset:33920
v_accvgpr_read_b32 v195, a3
v_accvgpr_read_b32 v196, a8
v_mfma_f32_16x16x32_bf16 a[16:19], a[236:239], v[184:187], a[16:19]
ds_read_b64_tr_b16 a[228:229], v240 offset:34048
v_accvgpr_read_b32 v197, a9
v_accvgpr_read_b32 v198, a10
v_mfma_f32_16x16x32_bf16 a[16:19], a[232:235], v[168:171], a[16:19]
s_waitcnt lgkmcnt(7)
ds_read_b64_tr_b16 a[230:231], v240 offset:34176
v_accvgpr_read_b32 v199, a11
v_cvt_pk_bf16_f32 v208, v192, v193
v_mfma_f32_16x16x32_bf16 a[24:27], a[240:243], v[160:163], a[24:27]
ds_read_b64_tr_b16 a[232:233], v240 offset:34304
buffer_load_dwordx4 v253, s[16:19], s45 offen offset:3168 lds
v_cvt_pk_bf16_f32 v209, v194, v195
v_cvt_pk_bf16_f32 v210, v196, v197
v_mfma_f32_16x16x32_bf16 a[24:27], a[244:247], v[176:179], a[24:27]
s_add_u32 m0, s28, 16896
ds_read_b64_tr_b16 a[234:235], v240 offset:34432
v_cvt_pk_bf16_f32 v211, v198, v199
v_mfma_f32_16x16x32_bf16 a[28:31], a[244:247], v[180:183], a[28:31]
s_add_u32 s35, s72, 0
ds_read_b64_tr_b16 a[236:237], v240 offset:34560
buffer_store_dwordx4 v[208:211], v244, s[24:27], s35 offen sc1
v_mfma_f32_16x16x32_bf16 a[28:31], a[240:243], v[164:167], a[28:31]
s_waitcnt lgkmcnt(7)
ds_read_b64_tr_b16 a[238:239], v240 offset:34688
ds_write_b128 v233, v[208:211] offset:0
v_mfma_f32_16x16x32_bf16 a[28:31], a[248:251], v[172:175], a[28:31]
s_mov_b32 s45, 230144
ds_read_b64_tr_b16 a[240:241], v240 offset:33824
v_accvgpr_read_b32 v200, a4
v_accvgpr_read_b32 v201, a5
v_mfma_f32_16x16x32_bf16 a[28:31], a[252:255], v[188:191], a[28:31]
ds_read_b64_tr_b16 a[242:243], v240 offset:33952
v_accvgpr_read_b32 v202, a6
v_accvgpr_read_b32 v203, a7
v_mfma_f32_16x16x32_bf16 a[24:27], a[252:255], v[184:187], a[24:27]
ds_read_b64_tr_b16 a[244:245], v240 offset:34080
v_accvgpr_read_b32 v204, a12
v_accvgpr_read_b32 v205, a13
v_mfma_f32_16x16x32_bf16 a[24:27], a[248:251], v[168:171], a[24:27]
s_waitcnt lgkmcnt(8)
ds_read_b64_tr_b16 a[246:247], v240 offset:34208
v_accvgpr_read_b32 v206, a14
v_accvgpr_read_b32 v207, a15
v_mfma_f32_16x16x32_bf16 a[32:35], a[224:227], v[160:163], a[32:35]
ds_read_b64_tr_b16 a[248:249], v240 offset:34336
v_cvt_pk_bf16_f32 v212, v200, v201
v_cvt_pk_bf16_f32 v213, v202, v203
v_mfma_f32_16x16x32_bf16 a[32:35], a[228:231], v[176:179], a[32:35]
ds_read_b64_tr_b16 a[250:251], v240 offset:34464
buffer_load_dwordx4 v250, s[16:19], s45 offen offset:0 lds
v_cvt_pk_bf16_f32 v214, v204, v205
v_cvt_pk_bf16_f32 v215, v206, v207
v_mfma_f32_16x16x32_bf16 a[36:39], a[228:231], v[180:183], a[36:39]
ds_read_b64_tr_b16 a[252:253], v240 offset:34592
s_lshl_b32 s46, s33, 10
s_add_u32 s46, s46, 0
v_add_u32 v243, s46, v244
v_mfma_f32_16x16x32_bf16 a[36:39], a[224:227], v[164:167], a[36:39]
s_waitcnt lgkmcnt(8)
s_add_u32 s35, s3, 14336
ds_read_b64_tr_b16 a[254:255], v240 offset:34720
v_mfma_f32_16x16x32_bf16 a[36:39], a[232:235], v[172:175], a[36:39]
ds_read_b64_tr_b16 a[224:225], v240 offset:33856
buffer_store_dwordx4 v[212:215], v244, s[24:27], s35 offen sc1
v_mfma_f32_16x16x32_bf16 a[36:39], a[236:239], v[188:191], a[36:39]
ds_read_b64_tr_b16 a[226:227], v240 offset:33984
ds_write_b128 v235, v[212:215] offset:0
v_mfma_f32_16x16x32_bf16 a[32:35], a[236:239], v[184:187], a[32:35]
ds_read_b64_tr_b16 a[228:229], v240 offset:34112
v_accvgpr_read_b32 v192, a16
v_accvgpr_read_b32 v193, a17
v_mfma_f32_16x16x32_bf16 a[32:35], a[232:235], v[168:171], a[32:35]
s_waitcnt lgkmcnt(8)
ds_read_b64_tr_b16 a[230:231], v240 offset:34240
v_accvgpr_read_b32 v194, a18
v_accvgpr_read_b32 v195, a19
v_mfma_f32_16x16x32_bf16 a[40:43], a[240:243], v[160:163], a[40:43]
ds_read_b64_tr_b16 a[232:233], v240 offset:34368
buffer_load_dwordx4 v251, s[16:19], s45 offen offset:1056 lds
v_accvgpr_read_b32 v196, a24
v_accvgpr_read_b32 v197, a25
v_mfma_f32_16x16x32_bf16 a[40:43], a[244:247], v[176:179], a[40:43]
ds_read_b64_tr_b16 a[234:235], v240 offset:34496
v_accvgpr_read_b32 v198, a26
v_accvgpr_read_b32 v199, a27
v_cvt_pk_bf16_f32 v216, v192, v193
v_mfma_f32_16x16x32_bf16 a[44:47], a[244:247], v[180:183], a[44:47]
ds_read_b64_tr_b16 a[236:237], v240 offset:34624
v_cvt_pk_bf16_f32 v217, v194, v195
v_cvt_pk_bf16_f32 v218, v196, v197
v_cvt_pk_bf16_f32 v219, v198, v199
v_mfma_f32_16x16x32_bf16 a[44:47], a[240:243], v[164:167], a[44:47]
s_waitcnt lgkmcnt(8)
s_add_u32 s35, s72, 1024
ds_read_b64_tr_b16 a[238:239], v240 offset:34752
buffer_store_dwordx4 v[216:219], v244, s[24:27], s35 offen sc1
v_mfma_f32_16x16x32_bf16 a[44:47], a[248:251], v[172:175], a[44:47]
ds_read_b64_tr_b16 a[240:241], v240 offset:33888
ds_write_b128 v233, v[216:219] offset:1024
v_accvgpr_read_b32 v200, a20
v_mfma_f32_16x16x32_bf16 a[44:47], a[252:255], v[188:191], a[44:47]
ds_read_b64_tr_b16 a[242:243], v240 offset:34016
v_accvgpr_read_b32 v201, a21
v_accvgpr_read_b32 v202, a22
v_accvgpr_read_b32 v203, a23
v_mfma_f32_16x16x32_bf16 a[40:43], a[252:255], v[184:187], a[40:43]
ds_read_b64_tr_b16 a[244:245], v240 offset:34144
v_accvgpr_read_b32 v204, a28
v_accvgpr_read_b32 v205, a29
v_accvgpr_read_b32 v206, a30
v_mfma_f32_16x16x32_bf16 a[40:43], a[248:251], v[168:171], a[40:43]
s_waitcnt lgkmcnt(8)
ds_read_b64_tr_b16 a[246:247], v240 offset:34272
v_accvgpr_read_b32 v207, a31
v_cvt_pk_bf16_f32 v220, v200, v201
v_cvt_pk_bf16_f32 v221, v202, v203
v_mfma_f32_16x16x32_bf16 a[48:51], a[224:227], v[160:163], a[48:51]
ds_read_b64_tr_b16 a[248:249], v240 offset:34400
buffer_load_dwordx4 v252, s[16:19], s45 offen offset:2112 lds
v_cvt_pk_bf16_f32 v222, v204, v205
v_cvt_pk_bf16_f32 v223, v206, v207
v_mfma_f32_16x16x32_bf16 a[48:51], a[228:231], v[176:179], a[48:51]
s_add_u32 s35, s3, 15360
ds_read_b64_tr_b16 a[250:251], v240 offset:34528
buffer_store_dwordx4 v[220:223], v244, s[24:27], s35 offen sc1
v_mfma_f32_16x16x32_bf16 a[52:55], a[228:231], v[180:183], a[52:55]
ds_read_b64_tr_b16 a[252:253], v240 offset:34656
ds_write_b128 v235, v[220:223] offset:1024
v_mfma_f32_16x16x32_bf16 a[52:55], a[224:227], v[164:167], a[52:55]
s_waitcnt lgkmcnt(9)
ds_read_b64_tr_b16 a[254:255], v240 offset:34784
v_accvgpr_read_b32 v192, a32
v_accvgpr_read_b32 v193, a33
v_mfma_f32_16x16x32_bf16 a[52:55], a[232:235], v[172:175], a[52:55]
ds_read_b64_tr_b16 a[224:225], v239 offset:33792
v_accvgpr_read_b32 v194, a34
v_accvgpr_read_b32 v195, a35
v_mfma_f32_16x16x32_bf16 a[52:55], a[236:239], v[188:191], a[52:55]
ds_read_b64_tr_b16 a[226:227], v239 offset:33920
v_accvgpr_read_b32 v196, a40
v_accvgpr_read_b32 v197, a41
v_mfma_f32_16x16x32_bf16 a[48:51], a[236:239], v[184:187], a[48:51]
ds_read_b64_tr_b16 a[228:229], v239 offset:34048
v_accvgpr_read_b32 v198, a42
v_accvgpr_read_b32 v199, a43
v_mfma_f32_16x16x32_bf16 a[48:51], a[232:235], v[168:171], a[48:51]
s_waitcnt lgkmcnt(8)
ds_read_b64_tr_b16 a[230:231], v239 offset:34176
v_cvt_pk_bf16_f32 v208, v192, v193
v_cvt_pk_bf16_f32 v209, v194, v195
v_mfma_f32_16x16x32_bf16 a[56:59], a[240:243], v[160:163], a[56:59]
ds_read_b64_tr_b16 a[232:233], v239 offset:34304
buffer_load_dwordx4 v253, s[16:19], s45 offen offset:3168 lds
v_cvt_pk_bf16_f32 v210, v196, v197
v_cvt_pk_bf16_f32 v211, v198, v199
v_mfma_f32_16x16x32_bf16 a[56:59], a[244:247], v[176:179], a[56:59]
s_add_u32 s35, s72, 2048
ds_read_b64_tr_b16 a[234:235], v239 offset:34432
buffer_store_dwordx4 v[208:211], v244, s[24:27], s35 offen sc1
v_mfma_f32_16x16x32_bf16 a[60:63], a[244:247], v[180:183], a[60:63]
s_add_u32 m0, s28, 84480
ds_read_b64_tr_b16 a[236:237], v239 offset:34560
ds_write_b128 v233, v[208:211] offset:2048
v_mfma_f32_16x16x32_bf16 a[60:63], a[240:243], v[164:167], a[60:63]
s_waitcnt lgkmcnt(8)
ds_read_b64_tr_b16 a[238:239], v239 offset:34688
v_accvgpr_read_b32 v200, a36
v_accvgpr_read_b32 v201, a37
v_mfma_f32_16x16x32_bf16 a[60:63], a[248:251], v[172:175], a[60:63]
s_mov_b32 s45, 344832
ds_read_b64_tr_b16 a[240:241], v239 offset:33824
v_accvgpr_read_b32 v202, a38
v_accvgpr_read_b32 v203, a39
v_mfma_f32_16x16x32_bf16 a[60:63], a[252:255], v[188:191], a[60:63]
ds_read_b64_tr_b16 a[242:243], v239 offset:33952
v_accvgpr_read_b32 v204, a44
v_accvgpr_read_b32 v205, a45
v_mfma_f32_16x16x32_bf16 a[56:59], a[252:255], v[184:187], a[56:59]
ds_read_b64_tr_b16 a[244:245], v239 offset:34080
v_accvgpr_read_b32 v206, a46
v_accvgpr_read_b32 v207, a47
v_mfma_f32_16x16x32_bf16 a[56:59], a[248:251], v[168:171], a[56:59]
s_waitcnt lgkmcnt(8)
ds_read_b64_tr_b16 a[246:247], v239 offset:34208
v_cvt_pk_bf16_f32 v212, v200, v201
v_cvt_pk_bf16_f32 v213, v202, v203
v_mfma_f32_16x16x32_bf16 a[64:67], a[224:227], v[160:163], a[64:67]
ds_read_b64_tr_b16 a[248:249], v239 offset:34336
buffer_load_dwordx4 v250, s[16:19], s45 offen offset:0 lds
v_cvt_pk_bf16_f32 v214, v204, v205
v_cvt_pk_bf16_f32 v215, v206, v207
v_mfma_f32_16x16x32_bf16 a[64:67], a[228:231], v[176:179], a[64:67]
s_add_u32 s35, s3, 16384
ds_read_b64_tr_b16 a[250:251], v239 offset:34464
buffer_store_dwordx4 v[212:215], v244, s[24:27], s35 offen sc1
v_mfma_f32_16x16x32_bf16 a[68:71], a[228:231], v[180:183], a[68:71]
ds_read_b64_tr_b16 a[252:253], v239 offset:34592
ds_write_b128 v235, v[212:215] offset:2048
v_mfma_f32_16x16x32_bf16 a[68:71], a[224:227], v[164:167], a[68:71]
s_waitcnt lgkmcnt(8)
ds_read_b64_tr_b16 a[254:255], v239 offset:34720
v_accvgpr_read_b32 v192, a48
v_accvgpr_read_b32 v193, a49
v_mfma_f32_16x16x32_bf16 a[68:71], a[232:235], v[172:175], a[68:71]
ds_read_b64_tr_b16 a[224:225], v239 offset:33856
v_accvgpr_read_b32 v194, a50
v_accvgpr_read_b32 v195, a51
v_mfma_f32_16x16x32_bf16 a[68:71], a[236:239], v[188:191], a[68:71]
ds_read_b64_tr_b16 a[226:227], v239 offset:33984
v_accvgpr_read_b32 v196, a56
v_accvgpr_read_b32 v197, a57
v_mfma_f32_16x16x32_bf16 a[64:67], a[236:239], v[184:187], a[64:67]
ds_read_b64_tr_b16 a[228:229], v239 offset:34112
v_accvgpr_read_b32 v198, a58
v_accvgpr_read_b32 v199, a59
v_mfma_f32_16x16x32_bf16 a[64:67], a[232:235], v[168:171], a[64:67]
s_waitcnt lgkmcnt(8)
ds_read_b64_tr_b16 a[230:231], v239 offset:34240
v_cvt_pk_bf16_f32 v216, v192, v193
v_cvt_pk_bf16_f32 v217, v194, v195
v_mfma_f32_16x16x32_bf16 a[72:75], a[240:243], v[160:163], a[72:75]
ds_read_b64_tr_b16 a[232:233], v239 offset:34368
buffer_load_dwordx4 v251, s[16:19], s45 offen offset:1056 lds
v_cvt_pk_bf16_f32 v218, v196, v197
v_cvt_pk_bf16_f32 v219, v198, v199
v_mfma_f32_16x16x32_bf16 a[72:75], a[244:247], v[176:179], a[72:75]
s_add_u32 s35, s72, 3072
ds_read_b64_tr_b16 a[234:235], v239 offset:34496
buffer_store_dwordx4 v[216:219], v244, s[24:27], s35 offen sc1
v_mfma_f32_16x16x32_bf16 a[76:79], a[244:247], v[180:183], a[76:79]
ds_read_b64_tr_b16 a[236:237], v239 offset:34624
ds_write_b128 v233, v[216:219] offset:3072
v_mfma_f32_16x16x32_bf16 a[76:79], a[240:243], v[164:167], a[76:79]
s_waitcnt lgkmcnt(8)
ds_read_b64_tr_b16 a[238:239], v239 offset:34752
v_accvgpr_read_b32 v200, a52
v_accvgpr_read_b32 v201, a53
v_mfma_f32_16x16x32_bf16 a[76:79], a[248:251], v[172:175], a[76:79]
ds_read_b64_tr_b16 a[240:241], v239 offset:33888
v_accvgpr_read_b32 v202, a54
v_accvgpr_read_b32 v203, a55
v_mfma_f32_16x16x32_bf16 a[76:79], a[252:255], v[188:191], a[76:79]
ds_read_b64_tr_b16 a[242:243], v239 offset:34016
v_accvgpr_read_b32 v204, a60
v_accvgpr_read_b32 v205, a61
v_mfma_f32_16x16x32_bf16 a[72:75], a[252:255], v[184:187], a[72:75]
ds_read_b64_tr_b16 a[244:245], v239 offset:34144
v_accvgpr_read_b32 v206, a62
v_accvgpr_read_b32 v207, a63
v_mfma_f32_16x16x32_bf16 a[72:75], a[248:251], v[168:171], a[72:75]
s_waitcnt lgkmcnt(8)
ds_read_b64_tr_b16 a[246:247], v239 offset:34272
v_cvt_pk_bf16_f32 v220, v200, v201
v_cvt_pk_bf16_f32 v221, v202, v203
v_mfma_f32_16x16x32_bf16 a[80:83], a[224:227], v[160:163], a[80:83]
ds_read_b64_tr_b16 a[248:249], v239 offset:34400
buffer_load_dwordx4 v252, s[16:19], s45 offen offset:2112 lds
v_cvt_pk_bf16_f32 v222, v204, v205
v_cvt_pk_bf16_f32 v223, v206, v207
v_mfma_f32_16x16x32_bf16 a[80:83], a[228:231], v[176:179], a[80:83]
s_add_u32 s35, s3, 17408
ds_read_b64_tr_b16 a[250:251], v239 offset:34528
buffer_store_dwordx4 v[220:223], v244, s[24:27], s35 offen sc1
v_mfma_f32_16x16x32_bf16 a[84:87], a[228:231], v[180:183], a[84:87]
s_waitcnt lgkmcnt(6)
ds_read_b64_tr_b16 a[252:253], v239 offset:34656
ds_write_b128 v235, v[220:223] offset:3072
v_mfma_f32_16x16x32_bf16 a[84:87], a[224:227], v[164:167], a[84:87]
s_waitcnt vmcnt(23)
ds_read_b64_tr_b16 a[254:255], v239 offset:34784
s_barrier
v_accvgpr_read_b32 v192, a64
v_mfma_f32_16x16x32_bf16 a[84:87], a[232:235], v[172:175], a[84:87]
ds_read_b64_tr_b16 a[224:225], v240 offset:50688
v_accvgpr_read_b32 v193, a65
v_accvgpr_read_b32 v194, a66
v_mfma_f32_16x16x32_bf16 a[84:87], a[236:239], v[188:191], a[84:87]
ds_read_b64_tr_b16 a[226:227], v240 offset:50816
v_accvgpr_read_b32 v195, a67
v_accvgpr_read_b32 v196, a72
v_mfma_f32_16x16x32_bf16 a[80:83], a[236:239], v[184:187], a[80:83]
ds_read_b64_tr_b16 a[228:229], v240 offset:50944
v_accvgpr_read_b32 v197, a73
v_accvgpr_read_b32 v198, a74
v_mfma_f32_16x16x32_bf16 a[80:83], a[232:235], v[168:171], a[80:83]
s_waitcnt lgkmcnt(8)
ds_read_b64_tr_b16 a[230:231], v240 offset:51072
v_accvgpr_read_b32 v199, a75
v_cvt_pk_bf16_f32 v208, v192, v193
v_mfma_f32_16x16x32_bf16 a[88:91], a[240:243], v[160:163], a[88:91]
ds_read_b64_tr_b16 a[232:233], v240 offset:51200
buffer_load_dwordx4 v253, s[16:19], s45 offen offset:3168 lds
v_cvt_pk_bf16_f32 v209, v194, v195
v_cvt_pk_bf16_f32 v210, v196, v197
v_mfma_f32_16x16x32_bf16 a[88:91], a[244:247], v[176:179], a[88:91]
ds_read_b64_tr_b16 a[234:235], v240 offset:51328
v_cvt_pk_bf16_f32 v211, v198, v199
v_mfma_f32_16x16x32_bf16 a[92:95], a[244:247], v[180:183], a[92:95]
s_add_u32 s35, s72, 4096
ds_read_b64_tr_b16 a[236:237], v240 offset:51456
buffer_store_dwordx4 v[208:211], v244, s[24:27], s35 offen sc1
v_mfma_f32_16x16x32_bf16 a[92:95], a[240:243], v[164:167], a[92:95]
s_waitcnt lgkmcnt(7)
ds_read_b64_tr_b16 a[238:239], v240 offset:51584
ds_write_b128 v233, v[208:211] offset:4096
v_mfma_f32_16x16x32_bf16 a[92:95], a[248:251], v[172:175], a[92:95]
ds_read_b64_tr_b16 a[240:241], v240 offset:50720
v_accvgpr_read_b32 v200, a68
v_accvgpr_read_b32 v201, a69
v_mfma_f32_16x16x32_bf16 a[92:95], a[252:255], v[188:191], a[92:95]
ds_read_b64_tr_b16 a[242:243], v240 offset:50848
v_accvgpr_read_b32 v202, a70
v_accvgpr_read_b32 v203, a71
v_mfma_f32_16x16x32_bf16 a[88:91], a[252:255], v[184:187], a[88:91]
ds_read_b64_tr_b16 a[244:245], v240 offset:50976
v_accvgpr_read_b32 v204, a76
v_accvgpr_read_b32 v205, a77
v_mfma_f32_16x16x32_bf16 a[88:91], a[248:251], v[168:171], a[88:91]
s_waitcnt lgkmcnt(8)
ds_read_b64_tr_b16 a[246:247], v240 offset:51104
v_accvgpr_read_b32 v206, a78
v_accvgpr_read_b32 v207, a79
v_mfma_f32_16x16x32_bf16 a[96:99], a[224:227], v[160:163], a[96:99]
ds_read_b64_tr_b16 a[248:249], v240 offset:51232
v_cvt_pk_bf16_f32 v212, v200, v201
v_cvt_pk_bf16_f32 v213, v202, v203
v_mfma_f32_16x16x32_bf16 a[96:99], a[228:231], v[176:179], a[96:99]
ds_read_b64_tr_b16 a[250:251], v240 offset:51360
v_cvt_pk_bf16_f32 v214, v204, v205
v_cvt_pk_bf16_f32 v215, v206, v207
v_mfma_f32_16x16x32_bf16 a[100:103], a[228:231], v[180:183], a[100:103]
s_add_u32 s35, s3, 18432
ds_read_b64_tr_b16 a[252:253], v240 offset:51488
buffer_store_dwordx4 v[212:215], v244, s[24:27], s35 offen sc1
v_mfma_f32_16x16x32_bf16 a[100:103], a[224:227], v[164:167], a[100:103]
s_waitcnt lgkmcnt(8)
ds_read_b64_tr_b16 a[254:255], v240 offset:51616
ds_write_b128 v235, v[212:215] offset:4096
v_mfma_f32_16x16x32_bf16 a[100:103], a[232:235], v[172:175], a[100:103]
ds_read_b64_tr_b16 a[224:225], v240 offset:50752
v_accvgpr_read_b32 v192, a80
v_accvgpr_read_b32 v193, a81
v_mfma_f32_16x16x32_bf16 a[100:103], a[236:239], v[188:191], a[100:103]
ds_read_b64_tr_b16 a[226:227], v240 offset:50880
v_accvgpr_read_b32 v194, a82
v_accvgpr_read_b32 v195, a83
v_mfma_f32_16x16x32_bf16 a[96:99], a[236:239], v[184:187], a[96:99]
ds_read_b64_tr_b16 a[228:229], v240 offset:51008
v_accvgpr_read_b32 v196, a88
v_accvgpr_read_b32 v197, a89
v_mfma_f32_16x16x32_bf16 a[96:99], a[232:235], v[168:171], a[96:99]
s_waitcnt lgkmcnt(8)
ds_read_b64_tr_b16 a[230:231], v240 offset:51136
v_accvgpr_read_b32 v198, a90
v_accvgpr_read_b32 v199, a91
v_mfma_f32_16x16x32_bf16 a[104:107], a[240:243], v[160:163], a[104:107]
ds_read_b64_tr_b16 a[232:233], v240 offset:51264
v_cvt_pk_bf16_f32 v216, v192, v193
v_cvt_pk_bf16_f32 v217, v194, v195
v_mfma_f32_16x16x32_bf16 a[104:107], a[244:247], v[176:179], a[104:107]
ds_read_b64_tr_b16 a[234:235], v240 offset:51392
v_cvt_pk_bf16_f32 v218, v196, v197
v_cvt_pk_bf16_f32 v219, v198, v199
v_mfma_f32_16x16x32_bf16 a[108:111], a[244:247], v[180:183], a[108:111]
s_add_u32 s35, s72, 5120
ds_read_b64_tr_b16 a[236:237], v240 offset:51520
buffer_store_dwordx4 v[216:219], v244, s[24:27], s35 offen sc1
v_mfma_f32_16x16x32_bf16 a[108:111], a[240:243], v[164:167], a[108:111]
s_waitcnt lgkmcnt(8)
ds_read_b64_tr_b16 a[238:239], v240 offset:51648
ds_write_b128 v233, v[216:219] offset:5120
v_mfma_f32_16x16x32_bf16 a[108:111], a[248:251], v[172:175], a[108:111]
ds_read_b64_tr_b16 a[240:241], v240 offset:50784
v_accvgpr_read_b32 v200, a84
v_accvgpr_read_b32 v201, a85
v_mfma_f32_16x16x32_bf16 a[108:111], a[252:255], v[188:191], a[108:111]
ds_read_b64_tr_b16 a[242:243], v240 offset:50912
v_accvgpr_read_b32 v202, a86
v_accvgpr_read_b32 v203, a87
v_mfma_f32_16x16x32_bf16 a[104:107], a[252:255], v[184:187], a[104:107]
ds_read_b64_tr_b16 a[244:245], v240 offset:51040
v_accvgpr_read_b32 v204, a92
v_accvgpr_read_b32 v205, a93
v_mfma_f32_16x16x32_bf16 a[104:107], a[248:251], v[168:171], a[104:107]
s_waitcnt lgkmcnt(8)
ds_read_b64_tr_b16 a[246:247], v240 offset:51168
v_accvgpr_read_b32 v206, a94
v_accvgpr_read_b32 v207, a95
v_cvt_pk_bf16_f32 v220, v200, v201
v_mfma_f32_16x16x32_bf16 a[112:115], a[224:227], v[160:163], a[112:115]
ds_read_b64_tr_b16 a[248:249], v240 offset:51296
v_cvt_pk_bf16_f32 v221, v202, v203
v_cvt_pk_bf16_f32 v222, v204, v205
v_cvt_pk_bf16_f32 v223, v206, v207
v_mfma_f32_16x16x32_bf16 a[112:115], a[228:231], v[176:179], a[112:115]
s_add_u32 s35, s3, 19456
ds_read_b64_tr_b16 a[250:251], v240 offset:51424
buffer_store_dwordx4 v[220:223], v244, s[24:27], s35 offen sc1
v_mfma_f32_16x16x32_bf16 a[116:119], a[228:231], v[180:183], a[116:119]
ds_read_b64_tr_b16 a[252:253], v240 offset:51552
ds_write_b128 v235, v[220:223] offset:5120
v_mfma_f32_16x16x32_bf16 a[116:119], a[224:227], v[164:167], a[116:119]
s_waitcnt lgkmcnt(9)
ds_read_b64_tr_b16 a[254:255], v240 offset:51680
v_accvgpr_read_b32 v192, a96
v_accvgpr_read_b32 v193, a97
v_mfma_f32_16x16x32_bf16 a[116:119], a[232:235], v[172:175], a[116:119]
ds_read_b64_tr_b16 a[224:225], v240 offset:0
v_accvgpr_read_b32 v194, a98
v_accvgpr_read_b32 v195, a99
v_mfma_f32_16x16x32_bf16 a[116:119], a[236:239], v[188:191], a[116:119]
ds_read_b64_tr_b16 a[226:227], v240 offset:128
v_accvgpr_read_b32 v196, a104
v_accvgpr_read_b32 v197, a105
v_mfma_f32_16x16x32_bf16 a[112:115], a[236:239], v[184:187], a[112:115]
ds_read_b64_tr_b16 a[228:229], v240 offset:256
v_accvgpr_read_b32 v198, a106
v_accvgpr_read_b32 v199, a107
v_mfma_f32_16x16x32_bf16 a[112:115], a[232:235], v[168:171], a[112:115]
s_waitcnt lgkmcnt(8)
ds_read_b64_tr_b16 a[230:231], v240 offset:384
v_cvt_pk_bf16_f32 v208, v192, v193
v_cvt_pk_bf16_f32 v209, v194, v195
v_mfma_f32_16x16x32_bf16 a[120:123], a[240:243], v[160:163], a[120:123]
s_waitcnt lgkmcnt(15)
ds_read_b64_tr_b16 a[232:233], v240 offset:512
v_cvt_pk_bf16_f32 v210, v196, v197
v_cvt_pk_bf16_f32 v211, v198, v199
v_or_b32 v245, 256, v232
v_mfma_f32_16x16x32_bf16 a[120:123], a[244:247], v[176:179], a[120:123]
s_add_u32 s35, s72, 6144
s_waitcnt vmcnt(13)
ds_read_b64_tr_b16 a[234:235], v240 offset:640
buffer_store_dwordx4 v[208:211], v244, s[24:27], s35 offen sc1
v_mfma_f32_16x16x32_bf16 a[124:127], a[244:247], v[180:183], a[124:127]
ds_read_b64_tr_b16 a[236:237], v240 offset:768
ds_write_b128 v233, v[208:211] offset:6144
v_mfma_f32_16x16x32_bf16 a[124:127], a[240:243], v[164:167], a[124:127]
s_waitcnt lgkmcnt(8)
ds_read_b64_tr_b16 a[238:239], v240 offset:896
v_accvgpr_read_b32 v200, a100
v_accvgpr_read_b32 v201, a101
v_mfma_f32_16x16x32_bf16 a[124:127], a[248:251], v[172:175], a[124:127]
ds_read_b64_tr_b16 a[240:241], v240 offset:32
v_accvgpr_read_b32 v202, a102
v_accvgpr_read_b32 v203, a103
v_mfma_f32_16x16x32_bf16 a[124:127], a[252:255], v[188:191], a[124:127]
ds_read_b64_tr_b16 a[242:243], v240 offset:160
v_accvgpr_read_b32 v204, a108
v_accvgpr_read_b32 v205, a109
v_mfma_f32_16x16x32_bf16 a[120:123], a[252:255], v[184:187], a[120:123]
ds_read_b64_tr_b16 a[244:245], v240 offset:288
v_accvgpr_read_b32 v206, a110
v_accvgpr_read_b32 v207, a111
v_mfma_f32_16x16x32_bf16 a[120:123], a[248:251], v[168:171], a[120:123]
s_waitcnt lgkmcnt(8)
ds_read_b64_tr_b16 a[246:247], v240 offset:416
v_cvt_pk_bf16_f32 v212, v200, v201
v_cvt_pk_bf16_f32 v213, v202, v203
v_mfma_f32_16x16x32_bf16 a[128:131], a[224:227], v[160:163], a[128:131]
ds_read_b64_tr_b16 a[248:249], v240 offset:544
buffer_store_dword v245, v234, s[20:23], s73 offen sc1
v_cvt_pk_bf16_f32 v214, v204, v205
v_cvt_pk_bf16_f32 v215, v206, v207
v_mfma_f32_16x16x32_bf16 a[128:131], a[228:231], v[176:179], a[128:131]
s_add_u32 s35, s3, 20480
ds_read_b64_tr_b16 a[250:251], v240 offset:672
buffer_store_dwordx4 v[212:215], v244, s[24:27], s35 offen sc1
v_mfma_f32_16x16x32_bf16 a[132:135], a[228:231], v[180:183], a[132:135]
ds_read_b64_tr_b16 a[252:253], v240 offset:800
ds_write_b128 v235, v[212:215] offset:6144
v_mfma_f32_16x16x32_bf16 a[132:135], a[224:227], v[164:167], a[132:135]
s_waitcnt lgkmcnt(8)
ds_read_b64_tr_b16 a[254:255], v240 offset:928
v_accvgpr_read_b32 v192, a112
v_accvgpr_read_b32 v193, a113
v_mfma_f32_16x16x32_bf16 a[132:135], a[232:235], v[172:175], a[132:135]
ds_read_b64_tr_b16 a[224:225], v240 offset:64
v_accvgpr_read_b32 v194, a114
v_accvgpr_read_b32 v195, a115
v_mfma_f32_16x16x32_bf16 a[132:135], a[236:239], v[188:191], a[132:135]
ds_read_b64_tr_b16 a[226:227], v240 offset:192
v_accvgpr_read_b32 v196, a120
v_accvgpr_read_b32 v197, a121
v_mfma_f32_16x16x32_bf16 a[128:131], a[236:239], v[184:187], a[128:131]
ds_read_b64_tr_b16 a[228:229], v240 offset:320
v_accvgpr_read_b32 v198, a122
v_accvgpr_read_b32 v199, a123
v_mfma_f32_16x16x32_bf16 a[128:131], a[232:235], v[168:171], a[128:131]
s_waitcnt lgkmcnt(8)
ds_read_b64_tr_b16 a[230:231], v240 offset:448
v_cvt_pk_bf16_f32 v216, v192, v193
v_cvt_pk_bf16_f32 v217, v194, v195
v_mfma_f32_16x16x32_bf16 a[136:139], a[240:243], v[160:163], a[136:139]
ds_read_b64_tr_b16 a[232:233], v240 offset:576
v_cvt_pk_bf16_f32 v218, v196, v197
v_cvt_pk_bf16_f32 v219, v198, v199
v_mfma_f32_16x16x32_bf16 a[136:139], a[244:247], v[176:179], a[136:139]
s_add_u32 s35, s72, 7168
ds_read_b64_tr_b16 a[234:235], v240 offset:704
buffer_store_dwordx4 v[216:219], v244, s[24:27], s35 offen sc1
v_mfma_f32_16x16x32_bf16 a[140:143], a[244:247], v[180:183], a[140:143]
ds_read_b64_tr_b16 a[236:237], v240 offset:832
ds_write_b128 v233, v[216:219] offset:7168
v_mfma_f32_16x16x32_bf16 a[140:143], a[240:243], v[164:167], a[140:143]
s_waitcnt lgkmcnt(8)
ds_read_b64_tr_b16 a[238:239], v240 offset:960
v_accvgpr_read_b32 v200, a116
v_accvgpr_read_b32 v201, a117
v_mfma_f32_16x16x32_bf16 a[140:143], a[248:251], v[172:175], a[140:143]
ds_read_b64_tr_b16 a[240:241], v240 offset:96
v_accvgpr_read_b32 v202, a118
v_accvgpr_read_b32 v203, a119
v_mfma_f32_16x16x32_bf16 a[140:143], a[252:255], v[188:191], a[140:143]
ds_read_b64_tr_b16 a[242:243], v240 offset:224
v_accvgpr_read_b32 v204, a124
v_accvgpr_read_b32 v205, a125
v_mfma_f32_16x16x32_bf16 a[136:139], a[252:255], v[184:187], a[136:139]
ds_read_b64_tr_b16 a[244:245], v240 offset:352
v_accvgpr_read_b32 v206, a126
v_accvgpr_read_b32 v207, a127
v_mfma_f32_16x16x32_bf16 a[136:139], a[248:251], v[168:171], a[136:139]
s_waitcnt lgkmcnt(8)
ds_read_b64_tr_b16 a[246:247], v240 offset:480
v_cvt_pk_bf16_f32 v220, v200, v201
v_cvt_pk_bf16_f32 v221, v202, v203
v_mfma_f32_16x16x32_bf16 a[144:147], a[224:227], v[160:163], a[144:147]
ds_read_b64_tr_b16 a[248:249], v240 offset:608
v_cvt_pk_bf16_f32 v222, v204, v205
v_cvt_pk_bf16_f32 v223, v206, v207
v_mfma_f32_16x16x32_bf16 a[144:147], a[228:231], v[176:179], a[144:147]
s_add_u32 s35, s3, 21504
ds_read_b64_tr_b16 a[250:251], v240 offset:736
buffer_store_dwordx4 v[220:223], v244, s[24:27], s35 offen sc1
v_mfma_f32_16x16x32_bf16 a[148:151], a[228:231], v[180:183], a[148:151]
s_waitcnt lgkmcnt(6)
ds_read_b64_tr_b16 a[252:253], v240 offset:864
ds_write_b128 v235, v[220:223] offset:7168
v_mfma_f32_16x16x32_bf16 a[148:151], a[224:227], v[164:167], a[148:151]
s_waitcnt vmcnt(25)
ds_read_b64_tr_b16 a[254:255], v240 offset:992
s_barrier
v_mfma_f32_16x16x32_bf16 a[148:151], a[232:235], v[172:175], a[148:151]
ds_read_b64_tr_b16 a[224:225], v239 offset:50688
v_accvgpr_read_b32 v192, a128
v_mfma_f32_16x16x32_bf16 a[148:151], a[236:239], v[188:191], a[148:151]
ds_read_b64_tr_b16 a[226:227], v239 offset:50816
v_accvgpr_read_b32 v193, a129
v_mfma_f32_16x16x32_bf16 a[144:147], a[236:239], v[184:187], a[144:147]
ds_read_b64_tr_b16 a[228:229], v239 offset:50944
v_accvgpr_read_b32 v194, a130
v_mfma_f32_16x16x32_bf16 a[144:147], a[232:235], v[168:171], a[144:147]
s_waitcnt lgkmcnt(8)
ds_read_b64_tr_b16 a[230:231], v239 offset:51072
v_accvgpr_read_b32 v195, a131
v_mfma_f32_16x16x32_bf16 a[152:155], a[240:243], v[160:163], a[152:155]
s_waitcnt lgkmcnt(15)
ds_read_b64_tr_b16 a[232:233], v239 offset:51200
v_accvgpr_read_b32 v196, a136
v_or_b32 v245, 512, v232
v_mfma_f32_16x16x32_bf16 a[152:155], a[244:247], v[176:179], a[152:155]
s_waitcnt vmcnt(10)
ds_read_b64_tr_b16 a[234:235], v239 offset:51328
v_accvgpr_read_b32 v197, a137
v_mfma_f32_16x16x32_bf16 a[156:159], a[244:247], v[180:183], a[156:159]
ds_read_b64_tr_b16 a[236:237], v239 offset:51456
v_accvgpr_read_b32 v198, a138
v_mfma_f32_16x16x32_bf16 a[156:159], a[240:243], v[164:167], a[156:159]
s_waitcnt lgkmcnt(7)
ds_read_b64_tr_b16 a[238:239], v239 offset:51584
v_accvgpr_read_b32 v199, a139
v_mfma_f32_16x16x32_bf16 a[156:159], a[248:251], v[172:175], a[156:159]
ds_read_b64_tr_b16 a[240:241], v239 offset:50720
v_cvt_pk_bf16_f32 v208, v192, v193
v_mfma_f32_16x16x32_bf16 a[156:159], a[252:255], v[188:191], a[156:159]
ds_read_b64_tr_b16 a[242:243], v239 offset:50848
v_cvt_pk_bf16_f32 v209, v194, v195
v_mfma_f32_16x16x32_bf16 a[152:155], a[252:255], v[184:187], a[152:155]
ds_read_b64_tr_b16 a[244:245], v239 offset:50976
v_cvt_pk_bf16_f32 v210, v196, v197
v_mfma_f32_16x16x32_bf16 a[152:155], a[248:251], v[168:171], a[152:155]
s_waitcnt lgkmcnt(7)
ds_read_b64_tr_b16 a[246:247], v239 offset:51104
v_cvt_pk_bf16_f32 v211, v198, v199
v_mfma_f32_16x16x32_bf16 a[160:163], a[224:227], v[128:131], a[160:163]
s_add_u32 s35, s72, 8192
ds_read_b64_tr_b16 a[248:249], v239 offset:51232
buffer_store_dwordx4 v[208:211], v244, s[24:27], s35 offen sc1
buffer_store_dword v245, v234, s[20:23], s73 offen sc1
v_mfma_f32_16x16x32_bf16 a[160:163], a[228:231], v[136:139], a[160:163]
ds_read_b64_tr_b16 a[250:251], v239 offset:51360
ds_write_b128 v233, v[208:211] offset:8192
v_mfma_f32_16x16x32_bf16 a[164:167], a[228:231], v[140:143], a[164:167]
ds_read_b64_tr_b16 a[252:253], v239 offset:51488
v_accvgpr_read_b32 v200, a132
v_mfma_f32_16x16x32_bf16 a[164:167], a[224:227], v[132:135], a[164:167]
s_waitcnt lgkmcnt(8)
ds_read_b64_tr_b16 a[254:255], v239 offset:51616
v_accvgpr_read_b32 v201, a133
v_mfma_f32_16x16x32_bf16 a[164:167], a[232:235], v[148:151], a[164:167]
ds_read_b64_tr_b16 a[224:225], v239 offset:50752
v_accvgpr_read_b32 v202, a134
v_mfma_f32_16x16x32_bf16 a[164:167], a[236:239], v[156:159], a[164:167]
ds_read_b64_tr_b16 a[226:227], v239 offset:50880
v_accvgpr_read_b32 v203, a135
v_mfma_f32_16x16x32_bf16 a[160:163], a[236:239], v[152:155], a[160:163]
ds_read_b64_tr_b16 a[228:229], v239 offset:51008
v_accvgpr_read_b32 v204, a140
v_mfma_f32_16x16x32_bf16 a[160:163], a[232:235], v[144:147], a[160:163]
s_waitcnt lgkmcnt(8)
ds_read_b64_tr_b16 a[230:231], v239 offset:51136
v_accvgpr_read_b32 v205, a141
v_mfma_f32_16x16x32_bf16 a[168:171], a[240:243], v[128:131], a[168:171]
ds_read_b64_tr_b16 a[232:233], v239 offset:51264
v_accvgpr_read_b32 v206, a142
v_mfma_f32_16x16x32_bf16 a[168:171], a[244:247], v[136:139], a[168:171]
ds_read_b64_tr_b16 a[234:235], v239 offset:51392
v_accvgpr_read_b32 v207, a143
v_mfma_f32_16x16x32_bf16 a[172:175], a[244:247], v[140:143], a[172:175]
ds_read_b64_tr_b16 a[236:237], v239 offset:51520
v_cvt_pk_bf16_f32 v212, v200, v201
v_mfma_f32_16x16x32_bf16 a[172:175], a[240:243], v[132:135], a[172:175]
s_waitcnt lgkmcnt(7)
ds_read_b64_tr_b16 a[238:239], v239 offset:51648
v_cvt_pk_bf16_f32 v213, v202, v203
v_mfma_f32_16x16x32_bf16 a[172:175], a[248:251], v[148:151], a[172:175]
ds_read_b64_tr_b16 a[240:241], v239 offset:50784
v_cvt_pk_bf16_f32 v214, v204, v205
v_mfma_f32_16x16x32_bf16 a[172:175], a[252:255], v[156:159], a[172:175]
ds_read_b64_tr_b16 a[242:243], v239 offset:50912
v_cvt_pk_bf16_f32 v215, v206, v207
v_mfma_f32_16x16x32_bf16 a[168:171], a[252:255], v[152:155], a[168:171]
s_add_u32 s35, s3, 22528
ds_read_b64_tr_b16 a[244:245], v239 offset:51040
buffer_store_dwordx4 v[212:215], v244, s[24:27], s35 offen sc1
v_mfma_f32_16x16x32_bf16 a[168:171], a[248:251], v[144:147], a[168:171]
s_waitcnt lgkmcnt(7)
ds_read_b64_tr_b16 a[246:247], v239 offset:51168
ds_write_b128 v235, v[212:215] offset:8192
v_mfma_f32_16x16x32_bf16 a[176:179], a[224:227], v[128:131], a[176:179]
ds_read_b64_tr_b16 a[248:249], v239 offset:51296
v_accvgpr_read_b32 v192, a144
v_mfma_f32_16x16x32_bf16 a[176:179], a[228:231], v[136:139], a[176:179]
ds_read_b64_tr_b16 a[250:251], v239 offset:51424
v_accvgpr_read_b32 v193, a145
v_mfma_f32_16x16x32_bf16 a[180:183], a[228:231], v[140:143], a[180:183]
ds_read_b64_tr_b16 a[252:253], v239 offset:51552
v_accvgpr_read_b32 v194, a146
v_mfma_f32_16x16x32_bf16 a[180:183], a[224:227], v[132:135], a[180:183]
s_waitcnt lgkmcnt(8)
ds_read_b64_tr_b16 a[254:255], v239 offset:51680
v_accvgpr_read_b32 v195, a147
v_mfma_f32_16x16x32_bf16 a[180:183], a[232:235], v[148:151], a[180:183]
ds_read_b64_tr_b16 a[224:225], v241 offset:0
v_accvgpr_read_b32 v196, a152
v_mfma_f32_16x16x32_bf16 a[180:183], a[236:239], v[156:159], a[180:183]
ds_read_b64_tr_b16 a[226:227], v241 offset:128
v_accvgpr_read_b32 v197, a153
v_mfma_f32_16x16x32_bf16 a[176:179], a[236:239], v[152:155], a[176:179]
ds_read_b64_tr_b16 a[228:229], v241 offset:256
v_accvgpr_read_b32 v198, a154
v_mfma_f32_16x16x32_bf16 a[176:179], a[232:235], v[144:147], a[176:179]
s_waitcnt lgkmcnt(8)
ds_read_b64_tr_b16 a[230:231], v241 offset:384
v_accvgpr_read_b32 v199, a155
v_mfma_f32_16x16x32_bf16 a[184:187], a[240:243], v[128:131], a[184:187]
s_waitcnt lgkmcnt(15)
ds_read_b64_tr_b16 a[232:233], v241 offset:512
v_cvt_pk_bf16_f32 v216, v192, v193
v_or_b32 v245, 768, v232
v_mfma_f32_16x16x32_bf16 a[184:187], a[244:247], v[136:139], a[184:187]
s_waitcnt vmcnt(8)
ds_read_b64_tr_b16 a[234:235], v241 offset:640
v_cvt_pk_bf16_f32 v217, v194, v195
v_mfma_f32_16x16x32_bf16 a[188:191], a[244:247], v[140:143], a[188:191]
ds_read_b64_tr_b16 a[236:237], v241 offset:768
v_cvt_pk_bf16_f32 v218, v196, v197
v_mfma_f32_16x16x32_bf16 a[188:191], a[240:243], v[132:135], a[188:191]
s_waitcnt lgkmcnt(7)
ds_read_b64_tr_b16 a[238:239], v241 offset:896
v_cvt_pk_bf16_f32 v219, v198, v199
v_mfma_f32_16x16x32_bf16 a[188:191], a[248:251], v[148:151], a[188:191]
s_add_u32 s35, s72, 9216
ds_read_b64_tr_b16 a[240:241], v241 offset:32
buffer_store_dwordx4 v[216:219], v244, s[24:27], s35 offen sc1
v_mfma_f32_16x16x32_bf16 a[188:191], a[252:255], v[156:159], a[188:191]
ds_read_b64_tr_b16 a[242:243], v241 offset:160
ds_write_b128 v233, v[216:219] offset:9216
v_mfma_f32_16x16x32_bf16 a[184:187], a[252:255], v[152:155], a[184:187]
ds_read_b64_tr_b16 a[244:245], v241 offset:288
v_accvgpr_read_b32 v200, a148
v_mfma_f32_16x16x32_bf16 a[184:187], a[248:251], v[144:147], a[184:187]
s_waitcnt lgkmcnt(8)
ds_read_b64_tr_b16 a[246:247], v241 offset:416
v_accvgpr_read_b32 v201, a149
v_mfma_f32_16x16x32_bf16 a[160:163], a[224:227], v[160:163], a[160:163]
ds_read_b64_tr_b16 a[248:249], v241 offset:544
buffer_store_dword v245, v234, s[20:23], s73 offen sc1
v_accvgpr_read_b32 v202, a150
v_mfma_f32_16x16x32_bf16 a[160:163], a[228:231], v[176:179], a[160:163]
ds_read_b64_tr_b16 a[250:251], v241 offset:672
v_accvgpr_read_b32 v203, a151
v_mfma_f32_16x16x32_bf16 a[164:167], a[228:231], v[180:183], a[164:167]
ds_read_b64_tr_b16 a[252:253], v241 offset:800
v_accvgpr_read_b32 v204, a156
v_mfma_f32_16x16x32_bf16 a[164:167], a[224:227], v[164:167], a[164:167]
s_waitcnt lgkmcnt(8)
ds_read_b64_tr_b16 a[254:255], v241 offset:928
v_accvgpr_read_b32 v205, a157
v_mfma_f32_16x16x32_bf16 a[164:167], a[232:235], v[172:175], a[164:167]
ds_read_b64_tr_b16 a[224:225], v241 offset:64
v_accvgpr_read_b32 v206, a158
v_mfma_f32_16x16x32_bf16 a[164:167], a[236:239], v[188:191], a[164:167]
ds_read_b64_tr_b16 a[226:227], v241 offset:192
v_accvgpr_read_b32 v207, a159
v_mfma_f32_16x16x32_bf16 a[160:163], a[236:239], v[184:187], a[160:163]
ds_read_b64_tr_b16 a[228:229], v241 offset:320
v_cvt_pk_bf16_f32 v220, v200, v201
v_mfma_f32_16x16x32_bf16 a[160:163], a[232:235], v[168:171], a[160:163]
s_waitcnt lgkmcnt(7)
ds_read_b64_tr_b16 a[230:231], v241 offset:448
v_cvt_pk_bf16_f32 v221, v202, v203
v_mfma_f32_16x16x32_bf16 a[168:171], a[240:243], v[160:163], a[168:171]
ds_read_b64_tr_b16 a[232:233], v241 offset:576
v_cvt_pk_bf16_f32 v222, v204, v205
v_mfma_f32_16x16x32_bf16 a[168:171], a[244:247], v[176:179], a[168:171]
ds_read_b64_tr_b16 a[234:235], v241 offset:704
v_cvt_pk_bf16_f32 v223, v206, v207
v_mfma_f32_16x16x32_bf16 a[172:175], a[244:247], v[180:183], a[172:175]
s_add_u32 s35, s3, 23552
ds_read_b64_tr_b16 a[236:237], v241 offset:832
buffer_store_dwordx4 v[220:223], v244, s[24:27], s35 offen sc1
v_mfma_f32_16x16x32_bf16 a[172:175], a[240:243], v[164:167], a[172:175]
s_waitcnt lgkmcnt(7)
ds_read_b64_tr_b16 a[238:239], v241 offset:960
ds_write_b128 v235, v[220:223] offset:9216
v_mfma_f32_16x16x32_bf16 a[172:175], a[248:251], v[172:175], a[172:175]
ds_read_b64_tr_b16 a[240:241], v241 offset:96
v_mfma_f32_16x16x32_bf16 a[172:175], a[252:255], v[188:191], a[172:175]
ds_read_b64_tr_b16 a[242:243], v241 offset:224
v_mfma_f32_16x16x32_bf16 a[168:171], a[252:255], v[184:187], a[168:171]
ds_read_b64_tr_b16 a[244:245], v241 offset:352
v_mfma_f32_16x16x32_bf16 a[168:171], a[248:251], v[168:171], a[168:171]
s_waitcnt lgkmcnt(8)
ds_read_b64_tr_b16 a[246:247], v241 offset:480
v_mfma_f32_16x16x32_bf16 a[176:179], a[224:227], v[160:163], a[176:179]
ds_read_b64_tr_b16 a[248:249], v241 offset:608
v_mfma_f32_16x16x32_bf16 a[176:179], a[228:231], v[176:179], a[176:179]
ds_read_b64_tr_b16 a[250:251], v241 offset:736
v_mfma_f32_16x16x32_bf16 a[180:183], a[228:231], v[180:183], a[180:183]
s_waitcnt lgkmcnt(7)
ds_read_b64_tr_b16 a[252:253], v241 offset:864
v_mfma_f32_16x16x32_bf16 a[180:183], a[224:227], v[164:167], a[180:183]
s_waitcnt vmcnt(15)
ds_read_b64_tr_b16 a[254:255], v241 offset:992
s_barrier
v_mfma_f32_16x16x32_bf16 a[180:183], a[232:235], v[172:175], a[180:183]
ds_read_b64_tr_b16 a[224:225], v239 offset:16896
v_accvgpr_read_b32 v192, a160
v_mfma_f32_16x16x32_bf16 a[180:183], a[236:239], v[188:191], a[180:183]
ds_read_b64_tr_b16 a[226:227], v239 offset:17024
v_accvgpr_read_b32 v193, a161
v_mfma_f32_16x16x32_bf16 a[176:179], a[236:239], v[184:187], a[176:179]
ds_read_b64_tr_b16 a[228:229], v239 offset:17152
v_accvgpr_read_b32 v194, a162
v_mfma_f32_16x16x32_bf16 a[176:179], a[232:235], v[168:171], a[176:179]
s_waitcnt lgkmcnt(7)
ds_read_b64_tr_b16 a[230:231], v239 offset:17280
v_accvgpr_read_b32 v195, a163
v_mfma_f32_16x16x32_bf16 a[184:187], a[240:243], v[160:163], a[184:187]
s_waitcnt lgkmcnt(15)
ds_read_b64_tr_b16 a[232:233], v239 offset:17408
v_accvgpr_read_b32 v196, a168
v_or_b32 v245, 1024, v232
v_mfma_f32_16x16x32_bf16 a[184:187], a[244:247], v[176:179], a[184:187]
s_waitcnt vmcnt(6)
ds_read_b64_tr_b16 a[234:235], v239 offset:17536
v_accvgpr_read_b32 v197, a169
v_mfma_f32_16x16x32_bf16 a[188:191], a[244:247], v[180:183], a[188:191]
ds_read_b64_tr_b16 a[236:237], v239 offset:17664
v_accvgpr_read_b32 v198, a170
v_mfma_f32_16x16x32_bf16 a[188:191], a[240:243], v[164:167], a[188:191]
s_waitcnt lgkmcnt(7)
ds_read_b64_tr_b16 a[238:239], v239 offset:17792
v_accvgpr_read_b32 v199, a171
v_mfma_f32_16x16x32_bf16 a[188:191], a[248:251], v[172:175], a[188:191]
ds_read_b64_tr_b16 a[240:241], v239 offset:16928
v_cvt_pk_bf16_f32 v208, v192, v193
v_mfma_f32_16x16x32_bf16 a[188:191], a[252:255], v[188:191], a[188:191]
ds_read_b64_tr_b16 a[242:243], v239 offset:17056
v_cvt_pk_bf16_f32 v209, v194, v195
v_mfma_f32_16x16x32_bf16 a[184:187], a[252:255], v[184:187], a[184:187]
ds_read_b64_tr_b16 a[244:245], v239 offset:17184
v_cvt_pk_bf16_f32 v210, v196, v197
v_mfma_f32_16x16x32_bf16 a[184:187], a[248:251], v[168:171], a[184:187]
s_waitcnt lgkmcnt(7)
ds_read_b64_tr_b16 a[246:247], v239 offset:17312
v_cvt_pk_bf16_f32 v211, v198, v199
v_mfma_f32_16x16x32_bf16 a[192:195], a[224:227], v[128:131], a[192:195]
s_add_u32 s35, s72, 10240
ds_read_b64_tr_b16 a[248:249], v239 offset:17440
buffer_store_dwordx4 v[208:211], v244, s[24:27], s35 offen sc1
buffer_store_dword v245, v234, s[20:23], s73 offen sc1
v_mfma_f32_16x16x32_bf16 a[192:195], a[228:231], v[136:139], a[192:195]
ds_read_b64_tr_b16 a[250:251], v239 offset:17568
ds_write_b128 v233, v[208:211] offset:10240
v_mfma_f32_16x16x32_bf16 a[196:199], a[228:231], v[140:143], a[196:199]
ds_read_b64_tr_b16 a[252:253], v239 offset:17696
v_accvgpr_read_b32 v200, a164
v_mfma_f32_16x16x32_bf16 a[196:199], a[224:227], v[132:135], a[196:199]
s_waitcnt lgkmcnt(8)
ds_read_b64_tr_b16 a[254:255], v239 offset:17824
v_accvgpr_read_b32 v201, a165
v_mfma_f32_16x16x32_bf16 a[196:199], a[232:235], v[148:151], a[196:199]
ds_read_b64_tr_b16 a[224:225], v239 offset:16960
v_accvgpr_read_b32 v202, a166
v_mfma_f32_16x16x32_bf16 a[196:199], a[236:239], v[156:159], a[196:199]
ds_read_b64_tr_b16 a[226:227], v239 offset:17088
v_accvgpr_read_b32 v203, a167
v_mfma_f32_16x16x32_bf16 a[192:195], a[236:239], v[152:155], a[192:195]
ds_read_b64_tr_b16 a[228:229], v239 offset:17216
v_accvgpr_read_b32 v204, a172
v_mfma_f32_16x16x32_bf16 a[192:195], a[232:235], v[144:147], a[192:195]
s_waitcnt lgkmcnt(8)
ds_read_b64_tr_b16 a[230:231], v239 offset:17344
v_accvgpr_read_b32 v205, a173
v_mfma_f32_16x16x32_bf16 a[200:203], a[240:243], v[128:131], a[200:203]
ds_read_b64_tr_b16 a[232:233], v239 offset:17472
v_accvgpr_read_b32 v206, a174
v_mfma_f32_16x16x32_bf16 a[200:203], a[244:247], v[136:139], a[200:203]
ds_read_b64_tr_b16 a[234:235], v239 offset:17600
v_accvgpr_read_b32 v207, a175
v_mfma_f32_16x16x32_bf16 a[204:207], a[244:247], v[140:143], a[204:207]
ds_read_b64_tr_b16 a[236:237], v239 offset:17728
v_cvt_pk_bf16_f32 v212, v200, v201
v_mfma_f32_16x16x32_bf16 a[204:207], a[240:243], v[132:135], a[204:207]
s_waitcnt lgkmcnt(7)
ds_read_b64_tr_b16 a[238:239], v239 offset:17856
v_cvt_pk_bf16_f32 v213, v202, v203
v_mfma_f32_16x16x32_bf16 a[204:207], a[248:251], v[148:151], a[204:207]
ds_read_b64_tr_b16 a[240:241], v239 offset:16992
v_cvt_pk_bf16_f32 v214, v204, v205
v_mfma_f32_16x16x32_bf16 a[204:207], a[252:255], v[156:159], a[204:207]
ds_read_b64_tr_b16 a[242:243], v239 offset:17120
v_cvt_pk_bf16_f32 v215, v206, v207
v_mfma_f32_16x16x32_bf16 a[200:203], a[252:255], v[152:155], a[200:203]
s_add_u32 s35, s3, 24576
ds_read_b64_tr_b16 a[244:245], v239 offset:17248
buffer_store_dwordx4 v[212:215], v244, s[24:27], s35 offen sc1
v_mfma_f32_16x16x32_bf16 a[200:203], a[248:251], v[144:147], a[200:203]
s_waitcnt lgkmcnt(7)
ds_read_b64_tr_b16 a[246:247], v239 offset:17376
ds_write_b128 v235, v[212:215] offset:10240
v_mfma_f32_16x16x32_bf16 a[208:211], a[224:227], v[128:131], a[208:211]
ds_read_b64_tr_b16 a[248:249], v239 offset:17504
v_accvgpr_read_b32 v192, a176
v_mfma_f32_16x16x32_bf16 a[208:211], a[228:231], v[136:139], a[208:211]
ds_read_b64_tr_b16 a[250:251], v239 offset:17632
v_accvgpr_read_b32 v193, a177
v_mfma_f32_16x16x32_bf16 a[212:215], a[228:231], v[140:143], a[212:215]
ds_read_b64_tr_b16 a[252:253], v239 offset:17760
v_accvgpr_read_b32 v194, a178
v_mfma_f32_16x16x32_bf16 a[212:215], a[224:227], v[132:135], a[212:215]
s_waitcnt lgkmcnt(8)
ds_read_b64_tr_b16 a[254:255], v239 offset:17888
v_accvgpr_read_b32 v195, a179
v_mfma_f32_16x16x32_bf16 a[212:215], a[232:235], v[148:151], a[212:215]
ds_read_b64_tr_b16 a[224:225], v240 offset:16896
v_accvgpr_read_b32 v196, a184
v_mfma_f32_16x16x32_bf16 a[212:215], a[236:239], v[156:159], a[212:215]
ds_read_b64_tr_b16 a[226:227], v240 offset:17024
v_accvgpr_read_b32 v197, a185
v_mfma_f32_16x16x32_bf16 a[208:211], a[236:239], v[152:155], a[208:211]
ds_read_b64_tr_b16 a[228:229], v240 offset:17152
v_accvgpr_read_b32 v198, a186
v_mfma_f32_16x16x32_bf16 a[208:211], a[232:235], v[144:147], a[208:211]
s_waitcnt lgkmcnt(8)
ds_read_b64_tr_b16 a[230:231], v240 offset:17280
v_accvgpr_read_b32 v199, a187
v_mfma_f32_16x16x32_bf16 a[216:219], a[240:243], v[128:131], a[216:219]
ds_read_b64_tr_b16 a[232:233], v240 offset:17408
v_cvt_pk_bf16_f32 v216, v192, v193
v_mfma_f32_16x16x32_bf16 a[216:219], a[244:247], v[136:139], a[216:219]
ds_read_b64_tr_b16 a[234:235], v240 offset:17536
v_cvt_pk_bf16_f32 v217, v194, v195
v_mfma_f32_16x16x32_bf16 a[220:223], a[244:247], v[140:143], a[220:223]
ds_read_b64_tr_b16 a[236:237], v240 offset:17664
v_cvt_pk_bf16_f32 v218, v196, v197
v_mfma_f32_16x16x32_bf16 a[220:223], a[240:243], v[132:135], a[220:223]
s_waitcnt lgkmcnt(7)
ds_read_b64_tr_b16 a[238:239], v240 offset:17792
v_cvt_pk_bf16_f32 v219, v198, v199
v_mfma_f32_16x16x32_bf16 a[220:223], a[248:251], v[148:151], a[220:223]
s_add_u32 s35, s72, 11264
ds_read_b64_tr_b16 a[240:241], v240 offset:16928
buffer_store_dwordx4 v[216:219], v244, s[24:27], s35 offen sc1
v_mfma_f32_16x16x32_bf16 a[220:223], a[252:255], v[156:159], a[220:223]
ds_read_b64_tr_b16 a[242:243], v240 offset:17056
ds_write_b128 v233, v[216:219] offset:11264
v_mfma_f32_16x16x32_bf16 a[216:219], a[252:255], v[152:155], a[216:219]
ds_read_b64_tr_b16 a[244:245], v240 offset:17184
v_accvgpr_read_b32 v200, a180
v_mfma_f32_16x16x32_bf16 a[216:219], a[248:251], v[144:147], a[216:219]
s_waitcnt lgkmcnt(8)
ds_read_b64_tr_b16 a[246:247], v240 offset:17312
v_accvgpr_read_b32 v201, a181
v_mfma_f32_16x16x32_bf16 a[192:195], a[224:227], v[160:163], a[192:195]
ds_read_b64_tr_b16 a[248:249], v240 offset:17440
v_accvgpr_read_b32 v202, a182
v_mfma_f32_16x16x32_bf16 a[192:195], a[228:231], v[176:179], a[192:195]
ds_read_b64_tr_b16 a[250:251], v240 offset:17568
v_accvgpr_read_b32 v203, a183
v_mfma_f32_16x16x32_bf16 a[196:199], a[228:231], v[180:183], a[196:199]
ds_read_b64_tr_b16 a[252:253], v240 offset:17696
v_accvgpr_read_b32 v204, a188
v_mfma_f32_16x16x32_bf16 a[196:199], a[224:227], v[164:167], a[196:199]
s_waitcnt lgkmcnt(8)
ds_read_b64_tr_b16 a[254:255], v240 offset:17824
v_accvgpr_read_b32 v205, a189
v_mfma_f32_16x16x32_bf16 a[196:199], a[232:235], v[172:175], a[196:199]
ds_read_b64_tr_b16 a[224:225], v240 offset:16960
v_accvgpr_read_b32 v206, a190
v_mfma_f32_16x16x32_bf16 a[196:199], a[236:239], v[188:191], a[196:199]
ds_read_b64_tr_b16 a[226:227], v240 offset:17088
v_accvgpr_read_b32 v207, a191
v_mfma_f32_16x16x32_bf16 a[192:195], a[236:239], v[184:187], a[192:195]
ds_read_b64_tr_b16 a[228:229], v240 offset:17216
v_cvt_pk_bf16_f32 v220, v200, v201
v_mfma_f32_16x16x32_bf16 a[192:195], a[232:235], v[168:171], a[192:195]
s_waitcnt lgkmcnt(7)
ds_read_b64_tr_b16 a[230:231], v240 offset:17344
v_cvt_pk_bf16_f32 v221, v202, v203
v_mfma_f32_16x16x32_bf16 a[200:203], a[240:243], v[160:163], a[200:203]
ds_read_b64_tr_b16 a[232:233], v240 offset:17472
v_cvt_pk_bf16_f32 v222, v204, v205
v_mfma_f32_16x16x32_bf16 a[200:203], a[244:247], v[176:179], a[200:203]
ds_read_b64_tr_b16 a[234:235], v240 offset:17600
v_cvt_pk_bf16_f32 v223, v206, v207
v_mfma_f32_16x16x32_bf16 a[204:207], a[244:247], v[180:183], a[204:207]
s_add_u32 s35, s3, 25600
ds_read_b64_tr_b16 a[236:237], v240 offset:17728
buffer_store_dwordx4 v[220:223], v244, s[24:27], s35 offen sc1
v_mfma_f32_16x16x32_bf16 a[204:207], a[240:243], v[164:167], a[204:207]
s_waitcnt lgkmcnt(7)
ds_read_b64_tr_b16 a[238:239], v240 offset:17856
ds_write_b128 v235, v[220:223] offset:11264
v_mfma_f32_16x16x32_bf16 a[204:207], a[248:251], v[172:175], a[204:207]
ds_read_b64_tr_b16 a[240:241], v240 offset:16992
v_mfma_f32_16x16x32_bf16 a[204:207], a[252:255], v[188:191], a[204:207]
ds_read_b64_tr_b16 a[242:243], v240 offset:17120
v_mfma_f32_16x16x32_bf16 a[200:203], a[252:255], v[184:187], a[200:203]
ds_read_b64_tr_b16 a[244:245], v240 offset:17248
v_mfma_f32_16x16x32_bf16 a[200:203], a[248:251], v[168:171], a[200:203]
s_waitcnt lgkmcnt(8)
ds_read_b64_tr_b16 a[246:247], v240 offset:17376
v_mfma_f32_16x16x32_bf16 a[208:211], a[224:227], v[160:163], a[208:211]
ds_read_b64_tr_b16 a[248:249], v240 offset:17504
v_mfma_f32_16x16x32_bf16 a[208:211], a[228:231], v[176:179], a[208:211]
s_waitcnt lgkmcnt(15)
ds_read_b64_tr_b16 a[250:251], v240 offset:17632
v_or_b32 v245, 1280, v232
v_mfma_f32_16x16x32_bf16 a[212:215], a[228:231], v[180:183], a[212:215]
s_waitcnt vmcnt(5)
ds_read_b64_tr_b16 a[252:253], v240 offset:17760
buffer_store_dword v245, v234, s[20:23], s73 offen sc1
v_mfma_f32_16x16x32_bf16 a[212:215], a[224:227], v[164:167], a[212:215]
s_waitcnt lgkmcnt(8)
ds_read_b64_tr_b16 a[254:255], v240 offset:17888
v_accvgpr_read_b32 v192, a192
v_mfma_f32_16x16x32_bf16 a[212:215], a[232:235], v[172:175], a[212:215]
v_accvgpr_read_b32 v193, a193
v_accvgpr_read_b32 v194, a194
v_mfma_f32_16x16x32_bf16 a[212:215], a[236:239], v[188:191], a[212:215]
v_accvgpr_read_b32 v195, a195
v_accvgpr_read_b32 v196, a200
v_mfma_f32_16x16x32_bf16 a[208:211], a[236:239], v[184:187], a[208:211]
v_accvgpr_read_b32 v197, a201
v_accvgpr_read_b32 v198, a202
v_mfma_f32_16x16x32_bf16 a[208:211], a[232:235], v[168:171], a[208:211]
s_waitcnt lgkmcnt(4)
v_accvgpr_read_b32 v199, a203
v_cvt_pk_bf16_f32 v208, v192, v193
v_mfma_f32_16x16x32_bf16 a[216:219], a[240:243], v[160:163], a[216:219]
v_cvt_pk_bf16_f32 v209, v194, v195
v_cvt_pk_bf16_f32 v210, v196, v197
v_mfma_f32_16x16x32_bf16 a[216:219], a[244:247], v[176:179], a[216:219]
v_cvt_pk_bf16_f32 v211, v198, v199
v_mfma_f32_16x16x32_bf16 a[220:223], a[244:247], v[180:183], a[220:223]
s_add_u32 s35, s72, 12288
ds_write_b128 v233, v[208:211] offset:12288
buffer_store_dwordx4 v[208:211], v244, s[24:27], s35 offen sc1
v_mfma_f32_16x16x32_bf16 a[220:223], a[240:243], v[164:167], a[220:223]
s_waitcnt lgkmcnt(1)
v_accvgpr_read_b32 v200, a196
v_accvgpr_read_b32 v201, a197
v_accvgpr_read_b32 v202, a198
v_mfma_f32_16x16x32_bf16 a[220:223], a[248:251], v[172:175], a[220:223]
v_accvgpr_read_b32 v203, a199
v_accvgpr_read_b32 v204, a204
v_accvgpr_read_b32 v205, a205
v_mfma_f32_16x16x32_bf16 a[220:223], a[252:255], v[188:191], a[220:223]
v_accvgpr_read_b32 v206, a206
v_accvgpr_read_b32 v207, a207
v_cvt_pk_bf16_f32 v212, v200, v201
v_mfma_f32_16x16x32_bf16 a[216:219], a[252:255], v[184:187], a[216:219]
v_cvt_pk_bf16_f32 v213, v202, v203
v_cvt_pk_bf16_f32 v214, v204, v205
v_cvt_pk_bf16_f32 v215, v206, v207
v_mfma_f32_16x16x32_bf16 a[216:219], a[248:251], v[168:171], a[216:219]
s_add_u32 s35, s3, 26624
ds_write_b128 v235, v[212:215] offset:12288
buffer_store_dwordx4 v[212:215], v244, s[24:27], s35 offen sc1
s_nop 3
v_accvgpr_read_b32 v192, a208
v_accvgpr_read_b32 v193, a209
v_accvgpr_read_b32 v194, a210
v_accvgpr_read_b32 v195, a211
v_accvgpr_read_b32 v196, a216
v_accvgpr_read_b32 v197, a217
v_accvgpr_read_b32 v198, a218
v_accvgpr_read_b32 v199, a219
v_cvt_pk_bf16_f32 v216, v192, v193
v_cvt_pk_bf16_f32 v217, v194, v195
v_cvt_pk_bf16_f32 v218, v196, v197
v_cvt_pk_bf16_f32 v219, v198, v199
s_add_u32 s35, s72, 13312
buffer_store_dwordx4 v[216:219], v244, s[24:27], s35 offen sc1
ds_write_b128 v233, v[216:219] offset:13312
v_accvgpr_read_b32 v200, a212
v_accvgpr_read_b32 v201, a213
v_accvgpr_read_b32 v202, a214
v_accvgpr_read_b32 v203, a215
v_accvgpr_read_b32 v204, a220
v_accvgpr_read_b32 v205, a221
v_accvgpr_read_b32 v206, a222
v_accvgpr_read_b32 v207, a223
v_cvt_pk_bf16_f32 v220, v200, v201
v_cvt_pk_bf16_f32 v221, v202, v203
v_cvt_pk_bf16_f32 v222, v204, v205
v_cvt_pk_bf16_f32 v223, v206, v207
s_add_u32 s35, s3, 27648
buffer_store_dwordx4 v[220:223], v244, s[24:27], s35 offen sc1
ds_write_b128 v235, v[220:223] offset:13312
buffer_load_dword v237, v238, s[20:23], 0 offen sc1
s_load_dwordx2 s[12:13], s[0:1], 40
s_mul_i32 s35, s100, 114688
v_lshrrev_b32 v200, 4, v244
v_and_b32 v201, 15, v200
v_mul_u32_u24 v201, 896, v201
v_lshrrev_b32 v200, 4, v200
v_lshl_add_u32 v201, v200, 4, v201
s_waitcnt lgkmcnt(0)
s_add_u32 s8, s12, s35
s_addc_u32 s9, s13, 0
s_mov_b32 s10, 114688
v_or_b32 v245, 1792, v232
s_waitcnt lgkmcnt(0)
s_waitcnt vmcnt(1)
buffer_store_dword v245, v234, s[20:23], s73 offen sc1
s_waitcnt vmcnt(1)
s_mov_b32 s36, 0
s_and_b32 s47, s39, 0
L_tl:
v_xor_b32 v237, v237, v236
v_alignbit_b32 v237, v237, v237, 8
v_subrev_u32 v237, s38, v237
s_mov_b32 s37, s39
s_bitcmp1_b32 s39, 0
s_cbranch_scc1 L_tn0
v_subrev_u32 v242, 0, v237
v_cmp_lt_u32 vcc, 7, v242
s_cbranch_vccnz L_tx
ds_read_b128 v[28:31], v243 offset:0
s_add_u32 s74, s74, 114688
s_sub_u32 s46, s74, 917504
s_cselect_b32 s74, s74, s46
buffer_load_dwordx4 v[0:3], v244, s[4:7], s74 offen sc1
s_add_u32 s74, s74, 114688
s_sub_u32 s46, s74, 917504
s_cselect_b32 s74, s74, s46
buffer_load_dwordx4 v[4:7], v244, s[4:7], s74 offen sc1
s_add_u32 s74, s74, 114688
s_sub_u32 s46, s74, 917504
s_cselect_b32 s74, s74, s46
buffer_load_dwordx4 v[8:11], v244, s[4:7], s74 offen sc1
s_add_u32 s74, s74, 114688
s_sub_u32 s46, s74, 917504
s_cselect_b32 s74, s74, s46
buffer_load_dwordx4 v[12:15], v244, s[4:7], s74 offen sc1
s_add_u32 s74, s74, 114688
s_sub_u32 s46, s74, 917504
s_cselect_b32 s74, s74, s46
buffer_load_dwordx4 v[16:19], v244, s[4:7], s74 offen sc1
s_add_u32 s74, s74, 114688
s_sub_u32 s46, s74, 917504
s_cselect_b32 s74, s74, s46
buffer_load_dwordx4 v[20:23], v244, s[4:7], s74 offen sc1
s_add_u32 s74, s74, 114688
s_sub_u32 s46, s74, 917504
s_cselect_b32 s74, s74, s46
buffer_load_dwordx4 v[24:27], v244, s[4:7], s74 offen sc1
s_bitset1_b32 s39, 0
L_tn0:
s_bitcmp1_b32 s39, 1
s_cbranch_scc1 L_tn1
v_subrev_u32 v242, 2, v237
v_cmp_lt_u32 vcc, 7, v242
s_cbranch_vccnz L_tx
ds_read_b128 v[60:63], v243 offset:4096
s_add_u32 s75, s75, 114688
s_sub_u32 s46, s75, 917504
s_cselect_b32 s75, s75, s46
buffer_load_dwordx4 v[32:35], v244, s[4:7], s75 offen sc1
s_add_u32 s75, s75, 114688
s_sub_u32 s46, s75, 917504
s_cselect_b32 s75, s75, s46
buffer_load_dwordx4 v[36:39], v244, s[4:7], s75 offen sc1
s_add_u32 s75, s75, 114688
s_sub_u32 s46, s75, 917504
s_cselect_b32 s75, s75, s46
buffer_load_dwordx4 v[40:43], v244, s[4:7], s75 offen sc1
s_add_u32 s75, s75, 114688
s_sub_u32 s46, s75, 917504
s_cselect_b32 s75, s75, s46
buffer_load_dwordx4 v[44:47], v244, s[4:7], s75 offen sc1
s_add_u32 s75, s75, 114688
s_sub_u32 s46, s75, 917504
s_cselect_b32 s75, s75, s46
buffer_load_dwordx4 v[48:51], v244, s[4:7], s75 offen sc1
s_add_u32 s75, s75, 114688
s_sub_u32 s46, s75, 917504
s_cselect_b32 s75, s75, s46
buffer_load_dwordx4 v[52:55], v244, s[4:7], s75 offen sc1
s_add_u32 s75, s75, 114688
s_sub_u32 s46, s75, 917504
s_cselect_b32 s75, s75, s46
buffer_load_dwordx4 v[56:59], v244, s[4:7], s75 offen sc1
s_bitset1_b32 s39, 1
L_tn1:
s_bitcmp1_b32 s39, 2
s_cbranch_scc1 L_tn2
v_subrev_u32 v242, 4, v237
v_cmp_lt_u32 vcc, 7, v242
s_cbranch_vccnz L_tx
ds_read_b128 v[92:95], v243 offset:8192
s_add_u32 s76, s76, 114688
s_sub_u32 s46, s76, 917504
s_cselect_b32 s76, s76, s46
buffer_load_dwordx4 v[64:67], v244, s[4:7], s76 offen sc1
s_add_u32 s76, s76, 114688
s_sub_u32 s46, s76, 917504
s_cselect_b32 s76, s76, s46
buffer_load_dwordx4 v[68:71], v244, s[4:7], s76 offen sc1
s_add_u32 s76, s76, 114688
s_sub_u32 s46, s76, 917504
s_cselect_b32 s76, s76, s46
buffer_load_dwordx4 v[72:75], v244, s[4:7], s76 offen sc1
s_add_u32 s76, s76, 114688
s_sub_u32 s46, s76, 917504
s_cselect_b32 s76, s76, s46
buffer_load_dwordx4 v[76:79], v244, s[4:7], s76 offen sc1
s_add_u32 s76, s76, 114688
s_sub_u32 s46, s76, 917504
s_cselect_b32 s76, s76, s46
buffer_load_dwordx4 v[80:83], v244, s[4:7], s76 offen sc1
s_add_u32 s76, s76, 114688
s_sub_u32 s46, s76, 917504
s_cselect_b32 s76, s76, s46
buffer_load_dwordx4 v[84:87], v244, s[4:7], s76 offen sc1
s_add_u32 s76, s76, 114688
s_sub_u32 s46, s76, 917504
s_cselect_b32 s76, s76, s46
buffer_load_dwordx4 v[88:91], v244, s[4:7], s76 offen sc1
s_bitset1_b32 s39, 2
L_tn2:
s_bitcmp1_b32 s39, 3
s_cbranch_scc1 L_tn3
v_subrev_u32 v242, 6, v237
v_cmp_lt_u32 vcc, 7, v242
s_cbranch_vccnz L_tx
ds_read_b128 v[124:127], v243 offset:12288
s_add_u32 s77, s77, 114688
s_sub_u32 s46, s77, 917504
s_cselect_b32 s77, s77, s46
buffer_load_dwordx4 v[96:99], v244, s[4:7], s77 offen sc1
s_add_u32 s77, s77, 114688
s_sub_u32 s46, s77, 917504
s_cselect_b32 s77, s77, s46
buffer_load_dwordx4 v[100:103], v244, s[4:7], s77 offen sc1
s_add_u32 s77, s77, 114688
s_sub_u32 s46, s77, 917504
s_cselect_b32 s77, s77, s46
buffer_load_dwordx4 v[104:107], v244, s[4:7], s77 offen sc1
s_add_u32 s77, s77, 114688
s_sub_u32 s46, s77, 917504
s_cselect_b32 s77, s77, s46
buffer_load_dwordx4 v[108:111], v244, s[4:7], s77 offen sc1
s_add_u32 s77, s77, 114688
s_sub_u32 s46, s77, 917504
s_cselect_b32 s77, s77, s46
buffer_load_dwordx4 v[112:115], v244, s[4:7], s77 offen sc1
s_add_u32 s77, s77, 114688
s_sub_u32 s46, s77, 917504
s_cselect_b32 s77, s77, s46
buffer_load_dwordx4 v[116:119], v244, s[4:7], s77 offen sc1
s_add_u32 s77, s77, 114688
s_sub_u32 s46, s77, 917504
s_cselect_b32 s77, s77, s46
buffer_load_dwordx4 v[120:123], v244, s[4:7], s77 offen sc1
s_bitset1_b32 s39, 3
L_tn3:
L_tx:
s_cmp_eq_u32 s39, 15
s_cbranch_scc1 L_tnp
buffer_load_dword v237, v238, s[20:23], 0 offen sc1
L_tnp:
L_ts:
s_bitcmp1_b32 s47, 0
s_cbranch_scc0 L_tm0
v_dot2_f32_bf16 v128, v0, s78, 0
v_dot2_f32_bf16 v129, v0, s79, 0
v_dot2_f32_bf16 v130, v1, s78, 0
v_dot2_f32_bf16 v131, v1, s79, 0
v_dot2_f32_bf16 v132, v2, s78, 0
v_dot2_f32_bf16 v133, v2, s79, 0
v_dot2_f32_bf16 v134, v3, s78, 0
v_dot2_f32_bf16 v135, v3, s79, 0
v_dot2_f32_bf16 v128, v4, s78, v128
v_dot2_f32_bf16 v129, v4, s79, v129
v_dot2_f32_bf16 v130, v5, s78, v130
v_dot2_f32_bf16 v131, v5, s79, v131
v_dot2_f32_bf16 v132, v6, s78, v132
v_dot2_f32_bf16 v133, v6, s79, v133
v_dot2_f32_bf16 v134, v7, s78, v134
v_dot2_f32_bf16 v135, v7, s79, v135
v_dot2_f32_bf16 v128, v8, s78, v128
v_dot2_f32_bf16 v129, v8, s79, v129
v_dot2_f32_bf16 v130, v9, s78, v130
v_dot2_f32_bf16 v131, v9, s79, v131
v_dot2_f32_bf16 v132, v10, s78, v132
v_dot2_f32_bf16 v133, v10, s79, v133
v_dot2_f32_bf16 v134, v11, s78, v134
v_dot2_f32_bf16 v135, v11, s79, v135
v_dot2_f32_bf16 v128, v12, s78, v128
v_dot2_f32_bf16 v129, v12, s79, v129
v_dot2_f32_bf16 v130, v13, s78, v130
v_dot2_f32_bf16 v131, v13, s79, v131
v_dot2_f32_bf16 v132, v14, s78, v132
v_dot2_f32_bf16 v133, v14, s79, v133
v_dot2_f32_bf16 v134, v15, s78, v134
v_dot2_f32_bf16 v135, v15, s79, v135
v_dot2_f32_bf16 v128, v16, s78, v128
v_dot2_f32_bf16 v129, v16, s79, v129
v_dot2_f32_bf16 v130, v17, s78, v130
v_dot2_f32_bf16 v131, v17, s79, v131
v_dot2_f32_bf16 v132, v18, s78, v132
v_dot2_f32_bf16 v133, v18, s79, v133
v_dot2_f32_bf16 v134, v19, s78, v134
v_dot2_f32_bf16 v135, v19, s79, v135
v_dot2_f32_bf16 v128, v20, s78, v128
v_dot2_f32_bf16 v129, v20, s79, v129
v_dot2_f32_bf16 v130, v21, s78, v130
v_dot2_f32_bf16 v131, v21, s79, v131
v_dot2_f32_bf16 v132, v22, s78, v132
v_dot2_f32_bf16 v133, v22, s79, v133
v_dot2_f32_bf16 v134, v23, s78, v134
v_dot2_f32_bf16 v135, v23, s79, v135
v_dot2_f32_bf16 v128, v24, s78, v128
v_dot2_f32_bf16 v129, v24, s79, v129
v_dot2_f32_bf16 v130, v25, s78, v130
v_dot2_f32_bf16 v131, v25, s79, v131
v_dot2_f32_bf16 v132, v26, s78, v132
v_dot2_f32_bf16 v133, v26, s79, v133
v_dot2_f32_bf16 v134, v27, s78, v134
v_dot2_f32_bf16 v135, v27, s79, v135
v_dot2_f32_bf16 v128, v28, s78, v128
v_dot2_f32_bf16 v129, v28, s79, v129
v_dot2_f32_bf16 v130, v29, s78, v130
v_dot2_f32_bf16 v131, v29, s79, v131
v_dot2_f32_bf16 v132, v30, s78, v132
v_dot2_f32_bf16 v133, v30, s79, v133
v_dot2_f32_bf16 v134, v31, s78, v134
v_dot2_f32_bf16 v135, v31, s79, v135
s_nop 2
v_cvt_pk_bf16_f32 v160, v128, v129
v_cvt_pk_bf16_f32 v161, v130, v131
v_cvt_pk_bf16_f32 v162, v132, v133
v_cvt_pk_bf16_f32 v163, v134, v135
s_nop 1
v_permlane32_swap_b32 v160, v162
v_permlane32_swap_b32 v161, v163
buffer_store_dwordx4 v[160:163], v201, s[8:11], s68 offen sc1
L_tm0:
s_bitcmp1_b32 s47, 1
s_cbranch_scc0 L_tm1
v_dot2_f32_bf16 v136, v32, s78, 0
v_dot2_f32_bf16 v137, v32, s79, 0
v_dot2_f32_bf16 v138, v33, s78, 0
v_dot2_f32_bf16 v139, v33, s79, 0
v_dot2_f32_bf16 v140, v34, s78, 0
v_dot2_f32_bf16 v141, v34, s79, 0
v_dot2_f32_bf16 v142, v35, s78, 0
v_dot2_f32_bf16 v143, v35, s79, 0
v_dot2_f32_bf16 v136, v36, s78, v136
v_dot2_f32_bf16 v137, v36, s79, v137
v_dot2_f32_bf16 v138, v37, s78, v138
v_dot2_f32_bf16 v139, v37, s79, v139
v_dot2_f32_bf16 v140, v38, s78, v140
v_dot2_f32_bf16 v141, v38, s79, v141
v_dot2_f32_bf16 v142, v39, s78, v142
v_dot2_f32_bf16 v143, v39, s79, v143
v_dot2_f32_bf16 v136, v40, s78, v136
v_dot2_f32_bf16 v137, v40, s79, v137
v_dot2_f32_bf16 v138, v41, s78, v138
v_dot2_f32_bf16 v139, v41, s79, v139
v_dot2_f32_bf16 v140, v42, s78, v140
v_dot2_f32_bf16 v141, v42, s79, v141
v_dot2_f32_bf16 v142, v43, s78, v142
v_dot2_f32_bf16 v143, v43, s79, v143
v_dot2_f32_bf16 v136, v44, s78, v136
v_dot2_f32_bf16 v137, v44, s79, v137
v_dot2_f32_bf16 v138, v45, s78, v138
v_dot2_f32_bf16 v139, v45, s79, v139
v_dot2_f32_bf16 v140, v46, s78, v140
v_dot2_f32_bf16 v141, v46, s79, v141
v_dot2_f32_bf16 v142, v47, s78, v142
v_dot2_f32_bf16 v143, v47, s79, v143
v_dot2_f32_bf16 v136, v48, s78, v136
v_dot2_f32_bf16 v137, v48, s79, v137
v_dot2_f32_bf16 v138, v49, s78, v138
v_dot2_f32_bf16 v139, v49, s79, v139
v_dot2_f32_bf16 v140, v50, s78, v140
v_dot2_f32_bf16 v141, v50, s79, v141
v_dot2_f32_bf16 v142, v51, s78, v142
v_dot2_f32_bf16 v143, v51, s79, v143
v_dot2_f32_bf16 v136, v52, s78, v136
v_dot2_f32_bf16 v137, v52, s79, v137
v_dot2_f32_bf16 v138, v53, s78, v138
v_dot2_f32_bf16 v139, v53, s79, v139
v_dot2_f32_bf16 v140, v54, s78, v140
v_dot2_f32_bf16 v141, v54, s79, v141
v_dot2_f32_bf16 v142, v55, s78, v142
v_dot2_f32_bf16 v143, v55, s79, v143
v_dot2_f32_bf16 v136, v56, s78, v136
v_dot2_f32_bf16 v137, v56, s79, v137
v_dot2_f32_bf16 v138, v57, s78, v138
v_dot2_f32_bf16 v139, v57, s79, v139
v_dot2_f32_bf16 v140, v58, s78, v140
v_dot2_f32_bf16 v141, v58, s79, v141
v_dot2_f32_bf16 v142, v59, s78, v142
v_dot2_f32_bf16 v143, v59, s79, v143
v_dot2_f32_bf16 v136, v60, s78, v136
v_dot2_f32_bf16 v137, v60, s79, v137
v_dot2_f32_bf16 v138, v61, s78, v138
v_dot2_f32_bf16 v139, v61, s79, v139
v_dot2_f32_bf16 v140, v62, s78, v140
v_dot2_f32_bf16 v141, v62, s79, v141
v_dot2_f32_bf16 v142, v63, s78, v142
v_dot2_f32_bf16 v143, v63, s79, v143
s_nop 2
v_cvt_pk_bf16_f32 v164, v136, v137
v_cvt_pk_bf16_f32 v165, v138, v139
v_cvt_pk_bf16_f32 v166, v140, v141
v_cvt_pk_bf16_f32 v167, v142, v143
s_nop 1
v_permlane32_swap_b32 v164, v166
v_permlane32_swap_b32 v165, v167
buffer_store_dwordx4 v[164:167], v201, s[8:11], s69 offen sc1
L_tm1:
s_bitcmp1_b32 s47, 2
s_cbranch_scc0 L_tm2
v_dot2_f32_bf16 v144, v64, s78, 0
v_dot2_f32_bf16 v145, v64, s79, 0
v_dot2_f32_bf16 v146, v65, s78, 0
v_dot2_f32_bf16 v147, v65, s79, 0
v_dot2_f32_bf16 v148, v66, s78, 0
v_dot2_f32_bf16 v149, v66, s79, 0
v_dot2_f32_bf16 v150, v67, s78, 0
v_dot2_f32_bf16 v151, v67, s79, 0
v_dot2_f32_bf16 v144, v68, s78, v144
v_dot2_f32_bf16 v145, v68, s79, v145
v_dot2_f32_bf16 v146, v69, s78, v146
v_dot2_f32_bf16 v147, v69, s79, v147
v_dot2_f32_bf16 v148, v70, s78, v148
v_dot2_f32_bf16 v149, v70, s79, v149
v_dot2_f32_bf16 v150, v71, s78, v150
v_dot2_f32_bf16 v151, v71, s79, v151
v_dot2_f32_bf16 v144, v72, s78, v144
v_dot2_f32_bf16 v145, v72, s79, v145
v_dot2_f32_bf16 v146, v73, s78, v146
v_dot2_f32_bf16 v147, v73, s79, v147
v_dot2_f32_bf16 v148, v74, s78, v148
v_dot2_f32_bf16 v149, v74, s79, v149
v_dot2_f32_bf16 v150, v75, s78, v150
v_dot2_f32_bf16 v151, v75, s79, v151
v_dot2_f32_bf16 v144, v76, s78, v144
v_dot2_f32_bf16 v145, v76, s79, v145
v_dot2_f32_bf16 v146, v77, s78, v146
v_dot2_f32_bf16 v147, v77, s79, v147
v_dot2_f32_bf16 v148, v78, s78, v148
v_dot2_f32_bf16 v149, v78, s79, v149
v_dot2_f32_bf16 v150, v79, s78, v150
v_dot2_f32_bf16 v151, v79, s79, v151
v_dot2_f32_bf16 v144, v80, s78, v144
v_dot2_f32_bf16 v145, v80, s79, v145
v_dot2_f32_bf16 v146, v81, s78, v146
v_dot2_f32_bf16 v147, v81, s79, v147
v_dot2_f32_bf16 v148, v82, s78, v148
v_dot2_f32_bf16 v149, v82, s79, v149
v_dot2_f32_bf16 v150, v83, s78, v150
v_dot2_f32_bf16 v151, v83, s79, v151
v_dot2_f32_bf16 v144, v84, s78, v144
v_dot2_f32_bf16 v145, v84, s79, v145
v_dot2_f32_bf16 v146, v85, s78, v146
v_dot2_f32_bf16 v147, v85, s79, v147
v_dot2_f32_bf16 v148, v86, s78, v148
v_dot2_f32_bf16 v149, v86, s79, v149
v_dot2_f32_bf16 v150, v87, s78, v150
v_dot2_f32_bf16 v151, v87, s79, v151
v_dot2_f32_bf16 v144, v88, s78, v144
v_dot2_f32_bf16 v145, v88, s79, v145
v_dot2_f32_bf16 v146, v89, s78, v146
v_dot2_f32_bf16 v147, v89, s79, v147
v_dot2_f32_bf16 v148, v90, s78, v148
v_dot2_f32_bf16 v149, v90, s79, v149
v_dot2_f32_bf16 v150, v91, s78, v150
v_dot2_f32_bf16 v151, v91, s79, v151
v_dot2_f32_bf16 v144, v92, s78, v144
v_dot2_f32_bf16 v145, v92, s79, v145
v_dot2_f32_bf16 v146, v93, s78, v146
v_dot2_f32_bf16 v147, v93, s79, v147
v_dot2_f32_bf16 v148, v94, s78, v148
v_dot2_f32_bf16 v149, v94, s79, v149
v_dot2_f32_bf16 v150, v95, s78, v150
v_dot2_f32_bf16 v151, v95, s79, v151
s_nop 2
v_cvt_pk_bf16_f32 v168, v144, v145
v_cvt_pk_bf16_f32 v169, v146, v147
v_cvt_pk_bf16_f32 v170, v148, v149
v_cvt_pk_bf16_f32 v171, v150, v151
s_nop 1
v_permlane32_swap_b32 v168, v170
v_permlane32_swap_b32 v169, v171
buffer_store_dwordx4 v[168:171], v201, s[8:11], s70 offen sc1
L_tm2:
s_bitcmp1_b32 s47, 3
s_cbranch_scc0 L_tm3
v_dot2_f32_bf16 v152, v96, s78, 0
v_dot2_f32_bf16 v153, v96, s79, 0
v_dot2_f32_bf16 v154, v97, s78, 0
v_dot2_f32_bf16 v155, v97, s79, 0
v_dot2_f32_bf16 v156, v98, s78, 0
v_dot2_f32_bf16 v157, v98, s79, 0
v_dot2_f32_bf16 v158, v99, s78, 0
v_dot2_f32_bf16 v159, v99, s79, 0
v_dot2_f32_bf16 v152, v100, s78, v152
v_dot2_f32_bf16 v153, v100, s79, v153
v_dot2_f32_bf16 v154, v101, s78, v154
v_dot2_f32_bf16 v155, v101, s79, v155
v_dot2_f32_bf16 v156, v102, s78, v156
v_dot2_f32_bf16 v157, v102, s79, v157
v_dot2_f32_bf16 v158, v103, s78, v158
v_dot2_f32_bf16 v159, v103, s79, v159
v_dot2_f32_bf16 v152, v104, s78, v152
v_dot2_f32_bf16 v153, v104, s79, v153
v_dot2_f32_bf16 v154, v105, s78, v154
v_dot2_f32_bf16 v155, v105, s79, v155
v_dot2_f32_bf16 v156, v106, s78, v156
v_dot2_f32_bf16 v157, v106, s79, v157
v_dot2_f32_bf16 v158, v107, s78, v158
v_dot2_f32_bf16 v159, v107, s79, v159
v_dot2_f32_bf16 v152, v108, s78, v152
v_dot2_f32_bf16 v153, v108, s79, v153
v_dot2_f32_bf16 v154, v109, s78, v154
v_dot2_f32_bf16 v155, v109, s79, v155
v_dot2_f32_bf16 v156, v110, s78, v156
v_dot2_f32_bf16 v157, v110, s79, v157
v_dot2_f32_bf16 v158, v111, s78, v158
v_dot2_f32_bf16 v159, v111, s79, v159
v_dot2_f32_bf16 v152, v112, s78, v152
v_dot2_f32_bf16 v153, v112, s79, v153
v_dot2_f32_bf16 v154, v113, s78, v154
v_dot2_f32_bf16 v155, v113, s79, v155
v_dot2_f32_bf16 v156, v114, s78, v156
v_dot2_f32_bf16 v157, v114, s79, v157
v_dot2_f32_bf16 v158, v115, s78, v158
v_dot2_f32_bf16 v159, v115, s79, v159
v_dot2_f32_bf16 v152, v116, s78, v152
v_dot2_f32_bf16 v153, v116, s79, v153
v_dot2_f32_bf16 v154, v117, s78, v154
v_dot2_f32_bf16 v155, v117, s79, v155
v_dot2_f32_bf16 v156, v118, s78, v156
v_dot2_f32_bf16 v157, v118, s79, v157
v_dot2_f32_bf16 v158, v119, s78, v158
v_dot2_f32_bf16 v159, v119, s79, v159
v_dot2_f32_bf16 v152, v120, s78, v152
v_dot2_f32_bf16 v153, v120, s79, v153
v_dot2_f32_bf16 v154, v121, s78, v154
v_dot2_f32_bf16 v155, v121, s79, v155
v_dot2_f32_bf16 v156, v122, s78, v156
v_dot2_f32_bf16 v157, v122, s79, v157
v_dot2_f32_bf16 v158, v123, s78, v158
v_dot2_f32_bf16 v159, v123, s79, v159
v_dot2_f32_bf16 v152, v124, s78, v152
v_dot2_f32_bf16 v153, v124, s79, v153
v_dot2_f32_bf16 v154, v125, s78, v154
v_dot2_f32_bf16 v155, v125, s79, v155
v_dot2_f32_bf16 v156, v126, s78, v156
v_dot2_f32_bf16 v157, v126, s79, v157
v_dot2_f32_bf16 v158, v127, s78, v158
v_dot2_f32_bf16 v159, v127, s79, v159
s_nop 2
v_cvt_pk_bf16_f32 v172, v152, v153
v_cvt_pk_bf16_f32 v173, v154, v155
v_cvt_pk_bf16_f32 v174, v156, v157
v_cvt_pk_bf16_f32 v175, v158, v159
s_nop 1
v_permlane32_swap_b32 v172, v174
v_permlane32_swap_b32 v173, v175
buffer_store_dwordx4 v[172:175], v201, s[8:11], s71 offen sc1
L_tm3:
s_andn2_b32 s47, s39, s37
s_mov_b32 s37, s39
s_lshl_b32 s46, s47, 4
s_or_b32 s46, s46, s39
s_cmp_eq_u32 s46, 15
s_cbranch_scc1 L_tdone
s_waitcnt vmcnt(0) lgkmcnt(0)
s_cmp_eq_u32 s39, 15
s_cbranch_scc1 L_ts
s_add_u32 s36, s36, 1
s_cmp_lt_u32 s36, 0x400000
s_cbranch_scc1 L_tl
L_tdone:
L_exit:
s_endpgm
L_code_end:
L_rsB1:
s_call_b64 s[36:37], L_rare1
s_call_b64 s[36:37], L_scale0
s_branch L_rbB1
L_rsB2:
s_call_b64 s[36:37], L_rare0
s_call_b64 s[36:37], L_scale1
s_branch L_rbB2
L_rsB3:
s_call_b64 s[36:37], L_rare1
s_call_b64 s[36:37], L_scale2
s_branch L_rbB3
L_rsB4:
s_call_b64 s[36:37], L_rare0
s_call_b64 s[36:37], L_scale3
s_branch L_rbB4
L_rsB5:
s_call_b64 s[36:37], L_rare1
s_call_b64 s[36:37], L_scale4
s_branch L_rbB5
L_rsB6:
s_call_b64 s[36:37], L_rare0
s_call_b64 s[36:37], L_scale5
s_branch L_rbB6
L_rsB7:
s_call_b64 s[36:37], L_rare1
s_call_b64 s[36:37], L_scale6
s_branch L_rbB7
L_rsB8:
s_call_b64 s[36:37], L_rare0
s_call_b64 s[36:37], L_scale7
s_branch L_rbB8
L_rsB9:
s_call_b64 s[36:37], L_rare1
s_call_b64 s[36:37], L_scale8
s_branch L_rbB9
L_rsB10:
s_call_b64 s[36:37], L_rare0
s_call_b64 s[36:37], L_scale9
s_branch L_rbB10
L_rsB11:
s_call_b64 s[36:37], L_rare1
s_call_b64 s[36:37], L_scale10
s_branch L_rbB11
L_rsB12:
s_call_b64 s[36:37], L_rare0
s_call_b64 s[36:37], L_scale11
s_branch L_rbB12
L_rsB13:
s_call_b64 s[36:37], L_rare1
s_call_b64 s[36:37], L_scale12
s_branch L_rbB13
L_rsB14:
s_call_b64 s[36:37], L_rare0
s_call_b64 s[36:37], L_scale13
s_branch L_rbB14
L_rsB15:
s_call_b64 s[36:37], L_rare1
s_call_b64 s[36:37], L_scale14
s_branch L_rbB15
L_rsD1:
s_call_b64 s[36:37], L_rare1
s_call_b64 s[36:37], L_scale0
s_branch L_rbD1
L_rsD2:
s_call_b64 s[36:37], L_rare0
s_call_b64 s[36:37], L_scale1
s_branch L_rbD2
L_rsD3:
s_call_b64 s[36:37], L_rare1
s_call_b64 s[36:37], L_scale2
s_branch L_rbD3
L_rsD4:
s_call_b64 s[36:37], L_rare0
s_call_b64 s[36:37], L_scale3
s_branch L_rbD4
L_rsD5:
s_call_b64 s[36:37], L_rare1
s_call_b64 s[36:37], L_scale4
s_branch L_rbD5
L_rsD6:
s_call_b64 s[36:37], L_rare0
s_call_b64 s[36:37], L_scale5
s_branch L_rbD6
L_rsD7:
s_call_b64 s[36:37], L_rare1
s_call_b64 s[36:37], L_scale6
s_branch L_rbD7
L_rsD8:
s_call_b64 s[36:37], L_rare0
s_call_b64 s[36:37], L_scale7
s_branch L_rbD8
L_rsD9:
s_call_b64 s[36:37], L_rare1
s_call_b64 s[36:37], L_scale8
s_branch L_rbD9
L_rsD10:
s_call_b64 s[36:37], L_rare0
s_call_b64 s[36:37], L_scale9
s_branch L_rbD10
L_rsD11:
s_call_b64 s[36:37], L_rare1
s_call_b64 s[36:37], L_scale10
s_branch L_rbD11
L_rsD12:
s_call_b64 s[36:37], L_rare0
s_call_b64 s[36:37], L_scale11
s_branch L_rbD12
L_rsD13:
s_call_b64 s[36:37], L_rare1
s_call_b64 s[36:37], L_scale12
s_branch L_rbD13
L_rsD14:
s_call_b64 s[36:37], L_rare0
s_call_b64 s[36:37], L_scale13
s_branch L_rbD14
L_rsD15:
s_call_b64 s[36:37], L_rare1
s_call_b64 s[36:37], L_scale14
s_branch L_rbD15
L_rare0:
v_max3_f32 v242, v192, v193, v194
v_max3_f32 v242, v242, v195, v200
v_max3_f32 v242, v242, v201, v202
v_max_f32 v242, v242, v203
v_max3_f32 v243, v196, v197, v198
v_max3_f32 v243, v243, v199, v204
v_max3_f32 v243, v243, v205, v206
v_max_f32 v243, v243, v207
v_mov_b32 v244, v242
v_mov_b32 v245, v243
s_nop 1
v_permlane32_swap_b32 v242, v244
v_permlane32_swap_b32 v243, v245
v_max_f32 v242, v242, v244
v_max_f32 v243, v243, v245
v_mov_b32 v244, v242
v_mov_b32 v245, v243
s_nop 1
v_permlane16_swap_b32 v242, v244
v_permlane16_swap_b32 v243, v245
v_max_f32 v242, v242, v244
v_max_f32 v243, v243, v245
v_ceil_f32 v242, v242
v_max_f32 v242, 0, v242
v_sub_f32 v224, v224, v242
v_sub_f32 v225, v225, v242
v_sub_f32 v226, v226, v242
v_sub_f32 v227, v227, v242
v_sub_f32 v192, v192, v242
v_sub_f32 v193, v193, v242
v_sub_f32 v194, v194, v242
v_sub_f32 v195, v195, v242
v_sub_f32 v200, v200, v242
v_sub_f32 v201, v201, v242
v_sub_f32 v202, v202, v242
v_sub_f32 v203, v203, v242
v_min_f32 v244, 0x437f0000, v242
v_cvt_u32_f32 v244, v244
v_mul_u32_u24 v244, 0x800080, v244
v_ceil_f32 v243, v243
v_max_f32 v243, 0, v243
v_sub_f32 v228, v228, v243
v_sub_f32 v229, v229, v243
v_sub_f32 v230, v230, v243
v_sub_f32 v231, v231, v243
v_sub_f32 v196, v196, v243
v_sub_f32 v197, v197, v243
v_sub_f32 v198, v198, v243
v_sub_f32 v199, v199, v243
v_sub_f32 v204, v204, v243
v_sub_f32 v205, v205, v243
v_sub_f32 v206, v206, v243
v_sub_f32 v207, v207, v243
v_min_f32 v245, 0x437f0000, v243
v_cvt_u32_f32 v245, v245
v_mul_u32_u24 v245, 0x800080, v245
s_setpc_b64 s[36:37]
L_rare1:
v_max3_f32 v242, v208, v209, v210
v_max3_f32 v242, v242, v211, v216
v_max3_f32 v242, v242, v217, v218
v_max_f32 v242, v242, v219
v_max3_f32 v243, v212, v213, v214
v_max3_f32 v243, v243, v215, v220
v_max3_f32 v243, v243, v221, v222
v_max_f32 v243, v243, v223
v_mov_b32 v244, v242
v_mov_b32 v245, v243
s_nop 1
v_permlane32_swap_b32 v242, v244
v_permlane32_swap_b32 v243, v245
v_max_f32 v242, v242, v244
v_max_f32 v243, v243, v245
v_mov_b32 v244, v242
v_mov_b32 v245, v243
s_nop 1
v_permlane16_swap_b32 v242, v244
v_permlane16_swap_b32 v243, v245
v_max_f32 v242, v242, v244
v_max_f32 v243, v243, v245
v_ceil_f32 v242, v242
v_max_f32 v242, 0, v242
v_sub_f32 v224, v224, v242
v_sub_f32 v225, v225, v242
v_sub_f32 v226, v226, v242
v_sub_f32 v227, v227, v242
v_sub_f32 v208, v208, v242
v_sub_f32 v209, v209, v242
v_sub_f32 v210, v210, v242
v_sub_f32 v211, v211, v242
v_sub_f32 v216, v216, v242
v_sub_f32 v217, v217, v242
v_sub_f32 v218, v218, v242
v_sub_f32 v219, v219, v242
v_min_f32 v244, 0x437f0000, v242
v_cvt_u32_f32 v244, v244
v_mul_u32_u24 v244, 0x800080, v244
v_ceil_f32 v243, v243
v_max_f32 v243, 0, v243
v_sub_f32 v228, v228, v243
v_sub_f32 v229, v229, v243
v_sub_f32 v230, v230, v243
v_sub_f32 v231, v231, v243
v_sub_f32 v212, v212, v243
v_sub_f32 v213, v213, v243
v_sub_f32 v214, v214, v243
v_sub_f32 v215, v215, v243
v_sub_f32 v220, v220, v243
v_sub_f32 v221, v221, v243
v_sub_f32 v222, v222, v243
v_sub_f32 v223, v223, v243
v_min_f32 v245, 0x437f0000, v243
v_cvt_u32_f32 v245, v245
v_mul_u32_u24 v245, 0x800080, v245
s_setpc_b64 s[36:37]
L_scale14:
v_pk_sub_u16 v112, v112, v244 clamp
v_pk_sub_u16 v113, v113, v244 clamp
v_pk_sub_u16 v114, v114, v244 clamp
v_pk_sub_u16 v115, v115, v244 clamp
v_pk_sub_u16 v116, v116, v245 clamp
v_pk_sub_u16 v117, v117, v245 clamp
v_pk_sub_u16 v118, v118, v245 clamp
v_pk_sub_u16 v119, v119, v245 clamp
L_scale13:
v_pk_sub_u16 v104, v104, v244 clamp
v_pk_sub_u16 v105, v105, v244 clamp
v_pk_sub_u16 v106, v106, v244 clamp
v_pk_sub_u16 v107, v107, v244 clamp
v_pk_sub_u16 v108, v108, v245 clamp
v_pk_sub_u16 v109, v109, v245 clamp
v_pk_sub_u16 v110, v110, v245 clamp
v_pk_sub_u16 v111, v111, v245 clamp
L_scale12:
v_pk_sub_u16 v96, v96, v244 clamp
v_pk_sub_u16 v97, v97, v244 clamp
v_pk_sub_u16 v98, v98, v244 clamp
v_pk_sub_u16 v99, v99, v244 clamp
v_pk_sub_u16 v100, v100, v245 clamp
v_pk_sub_u16 v101, v101, v245 clamp
v_pk_sub_u16 v102, v102, v245 clamp
v_pk_sub_u16 v103, v103, v245 clamp
L_scale11:
v_pk_sub_u16 v88, v88, v244 clamp
v_pk_sub_u16 v89, v89, v244 clamp
v_pk_sub_u16 v90, v90, v244 clamp
v_pk_sub_u16 v91, v91, v244 clamp
v_pk_sub_u16 v92, v92, v245 clamp
v_pk_sub_u16 v93, v93, v245 clamp
v_pk_sub_u16 v94, v94, v245 clamp
v_pk_sub_u16 v95, v95, v245 clamp
L_scale10:
v_pk_sub_u16 v80, v80, v244 clamp
v_pk_sub_u16 v81, v81, v244 clamp
v_pk_sub_u16 v82, v82, v244 clamp
v_pk_sub_u16 v83, v83, v244 clamp
v_pk_sub_u16 v84, v84, v245 clamp
v_pk_sub_u16 v85, v85, v245 clamp
v_pk_sub_u16 v86, v86, v245 clamp
v_pk_sub_u16 v87, v87, v245 clamp
L_scale9:
v_pk_sub_u16 v72, v72, v244 clamp
v_pk_sub_u16 v73, v73, v244 clamp
v_pk_sub_u16 v74, v74, v244 clamp
v_pk_sub_u16 v75, v75, v244 clamp
v_pk_sub_u16 v76, v76, v245 clamp
v_pk_sub_u16 v77, v77, v245 clamp
v_pk_sub_u16 v78, v78, v245 clamp
v_pk_sub_u16 v79, v79, v245 clamp
L_scale8:
v_pk_sub_u16 v64, v64, v244 clamp
v_pk_sub_u16 v65, v65, v244 clamp
v_pk_sub_u16 v66, v66, v244 clamp
v_pk_sub_u16 v67, v67, v244 clamp
v_pk_sub_u16 v68, v68, v245 clamp
v_pk_sub_u16 v69, v69, v245 clamp
v_pk_sub_u16 v70, v70, v245 clamp
v_pk_sub_u16 v71, v71, v245 clamp
L_scale7:
v_pk_sub_u16 v56, v56, v244 clamp
v_pk_sub_u16 v57, v57, v244 clamp
v_pk_sub_u16 v58, v58, v244 clamp
v_pk_sub_u16 v59, v59, v244 clamp
v_pk_sub_u16 v60, v60, v245 clamp
v_pk_sub_u16 v61, v61, v245 clamp
v_pk_sub_u16 v62, v62, v245 clamp
v_pk_sub_u16 v63, v63, v245 clamp
L_scale6:
v_pk_sub_u16 v48, v48, v244 clamp
v_pk_sub_u16 v49, v49, v244 clamp
v_pk_sub_u16 v50, v50, v244 clamp
v_pk_sub_u16 v51, v51, v244 clamp
v_pk_sub_u16 v52, v52, v245 clamp
v_pk_sub_u16 v53, v53, v245 clamp
v_pk_sub_u16 v54, v54, v245 clamp
v_pk_sub_u16 v55, v55, v245 clamp
L_scale5:
v_pk_sub_u16 v40, v40, v244 clamp
v_pk_sub_u16 v41, v41, v244 clamp
v_pk_sub_u16 v42, v42, v244 clamp
v_pk_sub_u16 v43, v43, v244 clamp
v_pk_sub_u16 v44, v44, v245 clamp
v_pk_sub_u16 v45, v45, v245 clamp
v_pk_sub_u16 v46, v46, v245 clamp
v_pk_sub_u16 v47, v47, v245 clamp
L_scale4:
v_pk_sub_u16 v32, v32, v244 clamp
v_pk_sub_u16 v33, v33, v244 clamp
v_pk_sub_u16 v34, v34, v244 clamp
v_pk_sub_u16 v35, v35, v244 clamp
v_pk_sub_u16 v36, v36, v245 clamp
v_pk_sub_u16 v37, v37, v245 clamp
v_pk_sub_u16 v38, v38, v245 clamp
v_pk_sub_u16 v39, v39, v245 clamp
L_scale3:
v_pk_sub_u16 v24, v24, v244 clamp
v_pk_sub_u16 v25, v25, v244 clamp
v_pk_sub_u16 v26, v26, v244 clamp
v_pk_sub_u16 v27, v27, v244 clamp
v_pk_sub_u16 v28, v28, v245 clamp
v_pk_sub_u16 v29, v29, v245 clamp
v_pk_sub_u16 v30, v30, v245 clamp
v_pk_sub_u16 v31, v31, v245 clamp
L_scale2:
v_pk_sub_u16 v16, v16, v244 clamp
v_pk_sub_u16 v17, v17, v244 clamp
v_pk_sub_u16 v18, v18, v244 clamp
v_pk_sub_u16 v19, v19, v244 clamp
v_pk_sub_u16 v20, v20, v245 clamp
v_pk_sub_u16 v21, v21, v245 clamp
v_pk_sub_u16 v22, v22, v245 clamp
v_pk_sub_u16 v23, v23, v245 clamp
L_scale1:
v_pk_sub_u16 v8, v8, v244 clamp
v_pk_sub_u16 v9, v9, v244 clamp
v_pk_sub_u16 v10, v10, v244 clamp
v_pk_sub_u16 v11, v11, v244 clamp
v_pk_sub_u16 v12, v12, v245 clamp
v_pk_sub_u16 v13, v13, v245 clamp
v_pk_sub_u16 v14, v14, v245 clamp
v_pk_sub_u16 v15, v15, v245 clamp
L_scale0:
v_pk_sub_u16 v0, v0, v244 clamp
v_pk_sub_u16 v1, v1, v244 clamp
v_pk_sub_u16 v2, v2, v244 clamp
v_pk_sub_u16 v3, v3, v244 clamp
v_pk_sub_u16 v4, v4, v245 clamp
v_pk_sub_u16 v5, v5, v245 clamp
v_pk_sub_u16 v6, v6, v245 clamp
v_pk_sub_u16 v7, v7, v245 clamp
s_nop 1
s_setpc_b64 s[36:37]
L_spin_tag:
s_mov_b32 s36, 0
L_spinl_tag:
s_sleep 2
s_lshl_b32 s37, s100, 3
v_mov_b32 v237, s37
global_load_dwordx2 v[232:233], v237, s[80:81] sc1
s_waitcnt vmcnt(0)
v_cmp_eq_u32 vcc, 0, v233
s_cbranch_vccz L_back_tag
s_add_u32 s36, s36, 1
s_cmp_lt_u32 s36, 0x200000
s_cbranch_scc1 L_spinl_tag
s_branch L_back_tag
.section .rodata,"a"
.p2align 6
.amdhsa_kernel standalone__mha_block_cached__near_ridge_kernel
    .amdhsa_next_free_vgpr 512
    .amdhsa_next_free_sgpr 102
    .amdhsa_accum_offset 256
    .amdhsa_group_segment_fixed_size 0
    .amdhsa_kernarg_size 64
    .amdhsa_user_sgpr_count 2
    .amdhsa_user_sgpr_kernarg_segment_ptr 1
    .amdhsa_system_sgpr_workgroup_id_x 1
.end_amdhsa_kernel
```
